```python
import torch

def _softmax(x, axis=-1):
    return torch.softmax(x, dim=axis)

def _gelu(x):
    return torch.nn.functional.gelu(x, approximate='tanh')

def _silu(x):
    return torch.nn.functional.silu(x)

def _sigmoid(x):
    return torch.sigmoid(x)

def _layernorm(x, axis=-1, eps=1e-05):
    m = x.mean(dim=axis, keepdim=True)
    v = x.var(dim=axis, keepdim=True, unbiased=False)
    return (x - m) / torch.sqrt(v + eps)

def _scatter_add(tgt, idx, src, axis=0):
    return tgt.clone().index_add_(axis, idx, src)

def _segment_sum(src, seg, n):
    out = torch.zeros((n,) + src.shape[1:], dtype=src.dtype)
    return out.index_add_(0, seg, src)

def _pad(x, pw):
    flat = tuple((v for pair in reversed(pw) for v in pair))
    return torch.nn.functional.pad(x, flat)
kernel_name = 'interleave_layers__memory_aug_recurrent_mem_tr__spectral_gfnet__prompt'

def setup_inputs():

    _w = lambda a: (lambda t: t.to(torch.bfloat16) if t.is_floating_point() else t)(torch.as_tensor(a))

    def _A_setup():
        B, S, Dm = (1, 2048, 576)
        H, Dh = (32, 128)
        M, seg = (8, 32)
        seg = min(seg, S)
        S = S // seg * seg
        return {'x': _w((lambda *s: torch.randn(*s, dtype=torch.bfloat16) * 0.05)(B, S, Dm)), 'mem0': _w((lambda *s: torch.randn(*s, dtype=torch.bfloat16) * 0.2)(B, M, Dm)), 'Wq': _w((lambda *s: torch.randn(*s, dtype=torch.bfloat16) * 1.6)(Dm, H, Dh) * Dm ** (-0.5)), 'Wk': _w((lambda *s: torch.randn(*s, dtype=torch.bfloat16) * 1.6)(Dm, H, Dh) * Dm ** (-0.5)), 'Wv': _w((lambda *s: torch.randn(*s, dtype=torch.bfloat16) * 0.2)(Dm, H, Dh) * Dm ** (-0.5)), 'Wo': _w((lambda *s: torch.randn(*s, dtype=torch.bfloat16) * 0.2)(H, Dh, Dm) * (H * Dh) ** (-0.5)), 'seg_len': seg}
    _A_in = _A_setup()

    def _B_setup():
        B, S, D = (1, 2048, 576)
        Df = D // 2 + 1
        return {'x': _w((lambda *s: torch.randn(*s, dtype=torch.bfloat16) * 0.05)(B, S, D)), 'w_r': _w((lambda *s: torch.randn(*s, dtype=torch.bfloat16) * 0.4)(S, Df) * 0.02), 'w_i': _w((lambda *s: torch.randn(*s, dtype=torch.bfloat16) * 0.4)(S, Df) * 0.02)}
    _B_in = _B_setup()
    return {'A_x': _A_in['x'], 'A_mem0': _A_in['mem0'], 'A_Wq': _A_in['Wq'], 'A_Wk': _A_in['Wk'], 'A_Wv': _A_in['Wv'], 'A_Wo': _A_in['Wo'], 'A_seg_len': _A_in['seg_len'], 'B_x': _B_in['x'], 'B_w_r': _B_in['w_r'], 'B_w_i': _B_in['w_i']}

def reference(A_x, A_mem0, A_Wq, A_Wk, A_Wv, A_Wo, A_seg_len, B_x, B_w_r, B_w_i):

    def _A_ref(x, mem0, Wq, Wk, Wv, Wo, seg_len):
        B, S, Dm = x.shape
        H, Dh = (Wq.shape[1], Wq.shape[2])
        M = mem0.shape[1]
        scale = Dh ** (-0.5)
        n_seg = S // seg_len
        L = M + seg_len
        idx = torch.arange(L)
        mask = (idx[:, None] < M) | (idx[:, None] >= idx[None, :])
        mem = mem0
        outs = []
        for s in range(n_seg):
            xs = x[:, s * seg_len:(s + 1) * seg_len, :].clone()
            h = torch.concatenate([mem, xs], axis=1)
            q = torch.einsum('btd,dhe->bhte', h, Wq)
            k = torch.einsum('btd,dhe->bhte', h, Wk)
            v = torch.einsum('btd,dhe->bhte', h, Wv)
            scores = torch.einsum('bhqe,bhke->bhqk', q, k) * scale
            scores = torch.where(mask[None, None], scores, -1000000000.0)
            p = _softmax(scores, axis=-1)
            o = torch.einsum('bhqk,bhke->bhqe', p, v)
            o = torch.einsum('bhte,hed->btd', o, Wo)
            mem = o[:, :M, :].clone()
            outs.append(o[:, M:, :])
        return torch.concatenate(outs, axis=1)

    def _B_ref(x, w_r, w_i):
        B, S, D = x.shape
        X = (lambda x, axes=(-2, -1): torch.fft.rfft2(x.float(), dim=axes))(x, axes=(-2, -1))
        W = w_r + 1j * w_i
        X = X * W
        y = (lambda x, s, axes=(-2, -1): torch.fft.irfft2(x, s=s, dim=axes).to(torch.bfloat16))(X, (S, D), axes=(-2, -1))
        return y
    x = A_x
    x = x + _A_ref(_layernorm(x, axis=-1), A_mem0, A_Wq, A_Wk, A_Wv, A_Wo, A_seg_len)
    x = x + _B_ref(_layernorm(x, axis=-1), B_w_r, B_w_i)
    x = x + _A_ref(_layernorm(x, axis=-1), A_mem0, A_Wq, A_Wk, A_Wv, A_Wo, A_seg_len)
    x = x + _B_ref(_layernorm(x, axis=-1), B_w_r, B_w_i)
    return x
```

```asm
; @launch grid=(256,1,1) block=(256,1,1) lds=163840
.amdgcn_target "amdgcn-amd-amdhsa--gfx950"
.text
.globl interleave_layers__memory_aug_recurrent_mem_tr__spectral_gfnet__prompt_kernel
.p2align 8
.type interleave_layers__memory_aug_recurrent_mem_tr__spectral_gfnet__prompt_kernel,@function
interleave_layers__memory_aug_recurrent_mem_tr__spectral_gfnet__prompt_kernel:
    s_cmp_ge_u32 s2, 256
    s_cbranch_scc1 L_exit
    s_load_dwordx4 s[36:39], s[0:1], 88
    s_load_dwordx2 s[34:35], s[0:1], 8
    v_lshrrev_b32 v1, 6, v0
    s_getreg_b32 s3, hwreg(HW_REG_XCC_ID)
    v_readfirstlane_b32 s32, v1
    s_and_b32 s3, s3, 7
    s_lshl_b32 s3, s3, 2
    s_lshr_b32 s3, 0x36251407, s3
    s_and_b32 s3, s3, 7
    s_waitcnt lgkmcnt(0)
    s_mov_b32 s12, s36
    s_and_b32 s13, s37, 0xffff
    s_mov_b32 s14, 0x100
    s_mov_b32 s15, 0x20000
    s_mov_b32 s8, s38
    s_and_b32 s9, s39, 0xffff
    s_mov_b32 s10, 0x10000000
    s_mov_b32 s11, 0x20000
    s_mov_b32 s16, s34
    s_and_b32 s17, s35, 0xffff
    s_mov_b32 s18, 0x2400
    s_mov_b32 s19, 0x20000
    v_and_b32 v0, 63, v0
    v_mov_b32 v4, 16256
    s_cmp_eq_u32 s32, 3
    s_cbranch_scc1 L_init
    s_cmp_lg_u32 s32, 0
    s_cbranch_scc1 L_touch
    s_lshl_b32 s4, s3, 2
    s_add_u32 s4, s4, 128
    s_cmp_eq_u32 s3, 0
    s_cselect_b32 s4, 0, s4
    v_mov_b32 v2, 1
    s_mov_b64 exec, 1
    buffer_atomic_add v2, off, s[12:15], s4 sc0
    s_mov_b64 exec, -1
    s_waitcnt vmcnt(0)
    v_readfirstlane_b32 s5, v2
    s_lshl_b32 s6, s3, 5
    s_add_u32 s6, s6, s5
    s_cmp_ge_u32 s5, 32
    s_cbranch_scc1 L_overflow
L_have_role:
    v_mov_b32_e64 v2, s6
    ds_write_b32 v4, v2
    s_waitcnt lgkmcnt(0)
    s_branch L_entry_join
L_overflow:
    v_and_b32 v2, 7, v0
    v_lshlrev_b32 v3, 2, v2
    v_add_u32 v3, 128, v3
    v_cmp_ne_u32 vcc, 0, v2
    s_nop 1
    v_cndmask_b32 v3, 0, v3, vcc
    s_mov_b32 s40, 0
L_ov_wait:
    s_add_u32 s40, s40, 1
    s_cmp_gt_u32 s40, 0x100000
    s_cbranch_scc1 L_ov_fail
    buffer_load_dword v2, v3, s[12:15], 0 offen sc1
    s_waitcnt vmcnt(0)
    s_mov_b32 s7, 0
    v_readlane_b32 s44, v2, 0
    s_nop 0
    s_add_u32 s7, s7, s44
    v_readlane_b32 s45, v2, 1
    s_nop 0
    s_add_u32 s7, s7, s45
    v_readlane_b32 s46, v2, 2
    s_nop 0
    s_add_u32 s7, s7, s46
    v_readlane_b32 s47, v2, 3
    s_nop 0
    s_add_u32 s7, s7, s47
    v_readlane_b32 s48, v2, 4
    s_nop 0
    s_add_u32 s7, s7, s48
    v_readlane_b32 s49, v2, 5
    s_nop 0
    s_add_u32 s7, s7, s49
    v_readlane_b32 s50, v2, 6
    s_nop 0
    s_add_u32 s7, s7, s50
    v_readlane_b32 s51, v2, 7
    s_nop 0
    s_add_u32 s7, s7, s51
    s_cmp_lt_u32 s7, 256
    s_cbranch_scc1 L_ov_wait
    s_cmp_gt_u32 s7, 256
    s_cbranch_scc1 L_ov_fail
    s_sub_u32 s5, s5, 32
    s_max_u32 s7, s44, 32
    s_sub_u32 s7, s7, 32
    s_cmp_gt_u32 s3, 0
    s_cselect_b32 s7, s7, 0
    s_add_u32 s5, s5, s7
    s_max_u32 s7, s45, 32
    s_sub_u32 s7, s7, 32
    s_cmp_gt_u32 s3, 1
    s_cselect_b32 s7, s7, 0
    s_add_u32 s5, s5, s7
    s_max_u32 s7, s46, 32
    s_sub_u32 s7, s7, 32
    s_cmp_gt_u32 s3, 2
    s_cselect_b32 s7, s7, 0
    s_add_u32 s5, s5, s7
    s_max_u32 s7, s47, 32
    s_sub_u32 s7, s7, 32
    s_cmp_gt_u32 s3, 3
    s_cselect_b32 s7, s7, 0
    s_add_u32 s5, s5, s7
    s_max_u32 s7, s48, 32
    s_sub_u32 s7, s7, 32
    s_cmp_gt_u32 s3, 4
    s_cselect_b32 s7, s7, 0
    s_add_u32 s5, s5, s7
    s_max_u32 s7, s49, 32
    s_sub_u32 s7, s7, 32
    s_cmp_gt_u32 s3, 5
    s_cselect_b32 s7, s7, 0
    s_add_u32 s5, s5, s7
    s_max_u32 s7, s50, 32
    s_sub_u32 s7, s7, 32
    s_cmp_gt_u32 s3, 6
    s_cselect_b32 s7, s7, 0
    s_add_u32 s5, s5, s7
    s_max_u32 s7, s51, 32
    s_sub_u32 s7, s7, 32
    s_cmp_gt_u32 s3, 7
    s_cselect_b32 s7, s7, 0
    s_add_u32 s5, s5, s7
    s_min_u32 s7, s44, 32
    s_add_u32 s6, s7, s5
    s_add_u32 s6, s6, 0
    s_sub_u32 s7, 32, s7
    s_cmp_lt_u32 s5, s7
    s_cbranch_scc1 L_have_role
    s_sub_u32 s5, s5, s7
    s_min_u32 s7, s45, 32
    s_add_u32 s6, s7, s5
    s_add_u32 s6, s6, 32
    s_sub_u32 s7, 32, s7
    s_cmp_lt_u32 s5, s7
    s_cbranch_scc1 L_have_role
    s_sub_u32 s5, s5, s7
    s_min_u32 s7, s46, 32
    s_add_u32 s6, s7, s5
    s_add_u32 s6, s6, 64
    s_sub_u32 s7, 32, s7
    s_cmp_lt_u32 s5, s7
    s_cbranch_scc1 L_have_role
    s_sub_u32 s5, s5, s7
    s_min_u32 s7, s47, 32
    s_add_u32 s6, s7, s5
    s_add_u32 s6, s6, 96
    s_sub_u32 s7, 32, s7
    s_cmp_lt_u32 s5, s7
    s_cbranch_scc1 L_have_role
    s_sub_u32 s5, s5, s7
    s_min_u32 s7, s48, 32
    s_add_u32 s6, s7, s5
    s_add_u32 s6, s6, 128
    s_sub_u32 s7, 32, s7
    s_cmp_lt_u32 s5, s7
    s_cbranch_scc1 L_have_role
    s_sub_u32 s5, s5, s7
    s_min_u32 s7, s49, 32
    s_add_u32 s6, s7, s5
    s_add_u32 s6, s6, 160
    s_sub_u32 s7, 32, s7
    s_cmp_lt_u32 s5, s7
    s_cbranch_scc1 L_have_role
    s_sub_u32 s5, s5, s7
    s_min_u32 s7, s50, 32
    s_add_u32 s6, s7, s5
    s_add_u32 s6, s6, 192
    s_sub_u32 s7, 32, s7
    s_cmp_lt_u32 s5, s7
    s_cbranch_scc1 L_have_role
    s_sub_u32 s5, s5, s7
    s_min_u32 s7, s51, 32
    s_add_u32 s6, s7, s5
    s_add_u32 s6, s6, 224
    s_sub_u32 s7, 32, s7
    s_cmp_lt_u32 s5, s7
    s_cbranch_scc1 L_have_role
    s_sub_u32 s5, s5, s7
L_ov_fail:
    s_mov_b32 s6, 0x100
    s_branch L_have_role
L_touch:
    s_branch L_entry_join
L_init:
    v_lshlrev_b32 v3, 4, v0
    v_mov_b32 v8, -1
    v_mov_b32 v9, -1
    v_mov_b32 v10, -1
    v_mov_b32 v11, -1
    v_mov_b32 v12, -1
    v_mov_b32 v13, -1
    v_mov_b32 v14, -1
    v_mov_b32 v15, -1
    v_mov_b32 v16, -1
    v_mov_b32 v17, -1
    v_mov_b32 v18, -1
    v_mov_b32 v19, -1
    v_mov_b32 v20, -1
    v_mov_b32 v21, -1
    v_mov_b32 v22, -1
    v_mov_b32 v23, -1
    v_mov_b32 v24, -1
    v_mov_b32 v25, -1
    v_mov_b32 v26, -1
    v_mov_b32 v27, -1
    v_mov_b32 v28, -1
    v_mov_b32 v29, -1
    v_mov_b32 v30, -1
    v_mov_b32 v31, -1
    s_lshr_b32 s5, s2, 1
    s_and_b32 s6, s2, 1
    s_and_b32 s7, s5, 63
    s_cmp_lg_u32 s7, 0
    s_cbranch_scc1 L_nomem0
    s_mul_i32 s7, s6, 288
    v_add_u32 v5, s7, v0
    v_and_b32 v6, 7, v5
    v_mul_u32_u24 v6, 1152, v6
    v_lshrrev_b32_e64 v5, 3, v5
    v_lshl_add_u32 v5, v5, 4, v6
    buffer_load_dwordx4 v[8:11], v5, s[16:19], 0 offen offset:0
    buffer_load_dwordx4 v[12:15], v5, s[16:19], 0 offen offset:128
    buffer_load_dwordx4 v[16:19], v5, s[16:19], 0 offen offset:256
    buffer_load_dwordx4 v[20:23], v5, s[16:19], 0 offen offset:384
    buffer_load_dwordx4 v[24:27], v5, s[16:19], 0 offen offset:512
    s_waitcnt vmcnt(0)
    v_min_u32 v8, -2, v8
    v_min_u32 v9, -2, v9
    v_min_u32 v10, -2, v10
    v_min_u32 v11, -2, v11
    v_min_u32 v12, -2, v12
    v_min_u32 v13, -2, v13
    v_min_u32 v14, -2, v14
    v_min_u32 v15, -2, v15
    v_min_u32 v16, -2, v16
    v_min_u32 v17, -2, v17
    v_min_u32 v18, -2, v18
    v_min_u32 v19, -2, v19
    v_min_u32 v20, -2, v20
    v_min_u32 v21, -2, v21
    v_min_u32 v22, -2, v22
    v_min_u32 v23, -2, v23
    v_min_u32 v24, -2, v24
    v_min_u32 v25, -2, v25
    v_min_u32 v26, -2, v26
    v_min_u32_e64 v27, -2, v27
L_nomem0:
    s_mul_i32 s7, s2, 4608
    s_add_u32 s7, s7, 0x20000
    s_mul_i32 s5, s2, 2816
    s_add_u32 s5, s5, 0x140000
    buffer_store_dwordx4 v[8:11], v3, s[8:11], s7 offen offset:0 sc1
    buffer_store_dwordx4 v[12:15], v3, s[8:11], s7 offen offset:1024 sc1
    buffer_store_dwordx4 v[16:19], v3, s[8:11], s7 offen offset:2048 sc1
    buffer_store_dwordx4 v[20:23], v3, s[8:11], s7 offen offset:3072 sc1
    buffer_store_dwordx4 v[28:31], v3, s[8:11], s5 offen offset:0 sc1
    buffer_store_dwordx4 v[28:31], v3, s[8:11], s5 offen offset:1024 sc1
    s_mov_b32 exec_hi, 0
    s_add_u32 s7, s7, 4096
    buffer_store_dwordx4 v[24:27], v3, s[8:11], s7 offen sc1
    s_mov_b32 exec_hi, 0xffff
    buffer_store_dwordx4 v[28:31], v3, s[8:11], s5 offen offset:2048 sc1
    s_mov_b32 exec_hi, -1
    s_lshl_b32 s7, s2, 13
    s_add_u32 s7, s7, 0x1800000
    v_mov_b64 v[32:33], 0
    v_mov_b64_e64 v[34:35], 0
    buffer_store_dwordx4 v[32:35], v3, s[8:11], s7 offen offset:0 sc1
    buffer_store_dwordx4 v[32:35], v3, s[8:11], s7 offen offset:1024 sc1
    buffer_store_dwordx4 v[32:35], v3, s[8:11], s7 offen offset:2048 sc1
    buffer_store_dwordx4 v[32:35], v3, s[8:11], s7 offen offset:3072 sc1
    s_add_u32 s7, s7, 4096
    buffer_store_dwordx4 v[32:35], v3, s[8:11], s7 offen offset:0 sc1
    buffer_store_dwordx4 v[32:35], v3, s[8:11], s7 offen offset:1024 sc1
    buffer_store_dwordx4 v[32:35], v3, s[8:11], s7 offen offset:2048 sc1
    buffer_store_dwordx4 v[32:35], v3, s[8:11], s7 offen offset:3072 sc1
L_entry_join:
    s_barrier
    ds_read_b32 v2, v4
    s_cmp_lg_u32 s32, 3
    s_cbranch_scc1 L_noarr
    s_waitcnt vmcnt(0)
    v_mov_b32 v5, 1
    s_mov_b64 exec, 1
    buffer_atomic_add v5, off, s[12:15], 0 offset:64
    s_mov_b64 exec, -1
L_noarr:
    s_waitcnt lgkmcnt(0)
    v_readfirstlane_b32 s33, v2
    s_nop 0
    s_cmp_ge_u32 s33, 0x100
    s_cbranch_scc1 L_abort
    s_cmp_ge_u32 s33, 128
    s_cbranch_scc1 L_role_od
    s_cmp_ge_u32 s33, 32
    s_cbranch_scc1 L_role_p
    s_mov_b32 s41, s33
    s_load_dwordx8 s[80:87], s[0:1], 16
    v_and_b32 v12, 15, v0
    v_lshrrev_b32 v13, 4, v0
    v_and_b32 v14, 7, v0
    s_lshl_b32 s73, s41, 8
    s_lshl_b32 s47, s32, 6
    s_add_u32 s73, s73, s47
    v_lshlrev_b32 v15, 15, v13
    v_lshl_add_u32 v15, v12, 2, v15
    v_add_u32_e64 v15, s73, v15
    s_mov_b32 s56, 0x05040100
    s_mov_b32 s57, 0x07060302
    s_mul_i32 s72, s32, 5
    s_lshl_b32 s73, s32, 2
    s_add_u32 s73, s73, 2
    s_cmp_lt_u32 s32, 2
    s_cselect_b32 s72, s72, s73
    s_cselect_b32 s55, 1, 0
    v_lshlrev_b32 v6, 4, v0
    s_lshl_b32 s73, s72, 2
    s_sub_u32 s73, s73, s32
    s_lshl_b32 s73, s73, 11
    s_add_u32 s54, s73, 24576
    v_add_u32 v7, s54, v6
    s_waitcnt lgkmcnt(0)
    s_mov_b32 s16, s80
    s_and_b32 s17, s81, 0xffff
    s_mov_b32 s18, 0x480000
    s_mov_b32 s19, 0x20000
    s_mov_b32 s20, s82
    s_and_b32 s21, s83, 0xffff
    s_mov_b32 s22, 0x480000
    s_mov_b32 s23, 0x20000
    s_mov_b32 s24, s84
    s_and_b32 s25, s85, 0xffff
    s_mov_b32 s26, 0x480000
    s_mov_b32 s27, 0x20000
    s_mov_b32 s28, s86
    s_and_b32 s29, s87, 0xffff
    s_mov_b32 s30, 0x480000
    s_mov_b32 s31, 0x20000
    s_lshl_b32 s70, s41, 1
    s_add_u32 s70, s70, s32
    s_sub_u32 s70, s70, 2
    s_add_u32 s73, s41, 64
    s_cmp_ge_u32 s32, 2
    s_cselect_b32 s70, s70, s73
    s_cselect_b32 s53, 1, 0
    s_cmp_lt_u32 s41, 8
    s_cselect_b32 s73, 1, 0
    s_cmp_eq_u32 s32, 1
    s_cselect_b32 s73, s73, 0
    s_or_b32 s53, s53, s73
    s_lshl_b32 s6, s70, 7
    s_lshl_b32 s5, s70, 12
    s_add_u32 s5, s5, 0x150000
    s_cmp_eq_u32 s53, 0
    s_cselect_b32 s73, 0x70000000, 0
    s_add_u32 s6, s6, s73
    s_add_u32 s6, s6, 0x140000
    s_add_u32 s5, s5, s73
    s_cmp_ge_u32 s32, 2
    s_cselect_b32 s16, s20, s16
    s_cselect_b32 s17, s21, s17
    v_lshlrev_b32_e64 v8, 13, v13
    v_lshl_add_u32 v8, v12, 4, v8
    s_lshl_b32 s73, s41, 8
    s_lshl_b32 s74, s32, 17
    s_add_u32 s74, s74, s73
    v_add_u32 v9, s74, v8
    s_and_b32 s74, s74, 0x3ffff
    v_add_u32 v8, s74, v8
    s_lshl_b32 s77, s32, 12
    v_lshlrev_b32_e64 v10, 10, v13
    v_lshl_add_u32 v10, v12, 2, v10
    v_add_u32 v10, s47, v10
    v_and_b32 v3, 3, v0
    v_mul_u32_u24 v3, 1152, v3
    v_lshrrev_b32_e64 v2, 2, v0
    v_lshl_add_u32 v3, v2, 2, v3
    v_mul_u32_u24 v4, 4608, v13
    v_lshl_add_u32 v4, v12, 2, v4
    s_mul_i32 s75, s41, 147456
    s_lshl_b32 s73, s72, 6
    s_add_u32 s75, s75, s73
    s_add_u32 s76, s54, 16384
    s_barrier
    s_mov_b32 s73, 0x100000
    s_add_u32 m0, s77, 0
    s_nop 0
    buffer_load_dwordx4 v8, s[16:19], s73 offen lds
    s_mov_b32 s73, 0x108000
    s_add_u32 m0, s77, 1024
    s_nop 0
    buffer_load_dwordx4 v8, s[16:19], s73 offen lds
    s_mov_b32 s73, 0x110000
    s_add_u32 m0, s77, 2048
    s_nop 0
    buffer_load_dwordx4 v8, s[16:19], s73 offen lds
    s_mov_b32 s73, 0x118000
    s_add_u32 m0, s77, 3072
    s_nop 0
    buffer_load_dwordx4 v8, s[16:19], s73 offen lds
    s_mov_b32 s73, 0x140000
    s_add_u32 m0, s77, 24576
    s_nop 0
    buffer_load_dwordx4 v8, s[16:19], s73 offen lds
    s_mov_b32 s73, 0x148000
    s_add_u32 m0, s77, 25600
    s_nop 0
    buffer_load_dwordx4 v8, s[16:19], s73 offen lds
    s_mov_b32 s73, 0x150000
    s_add_u32 m0, s77, 26624
    s_nop 0
    buffer_load_dwordx4 v8, s[16:19], s73 offen lds
    s_mov_b32 s73, 0x158000
    s_add_u32 m0, s77, 27648
    s_nop 0
    buffer_load_dwordx4 v8, s[16:19], s73 offen lds
    s_mov_b32 s73, 0x180000
    s_add_u32 m0, s77, 63488
    s_nop 0
    buffer_load_dwordx4 v8, s[16:19], s73 offen lds
    s_mov_b32 s73, 0x188000
    s_add_u32 m0, s77, 64512
    s_nop 0
    buffer_load_dwordx4 v8, s[16:19], s73 offen lds
    s_mov_b32 s73, 0x190000
    s_add_u32 m0, s77, 65536
    s_nop 0
    buffer_load_dwordx4 v8, s[16:19], s73 offen lds
    s_mov_b32 s73, 0x198000
    s_add_u32 m0, s77, 66560
    s_nop 0
    buffer_load_dwordx4 v8, s[16:19], s73 offen lds
    s_mov_b32 s73, 0x1c0000
    s_add_u32 m0, s77, 102400
    s_nop 0
    buffer_load_dwordx4 v8, s[16:19], s73 offen lds
    s_mov_b32 s73, 0x1c8000
    s_add_u32 m0, s77, 103424
    s_nop 0
    buffer_load_dwordx4 v8, s[16:19], s73 offen lds
    s_mov_b32 s73, 0x1d0000
    s_add_u32 m0, s77, 104448
    s_nop 0
    buffer_load_dwordx4 v8, s[16:19], s73 offen lds
    s_mov_b32 s73, 0x1d8000
    s_add_u32 m0, s77, 105472
    s_nop 0
    buffer_load_dwordx4 v8, s[16:19], s73 offen lds
    s_cmp_eq_u32 s55, 0
    s_cbranch_scc1 L_wo4_1
    s_add_u32 s73, s75, 256
    s_add_u32 m0, s76, 14336
    s_nop 0
    buffer_load_dword v3, s[28:31], s73 offen lds
    s_add_u32 s73, s75, 4864
    s_add_u32 m0, s76, 14592
    s_nop 0
    buffer_load_dword v3, s[28:31], s73 offen lds
    s_add_u32 s73, s75, 9472
    s_add_u32 m0, s76, 14848
    s_nop 0
    buffer_load_dword v3, s[28:31], s73 offen lds
    s_add_u32 s73, s75, 14080
    s_add_u32 m0, s76, 15104
    s_nop 0
    buffer_load_dword v3, s[28:31], s73 offen lds
    s_add_u32 s73, s75, 18688
    s_add_u32 m0, s76, 15360
    s_nop 0
    buffer_load_dword v3, s[28:31], s73 offen lds
    s_add_u32 s73, s75, 23296
    s_add_u32 m0, s76, 15616
    s_nop 0
    buffer_load_dword v3, s[28:31], s73 offen lds
    s_add_u32 s73, s75, 27904
    s_add_u32 m0, s76, 15872
    s_nop 0
    buffer_load_dword v3, s[28:31], s73 offen lds
    s_add_u32 s73, s75, 32512
    s_add_u32 m0, s76, 16128
    s_nop 0
    buffer_load_dword v3, s[28:31], s73 offen lds
    s_add_u32 s73, s75, 37120
    s_add_u32 m0, s76, 16384
    s_nop 0
    buffer_load_dword v3, s[28:31], s73 offen lds
    s_add_u32 s73, s75, 41728
    s_add_u32 m0, s76, 16640
    s_nop 0
    buffer_load_dword v3, s[28:31], s73 offen lds
    s_add_u32 s73, s75, 46336
    s_add_u32 m0, s76, 16896
    s_nop 0
    buffer_load_dword v3, s[28:31], s73 offen lds
    s_add_u32 s73, s75, 50944
    s_add_u32 m0, s76, 17152
    s_nop 0
    buffer_load_dword v3, s[28:31], s73 offen lds
    s_add_u32 s73, s75, 55552
    s_add_u32 m0, s76, 17408
    s_nop 0
    buffer_load_dword v3, s[28:31], s73 offen lds
    s_add_u32 s73, s75, 60160
    s_add_u32 m0, s76, 17664
    s_nop 0
    buffer_load_dword v3, s[28:31], s73 offen lds
    s_add_u32 s73, s75, 64768
    s_add_u32 m0, s76, 17920
    s_nop 0
    buffer_load_dword v3, s[28:31], s73 offen lds
    s_add_u32 s73, s75, 69376
    s_add_u32 m0, s76, 18176
    s_nop 0
    buffer_load_dword v3, s[28:31], s73 offen lds
    s_add_u32 s73, s75, 73984
    s_add_u32 m0, s76, 18432
    s_nop 0
    buffer_load_dword v3, s[28:31], s73 offen lds
    s_add_u32 s73, s75, 78592
    s_add_u32 m0, s76, 18688
    s_nop 0
    buffer_load_dword v3, s[28:31], s73 offen lds
    s_add_u32 s73, s75, 83200
    s_add_u32 m0, s76, 18944
    s_nop 0
    buffer_load_dword v3, s[28:31], s73 offen lds
    s_add_u32 s73, s75, 87808
    s_add_u32 m0, s76, 19200
    s_nop 0
    buffer_load_dword v3, s[28:31], s73 offen lds
    s_add_u32 s73, s75, 92416
    s_add_u32 m0, s76, 19456
    s_nop 0
    buffer_load_dword v3, s[28:31], s73 offen lds
    s_add_u32 s73, s75, 97024
    s_add_u32 m0, s76, 19712
    s_nop 0
    buffer_load_dword v3, s[28:31], s73 offen lds
    s_add_u32 s73, s75, 101632
    s_add_u32 m0, s76, 19968
    s_nop 0
    buffer_load_dword v3, s[28:31], s73 offen lds
    s_add_u32 s73, s75, 106240
    s_add_u32 m0, s76, 20224
    s_nop 0
    buffer_load_dword v3, s[28:31], s73 offen lds
    s_add_u32 s73, s75, 110848
    s_add_u32 m0, s76, 20480
    s_nop 0
    buffer_load_dword v3, s[28:31], s73 offen lds
    s_add_u32 s73, s75, 115456
    s_add_u32 m0, s76, 20736
    s_nop 0
    buffer_load_dword v3, s[28:31], s73 offen lds
    s_add_u32 s73, s75, 120064
    s_add_u32 m0, s76, 20992
    s_nop 0
    buffer_load_dword v3, s[28:31], s73 offen lds
    s_add_u32 s73, s75, 124672
    s_add_u32 m0, s76, 21248
    s_nop 0
    buffer_load_dword v3, s[28:31], s73 offen lds
    s_add_u32 s73, s75, 129280
    s_add_u32 m0, s76, 21504
    s_nop 0
    buffer_load_dword v3, s[28:31], s73 offen lds
    s_add_u32 s73, s75, 133888
    s_add_u32 m0, s76, 21760
    s_nop 0
    buffer_load_dword v3, s[28:31], s73 offen lds
    s_add_u32 s73, s75, 138496
    s_add_u32 m0, s76, 22016
    s_nop 0
    buffer_load_dword v3, s[28:31], s73 offen lds
    s_add_u32 s73, s75, 143104
    s_add_u32 m0, s76, 22272
    s_nop 0
    buffer_load_dword v3, s[28:31], s73 offen lds
L_wo4_1:
    s_waitcnt vmcnt(12)
    s_barrier
    s_mov_b32 s73, 0x200000
    s_add_u32 m0, s77, 133120
    s_nop 0
    buffer_load_dwordx4 v8, s[16:19], s73 offen lds
    s_mov_b32 s73, 0x208000
    s_add_u32 m0, s77, 134144
    s_nop 0
    buffer_load_dwordx4 v8, s[16:19], s73 offen lds
    s_mov_b32 s73, 0x210000
    s_add_u32 m0, s77, 135168
    s_nop 0
    buffer_load_dwordx4 v8, s[16:19], s73 offen lds
    s_mov_b32 s73, 0x218000
    s_add_u32 m0, s77, 136192
    s_nop 0
    buffer_load_dwordx4 v8, s[16:19], s73 offen lds
    v_add_u32 v11, 0, v10
    ds_read2st64_b32 v[96:97], v11 offset0:0 offset1:1
    ds_read2st64_b32 v[98:99], v11 offset0:2 offset1:3
    ds_read2st64_b32 v[100:101], v11 offset0:16 offset1:17
    ds_read2st64_b32 v[102:103], v11 offset0:18 offset1:19
    ds_read2st64_b32 v[104:105], v11 offset0:32 offset1:33
    ds_read2st64_b32 v[106:107], v11 offset0:34 offset1:35
    ds_read2st64_b32 v[108:109], v11 offset0:48 offset1:49
    ds_read2st64_b32 v[110:111], v11 offset0:50 offset1:51
    s_waitcnt lgkmcnt(0)
    v_perm_b32 v1, v104, v96, s56
    v_perm_b32 v2, v104, v96, s57
    v_accvgpr_write_b32 a0, v1
    v_accvgpr_write_b32 a8, v2
    v_perm_b32 v1, v105, v97, s56
    v_perm_b32 v2, v105, v97, s57
    v_accvgpr_write_b32 a1, v1
    v_accvgpr_write_b32 a9, v2
    v_perm_b32 v1, v106, v98, s56
    v_perm_b32 v2, v106, v98, s57
    v_accvgpr_write_b32 a2, v1
    v_accvgpr_write_b32 a10, v2
    v_perm_b32 v1, v107, v99, s56
    v_perm_b32 v2, v107, v99, s57
    v_accvgpr_write_b32 a3, v1
    v_accvgpr_write_b32 a11, v2
    v_perm_b32 v1, v108, v100, s56
    v_perm_b32 v2, v108, v100, s57
    v_accvgpr_write_b32 a4, v1
    v_accvgpr_write_b32 a12, v2
    v_perm_b32 v1, v109, v101, s56
    v_perm_b32 v2, v109, v101, s57
    v_accvgpr_write_b32 a5, v1
    v_accvgpr_write_b32 a13, v2
    v_perm_b32 v1, v110, v102, s56
    v_perm_b32 v2, v110, v102, s57
    v_accvgpr_write_b32 a6, v1
    v_accvgpr_write_b32 a14, v2
    v_perm_b32 v1, v111, v103, s56
    v_perm_b32 v2, v111, v103, s57
    v_accvgpr_write_b32 a7, v1
    v_accvgpr_write_b32 a15, v2
    s_waitcnt vmcnt(12)
    s_barrier
    s_mov_b32 s73, 0x240000
    s_add_u32 m0, s77, 0
    s_nop 0
    buffer_load_dwordx4 v8, s[16:19], s73 offen lds
    s_mov_b32 s73, 0x248000
    s_add_u32 m0, s77, 1024
    s_nop 0
    buffer_load_dwordx4 v8, s[16:19], s73 offen lds
    s_mov_b32 s73, 0x250000
    s_add_u32 m0, s77, 2048
    s_nop 0
    buffer_load_dwordx4 v8, s[16:19], s73 offen lds
    s_mov_b32 s73, 0x258000
    s_add_u32 m0, s77, 3072
    s_nop 0
    buffer_load_dwordx4 v8, s[16:19], s73 offen lds
    v_add_u32 v11, 24576, v10
    ds_read2st64_b32 v[96:97], v11 offset0:0 offset1:1
    ds_read2st64_b32 v[98:99], v11 offset0:2 offset1:3
    ds_read2st64_b32 v[100:101], v11 offset0:16 offset1:17
    ds_read2st64_b32 v[102:103], v11 offset0:18 offset1:19
    ds_read2st64_b32 v[104:105], v11 offset0:32 offset1:33
    ds_read2st64_b32 v[106:107], v11 offset0:34 offset1:35
    ds_read2st64_b32 v[108:109], v11 offset0:48 offset1:49
    ds_read2st64_b32 v[110:111], v11 offset0:50 offset1:51
    s_waitcnt lgkmcnt(0)
    v_perm_b32 v1, v104, v96, s56
    v_perm_b32 v2, v104, v96, s57
    v_accvgpr_write_b32 a16, v1
    v_accvgpr_write_b32 a24, v2
    v_perm_b32 v1, v105, v97, s56
    v_perm_b32 v2, v105, v97, s57
    v_accvgpr_write_b32 a17, v1
    v_accvgpr_write_b32 a25, v2
    v_perm_b32 v1, v106, v98, s56
    v_perm_b32 v2, v106, v98, s57
    v_accvgpr_write_b32 a18, v1
    v_accvgpr_write_b32 a26, v2
    v_perm_b32 v1, v107, v99, s56
    v_perm_b32 v2, v107, v99, s57
    v_accvgpr_write_b32 a19, v1
    v_accvgpr_write_b32 a27, v2
    v_perm_b32 v1, v108, v100, s56
    v_perm_b32 v2, v108, v100, s57
    v_accvgpr_write_b32 a20, v1
    v_accvgpr_write_b32 a28, v2
    v_perm_b32 v1, v109, v101, s56
    v_perm_b32 v2, v109, v101, s57
    v_accvgpr_write_b32 a21, v1
    v_accvgpr_write_b32 a29, v2
    v_perm_b32 v1, v110, v102, s56
    v_perm_b32 v2, v110, v102, s57
    v_accvgpr_write_b32 a22, v1
    v_accvgpr_write_b32 a30, v2
    v_perm_b32 v1, v111, v103, s56
    v_perm_b32 v2, v111, v103, s57
    v_accvgpr_write_b32 a23, v1
    v_accvgpr_write_b32 a31, v2
    s_waitcnt vmcnt(12)
    s_barrier
    s_mov_b32 s73, 0x280000
    s_add_u32 m0, s77, 24576
    s_nop 0
    buffer_load_dwordx4 v8, s[16:19], s73 offen lds
    s_mov_b32 s73, 0x288000
    s_add_u32 m0, s77, 25600
    s_nop 0
    buffer_load_dwordx4 v8, s[16:19], s73 offen lds
    s_mov_b32 s73, 0x290000
    s_add_u32 m0, s77, 26624
    s_nop 0
    buffer_load_dwordx4 v8, s[16:19], s73 offen lds
    s_mov_b32 s73, 0x298000
    s_add_u32 m0, s77, 27648
    s_nop 0
    buffer_load_dwordx4 v8, s[16:19], s73 offen lds
    v_add_u32 v11, 63488, v10
    ds_read2st64_b32 v[96:97], v11 offset0:0 offset1:1
    ds_read2st64_b32 v[98:99], v11 offset0:2 offset1:3
    ds_read2st64_b32 v[100:101], v11 offset0:16 offset1:17
    ds_read2st64_b32 v[102:103], v11 offset0:18 offset1:19
    ds_read2st64_b32 v[104:105], v11 offset0:32 offset1:33
    ds_read2st64_b32 v[106:107], v11 offset0:34 offset1:35
    ds_read2st64_b32 v[108:109], v11 offset0:48 offset1:49
    ds_read2st64_b32 v[110:111], v11 offset0:50 offset1:51
    s_waitcnt lgkmcnt(0)
    v_perm_b32 v1, v104, v96, s56
    v_perm_b32 v2, v104, v96, s57
    v_accvgpr_write_b32 a32, v1
    v_accvgpr_write_b32 a40, v2
    v_perm_b32 v1, v105, v97, s56
    v_perm_b32 v2, v105, v97, s57
    v_accvgpr_write_b32 a33, v1
    v_accvgpr_write_b32 a41, v2
    v_perm_b32 v1, v106, v98, s56
    v_perm_b32 v2, v106, v98, s57
    v_accvgpr_write_b32 a34, v1
    v_accvgpr_write_b32 a42, v2
    v_perm_b32 v1, v107, v99, s56
    v_perm_b32 v2, v107, v99, s57
    v_accvgpr_write_b32 a35, v1
    v_accvgpr_write_b32 a43, v2
    v_perm_b32 v1, v108, v100, s56
    v_perm_b32 v2, v108, v100, s57
    v_accvgpr_write_b32 a36, v1
    v_accvgpr_write_b32 a44, v2
    v_perm_b32 v1, v109, v101, s56
    v_perm_b32 v2, v109, v101, s57
    v_accvgpr_write_b32 a37, v1
    v_accvgpr_write_b32 a45, v2
    v_perm_b32 v1, v110, v102, s56
    v_perm_b32 v2, v110, v102, s57
    v_accvgpr_write_b32 a38, v1
    v_accvgpr_write_b32 a46, v2
    v_perm_b32 v1, v111, v103, s56
    v_perm_b32 v2, v111, v103, s57
    v_accvgpr_write_b32 a39, v1
    v_accvgpr_write_b32 a47, v2
    s_waitcnt vmcnt(12)
    s_barrier
    s_mov_b32 s73, 0x2c0000
    s_add_u32 m0, s77, 63488
    s_nop 0
    buffer_load_dwordx4 v8, s[16:19], s73 offen lds
    s_mov_b32 s73, 0x2c8000
    s_add_u32 m0, s77, 64512
    s_nop 0
    buffer_load_dwordx4 v8, s[16:19], s73 offen lds
    s_mov_b32 s73, 0x2d0000
    s_add_u32 m0, s77, 65536
    s_nop 0
    buffer_load_dwordx4 v8, s[16:19], s73 offen lds
    s_mov_b32 s73, 0x2d8000
    s_add_u32 m0, s77, 66560
    s_nop 0
    buffer_load_dwordx4 v8, s[16:19], s73 offen lds
    s_add_u32 s73, s75, 0
    s_add_u32 m0, s76, 0
    s_nop 0
    buffer_load_dword v3, s[28:31], s73 offen lds
    s_add_u32 s73, s75, 4608
    s_add_u32 m0, s76, 256
    s_nop 0
    buffer_load_dword v3, s[28:31], s73 offen lds
    s_add_u32 s73, s75, 9216
    s_add_u32 m0, s76, 512
    s_nop 0
    buffer_load_dword v3, s[28:31], s73 offen lds
    s_add_u32 s73, s75, 13824
    s_add_u32 m0, s76, 768
    s_nop 0
    buffer_load_dword v3, s[28:31], s73 offen lds
    s_add_u32 s73, s75, 18432
    s_add_u32 m0, s76, 1024
    s_nop 0
    buffer_load_dword v3, s[28:31], s73 offen lds
    s_add_u32 s73, s75, 23040
    s_add_u32 m0, s76, 1280
    s_nop 0
    buffer_load_dword v3, s[28:31], s73 offen lds
    s_add_u32 s73, s75, 27648
    s_add_u32 m0, s76, 1536
    s_nop 0
    buffer_load_dword v3, s[28:31], s73 offen lds
    s_add_u32 s73, s75, 32256
    s_add_u32 m0, s76, 1792
    s_nop 0
    buffer_load_dword v3, s[28:31], s73 offen lds
    v_add_u32 v11, 102400, v10
    ds_read2st64_b32 v[96:97], v11 offset0:0 offset1:1
    ds_read2st64_b32 v[98:99], v11 offset0:2 offset1:3
    ds_read2st64_b32 v[100:101], v11 offset0:16 offset1:17
    ds_read2st64_b32 v[102:103], v11 offset0:18 offset1:19
    ds_read2st64_b32 v[104:105], v11 offset0:32 offset1:33
    ds_read2st64_b32 v[106:107], v11 offset0:34 offset1:35
    ds_read2st64_b32 v[108:109], v11 offset0:48 offset1:49
    ds_read2st64_b32 v[110:111], v11 offset0:50 offset1:51
    s_waitcnt lgkmcnt(0)
    v_perm_b32 v1, v104, v96, s56
    v_perm_b32 v2, v104, v96, s57
    v_accvgpr_write_b32 a48, v1
    v_accvgpr_write_b32 a56, v2
    v_perm_b32 v1, v105, v97, s56
    v_perm_b32 v2, v105, v97, s57
    v_accvgpr_write_b32 a49, v1
    v_accvgpr_write_b32 a57, v2
    v_perm_b32 v1, v106, v98, s56
    v_perm_b32 v2, v106, v98, s57
    v_accvgpr_write_b32 a50, v1
    v_accvgpr_write_b32 a58, v2
    v_perm_b32 v1, v107, v99, s56
    v_perm_b32 v2, v107, v99, s57
    v_accvgpr_write_b32 a51, v1
    v_accvgpr_write_b32 a59, v2
    v_perm_b32 v1, v108, v100, s56
    v_perm_b32 v2, v108, v100, s57
    v_accvgpr_write_b32 a52, v1
    v_accvgpr_write_b32 a60, v2
    v_perm_b32 v1, v109, v101, s56
    v_perm_b32 v2, v109, v101, s57
    v_accvgpr_write_b32 a53, v1
    v_accvgpr_write_b32 a61, v2
    v_perm_b32 v1, v110, v102, s56
    v_perm_b32 v2, v110, v102, s57
    v_accvgpr_write_b32 a54, v1
    v_accvgpr_write_b32 a62, v2
    v_perm_b32 v1, v111, v103, s56
    v_perm_b32 v2, v111, v103, s57
    v_accvgpr_write_b32 a55, v1
    v_accvgpr_write_b32 a63, v2
    s_waitcnt vmcnt(20)
    s_barrier
    s_mov_b32 s73, 0x300000
    s_add_u32 m0, s77, 102400
    s_nop 0
    buffer_load_dwordx4 v8, s[16:19], s73 offen lds
    s_mov_b32 s73, 0x308000
    s_add_u32 m0, s77, 103424
    s_nop 0
    buffer_load_dwordx4 v8, s[16:19], s73 offen lds
    s_mov_b32 s73, 0x310000
    s_add_u32 m0, s77, 104448
    s_nop 0
    buffer_load_dwordx4 v8, s[16:19], s73 offen lds
    s_mov_b32 s73, 0x318000
    s_add_u32 m0, s77, 105472
    s_nop 0
    buffer_load_dwordx4 v8, s[16:19], s73 offen lds
    s_add_u32 s73, s75, 36864
    s_add_u32 m0, s76, 2048
    s_nop 0
    buffer_load_dword v3, s[28:31], s73 offen lds
    s_add_u32 s73, s75, 41472
    s_add_u32 m0, s76, 2304
    s_nop 0
    buffer_load_dword v3, s[28:31], s73 offen lds
    s_add_u32 s73, s75, 46080
    s_add_u32 m0, s76, 2560
    s_nop 0
    buffer_load_dword v3, s[28:31], s73 offen lds
    s_add_u32 s73, s75, 50688
    s_add_u32 m0, s76, 2816
    s_nop 0
    buffer_load_dword v3, s[28:31], s73 offen lds
    s_add_u32 s73, s75, 55296
    s_add_u32 m0, s76, 3072
    s_nop 0
    buffer_load_dword v3, s[28:31], s73 offen lds
    s_add_u32 s73, s75, 59904
    s_add_u32 m0, s76, 3328
    s_nop 0
    buffer_load_dword v3, s[28:31], s73 offen lds
    s_add_u32 s73, s75, 64512
    s_add_u32 m0, s76, 3584
    s_nop 0
    buffer_load_dword v3, s[28:31], s73 offen lds
    s_add_u32 s73, s75, 69120
    s_add_u32 m0, s76, 3840
    s_nop 0
    buffer_load_dword v3, s[28:31], s73 offen lds
    v_add_u32 v11, 133120, v10
    ds_read2st64_b32 v[96:97], v11 offset0:0 offset1:1
    ds_read2st64_b32 v[98:99], v11 offset0:2 offset1:3
    ds_read2st64_b32 v[100:101], v11 offset0:16 offset1:17
    ds_read2st64_b32 v[102:103], v11 offset0:18 offset1:19
    ds_read2st64_b32 v[104:105], v11 offset0:32 offset1:33
    ds_read2st64_b32 v[106:107], v11 offset0:34 offset1:35
    ds_read2st64_b32 v[108:109], v11 offset0:48 offset1:49
    ds_read2st64_b32 v[110:111], v11 offset0:50 offset1:51
    s_waitcnt lgkmcnt(0)
    v_perm_b32 v1, v104, v96, s56
    v_perm_b32 v2, v104, v96, s57
    v_accvgpr_write_b32 a64, v1
    v_accvgpr_write_b32 a72, v2
    v_perm_b32 v1, v105, v97, s56
    v_perm_b32 v2, v105, v97, s57
    v_accvgpr_write_b32 a65, v1
    v_accvgpr_write_b32 a73, v2
    v_perm_b32 v1, v106, v98, s56
    v_perm_b32 v2, v106, v98, s57
    v_accvgpr_write_b32 a66, v1
    v_accvgpr_write_b32 a74, v2
    v_perm_b32 v1, v107, v99, s56
    v_perm_b32 v2, v107, v99, s57
    v_accvgpr_write_b32 a67, v1
    v_accvgpr_write_b32 a75, v2
    v_perm_b32 v1, v108, v100, s56
    v_perm_b32 v2, v108, v100, s57
    v_accvgpr_write_b32 a68, v1
    v_accvgpr_write_b32 a76, v2
    v_perm_b32 v1, v109, v101, s56
    v_perm_b32 v2, v109, v101, s57
    v_accvgpr_write_b32 a69, v1
    v_accvgpr_write_b32 a77, v2
    v_perm_b32 v1, v110, v102, s56
    v_perm_b32 v2, v110, v102, s57
    v_accvgpr_write_b32 a70, v1
    v_accvgpr_write_b32 a78, v2
    v_perm_b32 v1, v111, v103, s56
    v_perm_b32 v2, v111, v103, s57
    v_accvgpr_write_b32 a71, v1
    v_accvgpr_write_b32 a79, v2
    s_waitcnt vmcnt(28)
    s_barrier
    s_mov_b32 s73, 0x340000
    s_add_u32 m0, s77, 133120
    s_nop 0
    buffer_load_dwordx4 v8, s[16:19], s73 offen lds
    s_mov_b32 s73, 0x348000
    s_add_u32 m0, s77, 134144
    s_nop 0
    buffer_load_dwordx4 v8, s[16:19], s73 offen lds
    s_mov_b32 s73, 0x350000
    s_add_u32 m0, s77, 135168
    s_nop 0
    buffer_load_dwordx4 v8, s[16:19], s73 offen lds
    s_mov_b32 s73, 0x358000
    s_add_u32 m0, s77, 136192
    s_nop 0
    buffer_load_dwordx4 v8, s[16:19], s73 offen lds
    s_add_u32 s73, s75, 73728
    s_add_u32 m0, s76, 4096
    s_nop 0
    buffer_load_dword v3, s[28:31], s73 offen lds
    s_add_u32 s73, s75, 78336
    s_add_u32 m0, s76, 4352
    s_nop 0
    buffer_load_dword v3, s[28:31], s73 offen lds
    s_add_u32 s73, s75, 82944
    s_add_u32 m0, s76, 4608
    s_nop 0
    buffer_load_dword v3, s[28:31], s73 offen lds
    s_add_u32 s73, s75, 87552
    s_add_u32 m0, s76, 4864
    s_nop 0
    buffer_load_dword v3, s[28:31], s73 offen lds
    s_add_u32 s73, s75, 92160
    s_add_u32 m0, s76, 5120
    s_nop 0
    buffer_load_dword v3, s[28:31], s73 offen lds
    s_add_u32 s73, s75, 96768
    s_add_u32 m0, s76, 5376
    s_nop 0
    buffer_load_dword v3, s[28:31], s73 offen lds
    s_add_u32 s73, s75, 101376
    s_add_u32 m0, s76, 5632
    s_nop 0
    buffer_load_dword v3, s[28:31], s73 offen lds
    s_add_u32 s73, s75, 105984
    s_add_u32 m0, s76, 5888
    s_nop 0
    buffer_load_dword v3, s[28:31], s73 offen lds
    v_add_u32_e64 v11, 0, v10
    ds_read2st64_b32 v[96:97], v11 offset0:0 offset1:1
    ds_read2st64_b32 v[98:99], v11 offset0:2 offset1:3
    ds_read2st64_b32 v[100:101], v11 offset0:16 offset1:17
    ds_read2st64_b32 v[102:103], v11 offset0:18 offset1:19
    ds_read2st64_b32 v[104:105], v11 offset0:32 offset1:33
    ds_read2st64_b32 v[106:107], v11 offset0:34 offset1:35
    ds_read2st64_b32 v[108:109], v11 offset0:48 offset1:49
    ds_read2st64_b32 v[110:111], v11 offset0:50 offset1:51
    s_waitcnt lgkmcnt(0)
    v_perm_b32 v1, v104, v96, s56
    v_perm_b32 v2, v104, v96, s57
    v_accvgpr_write_b32 a80, v1
    v_accvgpr_write_b32 a88, v2
    v_perm_b32 v1, v105, v97, s56
    v_perm_b32 v2, v105, v97, s57
    v_accvgpr_write_b32 a81, v1
    v_accvgpr_write_b32 a89, v2
    v_perm_b32 v1, v106, v98, s56
    v_perm_b32 v2, v106, v98, s57
    v_accvgpr_write_b32 a82, v1
    v_accvgpr_write_b32 a90, v2
    v_perm_b32 v1, v107, v99, s56
    v_perm_b32 v2, v107, v99, s57
    v_accvgpr_write_b32 a83, v1
    v_accvgpr_write_b32 a91, v2
    v_perm_b32 v1, v108, v100, s56
    v_perm_b32 v2, v108, v100, s57
    v_accvgpr_write_b32 a84, v1
    v_accvgpr_write_b32 a92, v2
    v_perm_b32 v1, v109, v101, s56
    v_perm_b32 v2, v109, v101, s57
    v_accvgpr_write_b32 a85, v1
    v_accvgpr_write_b32 a93, v2
    v_perm_b32 v1, v110, v102, s56
    v_perm_b32 v2, v110, v102, s57
    v_accvgpr_write_b32 a86, v1
    v_accvgpr_write_b32 a94, v2
    v_perm_b32 v1, v111, v103, s56
    v_perm_b32 v2, v111, v103, s57
    v_accvgpr_write_b32 a87, v1
    v_accvgpr_write_b32 a95, v2
    s_waitcnt vmcnt(36)
    s_barrier
    s_mov_b32 s73, 0x380000
    s_add_u32 m0, s77, 0
    s_nop 0
    buffer_load_dwordx4 v8, s[16:19], s73 offen lds
    s_mov_b32 s73, 0x388000
    s_add_u32 m0, s77, 1024
    s_nop 0
    buffer_load_dwordx4 v8, s[16:19], s73 offen lds
    s_mov_b32 s73, 0x390000
    s_add_u32 m0, s77, 2048
    s_nop 0
    buffer_load_dwordx4 v8, s[16:19], s73 offen lds
    s_mov_b32 s73, 0x398000
    s_add_u32 m0, s77, 3072
    s_nop 0
    buffer_load_dwordx4 v8, s[16:19], s73 offen lds
    v_add_u32 v11, 24576, v10
    ds_read2st64_b32 v[96:97], v11 offset0:0 offset1:1
    ds_read2st64_b32 v[98:99], v11 offset0:2 offset1:3
    ds_read2st64_b32 v[100:101], v11 offset0:16 offset1:17
    ds_read2st64_b32 v[102:103], v11 offset0:18 offset1:19
    ds_read2st64_b32 v[104:105], v11 offset0:32 offset1:33
    ds_read2st64_b32 v[106:107], v11 offset0:34 offset1:35
    ds_read2st64_b32 v[108:109], v11 offset0:48 offset1:49
    ds_read2st64_b32 v[110:111], v11 offset0:50 offset1:51
    s_waitcnt lgkmcnt(0)
    v_perm_b32 v1, v104, v96, s56
    v_perm_b32 v2, v104, v96, s57
    v_accvgpr_write_b32 a96, v1
    v_accvgpr_write_b32 a104, v2
    v_perm_b32 v1, v105, v97, s56
    v_perm_b32 v2, v105, v97, s57
    v_accvgpr_write_b32 a97, v1
    v_accvgpr_write_b32 a105, v2
    v_perm_b32 v1, v106, v98, s56
    v_perm_b32 v2, v106, v98, s57
    v_accvgpr_write_b32 a98, v1
    v_accvgpr_write_b32 a106, v2
    v_perm_b32 v1, v107, v99, s56
    v_perm_b32 v2, v107, v99, s57
    v_accvgpr_write_b32 a99, v1
    v_accvgpr_write_b32 a107, v2
    v_perm_b32 v1, v108, v100, s56
    v_perm_b32 v2, v108, v100, s57
    v_accvgpr_write_b32 a100, v1
    v_accvgpr_write_b32 a108, v2
    v_perm_b32 v1, v109, v101, s56
    v_perm_b32 v2, v109, v101, s57
    v_accvgpr_write_b32 a101, v1
    v_accvgpr_write_b32 a109, v2
    v_perm_b32 v1, v110, v102, s56
    v_perm_b32 v2, v110, v102, s57
    v_accvgpr_write_b32 a102, v1
    v_accvgpr_write_b32 a110, v2
    v_perm_b32 v1, v111, v103, s56
    v_perm_b32 v2, v111, v103, s57
    v_accvgpr_write_b32 a103, v1
    v_accvgpr_write_b32 a111, v2
    s_waitcnt vmcnt(36)
    s_barrier
    s_mov_b32 s73, 0x3c0000
    s_add_u32 m0, s77, 24576
    s_nop 0
    buffer_load_dwordx4 v8, s[16:19], s73 offen lds
    s_mov_b32 s73, 0x3c8000
    s_add_u32 m0, s77, 25600
    s_nop 0
    buffer_load_dwordx4 v8, s[16:19], s73 offen lds
    s_mov_b32 s73, 0x3d0000
    s_add_u32 m0, s77, 26624
    s_nop 0
    buffer_load_dwordx4 v8, s[16:19], s73 offen lds
    s_mov_b32 s73, 0x3d8000
    s_add_u32 m0, s77, 27648
    s_nop 0
    buffer_load_dwordx4 v8, s[16:19], s73 offen lds
    s_add_u32 s73, s75, 110592
    s_add_u32 m0, s76, 6144
    s_nop 0
    buffer_load_dword v3, s[28:31], s73 offen lds
    s_add_u32 s73, s75, 115200
    s_add_u32 m0, s76, 6400
    s_nop 0
    buffer_load_dword v3, s[28:31], s73 offen lds
    s_add_u32 s73, s75, 119808
    s_add_u32 m0, s76, 6656
    s_nop 0
    buffer_load_dword v3, s[28:31], s73 offen lds
    s_add_u32 s73, s75, 124416
    s_add_u32 m0, s76, 6912
    s_nop 0
    buffer_load_dword v3, s[28:31], s73 offen lds
    s_add_u32 s73, s75, 129024
    s_add_u32 m0, s76, 7168
    s_nop 0
    buffer_load_dword v3, s[28:31], s73 offen lds
    s_add_u32 s73, s75, 133632
    s_add_u32 m0, s76, 7424
    s_nop 0
    buffer_load_dword v3, s[28:31], s73 offen lds
    s_add_u32 s73, s75, 138240
    s_add_u32 m0, s76, 7680
    s_nop 0
    buffer_load_dword v3, s[28:31], s73 offen lds
    s_add_u32 s73, s75, 142848
    s_add_u32 m0, s76, 7936
    s_nop 0
    buffer_load_dword v3, s[28:31], s73 offen lds
    v_add_u32 v11, 63488, v10
    ds_read2st64_b32 v[96:97], v11 offset0:0 offset1:1
    ds_read2st64_b32 v[98:99], v11 offset0:2 offset1:3
    ds_read2st64_b32 v[100:101], v11 offset0:16 offset1:17
    ds_read2st64_b32 v[102:103], v11 offset0:18 offset1:19
    ds_read2st64_b32 v[104:105], v11 offset0:32 offset1:33
    ds_read2st64_b32 v[106:107], v11 offset0:34 offset1:35
    ds_read2st64_b32 v[108:109], v11 offset0:48 offset1:49
    ds_read2st64_b32 v[110:111], v11 offset0:50 offset1:51
    s_waitcnt lgkmcnt(0)
    v_perm_b32 v1, v104, v96, s56
    v_perm_b32 v2, v104, v96, s57
    v_accvgpr_write_b32 a112, v1
    v_accvgpr_write_b32 a120, v2
    v_perm_b32 v1, v105, v97, s56
    v_perm_b32 v2, v105, v97, s57
    v_accvgpr_write_b32 a113, v1
    v_accvgpr_write_b32 a121, v2
    v_perm_b32 v1, v106, v98, s56
    v_perm_b32 v2, v106, v98, s57
    v_accvgpr_write_b32 a114, v1
    v_accvgpr_write_b32 a122, v2
    v_perm_b32 v1, v107, v99, s56
    v_perm_b32 v2, v107, v99, s57
    v_accvgpr_write_b32 a115, v1
    v_accvgpr_write_b32 a123, v2
    v_perm_b32 v1, v108, v100, s56
    v_perm_b32 v2, v108, v100, s57
    v_accvgpr_write_b32 a116, v1
    v_accvgpr_write_b32 a124, v2
    v_perm_b32 v1, v109, v101, s56
    v_perm_b32 v2, v109, v101, s57
    v_accvgpr_write_b32 a117, v1
    v_accvgpr_write_b32 a125, v2
    v_perm_b32 v1, v110, v102, s56
    v_perm_b32 v2, v110, v102, s57
    v_accvgpr_write_b32 a118, v1
    v_accvgpr_write_b32 a126, v2
    v_perm_b32 v1, v111, v103, s56
    v_perm_b32 v2, v111, v103, s57
    v_accvgpr_write_b32 a119, v1
    v_accvgpr_write_b32 a127, v2
    s_waitcnt vmcnt(36)
    s_barrier
    s_mov_b32 s73, 0x400000
    s_add_u32 m0, s77, 63488
    s_nop 0
    buffer_load_dwordx4 v8, s[16:19], s73 offen lds
    s_mov_b32 s73, 0x408000
    s_add_u32 m0, s77, 64512
    s_nop 0
    buffer_load_dwordx4 v8, s[16:19], s73 offen lds
    s_mov_b32 s73, 0x410000
    s_add_u32 m0, s77, 65536
    s_nop 0
    buffer_load_dwordx4 v8, s[16:19], s73 offen lds
    s_mov_b32 s73, 0x418000
    s_add_u32 m0, s77, 66560
    s_nop 0
    buffer_load_dwordx4 v8, s[16:19], s73 offen lds
    v_add_u32 v11, 102400, v10
    ds_read2st64_b32 v[96:97], v11 offset0:0 offset1:1
    ds_read2st64_b32 v[98:99], v11 offset0:2 offset1:3
    ds_read2st64_b32 v[100:101], v11 offset0:16 offset1:17
    ds_read2st64_b32 v[102:103], v11 offset0:18 offset1:19
    ds_read2st64_b32 v[104:105], v11 offset0:32 offset1:33
    ds_read2st64_b32 v[106:107], v11 offset0:34 offset1:35
    ds_read2st64_b32 v[108:109], v11 offset0:48 offset1:49
    ds_read2st64_b32 v[110:111], v11 offset0:50 offset1:51
    s_waitcnt lgkmcnt(0)
    v_perm_b32 v1, v104, v96, s56
    v_perm_b32 v2, v104, v96, s57
    v_accvgpr_write_b32 a128, v1
    v_accvgpr_write_b32 a136, v2
    v_perm_b32 v1, v105, v97, s56
    v_perm_b32 v2, v105, v97, s57
    v_accvgpr_write_b32 a129, v1
    v_accvgpr_write_b32 a137, v2
    v_perm_b32 v1, v106, v98, s56
    v_perm_b32 v2, v106, v98, s57
    v_accvgpr_write_b32 a130, v1
    v_accvgpr_write_b32 a138, v2
    v_perm_b32 v1, v107, v99, s56
    v_perm_b32 v2, v107, v99, s57
    v_accvgpr_write_b32 a131, v1
    v_accvgpr_write_b32 a139, v2
    v_perm_b32 v1, v108, v100, s56
    v_perm_b32 v2, v108, v100, s57
    v_accvgpr_write_b32 a132, v1
    v_accvgpr_write_b32 a140, v2
    v_perm_b32 v1, v109, v101, s56
    v_perm_b32 v2, v109, v101, s57
    v_accvgpr_write_b32 a133, v1
    v_accvgpr_write_b32 a141, v2
    v_perm_b32 v1, v110, v102, s56
    v_perm_b32 v2, v110, v102, s57
    v_accvgpr_write_b32 a134, v1
    v_accvgpr_write_b32 a142, v2
    v_perm_b32 v1, v111, v103, s56
    v_perm_b32 v2, v111, v103, s57
    v_accvgpr_write_b32 a135, v1
    v_accvgpr_write_b32 a143, v2
    s_waitcnt vmcnt(28)
    s_barrier
    s_mov_b32 s73, 0x440000
    s_add_u32 m0, s77, 102400
    s_nop 0
    buffer_load_dwordx4 v8, s[16:19], s73 offen lds
    s_mov_b32 s73, 0x448000
    s_add_u32 m0, s77, 103424
    s_nop 0
    buffer_load_dwordx4 v8, s[16:19], s73 offen lds
    s_mov_b32 s73, 0x450000
    s_add_u32 m0, s77, 104448
    s_nop 0
    buffer_load_dwordx4 v8, s[16:19], s73 offen lds
    s_mov_b32 s73, 0x458000
    s_add_u32 m0, s77, 105472
    s_nop 0
    buffer_load_dwordx4 v8, s[16:19], s73 offen lds
    s_add_u32 s73, s75, 64
    buffer_load_dword a224, v4, s[28:31], s73 offen
    s_add_u32 s73, s75, 1216
    buffer_load_dword a225, v4, s[28:31], s73 offen
    s_add_u32 s73, s75, 2368
    buffer_load_dword a226, v4, s[28:31], s73 offen
    s_add_u32 s73, s75, 3520
    buffer_load_dword a227, v4, s[28:31], s73 offen
    s_add_u32 s73, s75, 18496
    buffer_load_dword a228, v4, s[28:31], s73 offen
    s_add_u32 s73, s75, 19648
    buffer_load_dword a229, v4, s[28:31], s73 offen
    s_add_u32 s73, s75, 20800
    buffer_load_dword a230, v4, s[28:31], s73 offen
    s_add_u32 s73, s75, 21952
    buffer_load_dword a231, v4, s[28:31], s73 offen
    v_add_u32 v11, 133120, v10
    ds_read2st64_b32 v[96:97], v11 offset0:0 offset1:1
    ds_read2st64_b32 v[98:99], v11 offset0:2 offset1:3
    ds_read2st64_b32 v[100:101], v11 offset0:16 offset1:17
    ds_read2st64_b32 v[102:103], v11 offset0:18 offset1:19
    ds_read2st64_b32 v[104:105], v11 offset0:32 offset1:33
    ds_read2st64_b32 v[106:107], v11 offset0:34 offset1:35
    ds_read2st64_b32 v[108:109], v11 offset0:48 offset1:49
    ds_read2st64_b32 v[110:111], v11 offset0:50 offset1:51
    s_waitcnt lgkmcnt(0)
    v_perm_b32 v1, v104, v96, s56
    v_perm_b32 v2, v104, v96, s57
    v_accvgpr_write_b32 a144, v1
    v_accvgpr_write_b32 a152, v2
    v_perm_b32 v1, v105, v97, s56
    v_perm_b32 v2, v105, v97, s57
    v_accvgpr_write_b32 a145, v1
    v_accvgpr_write_b32 a153, v2
    v_perm_b32 v1, v106, v98, s56
    v_perm_b32 v2, v106, v98, s57
    v_accvgpr_write_b32 a146, v1
    v_accvgpr_write_b32 a154, v2
    v_perm_b32 v1, v107, v99, s56
    v_perm_b32 v2, v107, v99, s57
    v_accvgpr_write_b32 a147, v1
    v_accvgpr_write_b32 a155, v2
    v_perm_b32 v1, v108, v100, s56
    v_perm_b32 v2, v108, v100, s57
    v_accvgpr_write_b32 a148, v1
    v_accvgpr_write_b32 a156, v2
    v_perm_b32 v1, v109, v101, s56
    v_perm_b32 v2, v109, v101, s57
    v_accvgpr_write_b32 a149, v1
    v_accvgpr_write_b32 a157, v2
    v_perm_b32 v1, v110, v102, s56
    v_perm_b32 v2, v110, v102, s57
    v_accvgpr_write_b32 a150, v1
    v_accvgpr_write_b32 a158, v2
    v_perm_b32 v1, v111, v103, s56
    v_perm_b32 v2, v111, v103, s57
    v_accvgpr_write_b32 a151, v1
    v_accvgpr_write_b32 a159, v2
    s_waitcnt vmcnt(28)
    s_barrier
    s_mov_b32 s73, 0x0
    s_add_u32 m0, s77, 133120
    s_nop 0
    buffer_load_dwordx4 v9, s[24:27], s73 offen lds
    s_mov_b32 s73, 0x8000
    s_add_u32 m0, s77, 134144
    s_nop 0
    buffer_load_dwordx4 v9, s[24:27], s73 offen lds
    s_mov_b32 s73, 0x10000
    s_add_u32 m0, s77, 135168
    s_nop 0
    buffer_load_dwordx4 v9, s[24:27], s73 offen lds
    s_mov_b32 s73, 0x18000
    s_add_u32 m0, s77, 136192
    s_nop 0
    buffer_load_dwordx4 v9, s[24:27], s73 offen lds
    v_add_u32_e64 v11, 0, v10
    ds_read2st64_b32 v[96:97], v11 offset0:0 offset1:1
    ds_read2st64_b32 v[98:99], v11 offset0:2 offset1:3
    ds_read2st64_b32 v[100:101], v11 offset0:16 offset1:17
    ds_read2st64_b32 v[102:103], v11 offset0:18 offset1:19
    ds_read2st64_b32 v[104:105], v11 offset0:32 offset1:33
    ds_read2st64_b32 v[106:107], v11 offset0:34 offset1:35
    ds_read2st64_b32 v[108:109], v11 offset0:48 offset1:49
    ds_read2st64_b32 v[110:111], v11 offset0:50 offset1:51
    s_waitcnt lgkmcnt(0)
    v_perm_b32 v1, v104, v96, s56
    v_perm_b32 v2, v104, v96, s57
    v_accvgpr_write_b32 a160, v1
    v_accvgpr_write_b32 a168, v2
    v_perm_b32 v1, v105, v97, s56
    v_perm_b32 v2, v105, v97, s57
    v_accvgpr_write_b32 a161, v1
    v_accvgpr_write_b32 a169, v2
    v_perm_b32 v1, v106, v98, s56
    v_perm_b32 v2, v106, v98, s57
    v_accvgpr_write_b32 a162, v1
    v_accvgpr_write_b32 a170, v2
    v_perm_b32 v1, v107, v99, s56
    v_perm_b32 v2, v107, v99, s57
    v_accvgpr_write_b32 a163, v1
    v_accvgpr_write_b32 a171, v2
    v_perm_b32 v1, v108, v100, s56
    v_perm_b32 v2, v108, v100, s57
    v_accvgpr_write_b32 a164, v1
    v_accvgpr_write_b32 a172, v2
    v_perm_b32 v1, v109, v101, s56
    v_perm_b32 v2, v109, v101, s57
    v_accvgpr_write_b32 a165, v1
    v_accvgpr_write_b32 a173, v2
    v_perm_b32 v1, v110, v102, s56
    v_perm_b32 v2, v110, v102, s57
    v_accvgpr_write_b32 a166, v1
    v_accvgpr_write_b32 a174, v2
    v_perm_b32 v1, v111, v103, s56
    v_perm_b32 v2, v111, v103, s57
    v_accvgpr_write_b32 a167, v1
    v_accvgpr_write_b32 a175, v2
    s_waitcnt vmcnt(28)
    s_barrier
    s_mov_b32 s73, 0x80000
    s_add_u32 m0, s77, 0
    s_nop 0
    buffer_load_dwordx4 v9, s[24:27], s73 offen lds
    s_mov_b32 s73, 0x88000
    s_add_u32 m0, s77, 1024
    s_nop 0
    buffer_load_dwordx4 v9, s[24:27], s73 offen lds
    s_mov_b32 s73, 0x90000
    s_add_u32 m0, s77, 2048
    s_nop 0
    buffer_load_dwordx4 v9, s[24:27], s73 offen lds
    s_mov_b32 s73, 0x98000
    s_add_u32 m0, s77, 3072
    s_nop 0
    buffer_load_dwordx4 v9, s[24:27], s73 offen lds
    s_add_u32 s73, s75, 36928
    buffer_load_dword a232, v4, s[28:31], s73 offen
    s_add_u32 s73, s75, 38080
    buffer_load_dword a233, v4, s[28:31], s73 offen
    s_add_u32 s73, s75, 39232
    buffer_load_dword a234, v4, s[28:31], s73 offen
    s_add_u32 s73, s75, 40384
    buffer_load_dword a235, v4, s[28:31], s73 offen
    s_add_u32 s73, s75, 55360
    buffer_load_dword a236, v4, s[28:31], s73 offen
    s_add_u32 s73, s75, 56512
    buffer_load_dword a237, v4, s[28:31], s73 offen
    s_add_u32 s73, s75, 57664
    buffer_load_dword a238, v4, s[28:31], s73 offen
    s_add_u32 s73, s75, 58816
    buffer_load_dword a239, v4, s[28:31], s73 offen
    v_add_u32 v11, 24576, v10
    ds_read2st64_b32 v[96:97], v11 offset0:0 offset1:1
    ds_read2st64_b32 v[98:99], v11 offset0:2 offset1:3
    ds_read2st64_b32 v[100:101], v11 offset0:16 offset1:17
    ds_read2st64_b32 v[102:103], v11 offset0:18 offset1:19
    ds_read2st64_b32 v[104:105], v11 offset0:32 offset1:33
    ds_read2st64_b32 v[106:107], v11 offset0:34 offset1:35
    ds_read2st64_b32 v[108:109], v11 offset0:48 offset1:49
    ds_read2st64_b32 v[110:111], v11 offset0:50 offset1:51
    s_waitcnt lgkmcnt(0)
    v_perm_b32 v1, v104, v96, s56
    v_perm_b32 v2, v104, v96, s57
    v_accvgpr_write_b32 a176, v1
    v_accvgpr_write_b32 a184, v2
    v_perm_b32 v1, v105, v97, s56
    v_perm_b32 v2, v105, v97, s57
    v_accvgpr_write_b32 a177, v1
    v_accvgpr_write_b32 a185, v2
    v_perm_b32 v1, v106, v98, s56
    v_perm_b32 v2, v106, v98, s57
    v_accvgpr_write_b32 a178, v1
    v_accvgpr_write_b32 a186, v2
    v_perm_b32 v1, v107, v99, s56
    v_perm_b32 v2, v107, v99, s57
    v_accvgpr_write_b32 a179, v1
    v_accvgpr_write_b32 a187, v2
    v_perm_b32 v1, v108, v100, s56
    v_perm_b32 v2, v108, v100, s57
    v_accvgpr_write_b32 a180, v1
    v_accvgpr_write_b32 a188, v2
    v_perm_b32 v1, v109, v101, s56
    v_perm_b32 v2, v109, v101, s57
    v_accvgpr_write_b32 a181, v1
    v_accvgpr_write_b32 a189, v2
    v_perm_b32 v1, v110, v102, s56
    v_perm_b32 v2, v110, v102, s57
    v_accvgpr_write_b32 a182, v1
    v_accvgpr_write_b32 a190, v2
    v_perm_b32 v1, v111, v103, s56
    v_perm_b32 v2, v111, v103, s57
    v_accvgpr_write_b32 a183, v1
    v_accvgpr_write_b32 a191, v2
    s_waitcnt vmcnt(28)
    s_barrier
    s_mov_b32 s73, 0x100000
    s_add_u32 m0, s77, 24576
    s_nop 0
    buffer_load_dwordx4 v9, s[24:27], s73 offen lds
    s_mov_b32 s73, 0x108000
    s_add_u32 m0, s77, 25600
    s_nop 0
    buffer_load_dwordx4 v9, s[24:27], s73 offen lds
    s_mov_b32 s73, 0x110000
    s_add_u32 m0, s77, 26624
    s_nop 0
    buffer_load_dwordx4 v9, s[24:27], s73 offen lds
    s_mov_b32 s73, 0x118000
    s_add_u32 m0, s77, 27648
    s_nop 0
    buffer_load_dwordx4 v9, s[24:27], s73 offen lds
    v_add_u32 v11, 63488, v10
    ds_read2st64_b32 v[96:97], v11 offset0:0 offset1:1
    ds_read2st64_b32 v[98:99], v11 offset0:2 offset1:3
    ds_read2st64_b32 v[100:101], v11 offset0:16 offset1:17
    ds_read2st64_b32 v[102:103], v11 offset0:18 offset1:19
    ds_read2st64_b32 v[104:105], v11 offset0:32 offset1:33
    ds_read2st64_b32 v[106:107], v11 offset0:34 offset1:35
    ds_read2st64_b32 v[108:109], v11 offset0:48 offset1:49
    ds_read2st64_b32 v[110:111], v11 offset0:50 offset1:51
    s_waitcnt lgkmcnt(0)
    v_perm_b32 v1, v104, v96, s56
    v_perm_b32 v2, v104, v96, s57
    v_accvgpr_write_b32 a192, v1
    v_accvgpr_write_b32 a200, v2
    v_perm_b32 v1, v105, v97, s56
    v_perm_b32 v2, v105, v97, s57
    v_accvgpr_write_b32 a193, v1
    v_accvgpr_write_b32 a201, v2
    v_perm_b32 v1, v106, v98, s56
    v_perm_b32 v2, v106, v98, s57
    v_accvgpr_write_b32 a194, v1
    v_accvgpr_write_b32 a202, v2
    v_perm_b32 v1, v107, v99, s56
    v_perm_b32 v2, v107, v99, s57
    v_accvgpr_write_b32 a195, v1
    v_accvgpr_write_b32 a203, v2
    v_perm_b32 v1, v108, v100, s56
    v_perm_b32 v2, v108, v100, s57
    v_accvgpr_write_b32 a196, v1
    v_accvgpr_write_b32 a204, v2
    v_perm_b32 v1, v109, v101, s56
    v_perm_b32 v2, v109, v101, s57
    v_accvgpr_write_b32 a197, v1
    v_accvgpr_write_b32 a205, v2
    v_perm_b32 v1, v110, v102, s56
    v_perm_b32 v2, v110, v102, s57
    v_accvgpr_write_b32 a198, v1
    v_accvgpr_write_b32 a206, v2
    v_perm_b32 v1, v111, v103, s56
    v_perm_b32 v2, v111, v103, s57
    v_accvgpr_write_b32 a199, v1
    v_accvgpr_write_b32 a207, v2
    s_waitcnt vmcnt(28)
    s_barrier
    s_mov_b32 s73, 0x180000
    s_add_u32 m0, s77, 63488
    s_nop 0
    buffer_load_dwordx4 v9, s[24:27], s73 offen lds
    s_mov_b32 s73, 0x188000
    s_add_u32 m0, s77, 64512
    s_nop 0
    buffer_load_dwordx4 v9, s[24:27], s73 offen lds
    s_mov_b32 s73, 0x190000
    s_add_u32 m0, s77, 65536
    s_nop 0
    buffer_load_dwordx4 v9, s[24:27], s73 offen lds
    s_mov_b32 s73, 0x198000
    s_add_u32 m0, s77, 66560
    s_nop 0
    buffer_load_dwordx4 v9, s[24:27], s73 offen lds
    s_add_u32 s73, s75, 73792
    buffer_load_dword a240, v4, s[28:31], s73 offen
    s_add_u32 s73, s75, 74944
    buffer_load_dword a241, v4, s[28:31], s73 offen
    s_add_u32 s73, s75, 76096
    buffer_load_dword a242, v4, s[28:31], s73 offen
    s_add_u32 s73, s75, 77248
    buffer_load_dword a243, v4, s[28:31], s73 offen
    s_add_u32 s73, s75, 92224
    buffer_load_dword a244, v4, s[28:31], s73 offen
    s_add_u32 s73, s75, 93376
    buffer_load_dword a245, v4, s[28:31], s73 offen
    s_add_u32 s73, s75, 94528
    buffer_load_dword a246, v4, s[28:31], s73 offen
    s_add_u32 s73, s75, 95680
    buffer_load_dword a247, v4, s[28:31], s73 offen
    v_add_u32 v11, 102400, v10
    ds_read2st64_b32 v[96:97], v11 offset0:0 offset1:1
    ds_read2st64_b32 v[98:99], v11 offset0:2 offset1:3
    ds_read2st64_b32 v[100:101], v11 offset0:16 offset1:17
    ds_read2st64_b32 v[102:103], v11 offset0:18 offset1:19
    ds_read2st64_b32 v[104:105], v11 offset0:32 offset1:33
    ds_read2st64_b32 v[106:107], v11 offset0:34 offset1:35
    ds_read2st64_b32 v[108:109], v11 offset0:48 offset1:49
    ds_read2st64_b32 v[110:111], v11 offset0:50 offset1:51
    s_waitcnt lgkmcnt(0)
    v_perm_b32 v1, v104, v96, s56
    v_perm_b32 v2, v104, v96, s57
    v_accvgpr_write_b32 a208, v1
    v_accvgpr_write_b32 a216, v2
    v_perm_b32 v1, v105, v97, s56
    v_perm_b32 v2, v105, v97, s57
    v_accvgpr_write_b32 a209, v1
    v_accvgpr_write_b32 a217, v2
    v_perm_b32 v1, v106, v98, s56
    v_perm_b32 v2, v106, v98, s57
    v_accvgpr_write_b32 a210, v1
    v_accvgpr_write_b32 a218, v2
    v_perm_b32 v1, v107, v99, s56
    v_perm_b32 v2, v107, v99, s57
    v_accvgpr_write_b32 a211, v1
    v_accvgpr_write_b32 a219, v2
    v_perm_b32 v1, v108, v100, s56
    v_perm_b32 v2, v108, v100, s57
    v_accvgpr_write_b32 a212, v1
    v_accvgpr_write_b32 a220, v2
    v_perm_b32 v1, v109, v101, s56
    v_perm_b32 v2, v109, v101, s57
    v_accvgpr_write_b32 a213, v1
    v_accvgpr_write_b32 a221, v2
    v_perm_b32 v1, v110, v102, s56
    v_perm_b32 v2, v110, v102, s57
    v_accvgpr_write_b32 a214, v1
    v_accvgpr_write_b32 a222, v2
    v_perm_b32 v1, v111, v103, s56
    v_perm_b32 v2, v111, v103, s57
    v_accvgpr_write_b32 a215, v1
    v_accvgpr_write_b32 a223, v2
    s_waitcnt vmcnt(28)
    s_barrier
    s_mov_b32 s73, 0x200000
    s_add_u32 m0, s77, 102400
    s_nop 0
    buffer_load_dwordx4 v9, s[24:27], s73 offen lds
    s_mov_b32 s73, 0x208000
    s_add_u32 m0, s77, 103424
    s_nop 0
    buffer_load_dwordx4 v9, s[24:27], s73 offen lds
    s_mov_b32 s73, 0x210000
    s_add_u32 m0, s77, 104448
    s_nop 0
    buffer_load_dwordx4 v9, s[24:27], s73 offen lds
    s_mov_b32 s73, 0x218000
    s_add_u32 m0, s77, 105472
    s_nop 0
    buffer_load_dwordx4 v9, s[24:27], s73 offen lds
    v_add_u32 v11, 133120, v10
    ds_read2st64_b32 v[96:97], v11 offset0:0 offset1:1
    ds_read2st64_b32 v[98:99], v11 offset0:2 offset1:3
    ds_read2st64_b32 v[100:101], v11 offset0:16 offset1:17
    ds_read2st64_b32 v[102:103], v11 offset0:18 offset1:19
    ds_read2st64_b32 v[104:105], v11 offset0:32 offset1:33
    ds_read2st64_b32 v[106:107], v11 offset0:34 offset1:35
    ds_read2st64_b32 v[108:109], v11 offset0:48 offset1:49
    ds_read2st64_b32 v[110:111], v11 offset0:50 offset1:51
    s_waitcnt lgkmcnt(0)
    v_perm_b32 v112, v104, v96, s56
    v_perm_b32 v120, v104, v96, s57
    v_perm_b32 v113, v105, v97, s56
    v_perm_b32 v121, v105, v97, s57
    v_perm_b32 v114, v106, v98, s56
    v_perm_b32 v122, v106, v98, s57
    v_perm_b32 v115, v107, v99, s56
    v_perm_b32 v123, v107, v99, s57
    v_perm_b32 v116, v108, v100, s56
    v_perm_b32 v124, v108, v100, s57
    v_perm_b32 v117, v109, v101, s56
    v_perm_b32 v125, v109, v101, s57
    v_perm_b32 v118, v110, v102, s56
    v_perm_b32 v126, v110, v102, s57
    v_perm_b32 v119, v111, v103, s56
    v_perm_b32 v127, v111, v103, s57
    s_waitcnt vmcnt(28)
    s_barrier
    s_mov_b32 s73, 0x280000
    s_add_u32 m0, s77, 133120
    s_nop 0
    buffer_load_dwordx4 v9, s[24:27], s73 offen lds
    s_mov_b32 s73, 0x288000
    s_add_u32 m0, s77, 134144
    s_nop 0
    buffer_load_dwordx4 v9, s[24:27], s73 offen lds
    s_mov_b32 s73, 0x290000
    s_add_u32 m0, s77, 135168
    s_nop 0
    buffer_load_dwordx4 v9, s[24:27], s73 offen lds
    s_mov_b32 s73, 0x298000
    s_add_u32 m0, s77, 136192
    s_nop 0
    buffer_load_dwordx4 v9, s[24:27], s73 offen lds
    s_add_u32 s73, s75, 110656
    buffer_load_dword a248, v4, s[28:31], s73 offen
    s_add_u32 s73, s75, 111808
    buffer_load_dword a249, v4, s[28:31], s73 offen
    s_add_u32 s73, s75, 112960
    buffer_load_dword a250, v4, s[28:31], s73 offen
    s_add_u32 s73, s75, 114112
    buffer_load_dword a251, v4, s[28:31], s73 offen
    s_add_u32 s73, s75, 129088
    buffer_load_dword a252, v4, s[28:31], s73 offen
    s_add_u32 s73, s75, 130240
    buffer_load_dword a253, v4, s[28:31], s73 offen
    s_add_u32 s73, s75, 131392
    buffer_load_dword a254, v4, s[28:31], s73 offen
    s_add_u32 s73, s75, 132544
    buffer_load_dword a255, v4, s[28:31], s73 offen
    v_add_u32_e64 v11, 0, v10
    ds_read2st64_b32 v[96:97], v11 offset0:0 offset1:1
    ds_read2st64_b32 v[98:99], v11 offset0:2 offset1:3
    ds_read2st64_b32 v[100:101], v11 offset0:16 offset1:17
    ds_read2st64_b32 v[102:103], v11 offset0:18 offset1:19
    ds_read2st64_b32 v[104:105], v11 offset0:32 offset1:33
    ds_read2st64_b32 v[106:107], v11 offset0:34 offset1:35
    ds_read2st64_b32 v[108:109], v11 offset0:48 offset1:49
    ds_read2st64_b32 v[110:111], v11 offset0:50 offset1:51
    s_waitcnt lgkmcnt(0)
    v_perm_b32 v128, v104, v96, s56
    v_perm_b32 v136, v104, v96, s57
    v_perm_b32 v129, v105, v97, s56
    v_perm_b32 v137, v105, v97, s57
    v_perm_b32 v130, v106, v98, s56
    v_perm_b32 v138, v106, v98, s57
    v_perm_b32 v131, v107, v99, s56
    v_perm_b32 v139, v107, v99, s57
    v_perm_b32 v132, v108, v100, s56
    v_perm_b32 v140, v108, v100, s57
    v_perm_b32 v133, v109, v101, s56
    v_perm_b32 v141, v109, v101, s57
    v_perm_b32 v134, v110, v102, s56
    v_perm_b32 v142, v110, v102, s57
    v_perm_b32 v135, v111, v103, s56
    v_perm_b32 v143, v111, v103, s57
    s_waitcnt vmcnt(28)
    s_barrier
    s_mov_b32 s73, 0x300000
    s_add_u32 m0, s77, 0
    s_nop 0
    buffer_load_dwordx4 v9, s[24:27], s73 offen lds
    s_mov_b32 s73, 0x308000
    s_add_u32 m0, s77, 1024
    s_nop 0
    buffer_load_dwordx4 v9, s[24:27], s73 offen lds
    s_mov_b32 s73, 0x310000
    s_add_u32 m0, s77, 2048
    s_nop 0
    buffer_load_dwordx4 v9, s[24:27], s73 offen lds
    s_mov_b32 s73, 0x318000
    s_add_u32 m0, s77, 3072
    s_nop 0
    buffer_load_dwordx4 v9, s[24:27], s73 offen lds
    buffer_load_dword v5, off, s[12:15], 0 offset:64 sc1
    v_add_u32 v11, 24576, v10
    ds_read2st64_b32 v[96:97], v11 offset0:0 offset1:1
    ds_read2st64_b32 v[98:99], v11 offset0:2 offset1:3
    ds_read2st64_b32 v[100:101], v11 offset0:16 offset1:17
    ds_read2st64_b32 v[102:103], v11 offset0:18 offset1:19
    ds_read2st64_b32 v[104:105], v11 offset0:32 offset1:33
    ds_read2st64_b32 v[106:107], v11 offset0:34 offset1:35
    ds_read2st64_b32 v[108:109], v11 offset0:48 offset1:49
    ds_read2st64_b32 v[110:111], v11 offset0:50 offset1:51
    s_waitcnt lgkmcnt(0)
    v_perm_b32 v144, v104, v96, s56
    v_perm_b32 v152, v104, v96, s57
    v_perm_b32 v145, v105, v97, s56
    v_perm_b32 v153, v105, v97, s57
    v_perm_b32 v146, v106, v98, s56
    v_perm_b32 v154, v106, v98, s57
    v_perm_b32 v147, v107, v99, s56
    v_perm_b32 v155, v107, v99, s57
    v_perm_b32 v148, v108, v100, s56
    v_perm_b32 v156, v108, v100, s57
    v_perm_b32 v149, v109, v101, s56
    v_perm_b32 v157, v109, v101, s57
    v_perm_b32 v150, v110, v102, s56
    v_perm_b32 v158, v110, v102, s57
    v_perm_b32 v151, v111, v103, s56
    v_perm_b32 v159, v111, v103, s57
    s_waitcnt vmcnt(29)
    s_barrier
    s_mov_b32 s73, 0x380000
    s_add_u32 m0, s77, 24576
    s_nop 0
    buffer_load_dwordx4 v9, s[24:27], s73 offen lds
    s_mov_b32 s73, 0x388000
    s_add_u32 m0, s77, 25600
    s_nop 0
    buffer_load_dwordx4 v9, s[24:27], s73 offen lds
    s_mov_b32 s73, 0x390000
    s_add_u32 m0, s77, 26624
    s_nop 0
    buffer_load_dwordx4 v9, s[24:27], s73 offen lds
    s_mov_b32 s73, 0x398000
    s_add_u32 m0, s77, 27648
    s_nop 0
    buffer_load_dwordx4 v9, s[24:27], s73 offen lds
    s_add_u32 s73, s75, 36992
    buffer_load_dword v80, v4, s[28:31], s73 offen
    s_add_u32 s73, s75, 38144
    buffer_load_dword v81, v4, s[28:31], s73 offen
    s_add_u32 s73, s75, 39296
    buffer_load_dword v82, v4, s[28:31], s73 offen
    s_add_u32 s73, s75, 40448
    buffer_load_dword v83, v4, s[28:31], s73 offen
    s_add_u32 s73, s75, 55424
    buffer_load_dword v84, v4, s[28:31], s73 offen
    s_add_u32 s73, s75, 56576
    buffer_load_dword v85, v4, s[28:31], s73 offen
    s_add_u32 s73, s75, 57728
    buffer_load_dword v86, v4, s[28:31], s73 offen
    s_add_u32 s73, s75, 58880
    buffer_load_dword v87, v4, s[28:31], s73 offen
    v_add_u32 v11, 63488, v10
    ds_read2st64_b32 v[96:97], v11 offset0:0 offset1:1
    ds_read2st64_b32 v[98:99], v11 offset0:2 offset1:3
    ds_read2st64_b32 v[100:101], v11 offset0:16 offset1:17
    ds_read2st64_b32 v[102:103], v11 offset0:18 offset1:19
    ds_read2st64_b32 v[104:105], v11 offset0:32 offset1:33
    ds_read2st64_b32 v[106:107], v11 offset0:34 offset1:35
    ds_read2st64_b32 v[108:109], v11 offset0:48 offset1:49
    ds_read2st64_b32 v[110:111], v11 offset0:50 offset1:51
    s_waitcnt lgkmcnt(0)
    v_perm_b32 v160, v104, v96, s56
    v_perm_b32 v168, v104, v96, s57
    v_perm_b32 v161, v105, v97, s56
    v_perm_b32 v169, v105, v97, s57
    v_perm_b32 v162, v106, v98, s56
    v_perm_b32 v170, v106, v98, s57
    v_perm_b32 v163, v107, v99, s56
    v_perm_b32 v171, v107, v99, s57
    v_perm_b32 v164, v108, v100, s56
    v_perm_b32 v172, v108, v100, s57
    v_perm_b32 v165, v109, v101, s56
    v_perm_b32 v173, v109, v101, s57
    v_perm_b32 v166, v110, v102, s56
    v_perm_b32 v174, v110, v102, s57
    v_perm_b32 v167, v111, v103, s56
    v_perm_b32 v175, v111, v103, s57
    s_waitcnt vmcnt(29)
    s_barrier
    s_mov_b32 s73, 0x400000
    s_add_u32 m0, s77, 63488
    s_nop 0
    buffer_load_dwordx4 v9, s[24:27], s73 offen lds
    s_mov_b32 s73, 0x408000
    s_add_u32 m0, s77, 64512
    s_nop 0
    buffer_load_dwordx4 v9, s[24:27], s73 offen lds
    s_mov_b32 s73, 0x410000
    s_add_u32 m0, s77, 65536
    s_nop 0
    buffer_load_dwordx4 v9, s[24:27], s73 offen lds
    s_mov_b32 s73, 0x418000
    s_add_u32 m0, s77, 66560
    s_nop 0
    buffer_load_dwordx4 v9, s[24:27], s73 offen lds
    v_add_u32 v11, 102400, v10
    ds_read2st64_b32 v[96:97], v11 offset0:0 offset1:1
    ds_read2st64_b32 v[98:99], v11 offset0:2 offset1:3
    ds_read2st64_b32 v[100:101], v11 offset0:16 offset1:17
    ds_read2st64_b32 v[102:103], v11 offset0:18 offset1:19
    ds_read2st64_b32 v[104:105], v11 offset0:32 offset1:33
    ds_read2st64_b32 v[106:107], v11 offset0:34 offset1:35
    ds_read2st64_b32 v[108:109], v11 offset0:48 offset1:49
    ds_read2st64_b32 v[110:111], v11 offset0:50 offset1:51
    s_waitcnt lgkmcnt(0)
    v_perm_b32 v176, v104, v96, s56
    v_perm_b32 v184, v104, v96, s57
    v_perm_b32 v177, v105, v97, s56
    v_perm_b32 v185, v105, v97, s57
    v_perm_b32 v178, v106, v98, s56
    v_perm_b32 v186, v106, v98, s57
    v_perm_b32 v179, v107, v99, s56
    v_perm_b32 v187, v107, v99, s57
    v_perm_b32 v180, v108, v100, s56
    v_perm_b32 v188, v108, v100, s57
    v_perm_b32 v181, v109, v101, s56
    v_perm_b32 v189, v109, v101, s57
    v_perm_b32 v182, v110, v102, s56
    v_perm_b32 v190, v110, v102, s57
    v_perm_b32 v183, v111, v103, s56
    v_perm_b32 v191, v111, v103, s57
    s_waitcnt vmcnt(29)
    s_barrier
    s_mov_b32 s73, 0x0
    s_add_u32 m0, s77, 102400
    s_nop 0
    buffer_load_dwordx4 v8, s[16:19], s73 offen lds
    s_mov_b32 s73, 0x8000
    s_add_u32 m0, s77, 103424
    s_nop 0
    buffer_load_dwordx4 v8, s[16:19], s73 offen lds
    s_mov_b32 s73, 0x10000
    s_add_u32 m0, s77, 104448
    s_nop 0
    buffer_load_dwordx4 v8, s[16:19], s73 offen lds
    s_mov_b32 s73, 0x18000
    s_add_u32 m0, s77, 105472
    s_nop 0
    buffer_load_dwordx4 v8, s[16:19], s73 offen lds
    s_add_u32 s73, s75, 73856
    s_add_u32 m0, s76, 8192
    s_nop 0
    buffer_load_dword v3, s[28:31], s73 offen lds
    s_add_u32 s73, s75, 78464
    s_add_u32 m0, s76, 8448
    s_nop 0
    buffer_load_dword v3, s[28:31], s73 offen lds
    s_add_u32 s73, s75, 83072
    s_add_u32 m0, s76, 8704
    s_nop 0
    buffer_load_dword v3, s[28:31], s73 offen lds
    s_add_u32 s73, s75, 87680
    s_add_u32 m0, s76, 8960
    s_nop 0
    buffer_load_dword v3, s[28:31], s73 offen lds
    s_add_u32 s73, s75, 92288
    s_add_u32 m0, s76, 9216
    s_nop 0
    buffer_load_dword v3, s[28:31], s73 offen lds
    s_add_u32 s73, s75, 96896
    s_add_u32 m0, s76, 9472
    s_nop 0
    buffer_load_dword v3, s[28:31], s73 offen lds
    s_add_u32 s73, s75, 101504
    s_add_u32 m0, s76, 9728
    s_nop 0
    buffer_load_dword v3, s[28:31], s73 offen lds
    s_add_u32 s73, s75, 106112
    s_add_u32 m0, s76, 9984
    s_nop 0
    buffer_load_dword v3, s[28:31], s73 offen lds
    v_add_u32 v11, 133120, v10
    ds_read2st64_b32 v[96:97], v11 offset0:0 offset1:1
    ds_read2st64_b32 v[98:99], v11 offset0:2 offset1:3
    ds_read2st64_b32 v[100:101], v11 offset0:16 offset1:17
    ds_read2st64_b32 v[102:103], v11 offset0:18 offset1:19
    ds_read2st64_b32 v[104:105], v11 offset0:32 offset1:33
    ds_read2st64_b32 v[106:107], v11 offset0:34 offset1:35
    ds_read2st64_b32 v[108:109], v11 offset0:48 offset1:49
    ds_read2st64_b32 v[110:111], v11 offset0:50 offset1:51
    s_waitcnt lgkmcnt(0)
    v_perm_b32 v192, v104, v96, s56
    v_perm_b32 v200, v104, v96, s57
    v_perm_b32 v193, v105, v97, s56
    v_perm_b32 v201, v105, v97, s57
    v_perm_b32 v194, v106, v98, s56
    v_perm_b32 v202, v106, v98, s57
    v_perm_b32 v195, v107, v99, s56
    v_perm_b32 v203, v107, v99, s57
    v_perm_b32 v196, v108, v100, s56
    v_perm_b32 v204, v108, v100, s57
    v_perm_b32 v197, v109, v101, s56
    v_perm_b32 v205, v109, v101, s57
    v_perm_b32 v198, v110, v102, s56
    v_perm_b32 v206, v110, v102, s57
    v_perm_b32 v199, v111, v103, s56
    v_perm_b32 v207, v111, v103, s57
    s_waitcnt vmcnt(29)
    s_barrier
    s_mov_b32 s73, 0x40000
    s_add_u32 m0, s77, 133120
    s_nop 0
    buffer_load_dwordx4 v8, s[16:19], s73 offen lds
    s_mov_b32 s73, 0x48000
    s_add_u32 m0, s77, 134144
    s_nop 0
    buffer_load_dwordx4 v8, s[16:19], s73 offen lds
    s_mov_b32 s73, 0x50000
    s_add_u32 m0, s77, 135168
    s_nop 0
    buffer_load_dwordx4 v8, s[16:19], s73 offen lds
    s_mov_b32 s73, 0x58000
    s_add_u32 m0, s77, 136192
    s_nop 0
    buffer_load_dwordx4 v8, s[16:19], s73 offen lds
    v_add_u32 v11, 0, v10
    ds_read2st64_b32 v[96:97], v11 offset0:0 offset1:1
    ds_read2st64_b32 v[98:99], v11 offset0:2 offset1:3
    ds_read2st64_b32 v[100:101], v11 offset0:16 offset1:17
    ds_read2st64_b32 v[102:103], v11 offset0:18 offset1:19
    ds_read2st64_b32 v[104:105], v11 offset0:32 offset1:33
    ds_read2st64_b32 v[106:107], v11 offset0:34 offset1:35
    ds_read2st64_b32 v[108:109], v11 offset0:48 offset1:49
    ds_read2st64_b32 v[110:111], v11 offset0:50 offset1:51
    s_waitcnt lgkmcnt(0)
    v_perm_b32 v208, v104, v96, s56
    v_perm_b32 v216, v104, v96, s57
    v_perm_b32 v209, v105, v97, s56
    v_perm_b32 v217, v105, v97, s57
    v_perm_b32 v210, v106, v98, s56
    v_perm_b32 v218, v106, v98, s57
    v_perm_b32 v211, v107, v99, s56
    v_perm_b32 v219, v107, v99, s57
    v_perm_b32 v212, v108, v100, s56
    v_perm_b32 v220, v108, v100, s57
    v_perm_b32 v213, v109, v101, s56
    v_perm_b32 v221, v109, v101, s57
    v_perm_b32 v214, v110, v102, s56
    v_perm_b32 v222, v110, v102, s57
    v_perm_b32 v215, v111, v103, s56
    v_perm_b32 v223, v111, v103, s57
    s_waitcnt vmcnt(28)
    s_barrier
    s_mov_b32 s73, 0x80000
    s_add_u32 m0, s77, 0
    s_nop 0
    buffer_load_dwordx4 v8, s[16:19], s73 offen lds
    s_mov_b32 s73, 0x88000
    s_add_u32 m0, s77, 1024
    s_nop 0
    buffer_load_dwordx4 v8, s[16:19], s73 offen lds
    s_mov_b32 s73, 0x90000
    s_add_u32 m0, s77, 2048
    s_nop 0
    buffer_load_dwordx4 v8, s[16:19], s73 offen lds
    s_mov_b32 s73, 0x98000
    s_add_u32 m0, s77, 3072
    s_nop 0
    buffer_load_dwordx4 v8, s[16:19], s73 offen lds
    v_cmp_ne_u32 vcc, 0x100, v5
    s_cbranch_vccz L_iok_2
    s_mov_b32 s40, 0
L_ilp_3:
    s_add_u32 s40, s40, 1
    s_cmp_gt_u32 s40, 0x100000
    s_cbranch_scc1 L_abort
    buffer_load_dword v5, off, s[12:15], 0 offset:64 sc1
    s_waitcnt vmcnt(0)
    v_cmp_ne_u32 vcc, 0x100, v5
    s_cbranch_vccnz L_ilp_3
L_iok_2:
    v_and_b32 v1, 31, v0
    v_lshlrev_b32 v1, 7, v1
    v_lshrrev_b32 v2, 5, v0
    v_mul_u32_u24 v2, 327680, v2
    v_add_u32 v1, v1, v2
    v_and_b32 v2, 3, v0
    v_mul_u32_u24 v2, 9216, v2
    buffer_load_dword v15, v1, s[8:11], s5 offen sc1
    buffer_load_dword v15, v2, s[8:11], s6 offen sc1
    buffer_load_dword v15, off, s[12:15], 0 sc1
    s_add_u32 s73, s75, 110720
    s_add_u32 m0, s76, 10240
    s_nop 0
    buffer_load_dword v3, s[28:31], s73 offen lds
    s_add_u32 s73, s75, 115328
    s_add_u32 m0, s76, 10496
    s_nop 0
    buffer_load_dword v3, s[28:31], s73 offen lds
    s_add_u32 s73, s75, 119936
    s_add_u32 m0, s76, 10752
    s_nop 0
    buffer_load_dword v3, s[28:31], s73 offen lds
    s_add_u32 s73, s75, 124544
    s_add_u32 m0, s76, 11008
    s_nop 0
    buffer_load_dword v3, s[28:31], s73 offen lds
    s_add_u32 s73, s75, 129152
    s_add_u32 m0, s76, 11264
    s_nop 0
    buffer_load_dword v3, s[28:31], s73 offen lds
    s_add_u32 s73, s75, 133760
    s_add_u32 m0, s76, 11520
    s_nop 0
    buffer_load_dword v3, s[28:31], s73 offen lds
    s_add_u32 s73, s75, 138368
    s_add_u32 m0, s76, 11776
    s_nop 0
    buffer_load_dword v3, s[28:31], s73 offen lds
    s_add_u32 s73, s75, 142976
    s_add_u32 m0, s76, 12032
    s_nop 0
    buffer_load_dword v3, s[28:31], s73 offen lds
    v_add_u32 v11, 24576, v10
    ds_read2st64_b32 v[96:97], v11 offset0:0 offset1:1
    ds_read2st64_b32 v[98:99], v11 offset0:2 offset1:3
    ds_read2st64_b32 v[100:101], v11 offset0:16 offset1:17
    ds_read2st64_b32 v[102:103], v11 offset0:18 offset1:19
    ds_read2st64_b32 v[104:105], v11 offset0:32 offset1:33
    ds_read2st64_b32 v[106:107], v11 offset0:34 offset1:35
    ds_read2st64_b32 v[108:109], v11 offset0:48 offset1:49
    ds_read2st64_b32 v[110:111], v11 offset0:50 offset1:51
    s_waitcnt lgkmcnt(0)
    v_perm_b32 v224, v104, v96, s56
    v_perm_b32 v232, v104, v96, s57
    v_perm_b32 v225, v105, v97, s56
    v_perm_b32 v233, v105, v97, s57
    v_perm_b32 v226, v106, v98, s56
    v_perm_b32 v234, v106, v98, s57
    v_perm_b32 v227, v107, v99, s56
    v_perm_b32 v235, v107, v99, s57
    v_perm_b32 v228, v108, v100, s56
    v_perm_b32 v236, v108, v100, s57
    v_perm_b32 v229, v109, v101, s56
    v_perm_b32 v237, v109, v101, s57
    v_perm_b32 v230, v110, v102, s56
    v_perm_b32 v238, v110, v102, s57
    v_perm_b32 v231, v111, v103, s56
    v_perm_b32 v239, v111, v103, s57
    s_waitcnt vmcnt(31)
    s_barrier
    s_mov_b32 s73, 0xc0000
    s_add_u32 m0, s77, 24576
    s_nop 0
    buffer_load_dwordx4 v8, s[16:19], s73 offen lds
    s_mov_b32 s73, 0xc8000
    s_add_u32 m0, s77, 25600
    s_nop 0
    buffer_load_dwordx4 v8, s[16:19], s73 offen lds
    s_mov_b32 s73, 0xd0000
    s_add_u32 m0, s77, 26624
    s_nop 0
    buffer_load_dwordx4 v8, s[16:19], s73 offen lds
    s_mov_b32 s73, 0xd8000
    s_add_u32 m0, s77, 27648
    s_nop 0
    buffer_load_dwordx4 v8, s[16:19], s73 offen lds
    v_add_u32 v11, 63488, v10
    ds_read2st64_b32 v[96:97], v11 offset0:0 offset1:1
    ds_read2st64_b32 v[98:99], v11 offset0:2 offset1:3
    ds_read2st64_b32 v[100:101], v11 offset0:16 offset1:17
    ds_read2st64_b32 v[102:103], v11 offset0:18 offset1:19
    ds_read2st64_b32 v[104:105], v11 offset0:32 offset1:33
    ds_read2st64_b32 v[106:107], v11 offset0:34 offset1:35
    ds_read2st64_b32 v[108:109], v11 offset0:48 offset1:49
    ds_read2st64_b32 v[110:111], v11 offset0:50 offset1:51
    s_waitcnt lgkmcnt(0)
    v_perm_b32 v240, v104, v96, s56
    v_perm_b32 v248, v104, v96, s57
    v_perm_b32 v241, v105, v97, s56
    v_perm_b32 v249, v105, v97, s57
    v_perm_b32 v242, v106, v98, s56
    v_perm_b32 v250, v106, v98, s57
    v_perm_b32 v243, v107, v99, s56
    v_perm_b32 v251, v107, v99, s57
    v_perm_b32 v244, v108, v100, s56
    v_perm_b32 v252, v108, v100, s57
    v_perm_b32 v245, v109, v101, s56
    v_perm_b32 v253, v109, v101, s57
    v_perm_b32 v246, v110, v102, s56
    v_perm_b32 v254, v110, v102, s57
    v_perm_b32 v247, v111, v103, s56
    v_perm_b32 v255, v111, v103, s57
    s_waitcnt vmcnt(31)
    s_barrier
    s_add_u32 s73, s75, 192
    s_add_u32 m0, s76, 12288
    s_nop 0
    buffer_load_dword v3, s[28:31], s73 offen lds
    s_add_u32 s73, s75, 4800
    s_add_u32 m0, s76, 12544
    s_nop 0
    buffer_load_dword v3, s[28:31], s73 offen lds
    s_add_u32 s73, s75, 9408
    s_add_u32 m0, s76, 12800
    s_nop 0
    buffer_load_dword v3, s[28:31], s73 offen lds
    s_add_u32 s73, s75, 14016
    s_add_u32 m0, s76, 13056
    s_nop 0
    buffer_load_dword v3, s[28:31], s73 offen lds
    s_add_u32 s73, s75, 18624
    s_add_u32 m0, s76, 13312
    s_nop 0
    buffer_load_dword v3, s[28:31], s73 offen lds
    s_add_u32 s73, s75, 23232
    s_add_u32 m0, s76, 13568
    s_nop 0
    buffer_load_dword v3, s[28:31], s73 offen lds
    s_add_u32 s73, s75, 27840
    s_add_u32 m0, s76, 13824
    s_nop 0
    buffer_load_dword v3, s[28:31], s73 offen lds
    s_add_u32 s73, s75, 32448
    s_add_u32 m0, s76, 14080
    s_nop 0
    buffer_load_dword v3, s[28:31], s73 offen lds
    v_add_u32 v11, 102400, v10
    ds_read2st64_b32 v[96:97], v11 offset0:0 offset1:1
    ds_read2st64_b32 v[98:99], v11 offset0:2 offset1:3
    ds_read2st64_b32 v[100:101], v11 offset0:16 offset1:17
    ds_read2st64_b32 v[102:103], v11 offset0:18 offset1:19
    ds_read2st64_b32 v[104:105], v11 offset0:32 offset1:33
    ds_read2st64_b32 v[106:107], v11 offset0:34 offset1:35
    ds_read2st64_b32 v[108:109], v11 offset0:48 offset1:49
    ds_read2st64_b32 v[110:111], v11 offset0:50 offset1:51
    s_waitcnt lgkmcnt(0)
    v_perm_b32 v16, v104, v96, s56
    v_perm_b32 v24, v104, v96, s57
    v_perm_b32 v17, v105, v97, s56
    v_perm_b32 v25, v105, v97, s57
    v_perm_b32 v18, v106, v98, s56
    v_perm_b32 v26, v106, v98, s57
    v_perm_b32 v19, v107, v99, s56
    v_perm_b32 v27, v107, v99, s57
    v_perm_b32 v20, v108, v100, s56
    v_perm_b32 v28, v108, v100, s57
    v_perm_b32 v21, v109, v101, s56
    v_perm_b32 v29, v109, v101, s57
    v_perm_b32 v22, v110, v102, s56
    v_perm_b32 v30, v110, v102, s57
    v_perm_b32 v23, v111, v103, s56
    v_perm_b32 v31, v111, v103, s57
    s_waitcnt vmcnt(27)
    s_barrier
    v_add_u32 v11, 133120, v10
    ds_read2st64_b32 v[96:97], v11 offset0:0 offset1:1
    ds_read2st64_b32 v[98:99], v11 offset0:2 offset1:3
    ds_read2st64_b32 v[100:101], v11 offset0:16 offset1:17
    ds_read2st64_b32 v[102:103], v11 offset0:18 offset1:19
    ds_read2st64_b32 v[104:105], v11 offset0:32 offset1:33
    ds_read2st64_b32 v[106:107], v11 offset0:34 offset1:35
    ds_read2st64_b32 v[108:109], v11 offset0:48 offset1:49
    ds_read2st64_b32 v[110:111], v11 offset0:50 offset1:51
    s_waitcnt lgkmcnt(0)
    v_perm_b32 v32, v104, v96, s56
    v_perm_b32 v40, v104, v96, s57
    v_perm_b32 v33, v105, v97, s56
    v_perm_b32 v41, v105, v97, s57
    v_perm_b32 v34, v106, v98, s56
    v_perm_b32 v42, v106, v98, s57
    v_perm_b32 v35, v107, v99, s56
    v_perm_b32 v43, v107, v99, s57
    v_perm_b32 v36, v108, v100, s56
    v_perm_b32 v44, v108, v100, s57
    v_perm_b32 v37, v109, v101, s56
    v_perm_b32 v45, v109, v101, s57
    v_perm_b32 v38, v110, v102, s56
    v_perm_b32 v46, v110, v102, s57
    v_perm_b32 v39, v111, v103, s56
    v_perm_b32 v47, v111, v103, s57
    s_waitcnt vmcnt(23)
    s_barrier
    s_add_u32 s73, s75, 37056
    buffer_load_dword v88, v4, s[28:31], s73 offen
    s_add_u32 s73, s75, 38208
    buffer_load_dword v89, v4, s[28:31], s73 offen
    s_add_u32 s73, s75, 39360
    buffer_load_dword v90, v4, s[28:31], s73 offen
    s_add_u32 s73, s75, 40512
    buffer_load_dword v91, v4, s[28:31], s73 offen
    s_add_u32 s73, s75, 55488
    buffer_load_dword v92, v4, s[28:31], s73 offen
    s_add_u32 s73, s75, 56640
    buffer_load_dword v93, v4, s[28:31], s73 offen
    s_add_u32 s73, s75, 57792
    buffer_load_dword v94, v4, s[28:31], s73 offen
    s_add_u32 s73, s75, 58944
    buffer_load_dword v95, v4, s[28:31], s73 offen
    v_add_u32 v11, 0, v10
    ds_read2st64_b32 v[96:97], v11 offset0:0 offset1:1
    ds_read2st64_b32 v[98:99], v11 offset0:2 offset1:3
    ds_read2st64_b32 v[100:101], v11 offset0:16 offset1:17
    ds_read2st64_b32 v[102:103], v11 offset0:18 offset1:19
    ds_read2st64_b32 v[104:105], v11 offset0:32 offset1:33
    ds_read2st64_b32 v[106:107], v11 offset0:34 offset1:35
    ds_read2st64_b32 v[108:109], v11 offset0:48 offset1:49
    ds_read2st64_b32 v[110:111], v11 offset0:50 offset1:51
    s_waitcnt lgkmcnt(0)
    v_perm_b32 v48, v104, v96, s56
    v_perm_b32 v56, v104, v96, s57
    v_perm_b32 v49, v105, v97, s56
    v_perm_b32 v57, v105, v97, s57
    v_perm_b32 v50, v106, v98, s56
    v_perm_b32 v58, v106, v98, s57
    v_perm_b32 v51, v107, v99, s56
    v_perm_b32 v59, v107, v99, s57
    v_perm_b32 v52, v108, v100, s56
    v_perm_b32 v60, v108, v100, s57
    v_perm_b32 v53, v109, v101, s56
    v_perm_b32 v61, v109, v101, s57
    v_perm_b32 v54, v110, v102, s56
    v_perm_b32 v62, v110, v102, s57
    v_perm_b32 v55, v111, v103, s56
    v_perm_b32 v63, v111, v103, s57
    s_waitcnt vmcnt(16)
    s_barrier
    v_add_u32 v11, 24576, v10
    ds_read2st64_b32 v[96:97], v11 offset0:0 offset1:1
    ds_read2st64_b32 v[98:99], v11 offset0:2 offset1:3
    ds_read2st64_b32 v[100:101], v11 offset0:16 offset1:17
    ds_read2st64_b32 v[102:103], v11 offset0:18 offset1:19
    ds_read2st64_b32 v[104:105], v11 offset0:32 offset1:33
    ds_read2st64_b32 v[106:107], v11 offset0:34 offset1:35
    ds_read2st64_b32 v[108:109], v11 offset0:48 offset1:49
    ds_read2st64_b32 v[110:111], v11 offset0:50 offset1:51
    s_waitcnt lgkmcnt(0)
    v_perm_b32 v64, v104, v96, s56
    v_perm_b32 v72, v104, v96, s57
    v_perm_b32 v65, v105, v97, s56
    v_perm_b32 v73, v105, v97, s57
    v_perm_b32 v66, v106, v98, s56
    v_perm_b32 v74, v106, v98, s57
    v_perm_b32 v67, v107, v99, s56
    v_perm_b32 v75, v107, v99, s57
    v_perm_b32 v68, v108, v100, s56
    v_perm_b32 v76, v108, v100, s57
    v_perm_b32 v69, v109, v101, s56
    v_perm_b32 v77, v109, v101, s57
    v_perm_b32 v70, v110, v102, s56
    v_perm_b32 v78, v110, v102, s57
    v_perm_b32 v71, v111, v103, s56
    v_perm_b32 v79, v111, v103, s57
    v_readfirstlane_b32 s2, v15
    s_barrier
    ds_write_b128 v7, v[16:19] offset:0
    ds_write_b128 v7, v[20:23] offset:1024
    ds_write_b128 v7, v[24:27] offset:2048
    ds_write_b128 v7, v[28:31] offset:3072
    ds_write_b128 v7, v[32:35] offset:4096
    ds_write_b128 v7, v[36:39] offset:5120
    ds_write_b128 v7, v[40:43] offset:6144
    ds_write_b128 v7, v[44:47] offset:7168
    ds_write_b128 v7, v[48:51] offset:8192
    ds_write_b128 v7, v[52:55] offset:9216
    ds_write_b128 v7, v[56:59] offset:10240
    ds_write_b128 v7, v[60:63] offset:11264
    ds_write_b128 v7, v[64:67] offset:12288
    ds_write_b128 v7, v[68:71] offset:13312
    ds_write_b128 v7, v[72:75] offset:14336
    ds_write_b128 v7, v[76:79] offset:15360
    s_waitcnt lgkmcnt(0)
    s_add_u32 s73, s75, 128
    buffer_load_dword v72, v4, s[28:31], s73 offen
    s_add_u32 s73, s75, 1280
    buffer_load_dword v73, v4, s[28:31], s73 offen
    s_add_u32 s73, s75, 2432
    buffer_load_dword v74, v4, s[28:31], s73 offen
    s_add_u32 s73, s75, 3584
    buffer_load_dword v75, v4, s[28:31], s73 offen
    s_add_u32 s73, s75, 18560
    buffer_load_dword v76, v4, s[28:31], s73 offen
    s_add_u32 s73, s75, 19712
    buffer_load_dword v77, v4, s[28:31], s73 offen
    s_add_u32 s73, s75, 20864
    buffer_load_dword v78, v4, s[28:31], s73 offen
    s_add_u32 s73, s75, 22016
    buffer_load_dword v79, v4, s[28:31], s73 offen
    s_add_u32 s73, s75, 73920
    buffer_load_dword v96, v4, s[28:31], s73 offen
    s_add_u32 s73, s75, 75072
    buffer_load_dword v97, v4, s[28:31], s73 offen
    s_add_u32 s73, s75, 76224
    buffer_load_dword v98, v4, s[28:31], s73 offen
    s_add_u32 s73, s75, 77376
    buffer_load_dword v99, v4, s[28:31], s73 offen
    s_add_u32 s73, s75, 92352
    buffer_load_dword v100, v4, s[28:31], s73 offen
    s_add_u32 s73, s75, 93504
    buffer_load_dword v101, v4, s[28:31], s73 offen
    s_add_u32 s73, s75, 94656
    buffer_load_dword v102, v4, s[28:31], s73 offen
    s_add_u32 s73, s75, 95808
    buffer_load_dword v103, v4, s[28:31], s73 offen
    s_add_u32 s73, s75, 110784
    buffer_load_dword v104, v4, s[28:31], s73 offen
    s_add_u32 s73, s75, 111936
    buffer_load_dword v105, v4, s[28:31], s73 offen
    s_add_u32 s73, s75, 113088
    buffer_load_dword v106, v4, s[28:31], s73 offen
    s_add_u32 s73, s75, 114240
    buffer_load_dword v107, v4, s[28:31], s73 offen
    s_add_u32 s73, s75, 129216
    buffer_load_dword v108, v4, s[28:31], s73 offen
    s_add_u32 s73, s75, 130368
    buffer_load_dword v109, v4, s[28:31], s73 offen
    s_add_u32 s73, s75, 131520
    buffer_load_dword v110, v4, s[28:31], s73 offen
    s_add_u32 s73, s75, 132672
    buffer_load_dword v111, v4, s[28:31], s73 offen
    v_cmp_gt_u32_e64 vcc, 8, v12
    s_nop 0
    s_mov_b64 s[58:59], vcc
    v_mov_b32 v1, 0xdddddddd
    v_mov_b32 v2, 0x88888888
    v_cndmask_b32 v1, v1, v2, vcc
    v_lshlrev_b32 v2, 7, v13
    v_lshl_add_u32 v2, v14, 4, v2
    v_mul_u32_u24 v3, 288, v12
    v_lshl_add_u32 v3, v13, 4, v3
    v_mul_u32_u24 v4, 1152, v13
    v_lshl_add_u32 v4, v12, 2, v4
    s_add_u32 s74, s47, 9216
    v_add_u32 v4, s74, v4
    v_lshrrev_b32 v16, 3, v12
    v_lshl_add_u32 v5, v16, 9, v2
    v_and_b32 v24, 0x70, v6
    v_bfe_u32 v25, v6, 8, 1
    v_lshl_add_u32 v24, v25, 3, v24
    v_lshrrev_b32_e64 v25, 9, v6
    v_lshl_add_u32 v24, v25, 2, v24
    s_mul_i32 s71, s32, 2304
    v_lshrrev_b32_e64 v18, 1, v14
    v_cmp_eq_u32 s[60:61], 0, v18
    v_cmp_eq_u32 s[62:63], 1, v18
    v_cmp_eq_u32 s[64:65], 2, v18
    v_cmp_eq_u32 s[66:67], 3, v18
    s_mov_b32 s78, 0x3e0293ee
    s_mov_b32 s79, 0x3e0293ee
    s_mov_b32 s68, 0xbe0293ee
    s_mov_b32 s34, 0x3f803f80
    s_mov_b32 s35, 0x3f803f80
    s_mov_b32 s30, 0x3f003f00
    s_mov_b32 s31, 0x3f003f00
    s_mov_b32 s7, 0
    s_lshl_b32 s73, s41, 7
    s_lshl_b32 s4, s72, 14
    s_add_u32 s4, s4, s73
    s_add_u32 s4, s4, 0x150000
    s_mov_b32 s24, 1
    s_lshl_b32 s49, s32, 10
    s_add_u32 s49, s49, 16384
L_c_rdy:
    s_cmp_lt_u32 s2, 32
    s_cbranch_scc1 L_c_slow
    s_mov_b32 s42, 0
    s_and_b32 s73, s7, 3
    s_xor_b32 s74, s73, 2
    s_mul_i32 s37, s74, 9216
    s_add_u32 s37, s37, s6
L_cf_layer:
    s_mov_b32 s43, 0
    s_mov_b32 s39, 0x70000000
    s_mul_i32 s73, s42, 589824
    s_add_u32 s44, s73, 0x20000
    s_add_u32 s44, s44, s71
    s_add_u32 s73, s73, s6
    s_sub_u32 s51, s73, 0x120000
    s_lshl_b32 s73, s42, 24
    s_lshl_b32 s74, s41, 13
    s_add_u32 s73, s73, s74
    s_lshl_b32 s74, s32, 10
    s_add_u32 s73, s73, s74
    s_add_u32 s45, s73, 0x2000000
    s_add_u32 s73, s73, s74
    s_add_u32 s46, s73, 0x4000000
    s_lshl_b32 s73, s42, 20
    s_lshl_b32 s74, s41, 13
    s_add_u32 s73, s73, s74
    s_add_u32 s52, s73, 0x1810000
    s_mov_b32 s40, 0
L_f0l_4:
    s_add_u32 s40, s40, 1
    s_cmp_gt_u32 s40, 0x100000
    s_cbranch_scc1 L_abort
    s_sleep 1
    buffer_load_dword v60, off, s[8:11], s52 sc1
    buffer_load_dword v0, off, s[8:11], s52 offset:128 sc1
    s_waitcnt vmcnt(0)
    v_cmp_eq_u32_e64 vcc, 0, v60
    s_cbranch_vccnz L_f0l_4
    v_readfirstlane_b32 s3, v0
    s_barrier
    s_add_u32 m0, s49, 0
    s_nop 0
    buffer_load_dwordx4 v6, s[8:11], s45 offen sc1 lds
    s_add_u32 m0, s49, 4096
    s_add_u32 s75, s45, 4096
    buffer_load_dwordx4 v6, s[8:11], s75 offen sc1 lds
    s_add_u32 s45, s45, 262144
    s_add_u32 s52, s52, 128
L_cf_top:
    v_lshrrev_b32_e64 v70, 2, v6
    ds_read_b128 v[36:39], v7 offset:0
    ds_read_b128 v[40:43], v7 offset:1024
    ds_read_b128 v[44:47], v7 offset:2048
    ds_read_b128 v[48:51], v7 offset:3072
    s_nop 11
    buffer_load_dwordx4 v[52:55], v6, s[8:11], s44 offen sc1
    buffer_load_dwordx4 v[56:59], v6, s[8:11], s44 offen offset:1024 sc1
    buffer_load_dword v68, v70, s[8:11], s44 offen offset:2048 sc1
    v_add_u32 v69, s71, v70
    v_and_b32 v26, 0xf0, v6
    v_lshlrev_b32_e64 v26, 3, v26
    v_and_b32 v27, 0x100, v6
    v_lshl_add_u32 v26, v27, 17, v26
    v_mov_b32 v25, -1
    v_mov_b64 v[16:17], 0
    v_mov_b64 v[18:19], 0
    v_mov_b64 v[20:21], 0
    v_mov_b64 v[22:23], 0
    v_mov_b64 v[8:9], 0
    v_mov_b64 v[10:11], 0
    v_mov_b64 v[12:13], 0
    v_mov_b64_e64 v[14:15], 0
    s_bitcmp1_b32 s7, 0
    s_cselect_b32 s69, 327680, 0
    s_bfe_u32 s38, s7, 0x10001
    s_add_u32 s16, s4, s69
    s_add_u32 s17, s16, 16384
    s_add_u32 s18, s16, 32768
    s_add_u32 s19, s16, 49152
    s_add_u32 s20, s16, 65536
    s_add_u32 s48, s5, s69
    s_sub_u32 s24, s46, 0x1fc0000
    s_cmp_eq_u32 s3, 0
    s_cselect_b32 s24, 0x70000000, s24
    s_mov_b32 s40, 0
    s_waitcnt vmcnt(3)
    v_add_u32 v60, s71, v6
L_hb_6:
    buffer_load_dwordx4 v[52:55], v6, s[8:11], s44 offen sc1
    buffer_load_dwordx4 v[56:59], v6, s[8:11], s44 offen offset:1024 sc1
    buffer_load_dword v68, v70, s[8:11], s44 offen offset:2048 sc1
    s_add_u32 s40, s40, 1
    s_cmp_gt_u32 s40, 0x100000
    s_cbranch_scc1 L_abort
    s_waitcnt vmcnt(5)
    v_max3_u32 v71, v52, v53, v54
    v_max_u32 v71, v71, v55
    ds_write_b128 v60, v[52:55]
    s_waitcnt vmcnt(4)
    v_max3_u32 v71, v71, v56, v57
    v_max3_u32 v71, v71, v58, v59
    ds_write_b128 v60, v[56:59] offset:1024
    s_waitcnt vmcnt(3)
    v_max_u32 v71, v71, v68
    ds_write_b32 v69, v68 offset:2048
    v_cmp_eq_u32_e64 vcc, -1, v71
    s_cbranch_vccnz L_hb_6
L_hbok_7:
    s_waitcnt lgkmcnt(0)
    s_barrier
    ds_read_b128 v[60:63], v2 offset:0
    ds_read_b128 v[64:67], v2 offset:2048
    s_waitcnt vmcnt(0)
    ds_read_b128 v[52:55], v2 offset:2560
    ds_read_b128 v[56:59], v2 offset:3072
    ds_read_b128 v[68:71], v2 offset:3584
    buffer_load_dwordx4 v[28:31], v6, s[8:11], s46 offen sc1
    s_waitcnt lgkmcnt(4)
    v_smfmac_f32_16x16x64_bf16 v[16:19], v[60:63], v[36:43], v1
    ds_read_b128 v[36:39], v7 offset:4096
    v_smfmac_f32_16x16x64_bf16 v[20:23], v[60:63], v[44:51], v1
    ds_read_b128 v[60:63], v2 offset:512
    ds_read_b128 v[40:43], v7 offset:5120
    s_waitcnt lgkmcnt(5)
    v_smfmac_f32_16x16x64_bf16 v[16:19], v[64:67], a[0:7], v1
    ds_read_b128 v[44:47], v7 offset:6144
    v_smfmac_f32_16x16x64_bf16 v[20:23], v[64:67], a[8:15], v1
    ds_read_b128 v[64:67], v2 offset:4096
    ds_read_b128 v[48:51], v7 offset:7168
    v_smfmac_f32_16x16x64_bf16 v[16:19], v[52:55], a[16:23], v1
    buffer_load_dwordx4 v[32:35], v6, s[8:11], s46 offen offset:1024 sc1
    v_smfmac_f32_16x16x64_bf16 v[20:23], v[52:55], a[24:31], v1
    ds_read_b128 v[52:55], v2 offset:4608
    s_waitcnt lgkmcnt(7)
    v_smfmac_f32_16x16x64_bf16 v[16:19], v[56:59], a[32:39], v1
    buffer_store_dword v25, v24, s[8:11], s37 offen
    v_smfmac_f32_16x16x64_bf16 v[20:23], v[56:59], a[40:47], v1
    ds_read_b128 v[56:59], v2 offset:5120
    v_smfmac_f32_16x16x64_bf16 v[16:19], v[68:71], a[48:55], v1
    buffer_store_dword v0, v24, s[8:11], s39 offen sc1
    v_smfmac_f32_16x16x64_bf16 v[20:23], v[68:71], a[56:63], v1
    ds_read_b128 v[68:71], v2 offset:1024
    s_waitcnt lgkmcnt(4)
    s_waitcnt lgkmcnt(3)
    v_smfmac_f32_16x16x64_bf16 v[16:19], v[60:63], v[36:43], v1
    ds_read_b128 v[36:39], v7 offset:8192
    v_smfmac_f32_16x16x64_bf16 v[20:23], v[60:63], v[44:51], v1
    ds_read_b128 v[60:63], v2 offset:5632
    ds_read_b128 v[40:43], v7 offset:9216
    v_smfmac_f32_16x16x64_bf16 v[16:19], v[64:67], a[64:71], v1
    ds_read_b128 v[44:47], v7 offset:10240
    v_smfmac_f32_16x16x64_bf16 v[20:23], v[64:67], a[72:79], v1
    ds_read_b128 v[64:67], v2 offset:6144
    ds_read_b128 v[48:51], v7 offset:11264
    s_waitcnt lgkmcnt(7)
    v_smfmac_f32_16x16x64_bf16 v[16:19], v[52:55], a[80:87], v1
    s_mov_b32 exec_hi, 0
    buffer_load_dword v0, v26, s[8:11], s24 offen sc1
    s_mov_b32 exec_hi, -1
    v_smfmac_f32_16x16x64_bf16 v[20:23], v[52:55], a[88:95], v1
    ds_read_b128 v[52:55], v2 offset:6656
    v_smfmac_f32_16x16x64_bf16 v[16:19], v[56:59], a[96:103], v1
    buffer_load_dword v0, off, s[8:11], s52 offset:128 sc1
    v_smfmac_f32_16x16x64_bf16 v[20:23], v[56:59], a[104:111], v1
    ds_read_b128 v[56:59], v2 offset:1536
    s_waitcnt lgkmcnt(6)
    s_waitcnt lgkmcnt(2)
    v_smfmac_f32_16x16x64_bf16 v[16:19], v[68:71], v[36:43], v1
    ds_read_b128 v[36:39], v7 offset:12288
    v_smfmac_f32_16x16x64_bf16 v[20:23], v[68:71], v[44:51], v1
    ds_read_b128 v[68:71], v2 offset:7168
    ds_read_b128 v[40:43], v7 offset:13312
    v_smfmac_f32_16x16x64_bf16 v[16:19], v[60:63], a[112:119], v1
    ds_read_b128 v[44:47], v7 offset:14336
    v_smfmac_f32_16x16x64_bf16 v[20:23], v[60:63], a[120:127], v1
    ds_read_b128 v[60:63], v2 offset:7680
    ds_read_b128 v[48:51], v7 offset:15360
    s_waitcnt lgkmcnt(7)
    v_smfmac_f32_16x16x64_bf16 v[16:19], v[64:67], a[128:135], v1
    v_smfmac_f32_16x16x64_bf16 v[20:23], v[64:67], a[136:143], v1
    ds_read_b128 v[64:67], v2 offset:8192
    v_smfmac_f32_16x16x64_bf16 v[16:19], v[52:55], a[144:151], v1
    v_smfmac_f32_16x16x64_bf16 v[20:23], v[52:55], a[152:159], v1
    ds_read_b128 v[52:55], v2 offset:8704
    s_waitcnt lgkmcnt(6)
    s_waitcnt lgkmcnt(2)
    v_smfmac_f32_16x16x64_bf16 v[16:19], v[56:59], v[36:43], v1
    ds_read_b128 v[36:39], v6 offset:16384
    v_smfmac_f32_16x16x64_bf16 v[20:23], v[56:59], v[44:51], v1
    ds_read_b128 v[56:59], v5 offset:0
    ds_read_b128 v[40:43], v6 offset:17408
    v_smfmac_f32_16x16x64_bf16 v[16:19], v[68:71], a[160:167], v1
    ds_read_b128 v[44:47], v6 offset:18432
    v_smfmac_f32_16x16x64_bf16 v[20:23], v[68:71], a[168:175], v1
    ds_read_b128 v[68:71], v5 offset:1024
    ds_read_b128 v[48:51], v6 offset:19456
    s_waitcnt lgkmcnt(7)
    v_smfmac_f32_16x16x64_bf16 v[16:19], v[60:63], a[176:183], v1
    v_smfmac_f32_16x16x64_bf16 v[20:23], v[60:63], a[184:191], v1
    ds_read_b128 v[60:63], v5 offset:2048
    v_smfmac_f32_16x16x64_bf16 v[16:19], v[64:67], a[192:199], v1
    v_smfmac_f32_16x16x64_bf16 v[20:23], v[64:67], a[200:207], v1
    ds_read_b128 v[64:67], v5 offset:3072
    s_waitcnt lgkmcnt(8)
    v_smfmac_f32_16x16x64_bf16 v[16:19], v[52:55], a[208:215], v1
    v_smfmac_f32_16x16x64_bf16 v[20:23], v[52:55], a[216:223], v1
    ds_read_b128 v[52:55], v5 offset:4096
    s_waitcnt lgkmcnt(7)
    v_smfmac_f32_16x16x64_bf16 v[8:11], v[56:59], v[112:119], v1
    v_smfmac_f32_16x16x64_bf16 v[12:15], v[56:59], v[120:127], v1
    ds_read_b128 v[56:59], v5 offset:5120
    s_waitcnt lgkmcnt(5)
    v_smfmac_f32_16x16x64_bf16 v[8:11], v[68:71], v[128:135], v1
    s_nop 0
    v_cvt_pk_bf16_f32 v16, v16, v20
    v_cvt_pk_bf16_f32 v17, v17, v21
    v_cvt_pk_bf16_f32 v18, v18, v22
    v_cvt_pk_bf16_f32 v19, v19, v23
    ds_write2_b32 v4, v16, v17 offset0:0 offset1:72
    ds_write2_b32 v4, v18, v19 offset0:144 offset1:216
    v_smfmac_f32_16x16x64_bf16 v[12:15], v[68:71], v[136:143], v1
    ds_read_b128 v[68:71], v5 offset:6144
    s_waitcnt lgkmcnt(5)
    v_smfmac_f32_16x16x64_bf16 v[8:11], v[60:63], v[144:151], v1
    v_smfmac_f32_16x16x64_bf16 v[12:15], v[60:63], v[152:159], v1
    s_cmp_eq_u32 s3, 0
    s_cbranch_scc1 L_fls_9
L_rdy_8:
    s_mov_b32 m0, s49
    v_smfmac_f32_16x16x64_bf16 v[8:11], v[64:67], v[160:167], v1
    v_smfmac_f32_16x16x64_bf16 v[12:15], v[64:67], v[168:175], v1
    s_waitcnt lgkmcnt(1)
    s_barrier
    ds_read_b128 v[60:63], v3 offset:9216
    ds_read_b128 v[64:67], v3 offset:9280
    v_smfmac_f32_16x16x64_bf16 v[8:11], v[52:55], v[176:183], v1
    v_smfmac_f32_16x16x64_bf16 v[12:15], v[52:55], v[184:191], v1
    ds_read_b128 v[52:55], v3 offset:9344
    buffer_load_dwordx4 v6, s[8:11], s45 offen sc1 lds
    v_smfmac_f32_16x16x64_bf16 v[8:11], v[56:59], v[192:199], v1
    v_smfmac_f32_16x16x64_bf16 v[12:15], v[56:59], v[200:207], v1
    ds_read_b128 v[56:59], v3 offset:9408
    s_waitcnt lgkmcnt(4)
    v_smfmac_f32_16x16x64_bf16 v[8:11], v[68:71], v[208:215], v1
    v_smfmac_f32_16x16x64_bf16 v[12:15], v[68:71], v[216:223], v1
    ds_read_b128 v[68:71], v5 offset:7168
    s_waitcnt lgkmcnt(3)
    v_mfma_f32_16x16x32_bf16 v[16:19], v[36:39], v[60:63], 0
    ds_read_b128 v[36:39], v6 offset:20480
    v_mfma_f32_16x16x32_bf16 v[20:23], v[40:43], v[60:63], 0
    ds_read_b128 v[40:43], v6 offset:21504
    v_mfma_f32_16x16x32_bf16 v[16:19], v[44:47], v[64:67], v[16:19]
    ds_read_b128 v[44:47], v6 offset:22528
    v_mfma_f32_16x16x32_bf16 v[20:23], v[48:51], v[64:67], v[20:23]
    ds_read_b128 v[48:51], v6 offset:23552
    s_waitcnt lgkmcnt(5)
    v_mfma_f32_16x16x32_bf16 v[24:27], v[60:63], v[60:63], 0
    ds_read_b128 v[60:63], v5 offset:8192
    v_mfma_f32_16x16x32_bf16 v[24:27], v[64:67], v[64:67], v[24:27]
    v_mfma_f32_16x16x32_bf16 v[24:27], v[52:55], v[52:55], v[24:27]
    v_mfma_f32_16x16x32_bf16 v[24:27], v[56:59], v[56:59], v[24:27]
    s_waitcnt lgkmcnt(3)
    v_mfma_f32_16x16x32_bf16 v[16:19], v[36:39], v[52:55], v[16:19]
    v_mfma_f32_16x16x32_bf16 v[20:23], v[40:43], v[52:55], v[20:23]
    s_waitcnt lgkmcnt(1)
    v_mfma_f32_16x16x32_bf16 v[16:19], v[44:47], v[56:59], v[16:19]
    v_mfma_f32_16x16x32_bf16 v[20:23], v[48:51], v[56:59], v[20:23]
    s_waitcnt lgkmcnt(0)
    v_smfmac_f32_16x16x64_bf16 v[8:11], v[68:71], v[224:231], v1
    v_permlane32_swap_b32_e64 v24, v26
    v_smfmac_f32_16x16x64_bf16 v[12:15], v[68:71], v[232:239], v1
    v_permlane32_swap_b32_e64 v25, v27
    v_smfmac_f32_16x16x64_bf16 v[8:11], v[60:63], v[240:247], v1
    v_smfmac_f32_16x16x64_bf16 v[12:15], v[60:63], v[248:255], v1
    v_max3_f32 v64, v16, v17, v18
    v_max3_f32 v65, v19, v26, v27
    v_max3_f32 v64, v64, v20, v21
    v_max3_f32 v65, v65, v22, v23
    v_max_f32 v64, v64, v65
    v_mov_b32 v65, v64
    ds_read_b128 v[36:39], v7 offset:16384
    ds_read_b128 v[40:43], v7 offset:17408
    v_permlane32_swap_b32 v64, v65
    v_max_f32 v64, v64, v65
    v_mov_b32_e64 v65, v64
    v_cvt_pk_bf16_f32 v8, v8, v9
    v_cvt_pk_bf16_f32 v9, v10, v11
    v_permlane16_swap_b32 v64, v65
    v_max_f32 v64, v64, v65
    v_mul_f32_e64 v64, s68, v64
    v_pk_fma_f32 v[26:27], v[26:27], s[78:79], v[64:65] op_sel_hi:[1,1,0]
    v_pk_fma_f32 v[16:17], v[16:17], s[78:79], v[64:65] op_sel_hi:[1,1,0]
    v_pk_fma_f32 v[18:19], v[18:19], s[78:79], v[64:65] op_sel_hi:[1,1,0]
    v_pk_fma_f32 v[20:21], v[20:21], s[78:79], v[64:65] op_sel_hi:[1,1,0]
    v_pk_fma_f32 v[22:23], v[22:23], s[78:79], v[64:65] op_sel_hi:[1,1,0]
    v_exp_f32 v26, v26
    v_exp_f32 v27, v27
    v_mov_b64_e64 v[66:67], s[30:31]
    v_cvt_pk_bf16_f32 v24, v26, v27
    v_cvt_pk_bf16_f32 v25, v26, v27
    v_cvt_pk_bf16_f32 v10, v12, v13
    v_cvt_pk_bf16_f32 v11, v14, v15
    v_permlane32_swap_b32 v24, v25
    v_exp_f32 v16, v16
    v_exp_f32_e64 v17, v17
    v_mfma_f32_16x16x16_bf16 v[52:55], v[66:67], v[24:25], 0
    v_exp_f32 v18, v18
    v_exp_f32 v19, v19
    v_mfma_f32_16x16x16_bf16 v[68:71], v[8:9], v[24:25], 0
    v_exp_f32 v20, v20
    v_exp_f32 v21, v21
    v_mfma_f32_16x16x16_bf16 v[60:63], v[10:11], v[24:25], 0
    v_exp_f32 v22, v22
    v_exp_f32 v23, v23
    v_mov_b64 v[56:57], s[34:35]
    v_mov_b64 v[58:59], s[34:35]
    v_cvt_pk_bf16_f32 v16, v16, v17
    v_cvt_pk_bf16_f32 v17, v18, v19
    v_cvt_pk_bf16_f32 v18, v20, v21
    v_cvt_pk_bf16_f32 v19, v22, v23
    s_waitcnt vmcnt(5)
    v_add_u32 v64, s47, v3
    v_mfma_f32_16x16x32_bf16 v[52:55], v[56:59], v[16:19], v[52:55]
    v_mfma_f32_16x16x32_bf16 v[68:71], v[28:31], v[16:19], v[68:71]
    v_mfma_f32_16x16x32_bf16 v[60:63], v[32:35], v[16:19], v[60:63]
    ds_read_b128 v[44:47], v7 offset:18432
    ds_read_b128 v[48:51], v7 offset:19456
    ds_read_b128 v[8:11], v7 offset:20480
    ds_read_b128 v[12:15], v7 offset:21504
    ds_read_b128 v[28:31], v7 offset:22528
    ds_read_b128 v[32:35], v7 offset:23552
    v_rcp_f32 v52, v52
    s_mov_b64 exec, s[58:59]
    v_pk_mul_f32 v[68:69], v[68:69], v[52:53] op_sel_hi:[1,0]
    v_pk_mul_f32 v[70:71], v[70:71], v[52:53] op_sel_hi:[1,0]
    v_pk_mul_f32 v[60:61], v[60:61], v[52:53] op_sel_hi:[1,0]
    v_pk_mul_f32 v[62:63], v[62:63], v[52:53] op_sel_hi:[1,0]
    v_cvt_pk_bf16_f32 v68, v68, v60
    v_cvt_pk_bf16_f32 v69, v69, v61
    v_cvt_pk_bf16_f32 v70, v70, v62
    v_cvt_pk_bf16_f32 v71, v71, v63
    ds_write_b128 v64, v[68:71] offset:13824
    s_mov_b64 exec, -1
    v_subrev_u32 v65, 2304, v3
    v_cndmask_b32 v65, v65, v3, s[58:59]
    v_mov_b64 v[16:17], 0
    v_mov_b64 v[18:19], 0
    v_mov_b64 v[20:21], 0
    v_mov_b64 v[22:23], 0
    v_mov_b64 v[24:25], 0
    v_mov_b64 v[26:27], 0
    s_add_u32 m0, s49, 4096
    s_add_u32 s75, s45, 4096
    s_add_u32 s7, s7, 1
    s_cmp_lg_u32 s55, 0
    s_cbranch_scc1 L_five_10
    s_waitcnt lgkmcnt(0)
    s_barrier
    ds_read_b128 v[68:71], v65 offset:13824
    ds_read_b128 v[60:63], v65 offset:13888
    ds_read_b128 v[52:55], v65 offset:13952
    ds_read_b128 v[56:59], v65 offset:14016
    buffer_load_dwordx4 v6, s[8:11], s75 offen sc1 lds
    v_and_b32 v67, 0xc0, v6
    v_lshlrev_b32_e64 v66, 6, v67
    s_waitcnt lgkmcnt(3)
    v_smfmac_f32_16x16x64_bf16 v[16:19], v[68:71], v[36:43], v1
    ds_read_b128 v[36:39], v7 offset:24576
    ds_read_b128 v[40:43], v7 offset:25600
    s_waitcnt lgkmcnt(2)
    v_smfmac_f32_16x16x64_bf16 v[16:19], v[60:63], v[44:51], v1
    ds_read_b128 v[44:47], v7 offset:26624
    ds_read_b128 v[48:51], v7 offset:27648
    v_smfmac_f32_16x16x64_bf16 v[16:19], v[52:55], v[8:15], v1
    ds_read_b128 v[8:11], v7 offset:28672
    ds_read_b128 v[12:15], v7 offset:29696
    v_smfmac_f32_16x16x64_bf16 v[16:19], v[56:59], v[28:35], v1
    v_smfmac_f32_16x16x64_bf16 v[20:23], v[68:71], a[224:231], v1
    v_and_b32_e64 v67, 0x30, v6
    v_lshl_add_u32 v66, v67, 1, v66
    v_smfmac_f32_16x16x64_bf16 v[20:23], v[60:63], a[232:239], v1
    v_lshrrev_b32 v67, 8, v6
    v_lshl_add_u32 v66, v67, 3, v66
    v_smfmac_f32_16x16x64_bf16 v[20:23], v[52:55], a[240:247], v1
    s_nop 0
    v_cvt_pk_bf16_f32 v16, v16, v17
    v_cvt_pk_bf16_f32 v17, v18, v19
    v_smfmac_f32_16x16x64_bf16 v[20:23], v[56:59], a[248:255], v1
    v_and_or_b32 v16, v16, -2, s38
    buffer_store_dwordx2 v[16:17], v66, s[8:11], s16 offen
    v_smfmac_f32_16x16x64_bf16 v[24:27], v[68:71], v[72:79], v1
    v_mov_b64_e64 v[16:17], 0
    v_mov_b64 v[18:19], 0
    v_smfmac_f32_16x16x64_bf16 v[24:27], v[60:63], v[80:87], v1
    s_waitcnt lgkmcnt(0)
    v_smfmac_f32_16x16x64_bf16 v[24:27], v[52:55], v[36:43], v1
    v_cvt_pk_bf16_f32 v20, v20, v21
    v_cvt_pk_bf16_f32 v21, v22, v23
    v_smfmac_f32_16x16x64_bf16 v[24:27], v[56:59], v[44:51], v1
    v_and_or_b32 v20, v20, -2, s38
    buffer_store_dwordx2 v[20:21], v66, s[8:11], s17 offen
    v_smfmac_f32_16x16x64_bf16 v[16:19], v[68:71], v[8:15], v1
    v_smfmac_f32_16x16x64_bf16 v[16:19], v[60:63], v[88:95], v1
    v_smfmac_f32_16x16x64_bf16 v[16:19], v[52:55], v[96:103], v1
    s_nop 2
    v_cvt_pk_bf16_f32 v24, v24, v25
    v_cvt_pk_bf16_f32 v25, v26, v27
    v_smfmac_f32_16x16x64_bf16 v[16:19], v[56:59], v[104:111], v1
    v_and_or_b32 v24, v24, -2, s38
    buffer_store_dwordx2 v[24:25], v66, s[8:11], s18 offen
    s_add_u32 s51, s51, 9216
    s_add_u32 s52, s52, 128
    s_add_u32 s43, s43, 1
    s_mov_b32 s40, 0
    s_mov_b32 s39, s51
    s_cmp_eq_u32 s53, 0
    v_cvt_pk_bf16_f32 v16, v16, v17
    v_cvt_pk_bf16_f32 v17, v18, v19
    v_and_or_b32 v16, v16, -2, s38
    buffer_store_dwordx2 v[16:17], v66, s[8:11], s19 offen
    s_branch L_wojoin_11
L_five_10:
    s_waitcnt lgkmcnt(0)
    s_barrier
    ds_read_b128 v[68:71], v65 offset:13824
    ds_read_b128 v[60:63], v65 offset:13888
    ds_read_b128 v[52:55], v65 offset:13952
    ds_read_b128 v[56:59], v65 offset:14016
    buffer_load_dwordx4 v6, s[8:11], s75 offen sc1 lds
    v_and_b32 v67, 0xc0, v6
    v_lshlrev_b32_e64 v66, 6, v67
    s_waitcnt lgkmcnt(3)
    v_smfmac_f32_16x16x64_bf16 v[16:19], v[68:71], v[36:43], v1
    ds_read_b128 v[36:39], v7 offset:24576
    ds_read_b128 v[40:43], v7 offset:25600
    s_waitcnt lgkmcnt(2)
    v_smfmac_f32_16x16x64_bf16 v[16:19], v[60:63], v[44:51], v1
    ds_read_b128 v[44:47], v7 offset:26624
    ds_read_b128 v[48:51], v7 offset:27648
    v_smfmac_f32_16x16x64_bf16 v[16:19], v[52:55], v[8:15], v1
    ds_read_b128 v[8:11], v7 offset:28672
    ds_read_b128 v[12:15], v7 offset:29696
    v_smfmac_f32_16x16x64_bf16 v[16:19], v[56:59], v[28:35], v1
    ds_read_b128 v[28:31], v7 offset:30720
    ds_read_b128 v[32:35], v7 offset:31744
    v_smfmac_f32_16x16x64_bf16 v[20:23], v[68:71], a[224:231], v1
    v_and_b32_e64 v67, 0x30, v6
    v_lshl_add_u32 v66, v67, 1, v66
    v_smfmac_f32_16x16x64_bf16 v[20:23], v[60:63], a[232:239], v1
    v_lshrrev_b32_e64 v67, 8, v6
    v_lshl_add_u32 v66, v67, 3, v66
    v_smfmac_f32_16x16x64_bf16 v[20:23], v[52:55], a[240:247], v1
    v_cvt_pk_bf16_f32 v16, v16, v17
    v_cvt_pk_bf16_f32 v17, v18, v19
    v_smfmac_f32_16x16x64_bf16 v[20:23], v[56:59], a[248:255], v1
    v_and_or_b32 v16, v16, -2, s38
    buffer_store_dwordx2 v[16:17], v66, s[8:11], s16 offen
    v_smfmac_f32_16x16x64_bf16 v[24:27], v[68:71], v[72:79], v1
    v_mov_b64_e64 v[16:17], 0
    v_mov_b64 v[18:19], 0
    v_smfmac_f32_16x16x64_bf16 v[24:27], v[60:63], v[80:87], v1
    s_waitcnt lgkmcnt(0)
    v_smfmac_f32_16x16x64_bf16 v[24:27], v[52:55], v[36:43], v1
    ds_read_b128 v[36:39], v7 offset:32768
    ds_read_b128 v[40:43], v7 offset:33792
    v_cvt_pk_bf16_f32 v20, v20, v21
    v_cvt_pk_bf16_f32 v21, v22, v23
    v_smfmac_f32_16x16x64_bf16 v[24:27], v[56:59], v[44:51], v1
    ds_read_b128 v[44:47], v7 offset:34816
    ds_read_b128 v[48:51], v7 offset:35840
    v_and_or_b32 v20, v20, -2, s38
    buffer_store_dwordx2 v[20:21], v66, s[8:11], s17 offen
    v_smfmac_f32_16x16x64_bf16 v[16:19], v[68:71], v[8:15], v1
    ds_read_b128 v[8:11], v7 offset:36864
    ds_read_b128 v[12:15], v7 offset:37888
    v_mov_b64 v[20:21], 0
    v_mov_b64 v[22:23], 0
    v_smfmac_f32_16x16x64_bf16 v[16:19], v[60:63], v[88:95], v1
    v_smfmac_f32_16x16x64_bf16 v[16:19], v[52:55], v[96:103], v1
    v_cvt_pk_bf16_f32 v24, v24, v25
    v_cvt_pk_bf16_f32 v25, v26, v27
    v_smfmac_f32_16x16x64_bf16 v[16:19], v[56:59], v[104:111], v1
    v_and_or_b32 v24, v24, -2, s38
    buffer_store_dwordx2 v[24:25], v66, s[8:11], s18 offen
    v_smfmac_f32_16x16x64_bf16 v[20:23], v[68:71], v[28:35], v1
    s_waitcnt lgkmcnt(4)
    v_smfmac_f32_16x16x64_bf16 v[20:23], v[60:63], v[36:43], v1
    s_waitcnt lgkmcnt(2)
    v_smfmac_f32_16x16x64_bf16 v[20:23], v[52:55], v[44:51], v1
    s_nop 0
    v_cvt_pk_bf16_f32 v16, v16, v17
    v_cvt_pk_bf16_f32 v17, v18, v19
    s_waitcnt lgkmcnt(0)
    v_smfmac_f32_16x16x64_bf16 v[20:23], v[56:59], v[8:15], v1
    v_and_or_b32 v16, v16, -2, s38
    buffer_store_dwordx2 v[16:17], v66, s[8:11], s19 offen
    s_add_u32 s51, s51, 9216
    s_add_u32 s52, s52, 128
    s_add_u32 s43, s43, 1
    s_mov_b32 s40, 0
    s_mov_b32 s39, s51
    s_cmp_eq_u32 s53, 0
    v_cvt_pk_bf16_f32 v20, v20, v21
    v_cvt_pk_bf16_f32 v21, v22, v23
    v_and_or_b32 v20, v20, -2, s38
    buffer_store_dwordx2 v[20:21], v66, s[8:11], s20 offen
L_wojoin_11:
    s_barrier
    v_mov_b32_e64 v24, 0
    s_cselect_b32 s76, 1, 0
    s_and_b32 s73, s7, 3
    s_xor_b32 s74, s73, 2
    s_mul_i32 s37, s74, 9216
    s_add_u32 s37, s37, s6
    s_mul_i32 s50, s73, 9216
    s_add_u32 s44, s50, s71
    s_add_u32 s44, s44, 0x140000
    s_add_u32 s50, s50, s6
    s_add_u32 s45, s45, 262144
    s_add_u32 s46, s46, 262144
    s_cmp_lg_u32 s76, 0
    s_cbranch_scc1 L_rj_15
    s_nop 11
    buffer_load_dwordx4 v[52:55], v6, s[8:11], s48 offen offset:0 sc1
    buffer_load_dwordx4 v[56:59], v6, s[8:11], s48 offen offset:1024 sc1
    buffer_load_dwordx4 v[60:63], v6, s[8:11], s48 offen offset:2048 sc1
    buffer_load_dwordx4 v[64:67], v6, s[8:11], s48 offen offset:3072 sc1
    v_and_b32_e64 v21, 16, v6
    v_mov_b32 v22, 0x3f80
    v_lshlrev_b32_e64 v21, v21, v22
    v_cndmask_b32 v68, 0, v21, s[60:61]
    v_cndmask_b32 v69, 0, v21, s[62:63]
    v_cndmask_b32 v70, 0, v21, s[64:65]
    v_cndmask_b32 v71, 0, v21, s[66:67]
    v_and_b32 v24, 0x70, v6
    v_bfe_u32 v25, v6, 8, 1
    v_lshl_add_u32 v24, v25, 3, v24
    v_lshrrev_b32 v25, 9, v6
    v_lshl_add_u32 v24, v25, 2, v24
    s_nop 13
L_ha_13:
    buffer_load_dwordx4 v[52:55], v6, s[8:11], s48 offen offset:0 sc1
    buffer_load_dwordx4 v[56:59], v6, s[8:11], s48 offen offset:1024 sc1
    buffer_load_dwordx4 v[60:63], v6, s[8:11], s48 offen offset:2048 sc1
    buffer_load_dwordx4 v[64:67], v6, s[8:11], s48 offen offset:3072 sc1
    s_add_u32 s40, s40, 1
    s_cmp_gt_u32 s40, 0x100000
    s_cbranch_scc1 L_abort
    s_waitcnt vmcnt(7)
    v_bitop3_b32 v20, v52, v54, s38 bitop3:0x7e
    v_mfma_f32_16x16x32_bf16 v[16:19], v[52:55], v[68:71], 0
    s_waitcnt vmcnt(6)
    v_bitop3_b32 v21, v56, v58, s38 bitop3:0x7e
    v_mfma_f32_16x16x32_bf16 v[16:19], v[56:59], v[68:71], v[16:19]
    s_waitcnt vmcnt(5)
    v_bitop3_b32 v22, v60, v62, s38 bitop3:0x7e
    v_mfma_f32_16x16x32_bf16 v[16:19], v[60:63], v[68:71], v[16:19]
    v_or3_b32 v20, v20, v21, v22
    s_waitcnt vmcnt(4)
    v_bitop3_b32 v23, v64, v66, s38 bitop3:0x7e
    v_mfma_f32_16x16x32_bf16 v[16:19], v[64:67], v[68:71], v[16:19]
    v_bitop3_b32 v20, v20, v23, 1 bitop3:0xa8
    v_cmp_ne_u32 vcc, 0, v20
    s_cbranch_vccnz L_ha_13
L_haok_14:
    v_readfirstlane_b32 s3, v0
    s_nop 3
    v_permlane32_swap_b32 v16, v18
    v_permlane32_swap_b32 v17, v19
    v_pk_add_f32 v[16:17], v[16:17], v[18:19]
    v_cvt_pk_bf16_f32 v0, v16, v17
    buffer_store_dword v0, v24, s[8:11], s50 offen
    s_cmp_ge_u32 s43, 62
    s_cbranch_scc1 L_ea_16
L_nred_12:
    s_cmp_lt_u32 s43, 63
    s_barrier
    s_cbranch_scc1 L_cf_top
    s_waitcnt vmcnt(0)
    s_add_u32 s42, s42, 1
    s_cmp_lt_u32 s42, 2
    s_cbranch_scc1 L_cf_layer
    s_branch L_cf_end
L_fls_9:
    s_mov_b32 s40, 0
L_fl_17:
    s_add_u32 s40, s40, 1
    s_cmp_gt_u32 s40, 0x100000
    s_cbranch_scc1 L_abort
    buffer_load_dword v24, off, s[8:11], s52 sc1
    s_waitcnt vmcnt(0)
    v_cmp_eq_u32_e64 vcc, 0, v24
    s_cbranch_vccnz L_fl_17
    s_branch L_rdy_8
L_rj_15:
    s_waitcnt vmcnt(0)
    v_readfirstlane_b32 s3, v0
    s_branch L_nred_12
L_ea_16:
    buffer_store_dword v0, v24, s[8:11], s39 offen sc1
    s_mov_b32 s39, 0x70000000
    s_branch L_nred_12
L_cf_end:
    s_branch L_c_fin
L_c_slow:
    s_mov_b32 s42, 0
    s_and_b32 s73, s7, 3
    s_xor_b32 s74, s73, 2
    s_mul_i32 s37, s74, 9216
    s_add_u32 s37, s37, s6
L_cs_layer:
    s_mov_b32 s43, 0
    s_mov_b32 s39, 0x70000000
    s_mul_i32 s73, s42, 589824
    s_add_u32 s44, s73, 0x20000
    s_add_u32 s44, s44, s71
    s_add_u32 s73, s73, s6
    s_sub_u32 s51, s73, 0x120000
    s_lshl_b32 s73, s42, 24
    s_lshl_b32 s74, s41, 13
    s_add_u32 s73, s73, s74
    s_lshl_b32 s74, s32, 10
    s_add_u32 s73, s73, s74
    s_add_u32 s45, s73, 0x2000000
    s_add_u32 s73, s73, s74
    s_add_u32 s46, s73, 0x4000000
    s_lshl_b32 s73, s42, 20
    s_lshl_b32 s74, s41, 13
    s_add_u32 s73, s73, s74
    s_add_u32 s52, s73, 0x1810000
    s_mov_b32 s40, 0
L_f0l_18:
    s_add_u32 s40, s40, 1
    s_cmp_gt_u32 s40, 0x100000
    s_cbranch_scc1 L_abort
    s_sleep 1
    buffer_load_dword v60, off, s[8:11], s52 sc1
    buffer_load_dword v0, off, s[8:11], s52 offset:128 sc1
    s_waitcnt vmcnt(0)
    v_cmp_eq_u32 vcc, 0, v60
    s_cbranch_vccnz L_f0l_18
    v_readfirstlane_b32 s3, v0
    s_barrier
    s_add_u32 m0, s49, 0
    s_nop 0
    buffer_load_dwordx4 v6, s[8:11], s45 offen sc1 lds
    s_add_u32 m0, s49, 4096
    s_add_u32 s75, s45, 4096
    buffer_load_dwordx4 v6, s[8:11], s75 offen sc1 lds
    s_add_u32 s45, s45, 262144
    s_add_u32 s52, s52, 128
L_cs_top:
    v_lshrrev_b32_e64 v70, 2, v6
    ds_read_b128 v[36:39], v7 offset:0
    ds_read_b128 v[40:43], v7 offset:1024
    ds_read_b128 v[44:47], v7 offset:2048
    ds_read_b128 v[48:51], v7 offset:3072
    s_nop 11
    buffer_load_dwordx4 v[52:55], v6, s[8:11], s44 offen sc1
    buffer_load_dwordx4 v[56:59], v6, s[8:11], s44 offen offset:1024 sc1
    buffer_load_dword v68, v70, s[8:11], s44 offen offset:2048 sc1
    v_add_u32 v69, s71, v70
    v_and_b32 v26, 0xf0, v6
    v_lshlrev_b32_e64 v26, 3, v26
    v_and_b32 v27, 0x100, v6
    v_lshl_add_u32 v26, v27, 17, v26
    v_mov_b32 v25, -1
    v_mov_b64 v[16:17], 0
    v_mov_b64 v[18:19], 0
    v_mov_b64 v[20:21], 0
    v_mov_b64 v[22:23], 0
    v_mov_b64 v[8:9], 0
    v_mov_b64 v[10:11], 0
    v_mov_b64 v[12:13], 0
    v_mov_b64_e64 v[14:15], 0
    s_bitcmp1_b32 s7, 0
    s_cselect_b32 s69, 327680, 0
    s_bfe_u32 s38, s7, 0x10001
    s_add_u32 s16, s4, s69
    s_add_u32 s17, s16, 16384
    s_add_u32 s18, s16, 32768
    s_add_u32 s19, s16, 49152
    s_add_u32 s20, s16, 65536
    s_add_u32 s48, s5, s69
    s_sub_u32 s24, s46, 0x1fc0000
    s_cmp_eq_u32 s3, 0
    s_cselect_b32 s24, 0x70000000, s24
    s_mov_b32 s40, 0
    s_waitcnt vmcnt(3)
    v_add_u32 v60, s71, v6
L_hb_20:
    buffer_load_dwordx4 v[52:55], v6, s[8:11], s44 offen sc1
    buffer_load_dwordx4 v[56:59], v6, s[8:11], s44 offen offset:1024 sc1
    buffer_load_dword v68, v70, s[8:11], s44 offen offset:2048 sc1
    s_add_u32 s40, s40, 1
    s_cmp_gt_u32 s40, 0x100000
    s_cbranch_scc1 L_abort
    s_waitcnt vmcnt(5)
    v_max3_u32 v71, v52, v53, v54
    v_max_u32 v71, v71, v55
    ds_write_b128 v60, v[52:55]
    s_waitcnt vmcnt(4)
    v_max3_u32 v71, v71, v56, v57
    v_max3_u32 v71, v71, v58, v59
    ds_write_b128 v60, v[56:59] offset:1024
    s_waitcnt vmcnt(3)
    v_max_u32 v71, v71, v68
    ds_write_b32 v69, v68 offset:2048
    v_cmp_eq_u32_e64 vcc, -1, v71
    s_cbranch_vccnz L_hb_20
L_hbok_21:
    s_waitcnt lgkmcnt(0)
    s_barrier
    ds_read_b128 v[60:63], v2 offset:0
    ds_read_b128 v[64:67], v2 offset:2048
    s_waitcnt vmcnt(0)
    ds_read_b128 v[52:55], v2 offset:2560
    ds_read_b128 v[56:59], v2 offset:3072
    ds_read_b128 v[68:71], v2 offset:3584
    buffer_load_dwordx4 v[28:31], v6, s[8:11], s46 offen sc1
    s_waitcnt lgkmcnt(4)
    v_smfmac_f32_16x16x64_bf16 v[16:19], v[60:63], v[36:43], v1
    ds_read_b128 v[36:39], v7 offset:4096
    v_smfmac_f32_16x16x64_bf16 v[20:23], v[60:63], v[44:51], v1
    ds_read_b128 v[60:63], v2 offset:512
    ds_read_b128 v[40:43], v7 offset:5120
    s_waitcnt lgkmcnt(5)
    v_smfmac_f32_16x16x64_bf16 v[16:19], v[64:67], a[0:7], v1
    ds_read_b128 v[44:47], v7 offset:6144
    v_smfmac_f32_16x16x64_bf16 v[20:23], v[64:67], a[8:15], v1
    ds_read_b128 v[64:67], v2 offset:4096
    ds_read_b128 v[48:51], v7 offset:7168
    v_smfmac_f32_16x16x64_bf16 v[16:19], v[52:55], a[16:23], v1
    buffer_load_dwordx4 v[32:35], v6, s[8:11], s46 offen offset:1024 sc1
    v_smfmac_f32_16x16x64_bf16 v[20:23], v[52:55], a[24:31], v1
    ds_read_b128 v[52:55], v2 offset:4608
    s_waitcnt lgkmcnt(7)
    v_smfmac_f32_16x16x64_bf16 v[16:19], v[56:59], a[32:39], v1
    buffer_store_dword v25, v24, s[8:11], s37 offen sc1
    v_smfmac_f32_16x16x64_bf16 v[20:23], v[56:59], a[40:47], v1
    ds_read_b128 v[56:59], v2 offset:5120
    v_smfmac_f32_16x16x64_bf16 v[16:19], v[68:71], a[48:55], v1
    buffer_store_dword v0, v24, s[8:11], s39 offen sc1
    v_smfmac_f32_16x16x64_bf16 v[20:23], v[68:71], a[56:63], v1
    ds_read_b128 v[68:71], v2 offset:1024
    s_waitcnt lgkmcnt(4)
    s_waitcnt lgkmcnt(3)
    v_smfmac_f32_16x16x64_bf16 v[16:19], v[60:63], v[36:43], v1
    ds_read_b128 v[36:39], v7 offset:8192
    v_smfmac_f32_16x16x64_bf16 v[20:23], v[60:63], v[44:51], v1
    ds_read_b128 v[60:63], v2 offset:5632
    ds_read_b128 v[40:43], v7 offset:9216
    v_smfmac_f32_16x16x64_bf16 v[16:19], v[64:67], a[64:71], v1
    ds_read_b128 v[44:47], v7 offset:10240
    v_smfmac_f32_16x16x64_bf16 v[20:23], v[64:67], a[72:79], v1
    ds_read_b128 v[64:67], v2 offset:6144
    ds_read_b128 v[48:51], v7 offset:11264
    s_waitcnt lgkmcnt(7)
    v_smfmac_f32_16x16x64_bf16 v[16:19], v[52:55], a[80:87], v1
    s_mov_b32 exec_hi, 0
    buffer_load_dword v0, v26, s[8:11], s24 offen sc1
    s_mov_b32 exec_hi, -1
    v_smfmac_f32_16x16x64_bf16 v[20:23], v[52:55], a[88:95], v1
    ds_read_b128 v[52:55], v2 offset:6656
    v_smfmac_f32_16x16x64_bf16 v[16:19], v[56:59], a[96:103], v1
    buffer_load_dword v0, off, s[8:11], s52 offset:128 sc1
    v_smfmac_f32_16x16x64_bf16 v[20:23], v[56:59], a[104:111], v1
    ds_read_b128 v[56:59], v2 offset:1536
    s_waitcnt lgkmcnt(6)
    s_waitcnt lgkmcnt(2)
    v_smfmac_f32_16x16x64_bf16 v[16:19], v[68:71], v[36:43], v1
    ds_read_b128 v[36:39], v7 offset:12288
    v_smfmac_f32_16x16x64_bf16 v[20:23], v[68:71], v[44:51], v1
    ds_read_b128 v[68:71], v2 offset:7168
    ds_read_b128 v[40:43], v7 offset:13312
    v_smfmac_f32_16x16x64_bf16 v[16:19], v[60:63], a[112:119], v1
    ds_read_b128 v[44:47], v7 offset:14336
    v_smfmac_f32_16x16x64_bf16 v[20:23], v[60:63], a[120:127], v1
    ds_read_b128 v[60:63], v2 offset:7680
    ds_read_b128 v[48:51], v7 offset:15360
    s_waitcnt lgkmcnt(7)
    v_smfmac_f32_16x16x64_bf16 v[16:19], v[64:67], a[128:135], v1
    v_smfmac_f32_16x16x64_bf16 v[20:23], v[64:67], a[136:143], v1
    ds_read_b128 v[64:67], v2 offset:8192
    v_smfmac_f32_16x16x64_bf16 v[16:19], v[52:55], a[144:151], v1
    v_smfmac_f32_16x16x64_bf16 v[20:23], v[52:55], a[152:159], v1
    ds_read_b128 v[52:55], v2 offset:8704
    s_waitcnt lgkmcnt(6)
    s_waitcnt lgkmcnt(2)
    v_smfmac_f32_16x16x64_bf16 v[16:19], v[56:59], v[36:43], v1
    ds_read_b128 v[36:39], v6 offset:16384
    v_smfmac_f32_16x16x64_bf16 v[20:23], v[56:59], v[44:51], v1
    ds_read_b128 v[56:59], v5 offset:0
    ds_read_b128 v[40:43], v6 offset:17408
    v_smfmac_f32_16x16x64_bf16 v[16:19], v[68:71], a[160:167], v1
    ds_read_b128 v[44:47], v6 offset:18432
    v_smfmac_f32_16x16x64_bf16 v[20:23], v[68:71], a[168:175], v1
    ds_read_b128 v[68:71], v5 offset:1024
    ds_read_b128 v[48:51], v6 offset:19456
    s_waitcnt lgkmcnt(7)
    v_smfmac_f32_16x16x64_bf16 v[16:19], v[60:63], a[176:183], v1
    v_smfmac_f32_16x16x64_bf16 v[20:23], v[60:63], a[184:191], v1
    ds_read_b128 v[60:63], v5 offset:2048
    v_smfmac_f32_16x16x64_bf16 v[16:19], v[64:67], a[192:199], v1
    v_smfmac_f32_16x16x64_bf16 v[20:23], v[64:67], a[200:207], v1
    ds_read_b128 v[64:67], v5 offset:3072
    s_waitcnt lgkmcnt(8)
    v_smfmac_f32_16x16x64_bf16 v[16:19], v[52:55], a[208:215], v1
    v_smfmac_f32_16x16x64_bf16 v[20:23], v[52:55], a[216:223], v1
    ds_read_b128 v[52:55], v5 offset:4096
    s_waitcnt lgkmcnt(7)
    v_smfmac_f32_16x16x64_bf16 v[8:11], v[56:59], v[112:119], v1
    v_smfmac_f32_16x16x64_bf16 v[12:15], v[56:59], v[120:127], v1
    ds_read_b128 v[56:59], v5 offset:5120
    s_waitcnt lgkmcnt(5)
    v_smfmac_f32_16x16x64_bf16 v[8:11], v[68:71], v[128:135], v1
    s_nop 0
    v_cvt_pk_bf16_f32 v16, v16, v20
    v_cvt_pk_bf16_f32 v17, v17, v21
    v_cvt_pk_bf16_f32 v18, v18, v22
    v_cvt_pk_bf16_f32 v19, v19, v23
    ds_write2_b32 v4, v16, v17 offset0:0 offset1:72
    ds_write2_b32 v4, v18, v19 offset0:144 offset1:216
    v_smfmac_f32_16x16x64_bf16 v[12:15], v[68:71], v[136:143], v1
    ds_read_b128 v[68:71], v5 offset:6144
    s_waitcnt lgkmcnt(5)
    v_smfmac_f32_16x16x64_bf16 v[8:11], v[60:63], v[144:151], v1
    v_smfmac_f32_16x16x64_bf16 v[12:15], v[60:63], v[152:159], v1
    s_cmp_eq_u32 s3, 0
    s_cbranch_scc1 L_fls_23
L_rdy_22:
    s_mov_b32 m0, s49
    v_smfmac_f32_16x16x64_bf16 v[8:11], v[64:67], v[160:167], v1
    v_smfmac_f32_16x16x64_bf16 v[12:15], v[64:67], v[168:175], v1
    s_waitcnt lgkmcnt(1)
    s_barrier
    ds_read_b128 v[60:63], v3 offset:9216
    ds_read_b128 v[64:67], v3 offset:9280
    v_smfmac_f32_16x16x64_bf16 v[8:11], v[52:55], v[176:183], v1
    v_smfmac_f32_16x16x64_bf16 v[12:15], v[52:55], v[184:191], v1
    ds_read_b128 v[52:55], v3 offset:9344
    buffer_load_dwordx4 v6, s[8:11], s45 offen sc1 lds
    v_smfmac_f32_16x16x64_bf16 v[8:11], v[56:59], v[192:199], v1
    v_smfmac_f32_16x16x64_bf16 v[12:15], v[56:59], v[200:207], v1
    ds_read_b128 v[56:59], v3 offset:9408
    s_waitcnt lgkmcnt(4)
    v_smfmac_f32_16x16x64_bf16 v[8:11], v[68:71], v[208:215], v1
    v_smfmac_f32_16x16x64_bf16 v[12:15], v[68:71], v[216:223], v1
    ds_read_b128 v[68:71], v5 offset:7168
    s_waitcnt lgkmcnt(3)
    v_mfma_f32_16x16x32_bf16 v[16:19], v[36:39], v[60:63], 0
    ds_read_b128 v[36:39], v6 offset:20480
    v_mfma_f32_16x16x32_bf16 v[20:23], v[40:43], v[60:63], 0
    ds_read_b128 v[40:43], v6 offset:21504
    v_mfma_f32_16x16x32_bf16 v[16:19], v[44:47], v[64:67], v[16:19]
    ds_read_b128 v[44:47], v6 offset:22528
    v_mfma_f32_16x16x32_bf16 v[20:23], v[48:51], v[64:67], v[20:23]
    ds_read_b128 v[48:51], v6 offset:23552
    s_waitcnt lgkmcnt(5)
    v_mfma_f32_16x16x32_bf16 v[24:27], v[60:63], v[60:63], 0
    ds_read_b128 v[60:63], v5 offset:8192
    v_mfma_f32_16x16x32_bf16 v[24:27], v[64:67], v[64:67], v[24:27]
    v_mfma_f32_16x16x32_bf16 v[24:27], v[52:55], v[52:55], v[24:27]
    v_mfma_f32_16x16x32_bf16 v[24:27], v[56:59], v[56:59], v[24:27]
    s_waitcnt lgkmcnt(3)
    v_mfma_f32_16x16x32_bf16 v[16:19], v[36:39], v[52:55], v[16:19]
    v_mfma_f32_16x16x32_bf16 v[20:23], v[40:43], v[52:55], v[20:23]
    s_waitcnt lgkmcnt(1)
    v_mfma_f32_16x16x32_bf16 v[16:19], v[44:47], v[56:59], v[16:19]
    v_mfma_f32_16x16x32_bf16 v[20:23], v[48:51], v[56:59], v[20:23]
    s_waitcnt lgkmcnt(0)
    v_smfmac_f32_16x16x64_bf16 v[8:11], v[68:71], v[224:231], v1
    v_permlane32_swap_b32_e64 v24, v26
    v_smfmac_f32_16x16x64_bf16 v[12:15], v[68:71], v[232:239], v1
    v_permlane32_swap_b32_e64 v25, v27
    v_smfmac_f32_16x16x64_bf16 v[8:11], v[60:63], v[240:247], v1
    v_smfmac_f32_16x16x64_bf16 v[12:15], v[60:63], v[248:255], v1
    v_max3_f32 v64, v16, v17, v18
    v_max3_f32 v65, v19, v26, v27
    v_max3_f32 v64, v64, v20, v21
    v_max3_f32 v65, v65, v22, v23
    v_max_f32 v64, v64, v65
    v_mov_b32 v65, v64
    ds_read_b128 v[36:39], v7 offset:16384
    ds_read_b128 v[40:43], v7 offset:17408
    v_permlane32_swap_b32 v64, v65
    v_max_f32 v64, v64, v65
    v_mov_b32_e64 v65, v64
    v_cvt_pk_bf16_f32 v8, v8, v9
    v_cvt_pk_bf16_f32 v9, v10, v11
    v_permlane16_swap_b32 v64, v65
    v_max_f32 v64, v64, v65
    v_mul_f32_e64 v64, s68, v64
    v_pk_fma_f32 v[26:27], v[26:27], s[78:79], v[64:65] op_sel_hi:[1,1,0]
    v_pk_fma_f32 v[16:17], v[16:17], s[78:79], v[64:65] op_sel_hi:[1,1,0]
    v_pk_fma_f32 v[18:19], v[18:19], s[78:79], v[64:65] op_sel_hi:[1,1,0]
    v_pk_fma_f32 v[20:21], v[20:21], s[78:79], v[64:65] op_sel_hi:[1,1,0]
    v_pk_fma_f32 v[22:23], v[22:23], s[78:79], v[64:65] op_sel_hi:[1,1,0]
    v_exp_f32 v26, v26
    v_exp_f32 v27, v27
    v_mov_b64_e64 v[66:67], s[30:31]
    v_cvt_pk_bf16_f32 v24, v26, v27
    v_cvt_pk_bf16_f32 v25, v26, v27
    v_cvt_pk_bf16_f32 v10, v12, v13
    v_cvt_pk_bf16_f32 v11, v14, v15
    v_permlane32_swap_b32 v24, v25
    v_exp_f32 v16, v16
    v_exp_f32_e64 v17, v17
    v_mfma_f32_16x16x16_bf16 v[52:55], v[66:67], v[24:25], 0
    v_exp_f32 v18, v18
    v_exp_f32 v19, v19
    v_mfma_f32_16x16x16_bf16 v[68:71], v[8:9], v[24:25], 0
    v_exp_f32 v20, v20
    v_exp_f32 v21, v21
    v_mfma_f32_16x16x16_bf16 v[60:63], v[10:11], v[24:25], 0
    v_exp_f32 v22, v22
    v_exp_f32 v23, v23
    v_mov_b64 v[56:57], s[34:35]
    v_mov_b64 v[58:59], s[34:35]
    v_cvt_pk_bf16_f32 v16, v16, v17
    v_cvt_pk_bf16_f32 v17, v18, v19
    v_cvt_pk_bf16_f32 v18, v20, v21
    v_cvt_pk_bf16_f32 v19, v22, v23
    s_waitcnt vmcnt(5)
    v_add_u32 v64, s47, v3
    v_mfma_f32_16x16x32_bf16 v[52:55], v[56:59], v[16:19], v[52:55]
    v_mfma_f32_16x16x32_bf16 v[68:71], v[28:31], v[16:19], v[68:71]
    v_mfma_f32_16x16x32_bf16 v[60:63], v[32:35], v[16:19], v[60:63]
    ds_read_b128 v[44:47], v7 offset:18432
    ds_read_b128 v[48:51], v7 offset:19456
    ds_read_b128 v[8:11], v7 offset:20480
    ds_read_b128 v[12:15], v7 offset:21504
    ds_read_b128 v[28:31], v7 offset:22528
    ds_read_b128 v[32:35], v7 offset:23552
    v_rcp_f32 v52, v52
    s_mov_b64 exec, s[58:59]
    v_pk_mul_f32 v[68:69], v[68:69], v[52:53] op_sel_hi:[1,0]
    v_pk_mul_f32 v[70:71], v[70:71], v[52:53] op_sel_hi:[1,0]
    v_pk_mul_f32 v[60:61], v[60:61], v[52:53] op_sel_hi:[1,0]
    v_pk_mul_f32 v[62:63], v[62:63], v[52:53] op_sel_hi:[1,0]
    v_cvt_pk_bf16_f32 v68, v68, v60
    v_cvt_pk_bf16_f32 v69, v69, v61
    v_cvt_pk_bf16_f32 v70, v70, v62
    v_cvt_pk_bf16_f32 v71, v71, v63
    ds_write_b128 v64, v[68:71] offset:13824
    s_mov_b64 exec, -1
    v_subrev_u32 v65, 2304, v3
    v_cndmask_b32 v65, v65, v3, s[58:59]
    v_mov_b64 v[16:17], 0
    v_mov_b64 v[18:19], 0
    v_mov_b64 v[20:21], 0
    v_mov_b64 v[22:23], 0
    v_mov_b64 v[24:25], 0
    v_mov_b64 v[26:27], 0
    s_add_u32 m0, s49, 4096
    s_add_u32 s75, s45, 4096
    s_add_u32 s7, s7, 1
    s_cmp_lg_u32 s55, 0
    s_cbranch_scc1 L_five_24
    s_waitcnt lgkmcnt(0)
    s_barrier
    ds_read_b128 v[68:71], v65 offset:13824
    ds_read_b128 v[60:63], v65 offset:13888
    ds_read_b128 v[52:55], v65 offset:13952
    ds_read_b128 v[56:59], v65 offset:14016
    buffer_load_dwordx4 v6, s[8:11], s75 offen sc1 lds
    v_and_b32 v67, 0xc0, v6
    v_lshlrev_b32_e64 v66, 6, v67
    s_waitcnt lgkmcnt(3)
    v_smfmac_f32_16x16x64_bf16 v[16:19], v[68:71], v[36:43], v1
    ds_read_b128 v[36:39], v7 offset:24576
    ds_read_b128 v[40:43], v7 offset:25600
    s_waitcnt lgkmcnt(2)
    v_smfmac_f32_16x16x64_bf16 v[16:19], v[60:63], v[44:51], v1
    ds_read_b128 v[44:47], v7 offset:26624
    ds_read_b128 v[48:51], v7 offset:27648
    v_smfmac_f32_16x16x64_bf16 v[16:19], v[52:55], v[8:15], v1
    ds_read_b128 v[8:11], v7 offset:28672
    ds_read_b128 v[12:15], v7 offset:29696
    v_smfmac_f32_16x16x64_bf16 v[16:19], v[56:59], v[28:35], v1
    v_smfmac_f32_16x16x64_bf16 v[20:23], v[68:71], a[224:231], v1
    v_and_b32_e64 v67, 0x30, v6
    v_lshl_add_u32 v66, v67, 1, v66
    v_smfmac_f32_16x16x64_bf16 v[20:23], v[60:63], a[232:239], v1
    v_lshrrev_b32 v67, 8, v6
    v_lshl_add_u32 v66, v67, 3, v66
    v_smfmac_f32_16x16x64_bf16 v[20:23], v[52:55], a[240:247], v1
    s_nop 0
    v_cvt_pk_bf16_f32 v16, v16, v17
    v_cvt_pk_bf16_f32 v17, v18, v19
    v_smfmac_f32_16x16x64_bf16 v[20:23], v[56:59], a[248:255], v1
    v_and_or_b32 v16, v16, -2, s38
    buffer_store_dwordx2 v[16:17], v66, s[8:11], s16 offen sc1
    v_smfmac_f32_16x16x64_bf16 v[24:27], v[68:71], v[72:79], v1
    v_mov_b64_e64 v[16:17], 0
    v_mov_b64 v[18:19], 0
    v_smfmac_f32_16x16x64_bf16 v[24:27], v[60:63], v[80:87], v1
    s_waitcnt lgkmcnt(0)
    v_smfmac_f32_16x16x64_bf16 v[24:27], v[52:55], v[36:43], v1
    v_cvt_pk_bf16_f32 v20, v20, v21
    v_cvt_pk_bf16_f32 v21, v22, v23
    v_smfmac_f32_16x16x64_bf16 v[24:27], v[56:59], v[44:51], v1
    v_and_or_b32 v20, v20, -2, s38
    buffer_store_dwordx2 v[20:21], v66, s[8:11], s17 offen sc1
    v_smfmac_f32_16x16x64_bf16 v[16:19], v[68:71], v[8:15], v1
    v_smfmac_f32_16x16x64_bf16 v[16:19], v[60:63], v[88:95], v1
    v_smfmac_f32_16x16x64_bf16 v[16:19], v[52:55], v[96:103], v1
    s_nop 2
    v_cvt_pk_bf16_f32 v24, v24, v25
    v_cvt_pk_bf16_f32 v25, v26, v27
    v_smfmac_f32_16x16x64_bf16 v[16:19], v[56:59], v[104:111], v1
    v_and_or_b32 v24, v24, -2, s38
    buffer_store_dwordx2 v[24:25], v66, s[8:11], s18 offen sc1
    s_add_u32 s51, s51, 9216
    s_add_u32 s52, s52, 128
    s_add_u32 s43, s43, 1
    s_mov_b32 s40, 0
    s_mov_b32 s39, s51
    s_cmp_eq_u32 s53, 0
    v_cvt_pk_bf16_f32 v16, v16, v17
    v_cvt_pk_bf16_f32 v17, v18, v19
    v_and_or_b32 v16, v16, -2, s38
    buffer_store_dwordx2 v[16:17], v66, s[8:11], s19 offen sc1
    s_branch L_wojoin_25
L_five_24:
    s_waitcnt lgkmcnt(0)
    s_barrier
    ds_read_b128 v[68:71], v65 offset:13824
    ds_read_b128 v[60:63], v65 offset:13888
    ds_read_b128 v[52:55], v65 offset:13952
    ds_read_b128 v[56:59], v65 offset:14016
    buffer_load_dwordx4 v6, s[8:11], s75 offen sc1 lds
    v_and_b32 v67, 0xc0, v6
    v_lshlrev_b32_e64 v66, 6, v67
    s_waitcnt lgkmcnt(3)
    v_smfmac_f32_16x16x64_bf16 v[16:19], v[68:71], v[36:43], v1
    ds_read_b128 v[36:39], v7 offset:24576
    ds_read_b128 v[40:43], v7 offset:25600
    s_waitcnt lgkmcnt(2)
    v_smfmac_f32_16x16x64_bf16 v[16:19], v[60:63], v[44:51], v1
    ds_read_b128 v[44:47], v7 offset:26624
    ds_read_b128 v[48:51], v7 offset:27648
    v_smfmac_f32_16x16x64_bf16 v[16:19], v[52:55], v[8:15], v1
    ds_read_b128 v[8:11], v7 offset:28672
    ds_read_b128 v[12:15], v7 offset:29696
    v_smfmac_f32_16x16x64_bf16 v[16:19], v[56:59], v[28:35], v1
    ds_read_b128 v[28:31], v7 offset:30720
    ds_read_b128 v[32:35], v7 offset:31744
    v_smfmac_f32_16x16x64_bf16 v[20:23], v[68:71], a[224:231], v1
    v_and_b32_e64 v67, 0x30, v6
    v_lshl_add_u32 v66, v67, 1, v66
    v_smfmac_f32_16x16x64_bf16 v[20:23], v[60:63], a[232:239], v1
    v_lshrrev_b32_e64 v67, 8, v6
    v_lshl_add_u32 v66, v67, 3, v66
    v_smfmac_f32_16x16x64_bf16 v[20:23], v[52:55], a[240:247], v1
    v_cvt_pk_bf16_f32 v16, v16, v17
    v_cvt_pk_bf16_f32 v17, v18, v19
    v_smfmac_f32_16x16x64_bf16 v[20:23], v[56:59], a[248:255], v1
    v_and_or_b32 v16, v16, -2, s38
    buffer_store_dwordx2 v[16:17], v66, s[8:11], s16 offen sc1
    v_smfmac_f32_16x16x64_bf16 v[24:27], v[68:71], v[72:79], v1
    v_mov_b64_e64 v[16:17], 0
    v_mov_b64 v[18:19], 0
    v_smfmac_f32_16x16x64_bf16 v[24:27], v[60:63], v[80:87], v1
    s_waitcnt lgkmcnt(0)
    v_smfmac_f32_16x16x64_bf16 v[24:27], v[52:55], v[36:43], v1
    ds_read_b128 v[36:39], v7 offset:32768
    ds_read_b128 v[40:43], v7 offset:33792
    v_cvt_pk_bf16_f32 v20, v20, v21
    v_cvt_pk_bf16_f32 v21, v22, v23
    v_smfmac_f32_16x16x64_bf16 v[24:27], v[56:59], v[44:51], v1
    ds_read_b128 v[44:47], v7 offset:34816
    ds_read_b128 v[48:51], v7 offset:35840
    v_and_or_b32 v20, v20, -2, s38
    buffer_store_dwordx2 v[20:21], v66, s[8:11], s17 offen sc1
    v_smfmac_f32_16x16x64_bf16 v[16:19], v[68:71], v[8:15], v1
    ds_read_b128 v[8:11], v7 offset:36864
    ds_read_b128 v[12:15], v7 offset:37888
    v_mov_b64 v[20:21], 0
    v_mov_b64 v[22:23], 0
    v_smfmac_f32_16x16x64_bf16 v[16:19], v[60:63], v[88:95], v1
    v_smfmac_f32_16x16x64_bf16 v[16:19], v[52:55], v[96:103], v1
    v_cvt_pk_bf16_f32 v24, v24, v25
    v_cvt_pk_bf16_f32 v25, v26, v27
    v_smfmac_f32_16x16x64_bf16 v[16:19], v[56:59], v[104:111], v1
    v_and_or_b32 v24, v24, -2, s38
    buffer_store_dwordx2 v[24:25], v66, s[8:11], s18 offen sc1
    v_smfmac_f32_16x16x64_bf16 v[20:23], v[68:71], v[28:35], v1
    s_waitcnt lgkmcnt(4)
    v_smfmac_f32_16x16x64_bf16 v[20:23], v[60:63], v[36:43], v1
    s_waitcnt lgkmcnt(2)
    v_smfmac_f32_16x16x64_bf16 v[20:23], v[52:55], v[44:51], v1
    s_nop 0
    v_cvt_pk_bf16_f32 v16, v16, v17
    v_cvt_pk_bf16_f32 v17, v18, v19
    s_waitcnt lgkmcnt(0)
    v_smfmac_f32_16x16x64_bf16 v[20:23], v[56:59], v[8:15], v1
    v_and_or_b32 v16, v16, -2, s38
    buffer_store_dwordx2 v[16:17], v66, s[8:11], s19 offen sc1
    s_add_u32 s51, s51, 9216
    s_add_u32 s52, s52, 128
    s_add_u32 s43, s43, 1
    s_mov_b32 s40, 0
    s_mov_b32 s39, s51
    s_cmp_eq_u32 s53, 0
    v_cvt_pk_bf16_f32 v20, v20, v21
    v_cvt_pk_bf16_f32 v21, v22, v23
    v_and_or_b32 v20, v20, -2, s38
    buffer_store_dwordx2 v[20:21], v66, s[8:11], s20 offen sc1
L_wojoin_25:
    s_barrier
    v_mov_b32_e64 v24, 0
    s_cselect_b32 s76, 1, 0
    s_and_b32 s73, s7, 3
    s_xor_b32 s74, s73, 2
    s_mul_i32 s37, s74, 9216
    s_add_u32 s37, s37, s6
    s_mul_i32 s50, s73, 9216
    s_add_u32 s44, s50, s71
    s_add_u32 s44, s44, 0x140000
    s_add_u32 s50, s50, s6
    s_add_u32 s45, s45, 262144
    s_add_u32 s46, s46, 262144
    s_cmp_lg_u32 s76, 0
    s_cbranch_scc1 L_rj_29
    s_nop 11
    buffer_load_dwordx4 v[52:55], v6, s[8:11], s48 offen offset:0 sc1
    buffer_load_dwordx4 v[56:59], v6, s[8:11], s48 offen offset:1024 sc1
    buffer_load_dwordx4 v[60:63], v6, s[8:11], s48 offen offset:2048 sc1
    buffer_load_dwordx4 v[64:67], v6, s[8:11], s48 offen offset:3072 sc1
    v_and_b32_e64 v21, 16, v6
    v_mov_b32 v22, 0x3f80
    v_lshlrev_b32_e64 v21, v21, v22
    v_cndmask_b32 v68, 0, v21, s[60:61]
    v_cndmask_b32 v69, 0, v21, s[62:63]
    v_cndmask_b32 v70, 0, v21, s[64:65]
    v_cndmask_b32 v71, 0, v21, s[66:67]
    v_and_b32 v24, 0x70, v6
    v_bfe_u32 v25, v6, 8, 1
    v_lshl_add_u32 v24, v25, 3, v24
    v_lshrrev_b32 v25, 9, v6
    v_lshl_add_u32 v24, v25, 2, v24
    s_nop 13
L_ha_27:
    buffer_load_dwordx4 v[52:55], v6, s[8:11], s48 offen offset:0 sc1
    buffer_load_dwordx4 v[56:59], v6, s[8:11], s48 offen offset:1024 sc1
    buffer_load_dwordx4 v[60:63], v6, s[8:11], s48 offen offset:2048 sc1
    buffer_load_dwordx4 v[64:67], v6, s[8:11], s48 offen offset:3072 sc1
    s_add_u32 s40, s40, 1
    s_cmp_gt_u32 s40, 0x100000
    s_cbranch_scc1 L_abort
    s_waitcnt vmcnt(7)
    v_bitop3_b32 v20, v52, v54, s38 bitop3:0x7e
    v_mfma_f32_16x16x32_bf16 v[16:19], v[52:55], v[68:71], 0
    s_waitcnt vmcnt(6)
    v_bitop3_b32 v21, v56, v58, s38 bitop3:0x7e
    v_mfma_f32_16x16x32_bf16 v[16:19], v[56:59], v[68:71], v[16:19]
    s_waitcnt vmcnt(5)
    v_bitop3_b32 v22, v60, v62, s38 bitop3:0x7e
    v_mfma_f32_16x16x32_bf16 v[16:19], v[60:63], v[68:71], v[16:19]
    v_or3_b32 v20, v20, v21, v22
    s_waitcnt vmcnt(4)
    v_bitop3_b32 v23, v64, v66, s38 bitop3:0x7e
    v_mfma_f32_16x16x32_bf16 v[16:19], v[64:67], v[68:71], v[16:19]
    v_bitop3_b32 v20, v20, v23, 1 bitop3:0xa8
    v_cmp_ne_u32 vcc, 0, v20
    s_cbranch_vccnz L_ha_27
L_haok_28:
    v_readfirstlane_b32 s3, v0
    s_nop 3
    v_permlane32_swap_b32 v16, v18
    v_permlane32_swap_b32 v17, v19
    v_pk_add_f32 v[16:17], v[16:17], v[18:19]
    v_cvt_pk_bf16_f32 v0, v16, v17
    buffer_store_dword v0, v24, s[8:11], s50 offen sc1
    s_cmp_ge_u32 s43, 62
    s_cbranch_scc1 L_ea_30
L_nred_26:
    s_cmp_lt_u32 s43, 63
    s_barrier
    s_cbranch_scc1 L_cs_top
    s_waitcnt vmcnt(0)
    s_add_u32 s42, s42, 1
    s_cmp_lt_u32 s42, 2
    s_cbranch_scc1 L_cs_layer
    s_branch L_cs_end
L_fls_23:
    s_mov_b32 s40, 0
L_fl_31:
    s_add_u32 s40, s40, 1
    s_cmp_gt_u32 s40, 0x100000
    s_cbranch_scc1 L_abort
    buffer_load_dword v24, off, s[8:11], s52 sc1
    s_waitcnt vmcnt(0)
    v_cmp_eq_u32 vcc, 0, v24
    s_cbranch_vccnz L_fl_31
    s_branch L_rdy_22
L_rj_29:
    s_waitcnt vmcnt(0)
    v_readfirstlane_b32 s3, v0
    s_branch L_nred_26
L_ea_30:
    buffer_store_dword v0, v24, s[8:11], s39 offen sc1
    s_mov_b32 s39, 0x70000000
    s_branch L_nred_26
L_cs_end:
L_c_fin:
    s_branch L_exit
L_abort:
    s_nop 7
    v_mov_b32 v16, 0xdead
    buffer_store_dword v16, off, s[12:15], 0 offset:60
L_exit:
    s_endpgm
L_role_p:
    s_sub_u32 s46, s33, 32
    s_mul_i32 s41, s46, 21846
    s_lshr_b32 s41, s41, 16
    s_mul_i32 s42, s41, 3
    s_sub_u32 s42, s46, s42
    s_load_dwordx4 s[80:83], s[0:1], 16
    s_load_dwordx2 s[84:85], s[0:1], 32
    v_and_b32 v12, 15, v0
    v_lshrrev_b32 v13, 4, v0
    s_lshl_b32 s46, s41, 8
    s_lshl_b32 s56, s32, 6
    s_add_u32 s46, s46, s56
    v_lshlrev_b32 v15, 16, v13
    v_lshl_add_u32 v15, v12, 2, v15
    v_add_u32_e64 v15, s46, v15
    s_mov_b32 s47, 0x05040100
    s_mov_b32 s48, 0x07060302
    s_waitcnt lgkmcnt(0)
    s_mov_b32 s16, s80
    s_and_b32 s17, s81, 0xffff
    s_mov_b32 s18, 0x480000
    s_mov_b32 s19, 0x20000
    s_mov_b32 s20, s82
    s_and_b32 s21, s83, 0xffff
    s_mov_b32 s22, 0x480000
    s_mov_b32 s23, 0x20000
    s_mov_b32 s24, s84
    s_and_b32 s25, s85, 0xffff
    s_mov_b32 s26, 0x480000
    s_mov_b32 s27, 0x20000
    v_lshlrev_b32_e64 v8, 13, v13
    v_lshl_add_u32 v8, v12, 4, v8
    s_lshl_b32 s46, s41, 8
    s_lshl_b32 s57, s32, 17
    s_add_u32 s46, s46, s57
    v_add_u32 v8, s46, v8
    s_lshl_b32 s57, s32, 12
    v_lshlrev_b32 v10, 11, v13
    v_lshl_add_u32 v10, v12, 2, v10
    v_add_u32_e64 v10, s56, v10
    s_mov_b32 s46, 0x0
    s_add_u32 m0, s57, 16384
    s_nop 0
    buffer_load_dwordx4 v8, s[20:23], s46 offen lds
    s_mov_b32 s46, 0x8000
    s_add_u32 m0, s57, 17408
    s_nop 0
    buffer_load_dwordx4 v8, s[20:23], s46 offen lds
    s_mov_b32 s46, 0x10000
    s_add_u32 m0, s57, 18432
    s_nop 0
    buffer_load_dwordx4 v8, s[20:23], s46 offen lds
    s_mov_b32 s46, 0x18000
    s_add_u32 m0, s57, 19456
    s_nop 0
    buffer_load_dwordx4 v8, s[20:23], s46 offen lds
    s_mov_b32 s46, 0x80000
    s_add_u32 m0, s57, 32768
    s_nop 0
    buffer_load_dwordx4 v8, s[20:23], s46 offen lds
    s_mov_b32 s46, 0x88000
    s_add_u32 m0, s57, 33792
    s_nop 0
    buffer_load_dwordx4 v8, s[20:23], s46 offen lds
    s_mov_b32 s46, 0x90000
    s_add_u32 m0, s57, 34816
    s_nop 0
    buffer_load_dwordx4 v8, s[20:23], s46 offen lds
    s_mov_b32 s46, 0x98000
    s_add_u32 m0, s57, 35840
    s_nop 0
    buffer_load_dwordx4 v8, s[20:23], s46 offen lds
    s_mov_b32 s46, 0x100000
    s_add_u32 m0, s57, 49152
    s_nop 0
    buffer_load_dwordx4 v8, s[20:23], s46 offen lds
    s_mov_b32 s46, 0x108000
    s_add_u32 m0, s57, 50176
    s_nop 0
    buffer_load_dwordx4 v8, s[20:23], s46 offen lds
    s_mov_b32 s46, 0x110000
    s_add_u32 m0, s57, 51200
    s_nop 0
    buffer_load_dwordx4 v8, s[20:23], s46 offen lds
    s_mov_b32 s46, 0x118000
    s_add_u32 m0, s57, 52224
    s_nop 0
    buffer_load_dwordx4 v8, s[20:23], s46 offen lds
    s_mov_b32 s46, 0x180000
    s_add_u32 m0, s57, 65536
    s_nop 0
    buffer_load_dwordx4 v8, s[20:23], s46 offen lds
    s_mov_b32 s46, 0x188000
    s_add_u32 m0, s57, 66560
    s_nop 0
    buffer_load_dwordx4 v8, s[20:23], s46 offen lds
    s_mov_b32 s46, 0x190000
    s_add_u32 m0, s57, 67584
    s_nop 0
    buffer_load_dwordx4 v8, s[20:23], s46 offen lds
    s_mov_b32 s46, 0x198000
    s_add_u32 m0, s57, 68608
    s_nop 0
    buffer_load_dwordx4 v8, s[20:23], s46 offen lds
    s_mov_b32 s46, 0x200000
    s_add_u32 m0, s57, 81920
    s_nop 0
    buffer_load_dwordx4 v8, s[20:23], s46 offen lds
    s_mov_b32 s46, 0x208000
    s_add_u32 m0, s57, 82944
    s_nop 0
    buffer_load_dwordx4 v8, s[20:23], s46 offen lds
    s_mov_b32 s46, 0x210000
    s_add_u32 m0, s57, 83968
    s_nop 0
    buffer_load_dwordx4 v8, s[20:23], s46 offen lds
    s_mov_b32 s46, 0x218000
    s_add_u32 m0, s57, 84992
    s_nop 0
    buffer_load_dwordx4 v8, s[20:23], s46 offen lds
    s_mov_b32 s46, 0x280000
    s_add_u32 m0, s57, 98304
    s_nop 0
    buffer_load_dwordx4 v8, s[20:23], s46 offen lds
    s_mov_b32 s46, 0x288000
    s_add_u32 m0, s57, 99328
    s_nop 0
    buffer_load_dwordx4 v8, s[20:23], s46 offen lds
    s_mov_b32 s46, 0x290000
    s_add_u32 m0, s57, 100352
    s_nop 0
    buffer_load_dwordx4 v8, s[20:23], s46 offen lds
    s_mov_b32 s46, 0x298000
    s_add_u32 m0, s57, 101376
    s_nop 0
    buffer_load_dwordx4 v8, s[20:23], s46 offen lds
    s_mov_b32 s46, 0x300000
    s_add_u32 m0, s57, 114688
    s_nop 0
    buffer_load_dwordx4 v8, s[20:23], s46 offen lds
    s_mov_b32 s46, 0x308000
    s_add_u32 m0, s57, 115712
    s_nop 0
    buffer_load_dwordx4 v8, s[20:23], s46 offen lds
    s_mov_b32 s46, 0x310000
    s_add_u32 m0, s57, 116736
    s_nop 0
    buffer_load_dwordx4 v8, s[20:23], s46 offen lds
    s_mov_b32 s46, 0x318000
    s_add_u32 m0, s57, 117760
    s_nop 0
    buffer_load_dwordx4 v8, s[20:23], s46 offen lds
    s_mov_b32 s46, 0x380000
    s_add_u32 m0, s57, 131072
    s_nop 0
    buffer_load_dwordx4 v8, s[20:23], s46 offen lds
    s_mov_b32 s46, 0x388000
    s_add_u32 m0, s57, 132096
    s_nop 0
    buffer_load_dwordx4 v8, s[20:23], s46 offen lds
    s_mov_b32 s46, 0x390000
    s_add_u32 m0, s57, 133120
    s_nop 0
    buffer_load_dwordx4 v8, s[20:23], s46 offen lds
    s_mov_b32 s46, 0x398000
    s_add_u32 m0, s57, 134144
    s_nop 0
    buffer_load_dwordx4 v8, s[20:23], s46 offen lds
    s_waitcnt vmcnt(28)
    s_barrier
    s_mov_b32 s46, 0x400000
    s_add_u32 m0, s57, 147456
    s_nop 0
    buffer_load_dwordx4 v8, s[20:23], s46 offen lds
    s_mov_b32 s46, 0x408000
    s_add_u32 m0, s57, 148480
    s_nop 0
    buffer_load_dwordx4 v8, s[20:23], s46 offen lds
    s_mov_b32 s46, 0x410000
    s_add_u32 m0, s57, 149504
    s_nop 0
    buffer_load_dwordx4 v8, s[20:23], s46 offen lds
    s_mov_b32 s46, 0x418000
    s_add_u32 m0, s57, 150528
    s_nop 0
    buffer_load_dwordx4 v8, s[20:23], s46 offen lds
    v_add_u32 v11, 16384, v10
    ds_read2st64_b32 v[16:17], v11 offset0:0 offset1:1
    ds_read2st64_b32 v[18:19], v11 offset0:2 offset1:3
    ds_read2st64_b32 v[20:21], v11 offset0:4 offset1:5
    ds_read2st64_b32 v[22:23], v11 offset0:6 offset1:7
    ds_read2st64_b32 v[24:25], v11 offset0:32 offset1:33
    ds_read2st64_b32 v[26:27], v11 offset0:34 offset1:35
    ds_read2st64_b32 v[28:29], v11 offset0:36 offset1:37
    ds_read2st64_b32 v[30:31], v11 offset0:38 offset1:39
    s_waitcnt lgkmcnt(0)
    v_perm_b32 v1, v17, v16, s47
    v_accvgpr_write_b32 a144, v1
    v_perm_b32 v2, v19, v18, s47
    v_accvgpr_write_b32 a145, v2
    v_perm_b32 v1, v21, v20, s47
    v_accvgpr_write_b32 a146, v1
    v_perm_b32 v2, v23, v22, s47
    v_accvgpr_write_b32 a147, v2
    v_perm_b32 v1, v17, v16, s48
    v_accvgpr_write_b32 a148, v1
    v_perm_b32 v2, v19, v18, s48
    v_accvgpr_write_b32 a149, v2
    v_perm_b32 v1, v21, v20, s48
    v_accvgpr_write_b32 a150, v1
    v_perm_b32 v2, v23, v22, s48
    v_accvgpr_write_b32 a151, v2
    v_perm_b32 v1, v25, v24, s47
    v_accvgpr_write_b32 a152, v1
    v_perm_b32 v2, v27, v26, s47
    v_accvgpr_write_b32 a153, v2
    v_perm_b32 v1, v29, v28, s47
    v_accvgpr_write_b32 a154, v1
    v_perm_b32 v2, v31, v30, s47
    v_accvgpr_write_b32 a155, v2
    v_perm_b32 v1, v25, v24, s48
    v_accvgpr_write_b32 a156, v1
    v_perm_b32 v2, v27, v26, s48
    v_accvgpr_write_b32 a157, v2
    v_perm_b32 v1, v29, v28, s48
    v_accvgpr_write_b32 a158, v1
    v_perm_b32 v2, v31, v30, s48
    v_accvgpr_write_b32 a159, v2
    s_waitcnt vmcnt(28)
    s_barrier
    s_mov_b32 s46, 0x0
    s_add_u32 m0, s57, 16384
    s_nop 0
    buffer_load_dwordx4 v8, s[24:27], s46 offen lds
    s_mov_b32 s46, 0x8000
    s_add_u32 m0, s57, 17408
    s_nop 0
    buffer_load_dwordx4 v8, s[24:27], s46 offen lds
    s_mov_b32 s46, 0x10000
    s_add_u32 m0, s57, 18432
    s_nop 0
    buffer_load_dwordx4 v8, s[24:27], s46 offen lds
    s_mov_b32 s46, 0x18000
    s_add_u32 m0, s57, 19456
    s_nop 0
    buffer_load_dwordx4 v8, s[24:27], s46 offen lds
    v_add_u32 v11, 32768, v10
    ds_read2st64_b32 v[16:17], v11 offset0:0 offset1:1
    ds_read2st64_b32 v[18:19], v11 offset0:2 offset1:3
    ds_read2st64_b32 v[20:21], v11 offset0:4 offset1:5
    ds_read2st64_b32 v[22:23], v11 offset0:6 offset1:7
    ds_read2st64_b32 v[24:25], v11 offset0:32 offset1:33
    ds_read2st64_b32 v[26:27], v11 offset0:34 offset1:35
    ds_read2st64_b32 v[28:29], v11 offset0:36 offset1:37
    ds_read2st64_b32 v[30:31], v11 offset0:38 offset1:39
    s_waitcnt lgkmcnt(0)
    v_perm_b32 v1, v17, v16, s47
    v_accvgpr_write_b32 a160, v1
    v_perm_b32 v2, v19, v18, s47
    v_accvgpr_write_b32 a161, v2
    v_perm_b32 v1, v21, v20, s47
    v_accvgpr_write_b32 a162, v1
    v_perm_b32 v2, v23, v22, s47
    v_accvgpr_write_b32 a163, v2
    v_perm_b32 v1, v17, v16, s48
    v_accvgpr_write_b32 a164, v1
    v_perm_b32 v2, v19, v18, s48
    v_accvgpr_write_b32 a165, v2
    v_perm_b32 v1, v21, v20, s48
    v_accvgpr_write_b32 a166, v1
    v_perm_b32 v2, v23, v22, s48
    v_accvgpr_write_b32 a167, v2
    v_perm_b32 v1, v25, v24, s47
    v_accvgpr_write_b32 a168, v1
    v_perm_b32 v2, v27, v26, s47
    v_accvgpr_write_b32 a169, v2
    v_perm_b32 v1, v29, v28, s47
    v_accvgpr_write_b32 a170, v1
    v_perm_b32 v2, v31, v30, s47
    v_accvgpr_write_b32 a171, v2
    v_perm_b32 v1, v25, v24, s48
    v_accvgpr_write_b32 a172, v1
    v_perm_b32 v2, v27, v26, s48
    v_accvgpr_write_b32 a173, v2
    v_perm_b32 v1, v29, v28, s48
    v_accvgpr_write_b32 a174, v1
    v_perm_b32 v2, v31, v30, s48
    v_accvgpr_write_b32 a175, v2
    s_waitcnt vmcnt(28)
    s_barrier
    s_mov_b32 s46, 0x80000
    s_add_u32 m0, s57, 32768
    s_nop 0
    buffer_load_dwordx4 v8, s[24:27], s46 offen lds
    s_mov_b32 s46, 0x88000
    s_add_u32 m0, s57, 33792
    s_nop 0
    buffer_load_dwordx4 v8, s[24:27], s46 offen lds
    s_mov_b32 s46, 0x90000
    s_add_u32 m0, s57, 34816
    s_nop 0
    buffer_load_dwordx4 v8, s[24:27], s46 offen lds
    s_mov_b32 s46, 0x98000
    s_add_u32 m0, s57, 35840
    s_nop 0
    buffer_load_dwordx4 v8, s[24:27], s46 offen lds
    v_add_u32 v11, 49152, v10
    ds_read2st64_b32 v[16:17], v11 offset0:0 offset1:1
    ds_read2st64_b32 v[18:19], v11 offset0:2 offset1:3
    ds_read2st64_b32 v[20:21], v11 offset0:4 offset1:5
    ds_read2st64_b32 v[22:23], v11 offset0:6 offset1:7
    ds_read2st64_b32 v[24:25], v11 offset0:32 offset1:33
    ds_read2st64_b32 v[26:27], v11 offset0:34 offset1:35
    ds_read2st64_b32 v[28:29], v11 offset0:36 offset1:37
    ds_read2st64_b32 v[30:31], v11 offset0:38 offset1:39
    s_waitcnt lgkmcnt(0)
    v_perm_b32 v1, v17, v16, s47
    v_accvgpr_write_b32 a176, v1
    v_perm_b32 v2, v19, v18, s47
    v_accvgpr_write_b32 a177, v2
    v_perm_b32 v1, v21, v20, s47
    v_accvgpr_write_b32 a178, v1
    v_perm_b32 v2, v23, v22, s47
    v_accvgpr_write_b32 a179, v2
    v_perm_b32 v1, v17, v16, s48
    v_accvgpr_write_b32 a180, v1
    v_perm_b32 v2, v19, v18, s48
    v_accvgpr_write_b32 a181, v2
    v_perm_b32 v1, v21, v20, s48
    v_accvgpr_write_b32 a182, v1
    v_perm_b32 v2, v23, v22, s48
    v_accvgpr_write_b32 a183, v2
    v_perm_b32 v1, v25, v24, s47
    v_accvgpr_write_b32 a184, v1
    v_perm_b32 v2, v27, v26, s47
    v_accvgpr_write_b32 a185, v2
    v_perm_b32 v1, v29, v28, s47
    v_accvgpr_write_b32 a186, v1
    v_perm_b32 v2, v31, v30, s47
    v_accvgpr_write_b32 a187, v2
    v_perm_b32 v1, v25, v24, s48
    v_accvgpr_write_b32 a188, v1
    v_perm_b32 v2, v27, v26, s48
    v_accvgpr_write_b32 a189, v2
    v_perm_b32 v1, v29, v28, s48
    v_accvgpr_write_b32 a190, v1
    v_perm_b32 v2, v31, v30, s48
    v_accvgpr_write_b32 a191, v2
    s_waitcnt vmcnt(28)
    s_barrier
    s_mov_b32 s46, 0x100000
    s_add_u32 m0, s57, 49152
    s_nop 0
    buffer_load_dwordx4 v8, s[24:27], s46 offen lds
    s_mov_b32 s46, 0x108000
    s_add_u32 m0, s57, 50176
    s_nop 0
    buffer_load_dwordx4 v8, s[24:27], s46 offen lds
    s_mov_b32 s46, 0x110000
    s_add_u32 m0, s57, 51200
    s_nop 0
    buffer_load_dwordx4 v8, s[24:27], s46 offen lds
    s_mov_b32 s46, 0x118000
    s_add_u32 m0, s57, 52224
    s_nop 0
    buffer_load_dwordx4 v8, s[24:27], s46 offen lds
    v_add_u32 v11, 65536, v10
    ds_read2st64_b32 v[16:17], v11 offset0:0 offset1:1
    ds_read2st64_b32 v[18:19], v11 offset0:2 offset1:3
    ds_read2st64_b32 v[20:21], v11 offset0:4 offset1:5
    ds_read2st64_b32 v[22:23], v11 offset0:6 offset1:7
    ds_read2st64_b32 v[24:25], v11 offset0:32 offset1:33
    ds_read2st64_b32 v[26:27], v11 offset0:34 offset1:35
    ds_read2st64_b32 v[28:29], v11 offset0:36 offset1:37
    ds_read2st64_b32 v[30:31], v11 offset0:38 offset1:39
    s_waitcnt lgkmcnt(0)
    v_perm_b32 v1, v17, v16, s47
    v_accvgpr_write_b32 a192, v1
    v_perm_b32 v2, v19, v18, s47
    v_accvgpr_write_b32 a193, v2
    v_perm_b32 v1, v21, v20, s47
    v_accvgpr_write_b32 a194, v1
    v_perm_b32 v2, v23, v22, s47
    v_accvgpr_write_b32 a195, v2
    v_perm_b32 v1, v17, v16, s48
    v_accvgpr_write_b32 a196, v1
    v_perm_b32 v2, v19, v18, s48
    v_accvgpr_write_b32 a197, v2
    v_perm_b32 v1, v21, v20, s48
    v_accvgpr_write_b32 a198, v1
    v_perm_b32 v2, v23, v22, s48
    v_accvgpr_write_b32 a199, v2
    v_perm_b32 v1, v25, v24, s47
    v_accvgpr_write_b32 a200, v1
    v_perm_b32 v2, v27, v26, s47
    v_accvgpr_write_b32 a201, v2
    v_perm_b32 v1, v29, v28, s47
    v_accvgpr_write_b32 a202, v1
    v_perm_b32 v2, v31, v30, s47
    v_accvgpr_write_b32 a203, v2
    v_perm_b32 v1, v25, v24, s48
    v_accvgpr_write_b32 a204, v1
    v_perm_b32 v2, v27, v26, s48
    v_accvgpr_write_b32 a205, v2
    v_perm_b32 v1, v29, v28, s48
    v_accvgpr_write_b32 a206, v1
    v_perm_b32 v2, v31, v30, s48
    v_accvgpr_write_b32 a207, v2
    s_waitcnt vmcnt(28)
    s_barrier
    s_mov_b32 s46, 0x180000
    s_add_u32 m0, s57, 65536
    s_nop 0
    buffer_load_dwordx4 v8, s[24:27], s46 offen lds
    s_mov_b32 s46, 0x188000
    s_add_u32 m0, s57, 66560
    s_nop 0
    buffer_load_dwordx4 v8, s[24:27], s46 offen lds
    s_mov_b32 s46, 0x190000
    s_add_u32 m0, s57, 67584
    s_nop 0
    buffer_load_dwordx4 v8, s[24:27], s46 offen lds
    s_mov_b32 s46, 0x198000
    s_add_u32 m0, s57, 68608
    s_nop 0
    buffer_load_dwordx4 v8, s[24:27], s46 offen lds
    v_add_u32 v11, 81920, v10
    ds_read2st64_b32 v[16:17], v11 offset0:0 offset1:1
    ds_read2st64_b32 v[18:19], v11 offset0:2 offset1:3
    ds_read2st64_b32 v[20:21], v11 offset0:4 offset1:5
    ds_read2st64_b32 v[22:23], v11 offset0:6 offset1:7
    ds_read2st64_b32 v[24:25], v11 offset0:32 offset1:33
    ds_read2st64_b32 v[26:27], v11 offset0:34 offset1:35
    ds_read2st64_b32 v[28:29], v11 offset0:36 offset1:37
    ds_read2st64_b32 v[30:31], v11 offset0:38 offset1:39
    s_waitcnt lgkmcnt(0)
    v_perm_b32 v1, v17, v16, s47
    v_accvgpr_write_b32 a208, v1
    v_perm_b32 v2, v19, v18, s47
    v_accvgpr_write_b32 a209, v2
    v_perm_b32 v1, v21, v20, s47
    v_accvgpr_write_b32 a210, v1
    v_perm_b32 v2, v23, v22, s47
    v_accvgpr_write_b32 a211, v2
    v_perm_b32 v1, v17, v16, s48
    v_accvgpr_write_b32 a212, v1
    v_perm_b32 v2, v19, v18, s48
    v_accvgpr_write_b32 a213, v2
    v_perm_b32 v1, v21, v20, s48
    v_accvgpr_write_b32 a214, v1
    v_perm_b32 v2, v23, v22, s48
    v_accvgpr_write_b32 a215, v2
    v_perm_b32 v1, v25, v24, s47
    v_accvgpr_write_b32 a216, v1
    v_perm_b32 v2, v27, v26, s47
    v_accvgpr_write_b32 a217, v2
    v_perm_b32 v1, v29, v28, s47
    v_accvgpr_write_b32 a218, v1
    v_perm_b32 v2, v31, v30, s47
    v_accvgpr_write_b32 a219, v2
    v_perm_b32 v1, v25, v24, s48
    v_accvgpr_write_b32 a220, v1
    v_perm_b32 v2, v27, v26, s48
    v_accvgpr_write_b32 a221, v2
    v_perm_b32 v1, v29, v28, s48
    v_accvgpr_write_b32 a222, v1
    v_perm_b32 v2, v31, v30, s48
    v_accvgpr_write_b32 a223, v2
    s_waitcnt vmcnt(28)
    s_barrier
    s_mov_b32 s46, 0x200000
    s_add_u32 m0, s57, 81920
    s_nop 0
    buffer_load_dwordx4 v8, s[24:27], s46 offen lds
    s_mov_b32 s46, 0x208000
    s_add_u32 m0, s57, 82944
    s_nop 0
    buffer_load_dwordx4 v8, s[24:27], s46 offen lds
    s_mov_b32 s46, 0x210000
    s_add_u32 m0, s57, 83968
    s_nop 0
    buffer_load_dwordx4 v8, s[24:27], s46 offen lds
    s_mov_b32 s46, 0x218000
    s_add_u32 m0, s57, 84992
    s_nop 0
    buffer_load_dwordx4 v8, s[24:27], s46 offen lds
    v_add_u32 v11, 98304, v10
    ds_read2st64_b32 v[16:17], v11 offset0:0 offset1:1
    ds_read2st64_b32 v[18:19], v11 offset0:2 offset1:3
    ds_read2st64_b32 v[20:21], v11 offset0:4 offset1:5
    ds_read2st64_b32 v[22:23], v11 offset0:6 offset1:7
    ds_read2st64_b32 v[24:25], v11 offset0:32 offset1:33
    ds_read2st64_b32 v[26:27], v11 offset0:34 offset1:35
    ds_read2st64_b32 v[28:29], v11 offset0:36 offset1:37
    ds_read2st64_b32 v[30:31], v11 offset0:38 offset1:39
    s_waitcnt lgkmcnt(0)
    v_perm_b32 v1, v17, v16, s47
    v_accvgpr_write_b32 a224, v1
    v_perm_b32 v2, v19, v18, s47
    v_accvgpr_write_b32 a225, v2
    v_perm_b32 v1, v21, v20, s47
    v_accvgpr_write_b32 a226, v1
    v_perm_b32 v2, v23, v22, s47
    v_accvgpr_write_b32 a227, v2
    v_perm_b32 v1, v17, v16, s48
    v_accvgpr_write_b32 a228, v1
    v_perm_b32 v2, v19, v18, s48
    v_accvgpr_write_b32 a229, v2
    v_perm_b32 v1, v21, v20, s48
    v_accvgpr_write_b32 a230, v1
    v_perm_b32 v2, v23, v22, s48
    v_accvgpr_write_b32 a231, v2
    v_perm_b32 v1, v25, v24, s47
    v_accvgpr_write_b32 a232, v1
    v_perm_b32 v2, v27, v26, s47
    v_accvgpr_write_b32 a233, v2
    v_perm_b32 v1, v29, v28, s47
    v_accvgpr_write_b32 a234, v1
    v_perm_b32 v2, v31, v30, s47
    v_accvgpr_write_b32 a235, v2
    v_perm_b32 v1, v25, v24, s48
    v_accvgpr_write_b32 a236, v1
    v_perm_b32 v2, v27, v26, s48
    v_accvgpr_write_b32 a237, v2
    v_perm_b32 v1, v29, v28, s48
    v_accvgpr_write_b32 a238, v1
    v_perm_b32 v2, v31, v30, s48
    v_accvgpr_write_b32 a239, v2
    s_waitcnt vmcnt(28)
    s_barrier
    s_mov_b32 s46, 0x280000
    s_add_u32 m0, s57, 98304
    s_nop 0
    buffer_load_dwordx4 v8, s[24:27], s46 offen lds
    s_mov_b32 s46, 0x288000
    s_add_u32 m0, s57, 99328
    s_nop 0
    buffer_load_dwordx4 v8, s[24:27], s46 offen lds
    s_mov_b32 s46, 0x290000
    s_add_u32 m0, s57, 100352
    s_nop 0
    buffer_load_dwordx4 v8, s[24:27], s46 offen lds
    s_mov_b32 s46, 0x298000
    s_add_u32 m0, s57, 101376
    s_nop 0
    buffer_load_dwordx4 v8, s[24:27], s46 offen lds
    v_add_u32 v11, 114688, v10
    ds_read2st64_b32 v[16:17], v11 offset0:0 offset1:1
    ds_read2st64_b32 v[18:19], v11 offset0:2 offset1:3
    ds_read2st64_b32 v[20:21], v11 offset0:4 offset1:5
    ds_read2st64_b32 v[22:23], v11 offset0:6 offset1:7
    ds_read2st64_b32 v[24:25], v11 offset0:32 offset1:33
    ds_read2st64_b32 v[26:27], v11 offset0:34 offset1:35
    ds_read2st64_b32 v[28:29], v11 offset0:36 offset1:37
    ds_read2st64_b32 v[30:31], v11 offset0:38 offset1:39
    s_waitcnt lgkmcnt(0)
    v_perm_b32 v1, v17, v16, s47
    v_accvgpr_write_b32 a240, v1
    v_perm_b32 v2, v19, v18, s47
    v_accvgpr_write_b32 a241, v2
    v_perm_b32 v1, v21, v20, s47
    v_accvgpr_write_b32 a242, v1
    v_perm_b32 v2, v23, v22, s47
    v_accvgpr_write_b32 a243, v2
    v_perm_b32 v1, v17, v16, s48
    v_accvgpr_write_b32 a244, v1
    v_perm_b32 v2, v19, v18, s48
    v_accvgpr_write_b32 a245, v2
    v_perm_b32 v1, v21, v20, s48
    v_accvgpr_write_b32 a246, v1
    v_perm_b32 v2, v23, v22, s48
    v_accvgpr_write_b32 a247, v2
    v_perm_b32 v1, v25, v24, s47
    v_accvgpr_write_b32 a248, v1
    v_perm_b32 v2, v27, v26, s47
    v_accvgpr_write_b32 a249, v2
    v_perm_b32 v1, v29, v28, s47
    v_accvgpr_write_b32 a250, v1
    v_perm_b32 v2, v31, v30, s47
    v_accvgpr_write_b32 a251, v2
    v_perm_b32 v1, v25, v24, s48
    v_accvgpr_write_b32 a252, v1
    v_perm_b32 v2, v27, v26, s48
    v_accvgpr_write_b32 a253, v2
    v_perm_b32 v1, v29, v28, s48
    v_accvgpr_write_b32 a254, v1
    v_perm_b32 v2, v31, v30, s48
    v_accvgpr_write_b32 a255, v2
    s_waitcnt vmcnt(28)
    s_barrier
    s_mov_b32 s46, 0x300000
    s_add_u32 m0, s57, 114688
    s_nop 0
    buffer_load_dwordx4 v8, s[24:27], s46 offen lds
    s_mov_b32 s46, 0x308000
    s_add_u32 m0, s57, 115712
    s_nop 0
    buffer_load_dwordx4 v8, s[24:27], s46 offen lds
    s_mov_b32 s46, 0x310000
    s_add_u32 m0, s57, 116736
    s_nop 0
    buffer_load_dwordx4 v8, s[24:27], s46 offen lds
    s_mov_b32 s46, 0x318000
    s_add_u32 m0, s57, 117760
    s_nop 0
    buffer_load_dwordx4 v8, s[24:27], s46 offen lds
    v_add_u32 v11, 131072, v10
    ds_read2st64_b32 v[16:17], v11 offset0:0 offset1:1
    ds_read2st64_b32 v[18:19], v11 offset0:2 offset1:3
    ds_read2st64_b32 v[20:21], v11 offset0:4 offset1:5
    ds_read2st64_b32 v[22:23], v11 offset0:6 offset1:7
    ds_read2st64_b32 v[24:25], v11 offset0:32 offset1:33
    ds_read2st64_b32 v[26:27], v11 offset0:34 offset1:35
    ds_read2st64_b32 v[28:29], v11 offset0:36 offset1:37
    ds_read2st64_b32 v[30:31], v11 offset0:38 offset1:39
    s_waitcnt lgkmcnt(0)
    v_perm_b32 v80, v17, v16, s47
    v_perm_b32 v81, v19, v18, s47
    v_perm_b32 v82, v21, v20, s47
    v_perm_b32 v83, v23, v22, s47
    v_perm_b32 v84, v17, v16, s48
    v_perm_b32 v85, v19, v18, s48
    v_perm_b32 v86, v21, v20, s48
    v_perm_b32 v87, v23, v22, s48
    v_perm_b32 v88, v25, v24, s47
    v_perm_b32 v89, v27, v26, s47
    v_perm_b32 v90, v29, v28, s47
    v_perm_b32 v91, v31, v30, s47
    v_perm_b32 v92, v25, v24, s48
    v_perm_b32 v93, v27, v26, s48
    v_perm_b32 v94, v29, v28, s48
    v_perm_b32 v95, v31, v30, s48
    s_waitcnt vmcnt(28)
    s_barrier
    s_mov_b32 s46, 0x380000
    s_add_u32 m0, s57, 131072
    s_nop 0
    buffer_load_dwordx4 v8, s[24:27], s46 offen lds
    s_mov_b32 s46, 0x388000
    s_add_u32 m0, s57, 132096
    s_nop 0
    buffer_load_dwordx4 v8, s[24:27], s46 offen lds
    s_mov_b32 s46, 0x390000
    s_add_u32 m0, s57, 133120
    s_nop 0
    buffer_load_dwordx4 v8, s[24:27], s46 offen lds
    s_mov_b32 s46, 0x398000
    s_add_u32 m0, s57, 134144
    s_nop 0
    buffer_load_dwordx4 v8, s[24:27], s46 offen lds
    v_add_u32 v11, 147456, v10
    ds_read2st64_b32 v[16:17], v11 offset0:0 offset1:1
    ds_read2st64_b32 v[18:19], v11 offset0:2 offset1:3
    ds_read2st64_b32 v[20:21], v11 offset0:4 offset1:5
    ds_read2st64_b32 v[22:23], v11 offset0:6 offset1:7
    ds_read2st64_b32 v[24:25], v11 offset0:32 offset1:33
    ds_read2st64_b32 v[26:27], v11 offset0:34 offset1:35
    ds_read2st64_b32 v[28:29], v11 offset0:36 offset1:37
    ds_read2st64_b32 v[30:31], v11 offset0:38 offset1:39
    s_waitcnt lgkmcnt(0)
    v_perm_b32 v96, v17, v16, s47
    v_perm_b32 v97, v19, v18, s47
    v_perm_b32 v98, v21, v20, s47
    v_perm_b32 v99, v23, v22, s47
    v_perm_b32 v100, v17, v16, s48
    v_perm_b32 v101, v19, v18, s48
    v_perm_b32 v102, v21, v20, s48
    v_perm_b32 v103, v23, v22, s48
    v_perm_b32 v104, v25, v24, s47
    v_perm_b32 v105, v27, v26, s47
    v_perm_b32 v106, v29, v28, s47
    v_perm_b32 v107, v31, v30, s47
    v_perm_b32 v108, v25, v24, s48
    v_perm_b32 v109, v27, v26, s48
    v_perm_b32 v110, v29, v28, s48
    v_perm_b32 v111, v31, v30, s48
    s_waitcnt vmcnt(28)
    s_barrier
    s_mov_b32 s46, 0x400000
    s_add_u32 m0, s57, 147456
    s_nop 0
    buffer_load_dwordx4 v8, s[24:27], s46 offen lds
    s_mov_b32 s46, 0x408000
    s_add_u32 m0, s57, 148480
    s_nop 0
    buffer_load_dwordx4 v8, s[24:27], s46 offen lds
    s_mov_b32 s46, 0x410000
    s_add_u32 m0, s57, 149504
    s_nop 0
    buffer_load_dwordx4 v8, s[24:27], s46 offen lds
    s_mov_b32 s46, 0x418000
    s_add_u32 m0, s57, 150528
    s_nop 0
    buffer_load_dwordx4 v8, s[24:27], s46 offen lds
    v_add_u32 v11, 16384, v10
    ds_read2st64_b32 v[16:17], v11 offset0:0 offset1:1
    ds_read2st64_b32 v[18:19], v11 offset0:2 offset1:3
    ds_read2st64_b32 v[20:21], v11 offset0:4 offset1:5
    ds_read2st64_b32 v[22:23], v11 offset0:6 offset1:7
    ds_read2st64_b32 v[24:25], v11 offset0:32 offset1:33
    ds_read2st64_b32 v[26:27], v11 offset0:34 offset1:35
    ds_read2st64_b32 v[28:29], v11 offset0:36 offset1:37
    ds_read2st64_b32 v[30:31], v11 offset0:38 offset1:39
    s_waitcnt lgkmcnt(0)
    v_perm_b32 v112, v17, v16, s47
    v_perm_b32 v113, v19, v18, s47
    v_perm_b32 v114, v21, v20, s47
    v_perm_b32 v115, v23, v22, s47
    v_perm_b32 v116, v17, v16, s48
    v_perm_b32 v117, v19, v18, s48
    v_perm_b32 v118, v21, v20, s48
    v_perm_b32 v119, v23, v22, s48
    v_perm_b32 v120, v25, v24, s47
    v_perm_b32 v121, v27, v26, s47
    v_perm_b32 v122, v29, v28, s47
    v_perm_b32 v123, v31, v30, s47
    v_perm_b32 v124, v25, v24, s48
    v_perm_b32 v125, v27, v26, s48
    v_perm_b32 v126, v29, v28, s48
    v_perm_b32 v127, v31, v30, s48
    s_waitcnt vmcnt(28)
    s_barrier
    s_mov_b32 s46, 0x0
    s_add_u32 m0, s57, 16384
    s_nop 0
    buffer_load_dwordx4 v8, s[16:19], s46 offen lds
    s_mov_b32 s46, 0x8000
    s_add_u32 m0, s57, 17408
    s_nop 0
    buffer_load_dwordx4 v8, s[16:19], s46 offen lds
    s_mov_b32 s46, 0x10000
    s_add_u32 m0, s57, 18432
    s_nop 0
    buffer_load_dwordx4 v8, s[16:19], s46 offen lds
    s_mov_b32 s46, 0x18000
    s_add_u32 m0, s57, 19456
    s_nop 0
    buffer_load_dwordx4 v8, s[16:19], s46 offen lds
    v_add_u32 v11, 32768, v10
    ds_read2st64_b32 v[16:17], v11 offset0:0 offset1:1
    ds_read2st64_b32 v[18:19], v11 offset0:2 offset1:3
    ds_read2st64_b32 v[20:21], v11 offset0:4 offset1:5
    ds_read2st64_b32 v[22:23], v11 offset0:6 offset1:7
    ds_read2st64_b32 v[24:25], v11 offset0:32 offset1:33
    ds_read2st64_b32 v[26:27], v11 offset0:34 offset1:35
    ds_read2st64_b32 v[28:29], v11 offset0:36 offset1:37
    ds_read2st64_b32 v[30:31], v11 offset0:38 offset1:39
    s_waitcnt lgkmcnt(0)
    v_perm_b32 v128, v17, v16, s47
    v_perm_b32 v129, v19, v18, s47
    v_perm_b32 v130, v21, v20, s47
    v_perm_b32 v131, v23, v22, s47
    v_perm_b32 v132, v17, v16, s48
    v_perm_b32 v133, v19, v18, s48
    v_perm_b32 v134, v21, v20, s48
    v_perm_b32 v135, v23, v22, s48
    v_perm_b32 v136, v25, v24, s47
    v_perm_b32 v137, v27, v26, s47
    v_perm_b32 v138, v29, v28, s47
    v_perm_b32 v139, v31, v30, s47
    v_perm_b32 v140, v25, v24, s48
    v_perm_b32 v141, v27, v26, s48
    v_perm_b32 v142, v29, v28, s48
    v_perm_b32 v143, v31, v30, s48
    s_waitcnt vmcnt(28)
    s_barrier
    s_mov_b32 s46, 0x80000
    s_add_u32 m0, s57, 32768
    s_nop 0
    buffer_load_dwordx4 v8, s[16:19], s46 offen lds
    s_mov_b32 s46, 0x88000
    s_add_u32 m0, s57, 33792
    s_nop 0
    buffer_load_dwordx4 v8, s[16:19], s46 offen lds
    s_mov_b32 s46, 0x90000
    s_add_u32 m0, s57, 34816
    s_nop 0
    buffer_load_dwordx4 v8, s[16:19], s46 offen lds
    s_mov_b32 s46, 0x98000
    s_add_u32 m0, s57, 35840
    s_nop 0
    buffer_load_dwordx4 v8, s[16:19], s46 offen lds
    v_add_u32 v11, 49152, v10
    ds_read2st64_b32 v[16:17], v11 offset0:0 offset1:1
    ds_read2st64_b32 v[18:19], v11 offset0:2 offset1:3
    ds_read2st64_b32 v[20:21], v11 offset0:4 offset1:5
    ds_read2st64_b32 v[22:23], v11 offset0:6 offset1:7
    ds_read2st64_b32 v[24:25], v11 offset0:32 offset1:33
    ds_read2st64_b32 v[26:27], v11 offset0:34 offset1:35
    ds_read2st64_b32 v[28:29], v11 offset0:36 offset1:37
    ds_read2st64_b32 v[30:31], v11 offset0:38 offset1:39
    s_waitcnt lgkmcnt(0)
    v_perm_b32 v144, v17, v16, s47
    v_perm_b32 v145, v19, v18, s47
    v_perm_b32 v146, v21, v20, s47
    v_perm_b32 v147, v23, v22, s47
    v_perm_b32 v148, v17, v16, s48
    v_perm_b32 v149, v19, v18, s48
    v_perm_b32 v150, v21, v20, s48
    v_perm_b32 v151, v23, v22, s48
    v_perm_b32 v152, v25, v24, s47
    v_perm_b32 v153, v27, v26, s47
    v_perm_b32 v154, v29, v28, s47
    v_perm_b32 v155, v31, v30, s47
    v_perm_b32 v156, v25, v24, s48
    v_perm_b32 v157, v27, v26, s48
    v_perm_b32 v158, v29, v28, s48
    v_perm_b32 v159, v31, v30, s48
    s_waitcnt vmcnt(28)
    s_barrier
    s_mov_b32 s46, 0x100000
    s_add_u32 m0, s57, 49152
    s_nop 0
    buffer_load_dwordx4 v8, s[16:19], s46 offen lds
    s_mov_b32 s46, 0x108000
    s_add_u32 m0, s57, 50176
    s_nop 0
    buffer_load_dwordx4 v8, s[16:19], s46 offen lds
    s_mov_b32 s46, 0x110000
    s_add_u32 m0, s57, 51200
    s_nop 0
    buffer_load_dwordx4 v8, s[16:19], s46 offen lds
    s_mov_b32 s46, 0x118000
    s_add_u32 m0, s57, 52224
    s_nop 0
    buffer_load_dwordx4 v8, s[16:19], s46 offen lds
    v_add_u32 v11, 65536, v10
    ds_read2st64_b32 v[16:17], v11 offset0:0 offset1:1
    ds_read2st64_b32 v[18:19], v11 offset0:2 offset1:3
    ds_read2st64_b32 v[20:21], v11 offset0:4 offset1:5
    ds_read2st64_b32 v[22:23], v11 offset0:6 offset1:7
    ds_read2st64_b32 v[24:25], v11 offset0:32 offset1:33
    ds_read2st64_b32 v[26:27], v11 offset0:34 offset1:35
    ds_read2st64_b32 v[28:29], v11 offset0:36 offset1:37
    ds_read2st64_b32 v[30:31], v11 offset0:38 offset1:39
    s_waitcnt lgkmcnt(0)
    v_perm_b32 v160, v17, v16, s47
    v_perm_b32 v161, v19, v18, s47
    v_perm_b32 v162, v21, v20, s47
    v_perm_b32 v163, v23, v22, s47
    v_perm_b32 v164, v17, v16, s48
    v_perm_b32 v165, v19, v18, s48
    v_perm_b32 v166, v21, v20, s48
    v_perm_b32 v167, v23, v22, s48
    v_perm_b32 v168, v25, v24, s47
    v_perm_b32 v169, v27, v26, s47
    v_perm_b32 v170, v29, v28, s47
    v_perm_b32 v171, v31, v30, s47
    v_perm_b32 v172, v25, v24, s48
    v_perm_b32 v173, v27, v26, s48
    v_perm_b32 v174, v29, v28, s48
    v_perm_b32 v175, v31, v30, s48
    s_waitcnt vmcnt(28)
    s_barrier
    s_mov_b32 s46, 0x180000
    s_add_u32 m0, s57, 65536
    s_nop 0
    buffer_load_dwordx4 v8, s[16:19], s46 offen lds
    s_mov_b32 s46, 0x188000
    s_add_u32 m0, s57, 66560
    s_nop 0
    buffer_load_dwordx4 v8, s[16:19], s46 offen lds
    s_mov_b32 s46, 0x190000
    s_add_u32 m0, s57, 67584
    s_nop 0
    buffer_load_dwordx4 v8, s[16:19], s46 offen lds
    s_mov_b32 s46, 0x198000
    s_add_u32 m0, s57, 68608
    s_nop 0
    buffer_load_dwordx4 v8, s[16:19], s46 offen lds
    v_add_u32 v11, 81920, v10
    ds_read2st64_b32 v[16:17], v11 offset0:0 offset1:1
    ds_read2st64_b32 v[18:19], v11 offset0:2 offset1:3
    ds_read2st64_b32 v[20:21], v11 offset0:4 offset1:5
    ds_read2st64_b32 v[22:23], v11 offset0:6 offset1:7
    ds_read2st64_b32 v[24:25], v11 offset0:32 offset1:33
    ds_read2st64_b32 v[26:27], v11 offset0:34 offset1:35
    ds_read2st64_b32 v[28:29], v11 offset0:36 offset1:37
    ds_read2st64_b32 v[30:31], v11 offset0:38 offset1:39
    s_waitcnt lgkmcnt(0)
    v_perm_b32 v176, v17, v16, s47
    v_perm_b32 v177, v19, v18, s47
    v_perm_b32 v178, v21, v20, s47
    v_perm_b32 v179, v23, v22, s47
    v_perm_b32 v180, v17, v16, s48
    v_perm_b32 v181, v19, v18, s48
    v_perm_b32 v182, v21, v20, s48
    v_perm_b32 v183, v23, v22, s48
    v_perm_b32 v184, v25, v24, s47
    v_perm_b32 v185, v27, v26, s47
    v_perm_b32 v186, v29, v28, s47
    v_perm_b32 v187, v31, v30, s47
    v_perm_b32 v188, v25, v24, s48
    v_perm_b32 v189, v27, v26, s48
    v_perm_b32 v190, v29, v28, s48
    v_perm_b32 v191, v31, v30, s48
    s_waitcnt vmcnt(28)
    s_barrier
    s_mov_b32 s46, 0x200000
    s_add_u32 m0, s57, 81920
    s_nop 0
    buffer_load_dwordx4 v8, s[16:19], s46 offen lds
    s_mov_b32 s46, 0x208000
    s_add_u32 m0, s57, 82944
    s_nop 0
    buffer_load_dwordx4 v8, s[16:19], s46 offen lds
    s_mov_b32 s46, 0x210000
    s_add_u32 m0, s57, 83968
    s_nop 0
    buffer_load_dwordx4 v8, s[16:19], s46 offen lds
    s_mov_b32 s46, 0x218000
    s_add_u32 m0, s57, 84992
    s_nop 0
    buffer_load_dwordx4 v8, s[16:19], s46 offen lds
    v_add_u32 v11, 98304, v10
    ds_read2st64_b32 v[16:17], v11 offset0:0 offset1:1
    ds_read2st64_b32 v[18:19], v11 offset0:2 offset1:3
    ds_read2st64_b32 v[20:21], v11 offset0:4 offset1:5
    ds_read2st64_b32 v[22:23], v11 offset0:6 offset1:7
    ds_read2st64_b32 v[24:25], v11 offset0:32 offset1:33
    ds_read2st64_b32 v[26:27], v11 offset0:34 offset1:35
    ds_read2st64_b32 v[28:29], v11 offset0:36 offset1:37
    ds_read2st64_b32 v[30:31], v11 offset0:38 offset1:39
    s_waitcnt lgkmcnt(0)
    v_perm_b32 v192, v17, v16, s47
    v_perm_b32 v193, v19, v18, s47
    v_perm_b32 v194, v21, v20, s47
    v_perm_b32 v195, v23, v22, s47
    v_perm_b32 v196, v17, v16, s48
    v_perm_b32 v197, v19, v18, s48
    v_perm_b32 v198, v21, v20, s48
    v_perm_b32 v199, v23, v22, s48
    v_perm_b32 v200, v25, v24, s47
    v_perm_b32 v201, v27, v26, s47
    v_perm_b32 v202, v29, v28, s47
    v_perm_b32 v203, v31, v30, s47
    v_perm_b32 v204, v25, v24, s48
    v_perm_b32 v205, v27, v26, s48
    v_perm_b32 v206, v29, v28, s48
    v_perm_b32 v207, v31, v30, s48
    s_waitcnt vmcnt(28)
    s_barrier
    s_mov_b32 s46, 0x280000
    s_add_u32 m0, s57, 98304
    s_nop 0
    buffer_load_dwordx4 v8, s[16:19], s46 offen lds
    s_mov_b32 s46, 0x288000
    s_add_u32 m0, s57, 99328
    s_nop 0
    buffer_load_dwordx4 v8, s[16:19], s46 offen lds
    s_mov_b32 s46, 0x290000
    s_add_u32 m0, s57, 100352
    s_nop 0
    buffer_load_dwordx4 v8, s[16:19], s46 offen lds
    s_mov_b32 s46, 0x298000
    s_add_u32 m0, s57, 101376
    s_nop 0
    buffer_load_dwordx4 v8, s[16:19], s46 offen lds
    v_add_u32 v11, 114688, v10
    ds_read2st64_b32 v[16:17], v11 offset0:0 offset1:1
    ds_read2st64_b32 v[18:19], v11 offset0:2 offset1:3
    ds_read2st64_b32 v[20:21], v11 offset0:4 offset1:5
    ds_read2st64_b32 v[22:23], v11 offset0:6 offset1:7
    ds_read2st64_b32 v[24:25], v11 offset0:32 offset1:33
    ds_read2st64_b32 v[26:27], v11 offset0:34 offset1:35
    ds_read2st64_b32 v[28:29], v11 offset0:36 offset1:37
    ds_read2st64_b32 v[30:31], v11 offset0:38 offset1:39
    s_waitcnt lgkmcnt(0)
    v_perm_b32 v208, v17, v16, s47
    v_perm_b32 v209, v19, v18, s47
    v_perm_b32 v210, v21, v20, s47
    v_perm_b32 v211, v23, v22, s47
    v_perm_b32 v212, v17, v16, s48
    v_perm_b32 v213, v19, v18, s48
    v_perm_b32 v214, v21, v20, s48
    v_perm_b32 v215, v23, v22, s48
    v_perm_b32 v216, v25, v24, s47
    v_perm_b32 v217, v27, v26, s47
    v_perm_b32 v218, v29, v28, s47
    v_perm_b32 v219, v31, v30, s47
    v_perm_b32 v220, v25, v24, s48
    v_perm_b32 v221, v27, v26, s48
    v_perm_b32 v222, v29, v28, s48
    v_perm_b32 v223, v31, v30, s48
    s_waitcnt vmcnt(28)
    s_barrier
    s_mov_b32 s46, 0x300000
    s_add_u32 m0, s57, 114688
    s_nop 0
    buffer_load_dwordx4 v8, s[16:19], s46 offen lds
    s_mov_b32 s46, 0x308000
    s_add_u32 m0, s57, 115712
    s_nop 0
    buffer_load_dwordx4 v8, s[16:19], s46 offen lds
    s_mov_b32 s46, 0x310000
    s_add_u32 m0, s57, 116736
    s_nop 0
    buffer_load_dwordx4 v8, s[16:19], s46 offen lds
    s_mov_b32 s46, 0x318000
    s_add_u32 m0, s57, 117760
    s_nop 0
    buffer_load_dwordx4 v8, s[16:19], s46 offen lds
    v_add_u32 v11, 131072, v10
    ds_read2st64_b32 v[16:17], v11 offset0:0 offset1:1
    ds_read2st64_b32 v[18:19], v11 offset0:2 offset1:3
    ds_read2st64_b32 v[20:21], v11 offset0:4 offset1:5
    ds_read2st64_b32 v[22:23], v11 offset0:6 offset1:7
    ds_read2st64_b32 v[24:25], v11 offset0:32 offset1:33
    ds_read2st64_b32 v[26:27], v11 offset0:34 offset1:35
    ds_read2st64_b32 v[28:29], v11 offset0:36 offset1:37
    ds_read2st64_b32 v[30:31], v11 offset0:38 offset1:39
    s_waitcnt lgkmcnt(0)
    v_perm_b32 v224, v17, v16, s47
    v_perm_b32 v225, v19, v18, s47
    v_perm_b32 v226, v21, v20, s47
    v_perm_b32 v227, v23, v22, s47
    v_perm_b32 v228, v17, v16, s48
    v_perm_b32 v229, v19, v18, s48
    v_perm_b32 v230, v21, v20, s48
    v_perm_b32 v231, v23, v22, s48
    v_perm_b32 v232, v25, v24, s47
    v_perm_b32 v233, v27, v26, s47
    v_perm_b32 v234, v29, v28, s47
    v_perm_b32 v235, v31, v30, s47
    v_perm_b32 v236, v25, v24, s48
    v_perm_b32 v237, v27, v26, s48
    v_perm_b32 v238, v29, v28, s48
    v_perm_b32 v239, v31, v30, s48
    s_waitcnt vmcnt(28)
    s_barrier
    s_mov_b32 s46, 0x380000
    s_add_u32 m0, s57, 131072
    s_nop 0
    buffer_load_dwordx4 v8, s[16:19], s46 offen lds
    s_mov_b32 s46, 0x388000
    s_add_u32 m0, s57, 132096
    s_nop 0
    buffer_load_dwordx4 v8, s[16:19], s46 offen lds
    s_mov_b32 s46, 0x390000
    s_add_u32 m0, s57, 133120
    s_nop 0
    buffer_load_dwordx4 v8, s[16:19], s46 offen lds
    s_mov_b32 s46, 0x398000
    s_add_u32 m0, s57, 134144
    s_nop 0
    buffer_load_dwordx4 v8, s[16:19], s46 offen lds
    v_add_u32 v11, 147456, v10
    ds_read2st64_b32 v[16:17], v11 offset0:0 offset1:1
    ds_read2st64_b32 v[18:19], v11 offset0:2 offset1:3
    ds_read2st64_b32 v[20:21], v11 offset0:4 offset1:5
    ds_read2st64_b32 v[22:23], v11 offset0:6 offset1:7
    ds_read2st64_b32 v[24:25], v11 offset0:32 offset1:33
    ds_read2st64_b32 v[26:27], v11 offset0:34 offset1:35
    ds_read2st64_b32 v[28:29], v11 offset0:36 offset1:37
    ds_read2st64_b32 v[30:31], v11 offset0:38 offset1:39
    s_waitcnt lgkmcnt(0)
    v_perm_b32 v240, v17, v16, s47
    v_perm_b32 v241, v19, v18, s47
    v_perm_b32 v242, v21, v20, s47
    v_perm_b32 v243, v23, v22, s47
    v_perm_b32 v244, v17, v16, s48
    v_perm_b32 v245, v19, v18, s48
    v_perm_b32 v246, v21, v20, s48
    v_perm_b32 v247, v23, v22, s48
    v_perm_b32 v248, v25, v24, s47
    v_perm_b32 v249, v27, v26, s47
    v_perm_b32 v250, v29, v28, s47
    v_perm_b32 v251, v31, v30, s47
    v_perm_b32 v252, v25, v24, s48
    v_perm_b32 v253, v27, v26, s48
    v_perm_b32 v254, v29, v28, s48
    v_perm_b32 v255, v31, v30, s48
    s_waitcnt vmcnt(28)
    s_barrier
    s_mov_b32 s46, 0x400000
    s_add_u32 m0, s57, 147456
    s_nop 0
    buffer_load_dwordx4 v8, s[16:19], s46 offen lds
    s_mov_b32 s46, 0x408000
    s_add_u32 m0, s57, 148480
    s_nop 0
    buffer_load_dwordx4 v8, s[16:19], s46 offen lds
    s_mov_b32 s46, 0x410000
    s_add_u32 m0, s57, 149504
    s_nop 0
    buffer_load_dwordx4 v8, s[16:19], s46 offen lds
    s_mov_b32 s46, 0x418000
    s_add_u32 m0, s57, 150528
    s_nop 0
    buffer_load_dwordx4 v8, s[16:19], s46 offen lds
    v_add_u32 v11, 16384, v10
    ds_read2st64_b32 v[16:17], v11 offset0:0 offset1:1
    ds_read2st64_b32 v[18:19], v11 offset0:2 offset1:3
    ds_read2st64_b32 v[20:21], v11 offset0:4 offset1:5
    ds_read2st64_b32 v[22:23], v11 offset0:6 offset1:7
    ds_read2st64_b32 v[24:25], v11 offset0:32 offset1:33
    ds_read2st64_b32 v[26:27], v11 offset0:34 offset1:35
    ds_read2st64_b32 v[28:29], v11 offset0:36 offset1:37
    ds_read2st64_b32 v[30:31], v11 offset0:38 offset1:39
    s_waitcnt lgkmcnt(0)
    v_perm_b32 v1, v17, v16, s47
    v_accvgpr_write_b32 a0, v1
    v_perm_b32 v2, v19, v18, s47
    v_accvgpr_write_b32 a1, v2
    v_perm_b32 v1, v21, v20, s47
    v_accvgpr_write_b32 a2, v1
    v_perm_b32 v2, v23, v22, s47
    v_accvgpr_write_b32 a3, v2
    v_perm_b32 v1, v17, v16, s48
    v_accvgpr_write_b32 a4, v1
    v_perm_b32 v2, v19, v18, s48
    v_accvgpr_write_b32 a5, v2
    v_perm_b32 v1, v21, v20, s48
    v_accvgpr_write_b32 a6, v1
    v_perm_b32 v2, v23, v22, s48
    v_accvgpr_write_b32 a7, v2
    v_perm_b32 v1, v25, v24, s47
    v_accvgpr_write_b32 a8, v1
    v_perm_b32 v2, v27, v26, s47
    v_accvgpr_write_b32 a9, v2
    v_perm_b32 v1, v29, v28, s47
    v_accvgpr_write_b32 a10, v1
    v_perm_b32 v2, v31, v30, s47
    v_accvgpr_write_b32 a11, v2
    v_perm_b32 v1, v25, v24, s48
    v_accvgpr_write_b32 a12, v1
    v_perm_b32 v2, v27, v26, s48
    v_accvgpr_write_b32 a13, v2
    v_perm_b32 v1, v29, v28, s48
    v_accvgpr_write_b32 a14, v1
    v_perm_b32 v2, v31, v30, s48
    v_accvgpr_write_b32 a15, v2
    s_waitcnt vmcnt(28)
    s_barrier
    v_add_u32 v11, 32768, v10
    ds_read2st64_b32 v[16:17], v11 offset0:0 offset1:1
    ds_read2st64_b32 v[18:19], v11 offset0:2 offset1:3
    ds_read2st64_b32 v[20:21], v11 offset0:4 offset1:5
    ds_read2st64_b32 v[22:23], v11 offset0:6 offset1:7
    ds_read2st64_b32 v[24:25], v11 offset0:32 offset1:33
    ds_read2st64_b32 v[26:27], v11 offset0:34 offset1:35
    ds_read2st64_b32 v[28:29], v11 offset0:36 offset1:37
    ds_read2st64_b32 v[30:31], v11 offset0:38 offset1:39
    s_waitcnt lgkmcnt(0)
    v_perm_b32 v1, v17, v16, s47
    v_accvgpr_write_b32 a16, v1
    v_perm_b32 v2, v19, v18, s47
    v_accvgpr_write_b32 a17, v2
    v_perm_b32 v1, v21, v20, s47
    v_accvgpr_write_b32 a18, v1
    v_perm_b32 v2, v23, v22, s47
    v_accvgpr_write_b32 a19, v2
    v_perm_b32 v1, v17, v16, s48
    v_accvgpr_write_b32 a20, v1
    v_perm_b32 v2, v19, v18, s48
    v_accvgpr_write_b32 a21, v2
    v_perm_b32 v1, v21, v20, s48
    v_accvgpr_write_b32 a22, v1
    v_perm_b32 v2, v23, v22, s48
    v_accvgpr_write_b32 a23, v2
    v_perm_b32 v1, v25, v24, s47
    v_accvgpr_write_b32 a24, v1
    v_perm_b32 v2, v27, v26, s47
    v_accvgpr_write_b32 a25, v2
    v_perm_b32 v1, v29, v28, s47
    v_accvgpr_write_b32 a26, v1
    v_perm_b32 v2, v31, v30, s47
    v_accvgpr_write_b32 a27, v2
    v_perm_b32 v1, v25, v24, s48
    v_accvgpr_write_b32 a28, v1
    v_perm_b32 v2, v27, v26, s48
    v_accvgpr_write_b32 a29, v2
    v_perm_b32 v1, v29, v28, s48
    v_accvgpr_write_b32 a30, v1
    v_perm_b32 v2, v31, v30, s48
    v_accvgpr_write_b32 a31, v2
    s_waitcnt vmcnt(24)
    s_barrier
    v_add_u32 v11, 49152, v10
    ds_read2st64_b32 v[16:17], v11 offset0:0 offset1:1
    ds_read2st64_b32 v[18:19], v11 offset0:2 offset1:3
    ds_read2st64_b32 v[20:21], v11 offset0:4 offset1:5
    ds_read2st64_b32 v[22:23], v11 offset0:6 offset1:7
    ds_read2st64_b32 v[24:25], v11 offset0:32 offset1:33
    ds_read2st64_b32 v[26:27], v11 offset0:34 offset1:35
    ds_read2st64_b32 v[28:29], v11 offset0:36 offset1:37
    ds_read2st64_b32 v[30:31], v11 offset0:38 offset1:39
    s_waitcnt lgkmcnt(0)
    v_perm_b32 v1, v17, v16, s47
    v_accvgpr_write_b32 a32, v1
    v_perm_b32 v2, v19, v18, s47
    v_accvgpr_write_b32 a33, v2
    v_perm_b32 v1, v21, v20, s47
    v_accvgpr_write_b32 a34, v1
    v_perm_b32 v2, v23, v22, s47
    v_accvgpr_write_b32 a35, v2
    v_perm_b32 v1, v17, v16, s48
    v_accvgpr_write_b32 a36, v1
    v_perm_b32 v2, v19, v18, s48
    v_accvgpr_write_b32 a37, v2
    v_perm_b32 v1, v21, v20, s48
    v_accvgpr_write_b32 a38, v1
    v_perm_b32 v2, v23, v22, s48
    v_accvgpr_write_b32 a39, v2
    v_perm_b32 v1, v25, v24, s47
    v_accvgpr_write_b32 a40, v1
    v_perm_b32 v2, v27, v26, s47
    v_accvgpr_write_b32 a41, v2
    v_perm_b32 v1, v29, v28, s47
    v_accvgpr_write_b32 a42, v1
    v_perm_b32 v2, v31, v30, s47
    v_accvgpr_write_b32 a43, v2
    v_perm_b32 v1, v25, v24, s48
    v_accvgpr_write_b32 a44, v1
    v_perm_b32 v2, v27, v26, s48
    v_accvgpr_write_b32 a45, v2
    v_perm_b32 v1, v29, v28, s48
    v_accvgpr_write_b32 a46, v1
    v_perm_b32 v2, v31, v30, s48
    v_accvgpr_write_b32 a47, v2
    s_waitcnt vmcnt(20)
    s_barrier
    v_add_u32 v11, 65536, v10
    ds_read2st64_b32 v[16:17], v11 offset0:0 offset1:1
    ds_read2st64_b32 v[18:19], v11 offset0:2 offset1:3
    ds_read2st64_b32 v[20:21], v11 offset0:4 offset1:5
    ds_read2st64_b32 v[22:23], v11 offset0:6 offset1:7
    ds_read2st64_b32 v[24:25], v11 offset0:32 offset1:33
    ds_read2st64_b32 v[26:27], v11 offset0:34 offset1:35
    ds_read2st64_b32 v[28:29], v11 offset0:36 offset1:37
    ds_read2st64_b32 v[30:31], v11 offset0:38 offset1:39
    s_waitcnt lgkmcnt(0)
    v_perm_b32 v1, v17, v16, s47
    v_accvgpr_write_b32 a48, v1
    v_perm_b32 v2, v19, v18, s47
    v_accvgpr_write_b32 a49, v2
    v_perm_b32 v1, v21, v20, s47
    v_accvgpr_write_b32 a50, v1
    v_perm_b32 v2, v23, v22, s47
    v_accvgpr_write_b32 a51, v2
    v_perm_b32 v1, v17, v16, s48
    v_accvgpr_write_b32 a52, v1
    v_perm_b32 v2, v19, v18, s48
    v_accvgpr_write_b32 a53, v2
    v_perm_b32 v1, v21, v20, s48
    v_accvgpr_write_b32 a54, v1
    v_perm_b32 v2, v23, v22, s48
    v_accvgpr_write_b32 a55, v2
    v_perm_b32 v1, v25, v24, s47
    v_accvgpr_write_b32 a56, v1
    v_perm_b32 v2, v27, v26, s47
    v_accvgpr_write_b32 a57, v2
    v_perm_b32 v1, v29, v28, s47
    v_accvgpr_write_b32 a58, v1
    v_perm_b32 v2, v31, v30, s47
    v_accvgpr_write_b32 a59, v2
    v_perm_b32 v1, v25, v24, s48
    v_accvgpr_write_b32 a60, v1
    v_perm_b32 v2, v27, v26, s48
    v_accvgpr_write_b32 a61, v2
    v_perm_b32 v1, v29, v28, s48
    v_accvgpr_write_b32 a62, v1
    v_perm_b32 v2, v31, v30, s48
    v_accvgpr_write_b32 a63, v2
    s_waitcnt vmcnt(16)
    s_barrier
    v_add_u32 v11, 81920, v10
    ds_read2st64_b32 v[16:17], v11 offset0:0 offset1:1
    ds_read2st64_b32 v[18:19], v11 offset0:2 offset1:3
    ds_read2st64_b32 v[20:21], v11 offset0:4 offset1:5
    ds_read2st64_b32 v[22:23], v11 offset0:6 offset1:7
    ds_read2st64_b32 v[24:25], v11 offset0:32 offset1:33
    ds_read2st64_b32 v[26:27], v11 offset0:34 offset1:35
    ds_read2st64_b32 v[28:29], v11 offset0:36 offset1:37
    ds_read2st64_b32 v[30:31], v11 offset0:38 offset1:39
    s_waitcnt lgkmcnt(0)
    v_perm_b32 v1, v17, v16, s47
    v_accvgpr_write_b32 a64, v1
    v_perm_b32 v2, v19, v18, s47
    v_accvgpr_write_b32 a65, v2
    v_perm_b32 v1, v21, v20, s47
    v_accvgpr_write_b32 a66, v1
    v_perm_b32 v2, v23, v22, s47
    v_accvgpr_write_b32 a67, v2
    v_perm_b32 v1, v17, v16, s48
    v_accvgpr_write_b32 a68, v1
    v_perm_b32 v2, v19, v18, s48
    v_accvgpr_write_b32 a69, v2
    v_perm_b32 v1, v21, v20, s48
    v_accvgpr_write_b32 a70, v1
    v_perm_b32 v2, v23, v22, s48
    v_accvgpr_write_b32 a71, v2
    v_perm_b32 v1, v25, v24, s47
    v_accvgpr_write_b32 a72, v1
    v_perm_b32 v2, v27, v26, s47
    v_accvgpr_write_b32 a73, v2
    v_perm_b32 v1, v29, v28, s47
    v_accvgpr_write_b32 a74, v1
    v_perm_b32 v2, v31, v30, s47
    v_accvgpr_write_b32 a75, v2
    v_perm_b32 v1, v25, v24, s48
    v_accvgpr_write_b32 a76, v1
    v_perm_b32 v2, v27, v26, s48
    v_accvgpr_write_b32 a77, v2
    v_perm_b32 v1, v29, v28, s48
    v_accvgpr_write_b32 a78, v1
    v_perm_b32 v2, v31, v30, s48
    v_accvgpr_write_b32 a79, v2
    s_waitcnt vmcnt(12)
    s_barrier
    v_add_u32 v11, 98304, v10
    ds_read2st64_b32 v[16:17], v11 offset0:0 offset1:1
    ds_read2st64_b32 v[18:19], v11 offset0:2 offset1:3
    ds_read2st64_b32 v[20:21], v11 offset0:4 offset1:5
    ds_read2st64_b32 v[22:23], v11 offset0:6 offset1:7
    ds_read2st64_b32 v[24:25], v11 offset0:32 offset1:33
    ds_read2st64_b32 v[26:27], v11 offset0:34 offset1:35
    ds_read2st64_b32 v[28:29], v11 offset0:36 offset1:37
    ds_read2st64_b32 v[30:31], v11 offset0:38 offset1:39
    s_waitcnt lgkmcnt(0)
    v_perm_b32 v1, v17, v16, s47
    v_accvgpr_write_b32 a80, v1
    v_perm_b32 v2, v19, v18, s47
    v_accvgpr_write_b32 a81, v2
    v_perm_b32 v1, v21, v20, s47
    v_accvgpr_write_b32 a82, v1
    v_perm_b32 v2, v23, v22, s47
    v_accvgpr_write_b32 a83, v2
    v_perm_b32 v1, v17, v16, s48
    v_accvgpr_write_b32 a84, v1
    v_perm_b32 v2, v19, v18, s48
    v_accvgpr_write_b32 a85, v2
    v_perm_b32 v1, v21, v20, s48
    v_accvgpr_write_b32 a86, v1
    v_perm_b32 v2, v23, v22, s48
    v_accvgpr_write_b32 a87, v2
    v_perm_b32 v1, v25, v24, s47
    v_accvgpr_write_b32 a88, v1
    v_perm_b32 v2, v27, v26, s47
    v_accvgpr_write_b32 a89, v2
    v_perm_b32 v1, v29, v28, s47
    v_accvgpr_write_b32 a90, v1
    v_perm_b32 v2, v31, v30, s47
    v_accvgpr_write_b32 a91, v2
    v_perm_b32 v1, v25, v24, s48
    v_accvgpr_write_b32 a92, v1
    v_perm_b32 v2, v27, v26, s48
    v_accvgpr_write_b32 a93, v2
    v_perm_b32 v1, v29, v28, s48
    v_accvgpr_write_b32 a94, v1
    v_perm_b32 v2, v31, v30, s48
    v_accvgpr_write_b32 a95, v2
    s_waitcnt vmcnt(8)
    s_barrier
    v_add_u32 v11, 114688, v10
    ds_read2st64_b32 v[16:17], v11 offset0:0 offset1:1
    ds_read2st64_b32 v[18:19], v11 offset0:2 offset1:3
    ds_read2st64_b32 v[20:21], v11 offset0:4 offset1:5
    ds_read2st64_b32 v[22:23], v11 offset0:6 offset1:7
    ds_read2st64_b32 v[24:25], v11 offset0:32 offset1:33
    ds_read2st64_b32 v[26:27], v11 offset0:34 offset1:35
    ds_read2st64_b32 v[28:29], v11 offset0:36 offset1:37
    ds_read2st64_b32 v[30:31], v11 offset0:38 offset1:39
    s_waitcnt lgkmcnt(0)
    v_perm_b32 v1, v17, v16, s47
    v_accvgpr_write_b32 a96, v1
    v_perm_b32 v2, v19, v18, s47
    v_accvgpr_write_b32 a97, v2
    v_perm_b32 v1, v21, v20, s47
    v_accvgpr_write_b32 a98, v1
    v_perm_b32 v2, v23, v22, s47
    v_accvgpr_write_b32 a99, v2
    v_perm_b32 v1, v17, v16, s48
    v_accvgpr_write_b32 a100, v1
    v_perm_b32 v2, v19, v18, s48
    v_accvgpr_write_b32 a101, v2
    v_perm_b32 v1, v21, v20, s48
    v_accvgpr_write_b32 a102, v1
    v_perm_b32 v2, v23, v22, s48
    v_accvgpr_write_b32 a103, v2
    v_perm_b32 v1, v25, v24, s47
    v_accvgpr_write_b32 a104, v1
    v_perm_b32 v2, v27, v26, s47
    v_accvgpr_write_b32 a105, v2
    v_perm_b32 v1, v29, v28, s47
    v_accvgpr_write_b32 a106, v1
    v_perm_b32 v2, v31, v30, s47
    v_accvgpr_write_b32 a107, v2
    v_perm_b32 v1, v25, v24, s48
    v_accvgpr_write_b32 a108, v1
    v_perm_b32 v2, v27, v26, s48
    v_accvgpr_write_b32 a109, v2
    v_perm_b32 v1, v29, v28, s48
    v_accvgpr_write_b32 a110, v1
    v_perm_b32 v2, v31, v30, s48
    v_accvgpr_write_b32 a111, v2
    s_waitcnt vmcnt(4)
    s_barrier
    v_add_u32 v11, 131072, v10
    ds_read2st64_b32 v[16:17], v11 offset0:0 offset1:1
    ds_read2st64_b32 v[18:19], v11 offset0:2 offset1:3
    ds_read2st64_b32 v[20:21], v11 offset0:4 offset1:5
    ds_read2st64_b32 v[22:23], v11 offset0:6 offset1:7
    ds_read2st64_b32 v[24:25], v11 offset0:32 offset1:33
    ds_read2st64_b32 v[26:27], v11 offset0:34 offset1:35
    ds_read2st64_b32 v[28:29], v11 offset0:36 offset1:37
    ds_read2st64_b32 v[30:31], v11 offset0:38 offset1:39
    s_waitcnt lgkmcnt(0)
    v_perm_b32 v1, v17, v16, s47
    v_accvgpr_write_b32 a112, v1
    v_perm_b32 v2, v19, v18, s47
    v_accvgpr_write_b32 a113, v2
    v_perm_b32 v1, v21, v20, s47
    v_accvgpr_write_b32 a114, v1
    v_perm_b32 v2, v23, v22, s47
    v_accvgpr_write_b32 a115, v2
    v_perm_b32 v1, v17, v16, s48
    v_accvgpr_write_b32 a116, v1
    v_perm_b32 v2, v19, v18, s48
    v_accvgpr_write_b32 a117, v2
    v_perm_b32 v1, v21, v20, s48
    v_accvgpr_write_b32 a118, v1
    v_perm_b32 v2, v23, v22, s48
    v_accvgpr_write_b32 a119, v2
    v_perm_b32 v1, v25, v24, s47
    v_accvgpr_write_b32 a120, v1
    v_perm_b32 v2, v27, v26, s47
    v_accvgpr_write_b32 a121, v2
    v_perm_b32 v1, v29, v28, s47
    v_accvgpr_write_b32 a122, v1
    v_perm_b32 v2, v31, v30, s47
    v_accvgpr_write_b32 a123, v2
    v_perm_b32 v1, v25, v24, s48
    v_accvgpr_write_b32 a124, v1
    v_perm_b32 v2, v27, v26, s48
    v_accvgpr_write_b32 a125, v2
    v_perm_b32 v1, v29, v28, s48
    v_accvgpr_write_b32 a126, v1
    v_perm_b32 v2, v31, v30, s48
    v_accvgpr_write_b32 a127, v2
    s_waitcnt vmcnt(0)
    s_barrier
    v_add_u32 v11, 147456, v10
    ds_read2st64_b32 v[16:17], v11 offset0:0 offset1:1
    ds_read2st64_b32 v[18:19], v11 offset0:2 offset1:3
    ds_read2st64_b32 v[20:21], v11 offset0:4 offset1:5
    ds_read2st64_b32 v[22:23], v11 offset0:6 offset1:7
    ds_read2st64_b32 v[24:25], v11 offset0:32 offset1:33
    ds_read2st64_b32 v[26:27], v11 offset0:34 offset1:35
    ds_read2st64_b32 v[28:29], v11 offset0:36 offset1:37
    ds_read2st64_b32 v[30:31], v11 offset0:38 offset1:39
    s_waitcnt lgkmcnt(0)
    v_perm_b32 v1, v17, v16, s47
    v_accvgpr_write_b32 a128, v1
    v_perm_b32 v2, v19, v18, s47
    v_accvgpr_write_b32 a129, v2
    v_perm_b32 v1, v21, v20, s47
    v_accvgpr_write_b32 a130, v1
    v_perm_b32 v2, v23, v22, s47
    v_accvgpr_write_b32 a131, v2
    v_perm_b32 v1, v17, v16, s48
    v_accvgpr_write_b32 a132, v1
    v_perm_b32 v2, v19, v18, s48
    v_accvgpr_write_b32 a133, v2
    v_perm_b32 v1, v21, v20, s48
    v_accvgpr_write_b32 a134, v1
    v_perm_b32 v2, v23, v22, s48
    v_accvgpr_write_b32 a135, v2
    v_perm_b32 v1, v25, v24, s47
    v_accvgpr_write_b32 a136, v1
    v_perm_b32 v2, v27, v26, s47
    v_accvgpr_write_b32 a137, v2
    v_perm_b32 v1, v29, v28, s47
    v_accvgpr_write_b32 a138, v1
    v_perm_b32 v2, v31, v30, s47
    v_accvgpr_write_b32 a139, v2
    v_perm_b32 v1, v25, v24, s48
    v_accvgpr_write_b32 a140, v1
    v_perm_b32 v2, v27, v26, s48
    v_accvgpr_write_b32 a141, v2
    v_perm_b32 v1, v29, v28, s48
    v_accvgpr_write_b32 a142, v1
    v_perm_b32 v2, v31, v30, s48
    v_accvgpr_write_b32 a143, v2
    v_lshlrev_b32 v6, 4, v0
    v_lshrrev_b32 v1, 2, v12
    v_lshlrev_b32 v1, 3, v1
    v_and_b32 v2, 3, v12
    v_add_u32_e64 v1, v1, v2
    v_mul_u32_u24 v2, 288, v1
    v_lshl_add_u32 v2, v13, 4, v2
    s_lshl_b32 s46, s32, 6
    v_add_u32 v2, s46, v2
    v_mul_u32_u24 v3, 288, v12
    v_lshl_add_u32 v3, v13, 4, v3
    s_lshl_b32 s46, s32, 11
    v_add_u32 v4, s46, v6
    v_and_b32 v1, 7, v0
    v_lshlrev_b32 v5, 7, v13
    v_lshl_add_u32 v5, v1, 4, v5
    v_add_u32 v5, 88064, v5
    v_lshlrev_b32 v1, 3, v13
    v_sub_u32 v7, v12, v1
    s_mov_b32 s64, 0xf149f2ca
    v_cmp_gt_u32_e64 vcc, 2, v13
    v_mov_b32 v8, s64
    s_nop 0
    v_cndmask_b32 v8, v8, 0, vcc
    s_mul_i32 s53, s32, 2304
    v_lshlrev_b32_e64 v9, 2, v0
    s_mov_b32 s60, 0x3e0293ee
    s_mov_b32 s61, 0x3e0293ee
    s_mov_b32 s49, 0xbe0293ee
    s_mov_b32 s62, 0x3f803f80
    s_mov_b32 s63, 0x3f803f80
    s_cmp_eq_u32 s42, 0
    s_cselect_b32 s54, 22, 21
    s_mov_b32 s40, 0
L_wi_32:
    s_add_u32 s40, s40, 1
    s_cmp_gt_u32 s40, 0x100000
    s_cbranch_scc1 L_abort
    buffer_load_dword v16, off, s[12:15], 0 offset:64 sc1
    s_waitcnt vmcnt(0)
    v_cmp_ne_u32 vcc, 0x100, v16
    s_cbranch_vccnz L_wi_32
    s_mov_b32 s65, 0
    s_mov_b32 s43, 0
L_p_layer:
    s_mov_b32 s44, 0
    s_mov_b32 s45, s42
    s_lshl_b32 s46, s43, 20
    s_lshl_b32 s56, s45, 8
    s_add_u32 s46, s46, s56
    s_add_u32 s46, s46, 0x1800000
    s_cmp_lg_u32 s32, 0
    s_cbranch_scc1 L_wfs_35
    s_mov_b32 s40, 0
    v_min_u32 v16, 1, v0
    v_lshlrev_b32 v16, 7, v16
    s_branch L_wfe_37
L_wf_36:
    s_add_u32 s40, s40, 1
    s_cmp_gt_u32 s40, 0x100000
    s_cbranch_scc1 L_abort
    s_sleep 1
L_wfe_37:
    buffer_load_dword v18, v16, s[8:11], s46 offen sc1
    s_waitcnt vmcnt(0)
    v_cmpx_eq_u32 vcc, 0, v18
    s_cbranch_execnz L_wf_36
    s_mov_b64 exec, -1
L_wfs_35:
    s_barrier
    s_mul_i32 s46, s43, 2359296
    s_mul_i32 s56, s45, 36864
    s_add_u32 s46, s46, s56
    s_mul_i32 s56, s32, 9216
    s_add_u32 s46, s46, s56
    s_add_u32 s46, s46, 0x320000
    s_add_u32 m0, s56, 0
    s_nop 0
    buffer_load_dwordx4 v6, s[8:11], s46 offen offset:0 sc1 lds
    buffer_load_dwordx4 v6, s[8:11], s46 offen offset:1024 sc1 lds
    buffer_load_dwordx4 v6, s[8:11], s46 offen offset:2048 sc1 lds
    buffer_load_dwordx4 v6, s[8:11], s46 offen offset:3072 sc1 lds
    s_add_u32 m0, s56, 4096
    s_add_u32 s46, s46, 4096
    buffer_load_dwordx4 v6, s[8:11], s46 offen offset:0 sc1 lds
    buffer_load_dwordx4 v6, s[8:11], s46 offen offset:1024 sc1 lds
    buffer_load_dwordx4 v6, s[8:11], s46 offen offset:2048 sc1 lds
    buffer_load_dwordx4 v6, s[8:11], s46 offen offset:3072 sc1 lds
    s_add_u32 m0, s56, 8192
    s_add_u32 s46, s46, 4096
    buffer_load_dwordx4 v6, s[8:11], s46 offen offset:0 sc1 lds
L_p_loop:
    s_cmp_ge_u32 s44, s54
    s_cbranch_scc1 L_p_attn
    s_and_b32 s46, s44, 1
    s_mul_i32 s50, s46, 25600
    s_add_u32 s50, s50, 36864
    s_lshl_b32 s46, s45, 5
    s_add_u32 s46, s46, s41
    s_lshl_b32 s52, s41, 6
    s_add_u32 s52, s52, s45
    s_lshl_b32 s52, s52, 7
    s_lshl_b32 s56, s43, 20
    s_add_u32 s52, s52, s56
    s_add_u32 s52, s52, 0x1810000
    s_lshl_b32 s51, s46, 13
    s_lshl_b32 s56, s43, 24
    s_add_u32 s51, s51, s56
    s_add_u32 s56, s51, 0x2000000
    s_add_u32 s57, s51, 0x4000000
    v_add_u32 v10, s50, v4
    v_add_u32_e64 v11, s50, v2
    s_cmp_lg_u32 s65, 0
    s_cbranch_scc1 L_pw0_38
    s_waitcnt vmcnt(0)
L_pw0_38:
    s_barrier
    ds_read_b128 v[16:19], v6 offset:0
    ds_read_b128 v[20:23], v6 offset:1024
    ds_read_b128 v[24:27], v6 offset:2048
    ds_read_b128 v[28:31], v6 offset:3072
    s_waitcnt lgkmcnt(3)
    v_mfma_f32_16x16x32_bf16 v[48:51], a[144:147], v[16:19], 0
    v_mfma_f32_16x16x32_bf16 v[52:55], a[148:151], v[16:19], 0
    v_mfma_f32_16x16x32_bf16 v[64:67], v[16:19], v[112:115], 0
    v_mfma_f32_16x16x32_bf16 v[68:71], v[16:19], v[116:119], 0
    ds_read_b128 v[16:19], v6 offset:4096
    s_waitcnt lgkmcnt(3)
    v_mfma_f32_16x16x32_bf16 v[56:59], a[144:147], v[20:23], 0
    v_mfma_f32_16x16x32_bf16 v[60:63], a[148:151], v[20:23], 0
    v_mfma_f32_16x16x32_bf16 v[72:75], v[20:23], v[112:115], 0
    v_mfma_f32_16x16x32_bf16 v[76:79], v[20:23], v[116:119], 0
    ds_read_b128 v[20:23], v6 offset:5120
    s_waitcnt lgkmcnt(3)
    v_mfma_f32_16x16x32_bf16 v[48:51], a[152:155], v[24:27], v[48:51]
    v_mfma_f32_16x16x32_bf16 v[52:55], a[156:159], v[24:27], v[52:55]
    v_mfma_f32_16x16x32_bf16 v[64:67], v[24:27], v[120:123], v[64:67]
    v_mfma_f32_16x16x32_bf16 v[68:71], v[24:27], v[124:127], v[68:71]
    ds_read_b128 v[24:27], v6 offset:6144
    s_waitcnt lgkmcnt(3)
    v_mfma_f32_16x16x32_bf16 v[56:59], a[152:155], v[28:31], v[56:59]
    v_mfma_f32_16x16x32_bf16 v[60:63], a[156:159], v[28:31], v[60:63]
    v_mfma_f32_16x16x32_bf16 v[72:75], v[28:31], v[120:123], v[72:75]
    v_mfma_f32_16x16x32_bf16 v[76:79], v[28:31], v[124:127], v[76:79]
    ds_read_b128 v[28:31], v6 offset:7168
    s_waitcnt lgkmcnt(3)
    v_mfma_f32_16x16x32_bf16 v[48:51], a[160:163], v[16:19], v[48:51]
    v_mfma_f32_16x16x32_bf16 v[52:55], a[164:167], v[16:19], v[52:55]
    v_mfma_f32_16x16x32_bf16 v[64:67], v[16:19], v[128:131], v[64:67]
    v_mfma_f32_16x16x32_bf16 v[68:71], v[16:19], v[132:135], v[68:71]
    ds_read_b128 v[16:19], v6 offset:8192
    s_waitcnt lgkmcnt(3)
    v_mfma_f32_16x16x32_bf16 v[56:59], a[160:163], v[20:23], v[56:59]
    v_mfma_f32_16x16x32_bf16 v[60:63], a[164:167], v[20:23], v[60:63]
    v_mfma_f32_16x16x32_bf16 v[72:75], v[20:23], v[128:131], v[72:75]
    v_mfma_f32_16x16x32_bf16 v[76:79], v[20:23], v[132:135], v[76:79]
    ds_read_b128 v[20:23], v6 offset:9216
    s_waitcnt lgkmcnt(3)
    v_mfma_f32_16x16x32_bf16 v[48:51], a[168:171], v[24:27], v[48:51]
    v_mfma_f32_16x16x32_bf16 v[52:55], a[172:175], v[24:27], v[52:55]
    v_mfma_f32_16x16x32_bf16 v[64:67], v[24:27], v[136:139], v[64:67]
    v_mfma_f32_16x16x32_bf16 v[68:71], v[24:27], v[140:143], v[68:71]
    ds_read_b128 v[24:27], v6 offset:10240
    s_waitcnt lgkmcnt(3)
    v_mfma_f32_16x16x32_bf16 v[56:59], a[168:171], v[28:31], v[56:59]
    v_mfma_f32_16x16x32_bf16 v[60:63], a[172:175], v[28:31], v[60:63]
    v_mfma_f32_16x16x32_bf16 v[72:75], v[28:31], v[136:139], v[72:75]
    v_mfma_f32_16x16x32_bf16 v[76:79], v[28:31], v[140:143], v[76:79]
    ds_read_b128 v[28:31], v6 offset:11264
    s_waitcnt lgkmcnt(3)
    v_mfma_f32_16x16x32_bf16 v[48:51], a[176:179], v[16:19], v[48:51]
    v_mfma_f32_16x16x32_bf16 v[52:55], a[180:183], v[16:19], v[52:55]
    v_mfma_f32_16x16x32_bf16 v[64:67], v[16:19], v[144:147], v[64:67]
    v_mfma_f32_16x16x32_bf16 v[68:71], v[16:19], v[148:151], v[68:71]
    ds_read_b128 v[16:19], v6 offset:12288
    s_waitcnt lgkmcnt(3)
    v_mfma_f32_16x16x32_bf16 v[56:59], a[176:179], v[20:23], v[56:59]
    v_mfma_f32_16x16x32_bf16 v[60:63], a[180:183], v[20:23], v[60:63]
    v_mfma_f32_16x16x32_bf16 v[72:75], v[20:23], v[144:147], v[72:75]
    v_mfma_f32_16x16x32_bf16 v[76:79], v[20:23], v[148:151], v[76:79]
    ds_read_b128 v[20:23], v6 offset:13312
    s_cmp_eq_u32 s65, 0
    s_cbranch_scc1 L_lp_41
    s_waitcnt vmcnt(0)
    s_barrier
    s_cmp_lg_u32 s32, 0
    s_cbranch_scc1 L_lp_41
    v_mov_b32_e64 v14, 1
    s_mov_b64 exec, 1
    buffer_store_dword v14, off, s[8:11], s65 offset:0 sc1
    s_mov_b64 exec, -1
L_lp_41:
    s_mov_b32 s65, 0
    s_waitcnt lgkmcnt(3)
    v_mfma_f32_16x16x32_bf16 v[48:51], a[184:187], v[24:27], v[48:51]
    v_mfma_f32_16x16x32_bf16 v[52:55], a[188:191], v[24:27], v[52:55]
    v_mfma_f32_16x16x32_bf16 v[64:67], v[24:27], v[152:155], v[64:67]
    v_mfma_f32_16x16x32_bf16 v[68:71], v[24:27], v[156:159], v[68:71]
    ds_read_b128 v[24:27], v6 offset:14336
    s_waitcnt lgkmcnt(3)
    v_mfma_f32_16x16x32_bf16 v[56:59], a[184:187], v[28:31], v[56:59]
    v_mfma_f32_16x16x32_bf16 v[60:63], a[188:191], v[28:31], v[60:63]
    v_mfma_f32_16x16x32_bf16 v[72:75], v[28:31], v[152:155], v[72:75]
    v_mfma_f32_16x16x32_bf16 v[76:79], v[28:31], v[156:159], v[76:79]
    ds_read_b128 v[28:31], v6 offset:15360
    s_waitcnt lgkmcnt(3)
    v_mfma_f32_16x16x32_bf16 v[48:51], a[192:195], v[16:19], v[48:51]
    v_mfma_f32_16x16x32_bf16 v[52:55], a[196:199], v[16:19], v[52:55]
    v_mfma_f32_16x16x32_bf16 v[64:67], v[16:19], v[160:163], v[64:67]
    v_mfma_f32_16x16x32_bf16 v[68:71], v[16:19], v[164:167], v[68:71]
    ds_read_b128 v[16:19], v6 offset:16384
    s_waitcnt lgkmcnt(3)
    v_mfma_f32_16x16x32_bf16 v[56:59], a[192:195], v[20:23], v[56:59]
    v_mfma_f32_16x16x32_bf16 v[60:63], a[196:199], v[20:23], v[60:63]
    v_mfma_f32_16x16x32_bf16 v[72:75], v[20:23], v[160:163], v[72:75]
    v_mfma_f32_16x16x32_bf16 v[76:79], v[20:23], v[164:167], v[76:79]
    ds_read_b128 v[20:23], v6 offset:17408
    s_waitcnt lgkmcnt(3)
    v_mfma_f32_16x16x32_bf16 v[48:51], a[200:203], v[24:27], v[48:51]
    v_mfma_f32_16x16x32_bf16 v[52:55], a[204:207], v[24:27], v[52:55]
    v_mfma_f32_16x16x32_bf16 v[64:67], v[24:27], v[168:171], v[64:67]
    v_mfma_f32_16x16x32_bf16 v[68:71], v[24:27], v[172:175], v[68:71]
    ds_read_b128 v[24:27], v6 offset:18432
    s_waitcnt lgkmcnt(3)
    v_mfma_f32_16x16x32_bf16 v[56:59], a[200:203], v[28:31], v[56:59]
    v_mfma_f32_16x16x32_bf16 v[60:63], a[204:207], v[28:31], v[60:63]
    v_mfma_f32_16x16x32_bf16 v[72:75], v[28:31], v[168:171], v[72:75]
    v_mfma_f32_16x16x32_bf16 v[76:79], v[28:31], v[172:175], v[76:79]
    ds_read_b128 v[28:31], v6 offset:19456
    s_waitcnt lgkmcnt(3)
    v_mfma_f32_16x16x32_bf16 v[48:51], a[208:211], v[16:19], v[48:51]
    v_mfma_f32_16x16x32_bf16 v[52:55], a[212:215], v[16:19], v[52:55]
    v_mfma_f32_16x16x32_bf16 v[64:67], v[16:19], v[176:179], v[64:67]
    v_mfma_f32_16x16x32_bf16 v[68:71], v[16:19], v[180:183], v[68:71]
    ds_read_b128 v[16:19], v6 offset:20480
    s_waitcnt lgkmcnt(3)
    v_mfma_f32_16x16x32_bf16 v[56:59], a[208:211], v[20:23], v[56:59]
    v_mfma_f32_16x16x32_bf16 v[60:63], a[212:215], v[20:23], v[60:63]
    v_mfma_f32_16x16x32_bf16 v[72:75], v[20:23], v[176:179], v[72:75]
    v_mfma_f32_16x16x32_bf16 v[76:79], v[20:23], v[180:183], v[76:79]
    ds_read_b128 v[20:23], v6 offset:21504
    s_waitcnt lgkmcnt(3)
    v_mfma_f32_16x16x32_bf16 v[48:51], a[216:219], v[24:27], v[48:51]
    v_mfma_f32_16x16x32_bf16 v[52:55], a[220:223], v[24:27], v[52:55]
    v_mfma_f32_16x16x32_bf16 v[64:67], v[24:27], v[184:187], v[64:67]
    v_mfma_f32_16x16x32_bf16 v[68:71], v[24:27], v[188:191], v[68:71]
    ds_read_b128 v[24:27], v6 offset:22528
    s_waitcnt lgkmcnt(3)
    v_mfma_f32_16x16x32_bf16 v[56:59], a[216:219], v[28:31], v[56:59]
    v_mfma_f32_16x16x32_bf16 v[60:63], a[220:223], v[28:31], v[60:63]
    v_mfma_f32_16x16x32_bf16 v[72:75], v[28:31], v[184:187], v[72:75]
    v_mfma_f32_16x16x32_bf16 v[76:79], v[28:31], v[188:191], v[76:79]
    ds_read_b128 v[28:31], v6 offset:23552
    s_waitcnt lgkmcnt(3)
    v_mfma_f32_16x16x32_bf16 v[48:51], a[224:227], v[16:19], v[48:51]
    v_mfma_f32_16x16x32_bf16 v[52:55], a[228:231], v[16:19], v[52:55]
    v_mfma_f32_16x16x32_bf16 v[64:67], v[16:19], v[192:195], v[64:67]
    v_mfma_f32_16x16x32_bf16 v[68:71], v[16:19], v[196:199], v[68:71]
    ds_read_b128 v[16:19], v6 offset:24576
    s_waitcnt lgkmcnt(3)
    v_mfma_f32_16x16x32_bf16 v[56:59], a[224:227], v[20:23], v[56:59]
    v_mfma_f32_16x16x32_bf16 v[60:63], a[228:231], v[20:23], v[60:63]
    v_mfma_f32_16x16x32_bf16 v[72:75], v[20:23], v[192:195], v[72:75]
    v_mfma_f32_16x16x32_bf16 v[76:79], v[20:23], v[196:199], v[76:79]
    ds_read_b128 v[20:23], v6 offset:25600
    s_waitcnt lgkmcnt(3)
    v_mfma_f32_16x16x32_bf16 v[48:51], a[232:235], v[24:27], v[48:51]
    v_mfma_f32_16x16x32_bf16 v[52:55], a[236:239], v[24:27], v[52:55]
    v_mfma_f32_16x16x32_bf16 v[64:67], v[24:27], v[200:203], v[64:67]
    v_mfma_f32_16x16x32_bf16 v[68:71], v[24:27], v[204:207], v[68:71]
    ds_read_b128 v[24:27], v6 offset:26624
    s_waitcnt lgkmcnt(3)
    v_mfma_f32_16x16x32_bf16 v[56:59], a[232:235], v[28:31], v[56:59]
    v_mfma_f32_16x16x32_bf16 v[60:63], a[236:239], v[28:31], v[60:63]
    v_mfma_f32_16x16x32_bf16 v[72:75], v[28:31], v[200:203], v[72:75]
    v_mfma_f32_16x16x32_bf16 v[76:79], v[28:31], v[204:207], v[76:79]
    ds_read_b128 v[28:31], v6 offset:27648
    s_waitcnt lgkmcnt(3)
    v_mfma_f32_16x16x32_bf16 v[48:51], a[240:243], v[16:19], v[48:51]
    v_mfma_f32_16x16x32_bf16 v[52:55], a[244:247], v[16:19], v[52:55]
    v_mfma_f32_16x16x32_bf16 v[64:67], v[16:19], v[208:211], v[64:67]
    v_mfma_f32_16x16x32_bf16 v[68:71], v[16:19], v[212:215], v[68:71]
    ds_read_b128 v[16:19], v6 offset:28672
    s_waitcnt lgkmcnt(3)
    v_mfma_f32_16x16x32_bf16 v[56:59], a[240:243], v[20:23], v[56:59]
    v_mfma_f32_16x16x32_bf16 v[60:63], a[244:247], v[20:23], v[60:63]
    v_mfma_f32_16x16x32_bf16 v[72:75], v[20:23], v[208:211], v[72:75]
    v_mfma_f32_16x16x32_bf16 v[76:79], v[20:23], v[212:215], v[76:79]
    ds_read_b128 v[20:23], v6 offset:29696
    s_waitcnt lgkmcnt(3)
    v_mfma_f32_16x16x32_bf16 v[48:51], a[248:251], v[24:27], v[48:51]
    v_mfma_f32_16x16x32_bf16 v[52:55], a[252:255], v[24:27], v[52:55]
    v_mfma_f32_16x16x32_bf16 v[64:67], v[24:27], v[216:219], v[64:67]
    v_mfma_f32_16x16x32_bf16 v[68:71], v[24:27], v[220:223], v[68:71]
    ds_read_b128 v[24:27], v6 offset:30720
    s_waitcnt lgkmcnt(3)
    v_mfma_f32_16x16x32_bf16 v[56:59], a[248:251], v[28:31], v[56:59]
    v_mfma_f32_16x16x32_bf16 v[60:63], a[252:255], v[28:31], v[60:63]
    v_mfma_f32_16x16x32_bf16 v[72:75], v[28:31], v[216:219], v[72:75]
    v_mfma_f32_16x16x32_bf16 v[76:79], v[28:31], v[220:223], v[76:79]
    ds_read_b128 v[28:31], v6 offset:31744
    s_waitcnt lgkmcnt(3)
    v_mfma_f32_16x16x32_bf16 v[48:51], v[80:83], v[16:19], v[48:51]
    v_mfma_f32_16x16x32_bf16 v[52:55], v[84:87], v[16:19], v[52:55]
    v_mfma_f32_16x16x32_bf16 v[64:67], v[16:19], v[224:227], v[64:67]
    v_mfma_f32_16x16x32_bf16 v[68:71], v[16:19], v[228:231], v[68:71]
    ds_read_b128 v[16:19], v6 offset:32768
    s_waitcnt lgkmcnt(3)
    v_mfma_f32_16x16x32_bf16 v[56:59], v[80:83], v[20:23], v[56:59]
    v_mfma_f32_16x16x32_bf16 v[60:63], v[84:87], v[20:23], v[60:63]
    v_mfma_f32_16x16x32_bf16 v[72:75], v[20:23], v[224:227], v[72:75]
    v_mfma_f32_16x16x32_bf16 v[76:79], v[20:23], v[228:231], v[76:79]
    ds_read_b128 v[20:23], v6 offset:33792
    s_waitcnt lgkmcnt(3)
    v_mfma_f32_16x16x32_bf16 v[48:51], v[88:91], v[24:27], v[48:51]
    v_mfma_f32_16x16x32_bf16 v[52:55], v[92:95], v[24:27], v[52:55]
    v_mfma_f32_16x16x32_bf16 v[64:67], v[24:27], v[232:235], v[64:67]
    v_mfma_f32_16x16x32_bf16 v[68:71], v[24:27], v[236:239], v[68:71]
    ds_read_b128 v[24:27], v6 offset:34816
    s_waitcnt lgkmcnt(3)
    v_mfma_f32_16x16x32_bf16 v[56:59], v[88:91], v[28:31], v[56:59]
    v_mfma_f32_16x16x32_bf16 v[60:63], v[92:95], v[28:31], v[60:63]
    v_mfma_f32_16x16x32_bf16 v[72:75], v[28:31], v[232:235], v[72:75]
    v_mfma_f32_16x16x32_bf16 v[76:79], v[28:31], v[236:239], v[76:79]
    ds_read_b128 v[28:31], v6 offset:35840
    s_waitcnt lgkmcnt(3)
    v_mfma_f32_16x16x32_bf16 v[48:51], v[96:99], v[16:19], v[48:51]
    v_mfma_f32_16x16x32_bf16 v[52:55], v[100:103], v[16:19], v[52:55]
    v_mfma_f32_16x16x32_bf16 v[64:67], v[16:19], v[240:243], v[64:67]
    v_mfma_f32_16x16x32_bf16 v[68:71], v[16:19], v[244:247], v[68:71]
    s_waitcnt lgkmcnt(2)
    v_mfma_f32_16x16x32_bf16 v[56:59], v[96:99], v[20:23], v[56:59]
    v_mfma_f32_16x16x32_bf16 v[60:63], v[100:103], v[20:23], v[60:63]
    v_mfma_f32_16x16x32_bf16 v[72:75], v[20:23], v[240:243], v[72:75]
    v_mfma_f32_16x16x32_bf16 v[76:79], v[20:23], v[244:247], v[76:79]
    s_waitcnt lgkmcnt(1)
    v_mfma_f32_16x16x32_bf16 v[48:51], v[104:107], v[24:27], v[48:51]
    v_mfma_f32_16x16x32_bf16 v[52:55], v[108:111], v[24:27], v[52:55]
    v_mfma_f32_16x16x32_bf16 v[64:67], v[24:27], v[248:251], v[64:67]
    v_mfma_f32_16x16x32_bf16 v[68:71], v[24:27], v[252:255], v[68:71]
    s_waitcnt lgkmcnt(0)
    v_mfma_f32_16x16x32_bf16 v[56:59], v[104:107], v[28:31], v[56:59]
    v_mfma_f32_16x16x32_bf16 v[60:63], v[108:111], v[28:31], v[60:63]
    v_mfma_f32_16x16x32_bf16 v[72:75], v[28:31], v[248:251], v[72:75]
    v_mfma_f32_16x16x32_bf16 v[76:79], v[28:31], v[252:255], v[76:79]
    s_nop 0
    v_cvt_pk_bf16_f32 v48, v48, v52
    v_cvt_pk_bf16_f32 v49, v49, v53
    v_cvt_pk_bf16_f32 v50, v50, v54
    v_cvt_pk_bf16_f32 v51, v51, v55
    buffer_store_dwordx4 v[48:51], v4, s[8:11], s56 offen offset:0 sc1
    ds_write_b128 v10, v[48:51] offset:9216
    v_cvt_pk_bf16_f32 v56, v56, v60
    v_cvt_pk_bf16_f32 v57, v57, v61
    v_cvt_pk_bf16_f32 v58, v58, v62
    v_cvt_pk_bf16_f32 v59, v59, v63
    buffer_store_dwordx4 v[56:59], v4, s[8:11], s56 offen offset:1024 sc1
    ds_write_b128 v10, v[56:59] offset:10240
    v_cvt_pk_bf16_f32 v64, v64, v65
    v_cvt_pk_bf16_f32 v65, v66, v67
    v_cvt_pk_bf16_f32 v66, v72, v73
    v_cvt_pk_bf16_f32 v67, v74, v75
    buffer_store_dwordx4 v[64:67], v4, s[8:11], s57 offen offset:0 sc1
    ds_write_b128 v10, v[64:67] offset:17408
    v_cvt_pk_bf16_f32 v68, v68, v69
    v_cvt_pk_bf16_f32 v69, v70, v71
    v_cvt_pk_bf16_f32 v70, v76, v77
    v_cvt_pk_bf16_f32 v71, v78, v79
    buffer_store_dwordx4 v[68:71], v4, s[8:11], s57 offen offset:1024 sc1
    ds_write_b128 v10, v[68:71] offset:18432
    s_waitcnt lgkmcnt(0)
    ds_read_b128 v[16:19], v6 offset:0
    ds_read_b128 v[20:23], v6 offset:1024
    ds_read_b128 v[24:27], v6 offset:2048
    ds_read_b128 v[28:31], v6 offset:3072
    s_waitcnt lgkmcnt(3)
    v_mfma_f32_16x16x32_bf16 v[32:35], a[0:3], v[16:19], 0
    v_mfma_f32_16x16x32_bf16 v[36:39], a[4:7], v[16:19], 0
    ds_read_b128 v[16:19], v6 offset:4096
    s_waitcnt lgkmcnt(3)
    v_mfma_f32_16x16x32_bf16 v[40:43], a[0:3], v[20:23], 0
    v_mfma_f32_16x16x32_bf16 v[44:47], a[4:7], v[20:23], 0
    ds_read_b128 v[20:23], v6 offset:5120
    s_waitcnt lgkmcnt(3)
    v_mfma_f32_16x16x32_bf16 v[32:35], a[8:11], v[24:27], v[32:35]
    v_mfma_f32_16x16x32_bf16 v[36:39], a[12:15], v[24:27], v[36:39]
    ds_read_b128 v[24:27], v6 offset:6144
    s_waitcnt lgkmcnt(3)
    v_mfma_f32_16x16x32_bf16 v[40:43], a[8:11], v[28:31], v[40:43]
    v_mfma_f32_16x16x32_bf16 v[44:47], a[12:15], v[28:31], v[44:47]
    ds_read_b128 v[28:31], v6 offset:7168
    s_waitcnt lgkmcnt(3)
    v_mfma_f32_16x16x32_bf16 v[32:35], a[16:19], v[16:19], v[32:35]
    v_mfma_f32_16x16x32_bf16 v[36:39], a[20:23], v[16:19], v[36:39]
    ds_read_b128 v[16:19], v6 offset:8192
    s_waitcnt lgkmcnt(3)
    v_mfma_f32_16x16x32_bf16 v[40:43], a[16:19], v[20:23], v[40:43]
    v_mfma_f32_16x16x32_bf16 v[44:47], a[20:23], v[20:23], v[44:47]
    ds_read_b128 v[20:23], v6 offset:9216
    s_waitcnt lgkmcnt(3)
    v_mfma_f32_16x16x32_bf16 v[32:35], a[24:27], v[24:27], v[32:35]
    v_mfma_f32_16x16x32_bf16 v[36:39], a[28:31], v[24:27], v[36:39]
    ds_read_b128 v[24:27], v6 offset:10240
    s_waitcnt lgkmcnt(3)
    v_mfma_f32_16x16x32_bf16 v[40:43], a[24:27], v[28:31], v[40:43]
    v_mfma_f32_16x16x32_bf16 v[44:47], a[28:31], v[28:31], v[44:47]
    ds_read_b128 v[28:31], v6 offset:11264
    s_waitcnt lgkmcnt(3)
    v_mfma_f32_16x16x32_bf16 v[32:35], a[32:35], v[16:19], v[32:35]
    v_mfma_f32_16x16x32_bf16 v[36:39], a[36:39], v[16:19], v[36:39]
    ds_read_b128 v[16:19], v6 offset:12288
    s_waitcnt lgkmcnt(3)
    v_mfma_f32_16x16x32_bf16 v[40:43], a[32:35], v[20:23], v[40:43]
    v_mfma_f32_16x16x32_bf16 v[44:47], a[36:39], v[20:23], v[44:47]
    ds_read_b128 v[20:23], v6 offset:13312
    s_waitcnt lgkmcnt(3)
    v_mfma_f32_16x16x32_bf16 v[32:35], a[40:43], v[24:27], v[32:35]
    v_mfma_f32_16x16x32_bf16 v[36:39], a[44:47], v[24:27], v[36:39]
    ds_read_b128 v[24:27], v6 offset:14336
    s_waitcnt lgkmcnt(3)
    v_mfma_f32_16x16x32_bf16 v[40:43], a[40:43], v[28:31], v[40:43]
    v_mfma_f32_16x16x32_bf16 v[44:47], a[44:47], v[28:31], v[44:47]
    ds_read_b128 v[28:31], v6 offset:15360
    s_waitcnt lgkmcnt(3)
    v_mfma_f32_16x16x32_bf16 v[32:35], a[48:51], v[16:19], v[32:35]
    v_mfma_f32_16x16x32_bf16 v[36:39], a[52:55], v[16:19], v[36:39]
    ds_read_b128 v[16:19], v6 offset:16384
    s_waitcnt lgkmcnt(3)
    v_mfma_f32_16x16x32_bf16 v[40:43], a[48:51], v[20:23], v[40:43]
    v_mfma_f32_16x16x32_bf16 v[44:47], a[52:55], v[20:23], v[44:47]
    ds_read_b128 v[20:23], v6 offset:17408
    s_waitcnt vmcnt(0)
    s_barrier
    s_cmp_lg_u32 s32, 0
    s_cbranch_scc1 L_pf_43
    v_mov_b32_e64 v14, 1
    s_mov_b64 exec, 1
    buffer_store_dword v14, off, s[8:11], s52 offset:0 sc1
    s_mov_b64 exec, -1
L_pf_43:
    s_waitcnt lgkmcnt(3)
    v_mfma_f32_16x16x32_bf16 v[32:35], a[56:59], v[24:27], v[32:35]
    v_mfma_f32_16x16x32_bf16 v[36:39], a[60:63], v[24:27], v[36:39]
    ds_read_b128 v[24:27], v6 offset:18432
    s_waitcnt lgkmcnt(3)
    v_mfma_f32_16x16x32_bf16 v[40:43], a[56:59], v[28:31], v[40:43]
    v_mfma_f32_16x16x32_bf16 v[44:47], a[60:63], v[28:31], v[44:47]
    ds_read_b128 v[28:31], v6 offset:19456
    s_waitcnt lgkmcnt(3)
    v_mfma_f32_16x16x32_bf16 v[32:35], a[64:67], v[16:19], v[32:35]
    v_mfma_f32_16x16x32_bf16 v[36:39], a[68:71], v[16:19], v[36:39]
    ds_read_b128 v[16:19], v6 offset:20480
    s_waitcnt lgkmcnt(3)
    v_mfma_f32_16x16x32_bf16 v[40:43], a[64:67], v[20:23], v[40:43]
    v_mfma_f32_16x16x32_bf16 v[44:47], a[68:71], v[20:23], v[44:47]
    ds_read_b128 v[20:23], v6 offset:21504
    s_waitcnt lgkmcnt(3)
    v_mfma_f32_16x16x32_bf16 v[32:35], a[72:75], v[24:27], v[32:35]
    v_mfma_f32_16x16x32_bf16 v[36:39], a[76:79], v[24:27], v[36:39]
    ds_read_b128 v[24:27], v6 offset:22528
    s_waitcnt lgkmcnt(3)
    v_mfma_f32_16x16x32_bf16 v[40:43], a[72:75], v[28:31], v[40:43]
    v_mfma_f32_16x16x32_bf16 v[44:47], a[76:79], v[28:31], v[44:47]
    ds_read_b128 v[28:31], v6 offset:23552
    s_waitcnt lgkmcnt(3)
    v_mfma_f32_16x16x32_bf16 v[32:35], a[80:83], v[16:19], v[32:35]
    v_mfma_f32_16x16x32_bf16 v[36:39], a[84:87], v[16:19], v[36:39]
    ds_read_b128 v[16:19], v6 offset:24576
    s_waitcnt lgkmcnt(3)
    v_mfma_f32_16x16x32_bf16 v[40:43], a[80:83], v[20:23], v[40:43]
    v_mfma_f32_16x16x32_bf16 v[44:47], a[84:87], v[20:23], v[44:47]
    ds_read_b128 v[20:23], v6 offset:25600
    s_waitcnt lgkmcnt(3)
    v_mfma_f32_16x16x32_bf16 v[32:35], a[88:91], v[24:27], v[32:35]
    v_mfma_f32_16x16x32_bf16 v[36:39], a[92:95], v[24:27], v[36:39]
    ds_read_b128 v[24:27], v6 offset:26624
    s_waitcnt lgkmcnt(3)
    v_mfma_f32_16x16x32_bf16 v[40:43], a[88:91], v[28:31], v[40:43]
    v_mfma_f32_16x16x32_bf16 v[44:47], a[92:95], v[28:31], v[44:47]
    ds_read_b128 v[28:31], v6 offset:27648
    s_waitcnt lgkmcnt(3)
    v_mfma_f32_16x16x32_bf16 v[32:35], a[96:99], v[16:19], v[32:35]
    v_mfma_f32_16x16x32_bf16 v[36:39], a[100:103], v[16:19], v[36:39]
    ds_read_b128 v[16:19], v6 offset:28672
    s_waitcnt lgkmcnt(3)
    v_mfma_f32_16x16x32_bf16 v[40:43], a[96:99], v[20:23], v[40:43]
    v_mfma_f32_16x16x32_bf16 v[44:47], a[100:103], v[20:23], v[44:47]
    ds_read_b128 v[20:23], v6 offset:29696
    s_waitcnt lgkmcnt(3)
    v_mfma_f32_16x16x32_bf16 v[32:35], a[104:107], v[24:27], v[32:35]
    v_mfma_f32_16x16x32_bf16 v[36:39], a[108:111], v[24:27], v[36:39]
    ds_read_b128 v[24:27], v6 offset:30720
    s_waitcnt lgkmcnt(3)
    v_mfma_f32_16x16x32_bf16 v[40:43], a[104:107], v[28:31], v[40:43]
    v_mfma_f32_16x16x32_bf16 v[44:47], a[108:111], v[28:31], v[44:47]
    ds_read_b128 v[28:31], v6 offset:31744
    s_waitcnt lgkmcnt(3)
    v_mfma_f32_16x16x32_bf16 v[32:35], a[112:115], v[16:19], v[32:35]
    v_mfma_f32_16x16x32_bf16 v[36:39], a[116:119], v[16:19], v[36:39]
    ds_read_b128 v[16:19], v6 offset:32768
    s_waitcnt lgkmcnt(3)
    v_mfma_f32_16x16x32_bf16 v[40:43], a[112:115], v[20:23], v[40:43]
    v_mfma_f32_16x16x32_bf16 v[44:47], a[116:119], v[20:23], v[44:47]
    ds_read_b128 v[20:23], v6 offset:33792
    s_waitcnt lgkmcnt(3)
    v_mfma_f32_16x16x32_bf16 v[32:35], a[120:123], v[24:27], v[32:35]
    v_mfma_f32_16x16x32_bf16 v[36:39], a[124:127], v[24:27], v[36:39]
    ds_read_b128 v[24:27], v6 offset:34816
    s_waitcnt lgkmcnt(3)
    v_mfma_f32_16x16x32_bf16 v[40:43], a[120:123], v[28:31], v[40:43]
    v_mfma_f32_16x16x32_bf16 v[44:47], a[124:127], v[28:31], v[44:47]
    ds_read_b128 v[28:31], v6 offset:35840
    s_waitcnt lgkmcnt(3)
    v_mfma_f32_16x16x32_bf16 v[32:35], a[128:131], v[16:19], v[32:35]
    v_mfma_f32_16x16x32_bf16 v[36:39], a[132:135], v[16:19], v[36:39]
    s_waitcnt lgkmcnt(2)
    v_mfma_f32_16x16x32_bf16 v[40:43], a[128:131], v[20:23], v[40:43]
    v_mfma_f32_16x16x32_bf16 v[44:47], a[132:135], v[20:23], v[44:47]
    s_waitcnt lgkmcnt(1)
    v_mfma_f32_16x16x32_bf16 v[32:35], a[136:139], v[24:27], v[32:35]
    v_mfma_f32_16x16x32_bf16 v[36:39], a[140:143], v[24:27], v[36:39]
    s_waitcnt lgkmcnt(0)
    v_mfma_f32_16x16x32_bf16 v[40:43], a[136:139], v[28:31], v[40:43]
    v_mfma_f32_16x16x32_bf16 v[44:47], a[140:143], v[28:31], v[44:47]
    s_nop 4
    v_cvt_pk_bf16_f32 v32, v32, v36
    v_cvt_pk_bf16_f32 v33, v33, v37
    v_cvt_pk_bf16_f32 v34, v34, v38
    v_cvt_pk_bf16_f32 v35, v35, v39
    ds_write_b128 v11, v[32:35] offset:0
    v_cvt_pk_bf16_f32 v40, v40, v44
    v_cvt_pk_bf16_f32 v41, v41, v45
    v_cvt_pk_bf16_f32 v42, v42, v46
    v_cvt_pk_bf16_f32 v43, v43, v47
    ds_write_b128 v11, v[40:43] offset:1152
    s_waitcnt lgkmcnt(0)
    s_barrier
    s_cmp_lg_u32 s44, 0
    s_cbranch_scc1 L_mk_45
L_mk_45:
    s_add_u32 s55, s45, 3
    s_cmp_ge_u32 s55, 64
    s_cbranch_scc1 L_p_attn
    s_cmp_ge_u32 s55, 12
    s_cbranch_scc1 L_xk_46
    s_cmp_ge_u32 s55, 9
    s_cbranch_scc1 L_xa_47
    s_lshl_b32 s46, s43, 20
    s_lshl_b32 s56, s55, 8
    s_add_u32 s46, s46, s56
    s_add_u32 s46, s46, 0x1800000
    s_cmp_lg_u32 s32, 0
    s_cbranch_scc1 L_wfs_48
    s_mov_b32 s40, 0
    v_min_u32 v16, 1, v0
    v_lshlrev_b32_e64 v16, 7, v16
    s_branch L_wfe_50
L_wf_49:
    s_add_u32 s40, s40, 1
    s_cmp_gt_u32 s40, 0x100000
    s_cbranch_scc1 L_abort
    s_sleep 1
L_wfe_50:
    buffer_load_dword v18, v16, s[8:11], s46 offen sc1
    s_waitcnt vmcnt(0)
    v_cmpx_eq_u32 vcc, 0, v18
    s_cbranch_execnz L_wf_49
    s_mov_b64 exec, -1
L_wfs_48:
    s_barrier
    s_branch L_xk_46
L_xa_47:
    s_lshl_b32 s46, s43, 20
    s_add_u32 s46, s46, 0x1800000
    s_cmp_lg_u32 s32, 0
    s_cbranch_scc1 L_wfs_51
    s_mov_b32 s40, 0
    v_min_u32 v16, 63, v0
    v_lshlrev_b32 v16, 7, v16
    v_add_u32_e64 v17, 64, v0
    v_min_u32 v17, 127, v17
    v_lshlrev_b32_e64 v17, 7, v17
    s_branch L_wfe_53
L_wf_52:
    s_add_u32 s40, s40, 1
    s_cmp_gt_u32 s40, 0x100000
    s_cbranch_scc1 L_abort
    s_sleep 1
L_wfe_53:
    buffer_load_dword v18, v16, s[8:11], s46 offen sc1
    buffer_load_dword v19, v17, s[8:11], s46 offen sc1
    s_waitcnt vmcnt(0)
    v_min_u32 v20, v18, v19
    v_cmpx_eq_u32 vcc, 0, v20
    s_cbranch_execnz L_wf_52
    s_mov_b64 exec, -1
L_wfs_51:
    s_barrier
L_xk_46:
    s_mul_i32 s46, s43, 2359296
    s_mul_i32 s56, s55, 36864
    s_add_u32 s46, s46, s56
    s_mul_i32 s56, s32, 9216
    s_add_u32 s46, s46, s56
    s_add_u32 s46, s46, 0x320000
    s_add_u32 m0, s56, 0
    s_nop 0
    buffer_load_dwordx4 v6, s[8:11], s46 offen offset:0 sc1 lds
    buffer_load_dwordx4 v6, s[8:11], s46 offen offset:1024 sc1 lds
    buffer_load_dwordx4 v6, s[8:11], s46 offen offset:2048 sc1 lds
    buffer_load_dwordx4 v6, s[8:11], s46 offen offset:3072 sc1 lds
    s_add_u32 m0, s56, 4096
    s_add_u32 s46, s46, 4096
    buffer_load_dwordx4 v6, s[8:11], s46 offen offset:0 sc1 lds
    buffer_load_dwordx4 v6, s[8:11], s46 offen offset:1024 sc1 lds
    buffer_load_dwordx4 v6, s[8:11], s46 offen offset:2048 sc1 lds
    buffer_load_dwordx4 v6, s[8:11], s46 offen offset:3072 sc1 lds
    s_add_u32 m0, s56, 8192
    s_add_u32 s46, s46, 4096
    buffer_load_dwordx4 v6, s[8:11], s46 offen offset:0 sc1 lds
L_p_attn:
    s_cmp_eq_u32 s44, 0
    s_cbranch_scc1 L_p_next
    s_sub_u32 s55, s45, 3
    s_and_b32 s46, s44, 1
    s_xor_b32 s46, s46, 1
    s_mul_i32 s50, s46, 25600
    s_add_u32 s50, s50, 36864
    v_add_u32 v10, s50, v6
    v_add_u32 v11, s50, v3
    v_cmp_le_i32 vcc, 0, v7
    v_mov_b32 v64, s64
    s_nop 0
    v_cndmask_b32 v64, v64, 0, vcc
    v_cmp_le_i32_e64 vcc, 1, v7
    v_mov_b32 v65, s64
    s_nop 0
    v_cndmask_b32 v65, v65, 0, vcc
    v_cmp_le_i32_e64 vcc, 2, v7
    v_mov_b32 v66, s64
    s_nop 0
    v_cndmask_b32 v66, v66, 0, vcc
    v_cmp_le_i32_e64 vcc, 3, v7
    v_mov_b32 v67, s64
    s_nop 0
    v_cndmask_b32 v67, v67, 0, vcc
    v_cmp_le_i32_e64 vcc, 4, v7
    v_mov_b32 v68, s64
    s_nop 0
    v_cndmask_b32 v68, v68, 0, vcc
    v_cmp_le_i32_e64 vcc, 5, v7
    v_mov_b32 v69, s64
    s_nop 0
    v_cndmask_b32 v69, v69, 0, vcc
    v_cmp_le_i32_e64 vcc, 6, v7
    v_mov_b32 v70, s64
    s_nop 0
    v_cndmask_b32 v70, v70, 0, vcc
    v_cmp_le_i32_e64 vcc, 7, v7
    v_mov_b32 v71, s64
    s_nop 0
    v_cndmask_b32 v71, v71, 0, vcc
    v_cmp_le_i32_e64 vcc, -16, v7
    v_mov_b32 v72, s64
    s_nop 0
    v_cndmask_b32 v72, v72, 0, vcc
    v_cmp_le_i32_e64 vcc, -15, v7
    v_mov_b32 v73, s64
    s_nop 0
    v_cndmask_b32 v73, v73, 0, vcc
    v_cmp_le_i32_e64 vcc, -14, v7
    v_mov_b32 v74, s64
    s_nop 0
    v_cndmask_b32 v74, v74, 0, vcc
    v_cmp_le_i32_e64 vcc, -13, v7
    v_mov_b32 v75, s64
    s_nop 0
    v_cndmask_b32 v75, v75, 0, vcc
    v_cmp_le_i32_e64 vcc, -12, v7
    v_mov_b32 v76, s64
    s_nop 0
    v_cndmask_b32 v76, v76, 0, vcc
    v_cmp_le_i32_e64 vcc, -11, v7
    v_mov_b32 v77, s64
    s_nop 0
    v_cndmask_b32 v77, v77, 0, vcc
    v_cmp_le_i32_e64 vcc, -10, v7
    v_mov_b32 v78, s64
    s_nop 0
    v_cndmask_b32 v78, v78, 0, vcc
    v_cmp_le_i32_e64 vcc, -9, v7
    v_mov_b32 v79, s64
    s_nop 0
    v_cndmask_b32 v79, v79, 0, vcc
    ds_read_b128 v[16:19], v10 offset:9216
    ds_read_b128 v[20:23], v10 offset:10240
    ds_read_b128 v[24:27], v11 offset:0
    ds_read_b128 v[28:31], v11 offset:4608
    ds_read_b128 v[32:35], v10 offset:11264
    ds_read_b128 v[36:39], v10 offset:12288
    ds_read_b128 v[40:43], v11 offset:64
    ds_read_b128 v[44:47], v11 offset:4672
    s_waitcnt lgkmcnt(4)
    v_mfma_f32_16x16x32_bf16 v[64:67], v[16:19], v[24:27], v[64:67]
    v_mfma_f32_16x16x32_bf16 v[68:71], v[20:23], v[24:27], v[68:71]
    v_mfma_f32_16x16x32_bf16 v[72:75], v[16:19], v[28:31], v[72:75]
    v_mfma_f32_16x16x32_bf16 v[76:79], v[20:23], v[28:31], v[76:79]
    ds_read_b128 v[16:19], v10 offset:13312
    ds_read_b128 v[20:23], v10 offset:14336
    ds_read_b128 v[24:27], v11 offset:128
    ds_read_b128 v[28:31], v11 offset:4736
    s_waitcnt lgkmcnt(4)
    v_mfma_f32_16x16x32_bf16 v[64:67], v[32:35], v[40:43], v[64:67]
    v_mfma_f32_16x16x32_bf16 v[68:71], v[36:39], v[40:43], v[68:71]
    v_mfma_f32_16x16x32_bf16 v[72:75], v[32:35], v[44:47], v[72:75]
    v_mfma_f32_16x16x32_bf16 v[76:79], v[36:39], v[44:47], v[76:79]
    ds_read_b128 v[32:35], v10 offset:15360
    ds_read_b128 v[36:39], v10 offset:16384
    ds_read_b128 v[40:43], v11 offset:192
    ds_read_b128 v[44:47], v11 offset:4800
    s_waitcnt lgkmcnt(4)
    v_mfma_f32_16x16x32_bf16 v[64:67], v[16:19], v[24:27], v[64:67]
    v_mfma_f32_16x16x32_bf16 v[68:71], v[20:23], v[24:27], v[68:71]
    v_mfma_f32_16x16x32_bf16 v[72:75], v[16:19], v[28:31], v[72:75]
    v_mfma_f32_16x16x32_bf16 v[76:79], v[20:23], v[28:31], v[76:79]
    s_waitcnt lgkmcnt(0)
    v_mfma_f32_16x16x32_bf16 v[64:67], v[32:35], v[40:43], v[64:67]
    v_mfma_f32_16x16x32_bf16 v[68:71], v[36:39], v[40:43], v[68:71]
    v_mfma_f32_16x16x32_bf16 v[72:75], v[32:35], v[44:47], v[72:75]
    v_mfma_f32_16x16x32_bf16 v[76:79], v[36:39], v[44:47], v[76:79]
    s_lshl_b32 s46, s43, 6
    s_add_u32 s46, s46, s55
    s_mul_i32 s46, s46, 9216
    s_add_u32 s46, s46, s53
    s_add_u32 s46, s46, 0x20000
    s_add_u32 s56, s53, 88064
    v_add_u32 v14, s56, v6
    v_add_u32 v15, s56, v9
    s_mov_b32 s40, 0
L_pm_54:
    s_add_u32 s40, s40, 1
    s_cmp_gt_u32 s40, 0x100000
    s_cbranch_scc1 L_abort
    s_sleep 2
    buffer_load_dwordx4 v[16:19], v6, s[8:11], s46 offen sc1
    buffer_load_dwordx4 v[20:23], v6, s[8:11], s46 offen offset:1024 sc1
    buffer_load_dword v24, v9, s[8:11], s46 offen offset:2048 sc1
    s_waitcnt vmcnt(0)
    v_max3_u32 v25, v16, v17, v18
    v_max3_u32 v25, v25, v19, v20
    v_max3_u32 v25, v25, v21, v22
    v_max3_u32 v25, v25, v23, v24
    v_cmp_eq_u32 vcc, -1, v25
    s_cbranch_vccnz L_pm_54
    ds_write_b128 v14, v[16:19]
    ds_write_b128 v14, v[20:23] offset:1024
    ds_write_b32 v15, v24 offset:2048
    s_waitcnt lgkmcnt(0)
    s_barrier
    ds_read_b128 v[16:19], v5 offset:0
    ds_read_b128 v[20:23], v5 offset:512
    ds_read_b128 v[24:27], v5 offset:1024
    ds_read_b128 v[28:31], v5 offset:1536
    s_waitcnt lgkmcnt(3)
    v_mfma_f32_16x16x32_bf16 v[32:35], a[144:147], v[16:19], 0
    v_mfma_f32_16x16x32_bf16 v[36:39], a[148:151], v[16:19], 0
    ds_read_b128 v[16:19], v5 offset:2048
    v_mov_b32_e64 v56, v8
    s_waitcnt lgkmcnt(3)
    v_mfma_f32_16x16x32_bf16 v[32:35], a[152:155], v[20:23], v[32:35]
    v_mfma_f32_16x16x32_bf16 v[36:39], a[156:159], v[20:23], v[36:39]
    ds_read_b128 v[20:23], v5 offset:2560
    v_mov_b32 v57, v8
    s_waitcnt lgkmcnt(3)
    v_mfma_f32_16x16x32_bf16 v[32:35], a[160:163], v[24:27], v[32:35]
    v_mfma_f32_16x16x32_bf16 v[36:39], a[164:167], v[24:27], v[36:39]
    ds_read_b128 v[24:27], v5 offset:3072
    v_mov_b32 v58, v8
    s_waitcnt lgkmcnt(3)
    v_mfma_f32_16x16x32_bf16 v[32:35], a[168:171], v[28:31], v[32:35]
    v_mfma_f32_16x16x32_bf16 v[36:39], a[172:175], v[28:31], v[36:39]
    ds_read_b128 v[28:31], v5 offset:3584
    v_mov_b32 v59, v8
    s_waitcnt lgkmcnt(3)
    v_mfma_f32_16x16x32_bf16 v[32:35], a[176:179], v[16:19], v[32:35]
    v_mfma_f32_16x16x32_bf16 v[36:39], a[180:183], v[16:19], v[36:39]
    ds_read_b128 v[16:19], v5 offset:4096
    v_mov_b32 v60, v8
    s_waitcnt lgkmcnt(3)
    v_mfma_f32_16x16x32_bf16 v[32:35], a[184:187], v[20:23], v[32:35]
    v_mfma_f32_16x16x32_bf16 v[36:39], a[188:191], v[20:23], v[36:39]
    ds_read_b128 v[20:23], v5 offset:4608
    v_mov_b32 v61, v8
    s_waitcnt lgkmcnt(3)
    v_mfma_f32_16x16x32_bf16 v[32:35], a[192:195], v[24:27], v[32:35]
    v_mfma_f32_16x16x32_bf16 v[36:39], a[196:199], v[24:27], v[36:39]
    ds_read_b128 v[24:27], v5 offset:5120
    v_mov_b32 v62, v8
    s_waitcnt lgkmcnt(3)
    v_mfma_f32_16x16x32_bf16 v[32:35], a[200:203], v[28:31], v[32:35]
    v_mfma_f32_16x16x32_bf16 v[36:39], a[204:207], v[28:31], v[36:39]
    ds_read_b128 v[28:31], v5 offset:5632
    v_mov_b32 v63, v8
    s_waitcnt lgkmcnt(3)
    v_mfma_f32_16x16x32_bf16 v[32:35], a[208:211], v[16:19], v[32:35]
    v_mfma_f32_16x16x32_bf16 v[36:39], a[212:215], v[16:19], v[36:39]
    ds_read_b128 v[16:19], v5 offset:6144
    s_lshl_b32 s46, s32, 10
    s_waitcnt lgkmcnt(3)
    v_mfma_f32_16x16x32_bf16 v[32:35], a[216:219], v[20:23], v[32:35]
    v_mfma_f32_16x16x32_bf16 v[36:39], a[220:223], v[20:23], v[36:39]
    ds_read_b128 v[20:23], v5 offset:6656
    s_add_u32 s46, s46, 97280
    s_waitcnt lgkmcnt(3)
    v_mfma_f32_16x16x32_bf16 v[32:35], a[224:227], v[24:27], v[32:35]
    v_mfma_f32_16x16x32_bf16 v[36:39], a[228:231], v[24:27], v[36:39]
    ds_read_b128 v[24:27], v5 offset:7168
    v_add_u32 v14, s46, v6
    s_waitcnt lgkmcnt(3)
    v_mfma_f32_16x16x32_bf16 v[32:35], a[232:235], v[28:31], v[32:35]
    v_mfma_f32_16x16x32_bf16 v[36:39], a[236:239], v[28:31], v[36:39]
    ds_read_b128 v[28:31], v5 offset:7680
    v_add_u32 v15, 97280, v6
    s_waitcnt lgkmcnt(3)
    v_mfma_f32_16x16x32_bf16 v[32:35], a[240:243], v[16:19], v[32:35]
    v_mfma_f32_16x16x32_bf16 v[36:39], a[244:247], v[16:19], v[36:39]
    ds_read_b128 v[16:19], v5 offset:8192
    v_add_u32 v10, s50, v4
    s_waitcnt lgkmcnt(3)
    v_mfma_f32_16x16x32_bf16 v[32:35], a[248:251], v[20:23], v[32:35]
    v_mfma_f32_16x16x32_bf16 v[36:39], a[252:255], v[20:23], v[36:39]
    ds_read_b128 v[20:23], v5 offset:8704
    s_waitcnt lgkmcnt(3)
    v_mfma_f32_16x16x32_bf16 v[32:35], v[80:83], v[24:27], v[32:35]
    v_mfma_f32_16x16x32_bf16 v[36:39], v[84:87], v[24:27], v[36:39]
    ds_read_b128 v[24:27], v5 offset:0
    s_waitcnt lgkmcnt(3)
    v_mfma_f32_16x16x32_bf16 v[32:35], v[88:91], v[28:31], v[32:35]
    v_mfma_f32_16x16x32_bf16 v[36:39], v[92:95], v[28:31], v[36:39]
    ds_read_b128 v[28:31], v5 offset:512
    s_waitcnt lgkmcnt(3)
    v_mfma_f32_16x16x32_bf16 v[32:35], v[96:99], v[16:19], v[32:35]
    v_mfma_f32_16x16x32_bf16 v[36:39], v[100:103], v[16:19], v[36:39]
    ds_read_b128 v[16:19], v5 offset:1024
    s_waitcnt lgkmcnt(3)
    v_mfma_f32_16x16x32_bf16 v[32:35], v[104:107], v[20:23], v[32:35]
    v_mfma_f32_16x16x32_bf16 v[36:39], v[108:111], v[20:23], v[36:39]
    ds_read_b128 v[20:23], v5 offset:1536
    s_waitcnt lgkmcnt(3)
    v_mfma_f32_16x16x32_bf16 v[40:43], v[24:27], v[112:115], 0
    v_mfma_f32_16x16x32_bf16 v[44:47], v[24:27], v[116:119], 0
    ds_read_b128 v[24:27], v5 offset:2048
    s_waitcnt lgkmcnt(3)
    v_mfma_f32_16x16x32_bf16 v[40:43], v[28:31], v[120:123], v[40:43]
    v_mfma_f32_16x16x32_bf16 v[44:47], v[28:31], v[124:127], v[44:47]
    ds_read_b128 v[28:31], v5 offset:2560
    v_cvt_pk_bf16_f32 v32, v32, v36
    v_cvt_pk_bf16_f32 v33, v33, v37
    v_cvt_pk_bf16_f32 v34, v34, v38
    v_cvt_pk_bf16_f32 v35, v35, v39
    ds_write_b128 v14, v[32:35]
    s_waitcnt lgkmcnt(4)
    v_mfma_f32_16x16x32_bf16 v[40:43], v[16:19], v[128:131], v[40:43]
    v_mfma_f32_16x16x32_bf16 v[44:47], v[16:19], v[132:135], v[44:47]
    ds_read_b128 v[16:19], v5 offset:3072
    s_waitcnt lgkmcnt(4)
    v_mfma_f32_16x16x32_bf16 v[40:43], v[20:23], v[136:139], v[40:43]
    v_mfma_f32_16x16x32_bf16 v[44:47], v[20:23], v[140:143], v[44:47]
    ds_read_b128 v[20:23], v5 offset:3584
    s_waitcnt lgkmcnt(4)
    v_mfma_f32_16x16x32_bf16 v[40:43], v[24:27], v[144:147], v[40:43]
    v_mfma_f32_16x16x32_bf16 v[44:47], v[24:27], v[148:151], v[44:47]
    ds_read_b128 v[24:27], v5 offset:4096
    s_waitcnt lgkmcnt(4)
    v_mfma_f32_16x16x32_bf16 v[40:43], v[28:31], v[152:155], v[40:43]
    v_mfma_f32_16x16x32_bf16 v[44:47], v[28:31], v[156:159], v[44:47]
    ds_read_b128 v[28:31], v5 offset:4608
    s_waitcnt lgkmcnt(4)
    s_barrier
    ds_read_b128 v[48:51], v15 offset:0
    ds_read_b128 v[32:35], v11 offset:0
    ds_read_b128 v[36:39], v11 offset:4608
    s_waitcnt lgkmcnt(6)
    v_mfma_f32_16x16x32_bf16 v[40:43], v[16:19], v[160:163], v[40:43]
    v_mfma_f32_16x16x32_bf16 v[44:47], v[16:19], v[164:167], v[44:47]
    ds_read_b128 v[16:19], v5 offset:5120
    s_waitcnt lgkmcnt(6)
    v_mfma_f32_16x16x32_bf16 v[40:43], v[20:23], v[168:171], v[40:43]
    v_mfma_f32_16x16x32_bf16 v[44:47], v[20:23], v[172:175], v[44:47]
    ds_read_b128 v[20:23], v5 offset:5632
    s_waitcnt lgkmcnt(6)
    v_mfma_f32_16x16x32_bf16 v[40:43], v[24:27], v[176:179], v[40:43]
    v_mfma_f32_16x16x32_bf16 v[44:47], v[24:27], v[180:183], v[44:47]
    ds_read_b128 v[24:27], v5 offset:6144
    s_waitcnt lgkmcnt(3)
    v_mfma_f32_16x16x32_bf16 v[56:59], v[48:51], v[32:35], v[56:59]
    v_mfma_f32_16x16x32_bf16 v[60:63], v[48:51], v[36:39], v[60:63]
    ds_read_b128 v[48:51], v15 offset:1024
    ds_read_b128 v[32:35], v11 offset:64
    ds_read_b128 v[36:39], v11 offset:4672
    v_mfma_f32_16x16x32_bf16 v[40:43], v[28:31], v[184:187], v[40:43]
    v_mfma_f32_16x16x32_bf16 v[44:47], v[28:31], v[188:191], v[44:47]
    ds_read_b128 v[28:31], v5 offset:6656
    s_waitcnt lgkmcnt(6)
    v_mfma_f32_16x16x32_bf16 v[40:43], v[16:19], v[192:195], v[40:43]
    v_mfma_f32_16x16x32_bf16 v[44:47], v[16:19], v[196:199], v[44:47]
    ds_read_b128 v[16:19], v5 offset:7168
    s_waitcnt lgkmcnt(6)
    v_mfma_f32_16x16x32_bf16 v[40:43], v[20:23], v[200:203], v[40:43]
    v_mfma_f32_16x16x32_bf16 v[44:47], v[20:23], v[204:207], v[44:47]
    ds_read_b128 v[20:23], v5 offset:7680
    s_waitcnt lgkmcnt(3)
    v_mfma_f32_16x16x32_bf16 v[56:59], v[48:51], v[32:35], v[56:59]
    v_mfma_f32_16x16x32_bf16 v[60:63], v[48:51], v[36:39], v[60:63]
    ds_read_b128 v[48:51], v15 offset:2048
    ds_read_b128 v[32:35], v11 offset:128
    ds_read_b128 v[36:39], v11 offset:4736
    v_mfma_f32_16x16x32_bf16 v[40:43], v[24:27], v[208:211], v[40:43]
    v_mfma_f32_16x16x32_bf16 v[44:47], v[24:27], v[212:215], v[44:47]
    ds_read_b128 v[24:27], v5 offset:8192
    s_waitcnt lgkmcnt(6)
    v_mfma_f32_16x16x32_bf16 v[40:43], v[28:31], v[216:219], v[40:43]
    v_mfma_f32_16x16x32_bf16 v[44:47], v[28:31], v[220:223], v[44:47]
    ds_read_b128 v[28:31], v5 offset:8704
    s_waitcnt lgkmcnt(6)
    v_mfma_f32_16x16x32_bf16 v[40:43], v[16:19], v[224:227], v[40:43]
    v_mfma_f32_16x16x32_bf16 v[44:47], v[16:19], v[228:231], v[44:47]
    s_waitcnt lgkmcnt(2)
    v_mfma_f32_16x16x32_bf16 v[56:59], v[48:51], v[32:35], v[56:59]
    v_mfma_f32_16x16x32_bf16 v[60:63], v[48:51], v[36:39], v[60:63]
    ds_read_b128 v[48:51], v15 offset:3072
    ds_read_b128 v[32:35], v11 offset:192
    ds_read_b128 v[36:39], v11 offset:4800
    v_mfma_f32_16x16x32_bf16 v[40:43], v[20:23], v[232:235], v[40:43]
    v_mfma_f32_16x16x32_bf16 v[44:47], v[20:23], v[236:239], v[44:47]
    s_waitcnt lgkmcnt(4)
    v_mfma_f32_16x16x32_bf16 v[40:43], v[24:27], v[240:243], v[40:43]
    v_mfma_f32_16x16x32_bf16 v[44:47], v[24:27], v[244:247], v[44:47]
    s_waitcnt lgkmcnt(3)
    v_mfma_f32_16x16x32_bf16 v[40:43], v[28:31], v[248:251], v[40:43]
    v_mfma_f32_16x16x32_bf16 v[44:47], v[28:31], v[252:255], v[44:47]
    s_waitcnt lgkmcnt(0)
    v_mfma_f32_16x16x32_bf16 v[56:59], v[48:51], v[32:35], v[56:59]
    v_mfma_f32_16x16x32_bf16 v[60:63], v[48:51], v[36:39], v[60:63]
    ds_read_b128 v[48:51], v10 offset:17408
    ds_read_b128 v[52:55], v10 offset:18432
    s_nop 1
    v_cvt_pk_bf16_f32 v40, v40, v41
    v_cvt_pk_bf16_f32 v41, v42, v43
    v_cvt_pk_bf16_f32 v42, v44, v45
    v_cvt_pk_bf16_f32 v43, v46, v47
    v_mov_b64_e64 v[44:45], s[62:63]
    v_mov_b64 v[46:47], s[62:63]
    s_lshl_b32 s46, s55, 8
    s_lshl_b32 s56, s41, 2
    s_add_u32 s46, s46, s56
    s_add_u32 s46, s46, s32
    s_lshl_b32 s46, s46, 10
    s_lshl_b32 s56, s43, 24
    s_add_u32 s46, s46, s56
    s_add_u32 s46, s46, 0x6000000
    v_max3_f32 v14, v64, v65, v66
    v_max3_f32 v15, v67, v68, v69
    v_max3_f32 v14, v14, v70, v71
    v_max3_f32 v15, v15, v56, v57
    v_max3_f32 v14, v14, v58, v59
    v_max_f32 v14, v14, v15
    v_mov_b32 v15, v14
    s_nop 1
    v_permlane32_swap_b32 v14, v15
    v_max_f32 v14, v14, v15
    v_mov_b32 v15, v14
    s_nop 1
    v_permlane16_swap_b32 v14, v15
    v_max_f32 v14, v14, v15
    v_mul_f32 v14, s49, v14
    v_pk_fma_f32 v[64:65], v[64:65], s[60:61], v[14:15] op_sel_hi:[1,1,0]
    v_pk_fma_f32 v[66:67], v[66:67], s[60:61], v[14:15] op_sel_hi:[1,1,0]
    v_pk_fma_f32 v[68:69], v[68:69], s[60:61], v[14:15] op_sel_hi:[1,1,0]
    v_pk_fma_f32 v[70:71], v[70:71], s[60:61], v[14:15] op_sel_hi:[1,1,0]
    v_pk_fma_f32 v[56:57], v[56:57], s[60:61], v[14:15] op_sel_hi:[1,1,0]
    v_pk_fma_f32 v[58:59], v[58:59], s[60:61], v[14:15] op_sel_hi:[1,1,0]
    v_exp_f32 v64, v64
    v_exp_f32 v65, v65
    v_exp_f32 v66, v66
    v_exp_f32 v67, v67
    v_exp_f32 v68, v68
    v_exp_f32 v69, v69
    v_exp_f32 v70, v70
    v_exp_f32 v71, v71
    v_exp_f32 v56, v56
    v_exp_f32 v57, v57
    v_exp_f32_e64 v58, v58
    v_exp_f32 v59, v59
    s_waitcnt lgkmcnt(0)
    v_cvt_pk_bf16_f32 v56, v56, v57
    v_cvt_pk_bf16_f32 v57, v58, v59
    v_cvt_pk_bf16_f32 v64, v64, v65
    v_cvt_pk_bf16_f32 v65, v66, v67
    v_cvt_pk_bf16_f32 v66, v68, v69
    v_cvt_pk_bf16_f32 v67, v70, v71
    v_mfma_f32_16x16x16_bf16 v[16:19], v[44:45], v[56:57], 0
    v_mfma_f32_16x16x16_bf16 v[20:23], v[40:41], v[56:57], 0
    v_mfma_f32_16x16x16_bf16 v[24:27], v[42:43], v[56:57], 0
    v_mfma_f32_16x16x32_bf16 v[16:19], v[44:47], v[64:67], v[16:19]
    v_mfma_f32_16x16x32_bf16 v[20:23], v[48:51], v[64:67], v[20:23]
    v_mfma_f32_16x16x32_bf16 v[24:27], v[52:55], v[64:67], v[24:27]
    v_max3_f32 v14, v72, v73, v74
    v_max3_f32 v15, v75, v76, v77
    v_max3_f32 v14, v14, v78, v79
    v_max3_f32 v15, v15, v60, v61
    v_max3_f32 v14, v14, v62, v63
    v_max_f32 v14, v14, v15
    v_mov_b32 v15, v14
    s_nop 1
    v_permlane32_swap_b32 v14, v15
    v_max_f32 v14, v14, v15
    v_mov_b32 v15, v14
    s_nop 1
    v_permlane16_swap_b32 v14, v15
    v_max_f32 v14, v14, v15
    v_mul_f32 v14, s49, v14
    v_pk_fma_f32 v[72:73], v[72:73], s[60:61], v[14:15] op_sel_hi:[1,1,0]
    v_pk_fma_f32 v[74:75], v[74:75], s[60:61], v[14:15] op_sel_hi:[1,1,0]
    v_pk_fma_f32 v[76:77], v[76:77], s[60:61], v[14:15] op_sel_hi:[1,1,0]
    v_pk_fma_f32 v[78:79], v[78:79], s[60:61], v[14:15] op_sel_hi:[1,1,0]
    v_pk_fma_f32 v[60:61], v[60:61], s[60:61], v[14:15] op_sel_hi:[1,1,0]
    v_pk_fma_f32 v[62:63], v[62:63], s[60:61], v[14:15] op_sel_hi:[1,1,0]
    v_exp_f32 v72, v72
    v_exp_f32 v73, v73
    v_exp_f32 v74, v74
    v_exp_f32 v75, v75
    v_exp_f32 v76, v76
    v_exp_f32 v77, v77
    v_exp_f32 v78, v78
    v_exp_f32 v79, v79
    v_exp_f32 v60, v60
    v_exp_f32 v61, v61
    v_exp_f32 v62, v62
    v_exp_f32 v63, v63
    v_cvt_pk_bf16_f32 v60, v60, v61
    v_cvt_pk_bf16_f32 v61, v62, v63
    v_cvt_pk_bf16_f32 v72, v72, v73
    v_cvt_pk_bf16_f32 v73, v74, v75
    v_cvt_pk_bf16_f32 v74, v76, v77
    v_cvt_pk_bf16_f32 v75, v78, v79
    v_mfma_f32_16x16x16_bf16 v[28:31], v[44:45], v[60:61], 0
    v_mfma_f32_16x16x16_bf16 v[32:35], v[40:41], v[60:61], 0
    v_mfma_f32_16x16x16_bf16 v[36:39], v[42:43], v[60:61], 0
    v_mfma_f32_16x16x32_bf16 v[28:31], v[44:47], v[72:75], v[28:31]
    v_mfma_f32_16x16x32_bf16 v[32:35], v[48:51], v[72:75], v[32:35]
    v_mfma_f32_16x16x32_bf16 v[36:39], v[52:55], v[72:75], v[36:39]
    v_rcp_f32 v16, v16
    s_nop 0
    v_pk_mul_f32 v[20:21], v[20:21], v[16:17] op_sel_hi:[1,0]
    v_pk_mul_f32 v[22:23], v[22:23], v[16:17] op_sel_hi:[1,0]
    v_pk_mul_f32 v[24:25], v[24:25], v[16:17] op_sel_hi:[1,0]
    v_pk_mul_f32 v[26:27], v[26:27], v[16:17] op_sel_hi:[1,0]
    v_cvt_pk_bf16_f32 v20, v20, v24
    v_cvt_pk_bf16_f32 v21, v21, v25
    v_cvt_pk_bf16_f32 v22, v22, v26
    v_cvt_pk_bf16_f32 v23, v23, v27
    buffer_store_dwordx4 v[20:23], v6, s[8:11], s46 offen sc1
    s_add_u32 s46, s46, 131072
    v_rcp_f32 v28, v28
    s_nop 0
    v_pk_mul_f32 v[32:33], v[32:33], v[28:29] op_sel_hi:[1,0]
    v_pk_mul_f32 v[34:35], v[34:35], v[28:29] op_sel_hi:[1,0]
    v_pk_mul_f32 v[36:37], v[36:37], v[28:29] op_sel_hi:[1,0]
    v_pk_mul_f32 v[38:39], v[38:39], v[28:29] op_sel_hi:[1,0]
    v_cvt_pk_bf16_f32 v32, v32, v36
    v_cvt_pk_bf16_f32 v33, v33, v37
    v_cvt_pk_bf16_f32 v34, v34, v38
    v_cvt_pk_bf16_f32 v35, v35, v39
    buffer_store_dwordx4 v[32:35], v6, s[8:11], s46 offen sc1
    s_lshl_b32 s46, s55, 5
    s_add_u32 s46, s46, s41
    s_lshl_b32 s52, s46, 7
    s_lshl_b32 s56, s43, 20
    s_add_u32 s52, s52, s56
    s_add_u32 s52, s52, 0x1850000
    s_mov_b32 s65, s52
    s_add_u32 s46, s44, 1
    s_cmp_lt_u32 s46, s54
    s_cbranch_scc1 L_p_next
    s_mov_b32 s65, 0
    s_waitcnt vmcnt(0)
    s_barrier
    s_cmp_lg_u32 s32, 0
    s_cbranch_scc1 L_pf_55
    v_mov_b32_e64 v14, 1
    s_mov_b64 exec, 1
    buffer_store_dword v14, off, s[8:11], s52 offset:0 sc1
    s_mov_b64 exec, -1
L_pf_55:
L_p_next:
    s_add_u32 s45, s45, 3
    s_add_u32 s44, s44, 1
    s_cmp_le_u32 s44, s54
    s_cbranch_scc1 L_p_loop
    s_add_u32 s43, s43, 1
    s_cmp_lt_u32 s43, 2
    s_cbranch_scc1 L_p_layer
    s_cmp_eq_u32 s42, 0
    s_cbranch_scc1 L_exit
    s_lshl_b32 s90, s41, 1
    s_add_u32 s90, s90, s42
    s_mov_b32 s41, 8
    s_branch L_d_setup
L_role_od:
    s_and_b32 s4, s33, 31
    s_lshr_b32 s5, s33, 5
    s_sub_u32 s5, s5, 4
    s_cmp_eq_u32 s5, 3
    s_cbranch_scc1 L_role_d
    s_cmp_ge_u32 s4, 18
    s_cbranch_scc1 L_role_d
    s_mov_b32 s41, s5
    s_mov_b32 s42, s4
    s_load_dwordx2 s[80:81], s[0:1], 40
    s_load_dwordx2 s[82:83], s[0:1], 0
    v_and_b32 v12, 15, v0
    v_lshrrev_b32 v13, 4, v0
    v_mul_u32_u24 v15, 9216, v13
    v_lshl_add_u32 v15, v12, 2, v15
    s_mul_i32 s45, s32, 1179648
    s_lshl_b32 s48, s42, 6
    s_add_u32 s45, s45, s48
    v_add_u32_e64 v15, s45, v15
    s_mov_b32 s46, 0x05040100
    s_mov_b32 s47, 0x07060302
    s_waitcnt lgkmcnt(0)
    s_mov_b32 s16, s80
    s_and_b32 s17, s81, 0xffff
    s_mov_b32 s18, 0x480000
    s_mov_b32 s19, 0x20000
    s_mov_b32 s20, s82
    s_and_b32 s21, s83, 0xffff
    s_mov_b32 s22, 0x240000
    s_mov_b32 s23, 0x20000
    s_mov_b32 s45, 0x0
    buffer_load_dword v16, v15, s[16:19], s45 offen
    s_mov_b32 s45, 0x480
    buffer_load_dword v17, v15, s[16:19], s45 offen
    s_mov_b32 s45, 0x900
    buffer_load_dword v18, v15, s[16:19], s45 offen
    s_mov_b32 s45, 0xd80
    buffer_load_dword v19, v15, s[16:19], s45 offen
    s_mov_b32 s45, 0x1200
    buffer_load_dword v20, v15, s[16:19], s45 offen
    s_mov_b32 s45, 0x1680
    buffer_load_dword v21, v15, s[16:19], s45 offen
    s_mov_b32 s45, 0x1b00
    buffer_load_dword v22, v15, s[16:19], s45 offen
    s_mov_b32 s45, 0x1f80
    buffer_load_dword v23, v15, s[16:19], s45 offen
    s_mov_b32 s45, 0x9000
    buffer_load_dword v24, v15, s[16:19], s45 offen
    s_mov_b32 s45, 0x9480
    buffer_load_dword v25, v15, s[16:19], s45 offen
    s_mov_b32 s45, 0x9900
    buffer_load_dword v26, v15, s[16:19], s45 offen
    s_mov_b32 s45, 0x9d80
    buffer_load_dword v27, v15, s[16:19], s45 offen
    s_mov_b32 s45, 0xa200
    buffer_load_dword v28, v15, s[16:19], s45 offen
    s_mov_b32 s45, 0xa680
    buffer_load_dword v29, v15, s[16:19], s45 offen
    s_mov_b32 s45, 0xab00
    buffer_load_dword v30, v15, s[16:19], s45 offen
    s_mov_b32 s45, 0xaf80
    buffer_load_dword v31, v15, s[16:19], s45 offen
    s_mov_b32 s45, 0x12000
    buffer_load_dword v32, v15, s[16:19], s45 offen
    s_mov_b32 s45, 0x12480
    buffer_load_dword v33, v15, s[16:19], s45 offen
    s_mov_b32 s45, 0x12900
    buffer_load_dword v34, v15, s[16:19], s45 offen
    s_mov_b32 s45, 0x12d80
    buffer_load_dword v35, v15, s[16:19], s45 offen
    s_mov_b32 s45, 0x13200
    buffer_load_dword v36, v15, s[16:19], s45 offen
    s_mov_b32 s45, 0x13680
    buffer_load_dword v37, v15, s[16:19], s45 offen
    s_mov_b32 s45, 0x13b00
    buffer_load_dword v38, v15, s[16:19], s45 offen
    s_mov_b32 s45, 0x13f80
    buffer_load_dword v39, v15, s[16:19], s45 offen
    s_mov_b32 s45, 0x1b000
    buffer_load_dword v40, v15, s[16:19], s45 offen
    s_mov_b32 s45, 0x1b480
    buffer_load_dword v41, v15, s[16:19], s45 offen
    s_mov_b32 s45, 0x1b900
    buffer_load_dword v42, v15, s[16:19], s45 offen
    s_mov_b32 s45, 0x1bd80
    buffer_load_dword v43, v15, s[16:19], s45 offen
    s_mov_b32 s45, 0x1c200
    buffer_load_dword v44, v15, s[16:19], s45 offen
    s_mov_b32 s45, 0x1c680
    buffer_load_dword v45, v15, s[16:19], s45 offen
    s_mov_b32 s45, 0x1cb00
    buffer_load_dword v46, v15, s[16:19], s45 offen
    s_mov_b32 s45, 0x1cf80
    buffer_load_dword v47, v15, s[16:19], s45 offen
    s_mov_b32 s45, 0x24000
    buffer_load_dword v48, v15, s[16:19], s45 offen
    s_mov_b32 s45, 0x24480
    buffer_load_dword v49, v15, s[16:19], s45 offen
    s_mov_b32 s45, 0x24900
    buffer_load_dword v50, v15, s[16:19], s45 offen
    s_mov_b32 s45, 0x24d80
    buffer_load_dword v51, v15, s[16:19], s45 offen
    s_mov_b32 s45, 0x25200
    buffer_load_dword v52, v15, s[16:19], s45 offen
    s_mov_b32 s45, 0x25680
    buffer_load_dword v53, v15, s[16:19], s45 offen
    s_mov_b32 s45, 0x25b00
    buffer_load_dword v54, v15, s[16:19], s45 offen
    s_mov_b32 s45, 0x25f80
    buffer_load_dword v55, v15, s[16:19], s45 offen
    s_mov_b32 s45, 0x2d000
    buffer_load_dword v56, v15, s[16:19], s45 offen
    s_mov_b32 s45, 0x2d480
    buffer_load_dword v57, v15, s[16:19], s45 offen
    s_mov_b32 s45, 0x2d900
    buffer_load_dword v58, v15, s[16:19], s45 offen
    s_mov_b32 s45, 0x2dd80
    buffer_load_dword v59, v15, s[16:19], s45 offen
    s_mov_b32 s45, 0x2e200
    buffer_load_dword v60, v15, s[16:19], s45 offen
    s_mov_b32 s45, 0x2e680
    buffer_load_dword v61, v15, s[16:19], s45 offen
    s_mov_b32 s45, 0x2eb00
    buffer_load_dword v62, v15, s[16:19], s45 offen
    s_mov_b32 s45, 0x2ef80
    buffer_load_dword v63, v15, s[16:19], s45 offen
    s_mov_b32 s45, 0x36000
    buffer_load_dword v64, v15, s[16:19], s45 offen
    s_mov_b32 s45, 0x36480
    buffer_load_dword v65, v15, s[16:19], s45 offen
    s_mov_b32 s45, 0x36900
    buffer_load_dword v66, v15, s[16:19], s45 offen
    s_mov_b32 s45, 0x36d80
    buffer_load_dword v67, v15, s[16:19], s45 offen
    s_mov_b32 s45, 0x37200
    buffer_load_dword v68, v15, s[16:19], s45 offen
    s_mov_b32 s45, 0x37680
    buffer_load_dword v69, v15, s[16:19], s45 offen
    s_mov_b32 s45, 0x37b00
    buffer_load_dword v70, v15, s[16:19], s45 offen
    s_mov_b32 s45, 0x37f80
    buffer_load_dword v71, v15, s[16:19], s45 offen
    s_waitcnt vmcnt(48)
    v_perm_b32 v1, v17, v16, s46
    v_accvgpr_write_b32 a0, v1
    v_perm_b32 v2, v19, v18, s46
    v_accvgpr_write_b32 a1, v2
    v_perm_b32 v1, v21, v20, s46
    v_accvgpr_write_b32 a2, v1
    v_perm_b32 v2, v23, v22, s46
    v_accvgpr_write_b32 a3, v2
    v_perm_b32 v1, v17, v16, s47
    v_accvgpr_write_b32 a4, v1
    v_perm_b32 v2, v19, v18, s47
    v_accvgpr_write_b32 a5, v2
    v_perm_b32 v1, v21, v20, s47
    v_accvgpr_write_b32 a6, v1
    v_perm_b32 v2, v23, v22, s47
    v_accvgpr_write_b32 a7, v2
    s_mov_b32 s45, 0x3f000
    buffer_load_dword v16, v15, s[16:19], s45 offen
    s_mov_b32 s45, 0x3f480
    buffer_load_dword v17, v15, s[16:19], s45 offen
    s_mov_b32 s45, 0x3f900
    buffer_load_dword v18, v15, s[16:19], s45 offen
    s_mov_b32 s45, 0x3fd80
    buffer_load_dword v19, v15, s[16:19], s45 offen
    s_mov_b32 s45, 0x40200
    buffer_load_dword v20, v15, s[16:19], s45 offen
    s_mov_b32 s45, 0x40680
    buffer_load_dword v21, v15, s[16:19], s45 offen
    s_mov_b32 s45, 0x40b00
    buffer_load_dword v22, v15, s[16:19], s45 offen
    s_mov_b32 s45, 0x40f80
    buffer_load_dword v23, v15, s[16:19], s45 offen
    s_waitcnt vmcnt(48)
    v_perm_b32 v1, v25, v24, s46
    v_accvgpr_write_b32 a8, v1
    v_perm_b32 v2, v27, v26, s46
    v_accvgpr_write_b32 a9, v2
    v_perm_b32 v1, v29, v28, s46
    v_accvgpr_write_b32 a10, v1
    v_perm_b32 v2, v31, v30, s46
    v_accvgpr_write_b32 a11, v2
    v_perm_b32 v1, v25, v24, s47
    v_accvgpr_write_b32 a12, v1
    v_perm_b32 v2, v27, v26, s47
    v_accvgpr_write_b32 a13, v2
    v_perm_b32 v1, v29, v28, s47
    v_accvgpr_write_b32 a14, v1
    v_perm_b32 v2, v31, v30, s47
    v_accvgpr_write_b32 a15, v2
    s_mov_b32 s45, 0x48000
    buffer_load_dword v24, v15, s[16:19], s45 offen
    s_mov_b32 s45, 0x48480
    buffer_load_dword v25, v15, s[16:19], s45 offen
    s_mov_b32 s45, 0x48900
    buffer_load_dword v26, v15, s[16:19], s45 offen
    s_mov_b32 s45, 0x48d80
    buffer_load_dword v27, v15, s[16:19], s45 offen
    s_mov_b32 s45, 0x49200
    buffer_load_dword v28, v15, s[16:19], s45 offen
    s_mov_b32 s45, 0x49680
    buffer_load_dword v29, v15, s[16:19], s45 offen
    s_mov_b32 s45, 0x49b00
    buffer_load_dword v30, v15, s[16:19], s45 offen
    s_mov_b32 s45, 0x49f80
    buffer_load_dword v31, v15, s[16:19], s45 offen
    s_waitcnt vmcnt(48)
    v_perm_b32 v1, v33, v32, s46
    v_accvgpr_write_b32 a16, v1
    v_perm_b32 v2, v35, v34, s46
    v_accvgpr_write_b32 a17, v2
    v_perm_b32 v1, v37, v36, s46
    v_accvgpr_write_b32 a18, v1
    v_perm_b32 v2, v39, v38, s46
    v_accvgpr_write_b32 a19, v2
    v_perm_b32 v1, v33, v32, s47
    v_accvgpr_write_b32 a20, v1
    v_perm_b32 v2, v35, v34, s47
    v_accvgpr_write_b32 a21, v2
    v_perm_b32 v1, v37, v36, s47
    v_accvgpr_write_b32 a22, v1
    v_perm_b32 v2, v39, v38, s47
    v_accvgpr_write_b32 a23, v2
    s_mov_b32 s45, 0x51000
    buffer_load_dword v32, v15, s[16:19], s45 offen
    s_mov_b32 s45, 0x51480
    buffer_load_dword v33, v15, s[16:19], s45 offen
    s_mov_b32 s45, 0x51900
    buffer_load_dword v34, v15, s[16:19], s45 offen
    s_mov_b32 s45, 0x51d80
    buffer_load_dword v35, v15, s[16:19], s45 offen
    s_mov_b32 s45, 0x52200
    buffer_load_dword v36, v15, s[16:19], s45 offen
    s_mov_b32 s45, 0x52680
    buffer_load_dword v37, v15, s[16:19], s45 offen
    s_mov_b32 s45, 0x52b00
    buffer_load_dword v38, v15, s[16:19], s45 offen
    s_mov_b32 s45, 0x52f80
    buffer_load_dword v39, v15, s[16:19], s45 offen
    s_waitcnt vmcnt(48)
    v_perm_b32 v1, v41, v40, s46
    v_accvgpr_write_b32 a24, v1
    v_perm_b32 v2, v43, v42, s46
    v_accvgpr_write_b32 a25, v2
    v_perm_b32 v1, v45, v44, s46
    v_accvgpr_write_b32 a26, v1
    v_perm_b32 v2, v47, v46, s46
    v_accvgpr_write_b32 a27, v2
    v_perm_b32 v1, v41, v40, s47
    v_accvgpr_write_b32 a28, v1
    v_perm_b32 v2, v43, v42, s47
    v_accvgpr_write_b32 a29, v2
    v_perm_b32 v1, v45, v44, s47
    v_accvgpr_write_b32 a30, v1
    v_perm_b32 v2, v47, v46, s47
    v_accvgpr_write_b32 a31, v2
    s_mov_b32 s45, 0x5a000
    buffer_load_dword v40, v15, s[16:19], s45 offen
    s_mov_b32 s45, 0x5a480
    buffer_load_dword v41, v15, s[16:19], s45 offen
    s_mov_b32 s45, 0x5a900
    buffer_load_dword v42, v15, s[16:19], s45 offen
    s_mov_b32 s45, 0x5ad80
    buffer_load_dword v43, v15, s[16:19], s45 offen
    s_mov_b32 s45, 0x5b200
    buffer_load_dword v44, v15, s[16:19], s45 offen
    s_mov_b32 s45, 0x5b680
    buffer_load_dword v45, v15, s[16:19], s45 offen
    s_mov_b32 s45, 0x5bb00
    buffer_load_dword v46, v15, s[16:19], s45 offen
    s_mov_b32 s45, 0x5bf80
    buffer_load_dword v47, v15, s[16:19], s45 offen
    s_waitcnt vmcnt(48)
    v_perm_b32 v1, v49, v48, s46
    v_accvgpr_write_b32 a32, v1
    v_perm_b32 v2, v51, v50, s46
    v_accvgpr_write_b32 a33, v2
    v_perm_b32 v1, v53, v52, s46
    v_accvgpr_write_b32 a34, v1
    v_perm_b32 v2, v55, v54, s46
    v_accvgpr_write_b32 a35, v2
    v_perm_b32 v1, v49, v48, s47
    v_accvgpr_write_b32 a36, v1
    v_perm_b32 v2, v51, v50, s47
    v_accvgpr_write_b32 a37, v2
    v_perm_b32 v1, v53, v52, s47
    v_accvgpr_write_b32 a38, v1
    v_perm_b32 v2, v55, v54, s47
    v_accvgpr_write_b32 a39, v2
    s_mov_b32 s45, 0x63000
    buffer_load_dword v48, v15, s[16:19], s45 offen
    s_mov_b32 s45, 0x63480
    buffer_load_dword v49, v15, s[16:19], s45 offen
    s_mov_b32 s45, 0x63900
    buffer_load_dword v50, v15, s[16:19], s45 offen
    s_mov_b32 s45, 0x63d80
    buffer_load_dword v51, v15, s[16:19], s45 offen
    s_mov_b32 s45, 0x64200
    buffer_load_dword v52, v15, s[16:19], s45 offen
    s_mov_b32 s45, 0x64680
    buffer_load_dword v53, v15, s[16:19], s45 offen
    s_mov_b32 s45, 0x64b00
    buffer_load_dword v54, v15, s[16:19], s45 offen
    s_mov_b32 s45, 0x64f80
    buffer_load_dword v55, v15, s[16:19], s45 offen
    s_waitcnt vmcnt(48)
    v_perm_b32 v1, v57, v56, s46
    v_accvgpr_write_b32 a40, v1
    v_perm_b32 v2, v59, v58, s46
    v_accvgpr_write_b32 a41, v2
    v_perm_b32 v1, v61, v60, s46
    v_accvgpr_write_b32 a42, v1
    v_perm_b32 v2, v63, v62, s46
    v_accvgpr_write_b32 a43, v2
    v_perm_b32 v1, v57, v56, s47
    v_accvgpr_write_b32 a44, v1
    v_perm_b32 v2, v59, v58, s47
    v_accvgpr_write_b32 a45, v2
    v_perm_b32 v1, v61, v60, s47
    v_accvgpr_write_b32 a46, v1
    v_perm_b32 v2, v63, v62, s47
    v_accvgpr_write_b32 a47, v2
    s_mov_b32 s45, 0x6c000
    buffer_load_dword v56, v15, s[16:19], s45 offen
    s_mov_b32 s45, 0x6c480
    buffer_load_dword v57, v15, s[16:19], s45 offen
    s_mov_b32 s45, 0x6c900
    buffer_load_dword v58, v15, s[16:19], s45 offen
    s_mov_b32 s45, 0x6cd80
    buffer_load_dword v59, v15, s[16:19], s45 offen
    s_mov_b32 s45, 0x6d200
    buffer_load_dword v60, v15, s[16:19], s45 offen
    s_mov_b32 s45, 0x6d680
    buffer_load_dword v61, v15, s[16:19], s45 offen
    s_mov_b32 s45, 0x6db00
    buffer_load_dword v62, v15, s[16:19], s45 offen
    s_mov_b32 s45, 0x6df80
    buffer_load_dword v63, v15, s[16:19], s45 offen
    s_waitcnt vmcnt(48)
    v_perm_b32 v1, v65, v64, s46
    v_accvgpr_write_b32 a48, v1
    v_perm_b32 v2, v67, v66, s46
    v_accvgpr_write_b32 a49, v2
    v_perm_b32 v1, v69, v68, s46
    v_accvgpr_write_b32 a50, v1
    v_perm_b32 v2, v71, v70, s46
    v_accvgpr_write_b32 a51, v2
    v_perm_b32 v1, v65, v64, s47
    v_accvgpr_write_b32 a52, v1
    v_perm_b32 v2, v67, v66, s47
    v_accvgpr_write_b32 a53, v2
    v_perm_b32 v1, v69, v68, s47
    v_accvgpr_write_b32 a54, v1
    v_perm_b32 v2, v71, v70, s47
    v_accvgpr_write_b32 a55, v2
    s_mov_b32 s45, 0x75000
    buffer_load_dword v64, v15, s[16:19], s45 offen
    s_mov_b32 s45, 0x75480
    buffer_load_dword v65, v15, s[16:19], s45 offen
    s_mov_b32 s45, 0x75900
    buffer_load_dword v66, v15, s[16:19], s45 offen
    s_mov_b32 s45, 0x75d80
    buffer_load_dword v67, v15, s[16:19], s45 offen
    s_mov_b32 s45, 0x76200
    buffer_load_dword v68, v15, s[16:19], s45 offen
    s_mov_b32 s45, 0x76680
    buffer_load_dword v69, v15, s[16:19], s45 offen
    s_mov_b32 s45, 0x76b00
    buffer_load_dword v70, v15, s[16:19], s45 offen
    s_mov_b32 s45, 0x76f80
    buffer_load_dword v71, v15, s[16:19], s45 offen
    s_waitcnt vmcnt(48)
    v_perm_b32 v1, v17, v16, s46
    v_accvgpr_write_b32 a56, v1
    v_perm_b32 v2, v19, v18, s46
    v_accvgpr_write_b32 a57, v2
    v_perm_b32 v1, v21, v20, s46
    v_accvgpr_write_b32 a58, v1
    v_perm_b32 v2, v23, v22, s46
    v_accvgpr_write_b32 a59, v2
    v_perm_b32 v1, v17, v16, s47
    v_accvgpr_write_b32 a60, v1
    v_perm_b32 v2, v19, v18, s47
    v_accvgpr_write_b32 a61, v2
    v_perm_b32 v1, v21, v20, s47
    v_accvgpr_write_b32 a62, v1
    v_perm_b32 v2, v23, v22, s47
    v_accvgpr_write_b32 a63, v2
    s_mov_b32 s45, 0x7e000
    buffer_load_dword v16, v15, s[16:19], s45 offen
    s_mov_b32 s45, 0x7e480
    buffer_load_dword v17, v15, s[16:19], s45 offen
    s_mov_b32 s45, 0x7e900
    buffer_load_dword v18, v15, s[16:19], s45 offen
    s_mov_b32 s45, 0x7ed80
    buffer_load_dword v19, v15, s[16:19], s45 offen
    s_mov_b32 s45, 0x7f200
    buffer_load_dword v20, v15, s[16:19], s45 offen
    s_mov_b32 s45, 0x7f680
    buffer_load_dword v21, v15, s[16:19], s45 offen
    s_mov_b32 s45, 0x7fb00
    buffer_load_dword v22, v15, s[16:19], s45 offen
    s_mov_b32 s45, 0x7ff80
    buffer_load_dword v23, v15, s[16:19], s45 offen
    s_waitcnt vmcnt(48)
    v_perm_b32 v1, v25, v24, s46
    v_accvgpr_write_b32 a64, v1
    v_perm_b32 v2, v27, v26, s46
    v_accvgpr_write_b32 a65, v2
    v_perm_b32 v1, v29, v28, s46
    v_accvgpr_write_b32 a66, v1
    v_perm_b32 v2, v31, v30, s46
    v_accvgpr_write_b32 a67, v2
    v_perm_b32 v1, v25, v24, s47
    v_accvgpr_write_b32 a68, v1
    v_perm_b32 v2, v27, v26, s47
    v_accvgpr_write_b32 a69, v2
    v_perm_b32 v1, v29, v28, s47
    v_accvgpr_write_b32 a70, v1
    v_perm_b32 v2, v31, v30, s47
    v_accvgpr_write_b32 a71, v2
    s_mov_b32 s45, 0x87000
    buffer_load_dword v24, v15, s[16:19], s45 offen
    s_mov_b32 s45, 0x87480
    buffer_load_dword v25, v15, s[16:19], s45 offen
    s_mov_b32 s45, 0x87900
    buffer_load_dword v26, v15, s[16:19], s45 offen
    s_mov_b32 s45, 0x87d80
    buffer_load_dword v27, v15, s[16:19], s45 offen
    s_mov_b32 s45, 0x88200
    buffer_load_dword v28, v15, s[16:19], s45 offen
    s_mov_b32 s45, 0x88680
    buffer_load_dword v29, v15, s[16:19], s45 offen
    s_mov_b32 s45, 0x88b00
    buffer_load_dword v30, v15, s[16:19], s45 offen
    s_mov_b32 s45, 0x88f80
    buffer_load_dword v31, v15, s[16:19], s45 offen
    s_waitcnt vmcnt(48)
    v_perm_b32 v1, v33, v32, s46
    v_accvgpr_write_b32 a72, v1
    v_perm_b32 v2, v35, v34, s46
    v_accvgpr_write_b32 a73, v2
    v_perm_b32 v1, v37, v36, s46
    v_accvgpr_write_b32 a74, v1
    v_perm_b32 v2, v39, v38, s46
    v_accvgpr_write_b32 a75, v2
    v_perm_b32 v1, v33, v32, s47
    v_accvgpr_write_b32 a76, v1
    v_perm_b32 v2, v35, v34, s47
    v_accvgpr_write_b32 a77, v2
    v_perm_b32 v1, v37, v36, s47
    v_accvgpr_write_b32 a78, v1
    v_perm_b32 v2, v39, v38, s47
    v_accvgpr_write_b32 a79, v2
    s_mov_b32 s45, 0x90000
    buffer_load_dword v32, v15, s[16:19], s45 offen
    s_mov_b32 s45, 0x90480
    buffer_load_dword v33, v15, s[16:19], s45 offen
    s_mov_b32 s45, 0x90900
    buffer_load_dword v34, v15, s[16:19], s45 offen
    s_mov_b32 s45, 0x90d80
    buffer_load_dword v35, v15, s[16:19], s45 offen
    s_mov_b32 s45, 0x91200
    buffer_load_dword v36, v15, s[16:19], s45 offen
    s_mov_b32 s45, 0x91680
    buffer_load_dword v37, v15, s[16:19], s45 offen
    s_mov_b32 s45, 0x91b00
    buffer_load_dword v38, v15, s[16:19], s45 offen
    s_mov_b32 s45, 0x91f80
    buffer_load_dword v39, v15, s[16:19], s45 offen
    s_waitcnt vmcnt(48)
    v_perm_b32 v1, v41, v40, s46
    v_accvgpr_write_b32 a80, v1
    v_perm_b32 v2, v43, v42, s46
    v_accvgpr_write_b32 a81, v2
    v_perm_b32 v1, v45, v44, s46
    v_accvgpr_write_b32 a82, v1
    v_perm_b32 v2, v47, v46, s46
    v_accvgpr_write_b32 a83, v2
    v_perm_b32 v1, v41, v40, s47
    v_accvgpr_write_b32 a84, v1
    v_perm_b32 v2, v43, v42, s47
    v_accvgpr_write_b32 a85, v2
    v_perm_b32 v1, v45, v44, s47
    v_accvgpr_write_b32 a86, v1
    v_perm_b32 v2, v47, v46, s47
    v_accvgpr_write_b32 a87, v2
    s_mov_b32 s45, 0x99000
    buffer_load_dword v40, v15, s[16:19], s45 offen
    s_mov_b32 s45, 0x99480
    buffer_load_dword v41, v15, s[16:19], s45 offen
    s_mov_b32 s45, 0x99900
    buffer_load_dword v42, v15, s[16:19], s45 offen
    s_mov_b32 s45, 0x99d80
    buffer_load_dword v43, v15, s[16:19], s45 offen
    s_mov_b32 s45, 0x9a200
    buffer_load_dword v44, v15, s[16:19], s45 offen
    s_mov_b32 s45, 0x9a680
    buffer_load_dword v45, v15, s[16:19], s45 offen
    s_mov_b32 s45, 0x9ab00
    buffer_load_dword v46, v15, s[16:19], s45 offen
    s_mov_b32 s45, 0x9af80
    buffer_load_dword v47, v15, s[16:19], s45 offen
    s_waitcnt vmcnt(48)
    v_perm_b32 v1, v49, v48, s46
    v_accvgpr_write_b32 a88, v1
    v_perm_b32 v2, v51, v50, s46
    v_accvgpr_write_b32 a89, v2
    v_perm_b32 v1, v53, v52, s46
    v_accvgpr_write_b32 a90, v1
    v_perm_b32 v2, v55, v54, s46
    v_accvgpr_write_b32 a91, v2
    v_perm_b32 v1, v49, v48, s47
    v_accvgpr_write_b32 a92, v1
    v_perm_b32 v2, v51, v50, s47
    v_accvgpr_write_b32 a93, v2
    v_perm_b32 v1, v53, v52, s47
    v_accvgpr_write_b32 a94, v1
    v_perm_b32 v2, v55, v54, s47
    v_accvgpr_write_b32 a95, v2
    s_mov_b32 s45, 0xa2000
    buffer_load_dword v48, v15, s[16:19], s45 offen
    s_mov_b32 s45, 0xa2480
    buffer_load_dword v49, v15, s[16:19], s45 offen
    s_mov_b32 s45, 0xa2900
    buffer_load_dword v50, v15, s[16:19], s45 offen
    s_mov_b32 s45, 0xa2d80
    buffer_load_dword v51, v15, s[16:19], s45 offen
    s_mov_b32 s45, 0xa3200
    buffer_load_dword v52, v15, s[16:19], s45 offen
    s_mov_b32 s45, 0xa3680
    buffer_load_dword v53, v15, s[16:19], s45 offen
    s_mov_b32 s45, 0xa3b00
    buffer_load_dword v54, v15, s[16:19], s45 offen
    s_mov_b32 s45, 0xa3f80
    buffer_load_dword v55, v15, s[16:19], s45 offen
    s_waitcnt vmcnt(48)
    v_perm_b32 v1, v57, v56, s46
    v_accvgpr_write_b32 a96, v1
    v_perm_b32 v2, v59, v58, s46
    v_accvgpr_write_b32 a97, v2
    v_perm_b32 v1, v61, v60, s46
    v_accvgpr_write_b32 a98, v1
    v_perm_b32 v2, v63, v62, s46
    v_accvgpr_write_b32 a99, v2
    v_perm_b32 v1, v57, v56, s47
    v_accvgpr_write_b32 a100, v1
    v_perm_b32 v2, v59, v58, s47
    v_accvgpr_write_b32 a101, v2
    v_perm_b32 v1, v61, v60, s47
    v_accvgpr_write_b32 a102, v1
    v_perm_b32 v2, v63, v62, s47
    v_accvgpr_write_b32 a103, v2
    s_mov_b32 s45, 0xab000
    buffer_load_dword v56, v15, s[16:19], s45 offen
    s_mov_b32 s45, 0xab480
    buffer_load_dword v57, v15, s[16:19], s45 offen
    s_mov_b32 s45, 0xab900
    buffer_load_dword v58, v15, s[16:19], s45 offen
    s_mov_b32 s45, 0xabd80
    buffer_load_dword v59, v15, s[16:19], s45 offen
    s_mov_b32 s45, 0xac200
    buffer_load_dword v60, v15, s[16:19], s45 offen
    s_mov_b32 s45, 0xac680
    buffer_load_dword v61, v15, s[16:19], s45 offen
    s_mov_b32 s45, 0xacb00
    buffer_load_dword v62, v15, s[16:19], s45 offen
    s_mov_b32 s45, 0xacf80
    buffer_load_dword v63, v15, s[16:19], s45 offen
    s_waitcnt vmcnt(48)
    v_perm_b32 v1, v65, v64, s46
    v_accvgpr_write_b32 a104, v1
    v_perm_b32 v2, v67, v66, s46
    v_accvgpr_write_b32 a105, v2
    v_perm_b32 v1, v69, v68, s46
    v_accvgpr_write_b32 a106, v1
    v_perm_b32 v2, v71, v70, s46
    v_accvgpr_write_b32 a107, v2
    v_perm_b32 v1, v65, v64, s47
    v_accvgpr_write_b32 a108, v1
    v_perm_b32 v2, v67, v66, s47
    v_accvgpr_write_b32 a109, v2
    v_perm_b32 v1, v69, v68, s47
    v_accvgpr_write_b32 a110, v1
    v_perm_b32 v2, v71, v70, s47
    v_accvgpr_write_b32 a111, v2
    s_mov_b32 s45, 0xb4000
    buffer_load_dword v64, v15, s[16:19], s45 offen
    s_mov_b32 s45, 0xb4480
    buffer_load_dword v65, v15, s[16:19], s45 offen
    s_mov_b32 s45, 0xb4900
    buffer_load_dword v66, v15, s[16:19], s45 offen
    s_mov_b32 s45, 0xb4d80
    buffer_load_dword v67, v15, s[16:19], s45 offen
    s_mov_b32 s45, 0xb5200
    buffer_load_dword v68, v15, s[16:19], s45 offen
    s_mov_b32 s45, 0xb5680
    buffer_load_dword v69, v15, s[16:19], s45 offen
    s_mov_b32 s45, 0xb5b00
    buffer_load_dword v70, v15, s[16:19], s45 offen
    s_mov_b32 s45, 0xb5f80
    buffer_load_dword v71, v15, s[16:19], s45 offen
    s_waitcnt vmcnt(48)
    v_perm_b32 v1, v17, v16, s46
    v_accvgpr_write_b32 a112, v1
    v_perm_b32 v2, v19, v18, s46
    v_accvgpr_write_b32 a113, v2
    v_perm_b32 v1, v21, v20, s46
    v_accvgpr_write_b32 a114, v1
    v_perm_b32 v2, v23, v22, s46
    v_accvgpr_write_b32 a115, v2
    v_perm_b32 v1, v17, v16, s47
    v_accvgpr_write_b32 a116, v1
    v_perm_b32 v2, v19, v18, s47
    v_accvgpr_write_b32 a117, v2
    v_perm_b32 v1, v21, v20, s47
    v_accvgpr_write_b32 a118, v1
    v_perm_b32 v2, v23, v22, s47
    v_accvgpr_write_b32 a119, v2
    s_mov_b32 s45, 0xbd000
    buffer_load_dword v16, v15, s[16:19], s45 offen
    s_mov_b32 s45, 0xbd480
    buffer_load_dword v17, v15, s[16:19], s45 offen
    s_mov_b32 s45, 0xbd900
    buffer_load_dword v18, v15, s[16:19], s45 offen
    s_mov_b32 s45, 0xbdd80
    buffer_load_dword v19, v15, s[16:19], s45 offen
    s_mov_b32 s45, 0xbe200
    buffer_load_dword v20, v15, s[16:19], s45 offen
    s_mov_b32 s45, 0xbe680
    buffer_load_dword v21, v15, s[16:19], s45 offen
    s_mov_b32 s45, 0xbeb00
    buffer_load_dword v22, v15, s[16:19], s45 offen
    s_mov_b32 s45, 0xbef80
    buffer_load_dword v23, v15, s[16:19], s45 offen
    s_waitcnt vmcnt(48)
    v_perm_b32 v1, v25, v24, s46
    v_accvgpr_write_b32 a120, v1
    v_perm_b32 v2, v27, v26, s46
    v_accvgpr_write_b32 a121, v2
    v_perm_b32 v1, v29, v28, s46
    v_accvgpr_write_b32 a122, v1
    v_perm_b32 v2, v31, v30, s46
    v_accvgpr_write_b32 a123, v2
    v_perm_b32 v1, v25, v24, s47
    v_accvgpr_write_b32 a124, v1
    v_perm_b32 v2, v27, v26, s47
    v_accvgpr_write_b32 a125, v2
    v_perm_b32 v1, v29, v28, s47
    v_accvgpr_write_b32 a126, v1
    v_perm_b32 v2, v31, v30, s47
    v_accvgpr_write_b32 a127, v2
    s_mov_b32 s45, 0xc6000
    buffer_load_dword v24, v15, s[16:19], s45 offen
    s_mov_b32 s45, 0xc6480
    buffer_load_dword v25, v15, s[16:19], s45 offen
    s_mov_b32 s45, 0xc6900
    buffer_load_dword v26, v15, s[16:19], s45 offen
    s_mov_b32 s45, 0xc6d80
    buffer_load_dword v27, v15, s[16:19], s45 offen
    s_mov_b32 s45, 0xc7200
    buffer_load_dword v28, v15, s[16:19], s45 offen
    s_mov_b32 s45, 0xc7680
    buffer_load_dword v29, v15, s[16:19], s45 offen
    s_mov_b32 s45, 0xc7b00
    buffer_load_dword v30, v15, s[16:19], s45 offen
    s_mov_b32 s45, 0xc7f80
    buffer_load_dword v31, v15, s[16:19], s45 offen
    s_waitcnt vmcnt(48)
    v_perm_b32 v1, v33, v32, s46
    v_accvgpr_write_b32 a128, v1
    v_perm_b32 v2, v35, v34, s46
    v_accvgpr_write_b32 a129, v2
    v_perm_b32 v1, v37, v36, s46
    v_accvgpr_write_b32 a130, v1
    v_perm_b32 v2, v39, v38, s46
    v_accvgpr_write_b32 a131, v2
    v_perm_b32 v1, v33, v32, s47
    v_accvgpr_write_b32 a132, v1
    v_perm_b32 v2, v35, v34, s47
    v_accvgpr_write_b32 a133, v2
    v_perm_b32 v1, v37, v36, s47
    v_accvgpr_write_b32 a134, v1
    v_perm_b32 v2, v39, v38, s47
    v_accvgpr_write_b32 a135, v2
    s_mov_b32 s45, 0xcf000
    buffer_load_dword v32, v15, s[16:19], s45 offen
    s_mov_b32 s45, 0xcf480
    buffer_load_dword v33, v15, s[16:19], s45 offen
    s_mov_b32 s45, 0xcf900
    buffer_load_dword v34, v15, s[16:19], s45 offen
    s_mov_b32 s45, 0xcfd80
    buffer_load_dword v35, v15, s[16:19], s45 offen
    s_mov_b32 s45, 0xd0200
    buffer_load_dword v36, v15, s[16:19], s45 offen
    s_mov_b32 s45, 0xd0680
    buffer_load_dword v37, v15, s[16:19], s45 offen
    s_mov_b32 s45, 0xd0b00
    buffer_load_dword v38, v15, s[16:19], s45 offen
    s_mov_b32 s45, 0xd0f80
    buffer_load_dword v39, v15, s[16:19], s45 offen
    s_waitcnt vmcnt(48)
    v_perm_b32 v1, v41, v40, s46
    v_accvgpr_write_b32 a136, v1
    v_perm_b32 v2, v43, v42, s46
    v_accvgpr_write_b32 a137, v2
    v_perm_b32 v1, v45, v44, s46
    v_accvgpr_write_b32 a138, v1
    v_perm_b32 v2, v47, v46, s46
    v_accvgpr_write_b32 a139, v2
    v_perm_b32 v1, v41, v40, s47
    v_accvgpr_write_b32 a140, v1
    v_perm_b32 v2, v43, v42, s47
    v_accvgpr_write_b32 a141, v2
    v_perm_b32 v1, v45, v44, s47
    v_accvgpr_write_b32 a142, v1
    v_perm_b32 v2, v47, v46, s47
    v_accvgpr_write_b32 a143, v2
    s_mov_b32 s45, 0xd8000
    buffer_load_dword v40, v15, s[16:19], s45 offen
    s_mov_b32 s45, 0xd8480
    buffer_load_dword v41, v15, s[16:19], s45 offen
    s_mov_b32 s45, 0xd8900
    buffer_load_dword v42, v15, s[16:19], s45 offen
    s_mov_b32 s45, 0xd8d80
    buffer_load_dword v43, v15, s[16:19], s45 offen
    s_mov_b32 s45, 0xd9200
    buffer_load_dword v44, v15, s[16:19], s45 offen
    s_mov_b32 s45, 0xd9680
    buffer_load_dword v45, v15, s[16:19], s45 offen
    s_mov_b32 s45, 0xd9b00
    buffer_load_dword v46, v15, s[16:19], s45 offen
    s_mov_b32 s45, 0xd9f80
    buffer_load_dword v47, v15, s[16:19], s45 offen
    s_waitcnt vmcnt(48)
    v_perm_b32 v1, v49, v48, s46
    v_accvgpr_write_b32 a144, v1
    v_perm_b32 v2, v51, v50, s46
    v_accvgpr_write_b32 a145, v2
    v_perm_b32 v1, v53, v52, s46
    v_accvgpr_write_b32 a146, v1
    v_perm_b32 v2, v55, v54, s46
    v_accvgpr_write_b32 a147, v2
    v_perm_b32 v1, v49, v48, s47
    v_accvgpr_write_b32 a148, v1
    v_perm_b32 v2, v51, v50, s47
    v_accvgpr_write_b32 a149, v2
    v_perm_b32 v1, v53, v52, s47
    v_accvgpr_write_b32 a150, v1
    v_perm_b32 v2, v55, v54, s47
    v_accvgpr_write_b32 a151, v2
    s_mov_b32 s45, 0xe1000
    buffer_load_dword v48, v15, s[16:19], s45 offen
    s_mov_b32 s45, 0xe1480
    buffer_load_dword v49, v15, s[16:19], s45 offen
    s_mov_b32 s45, 0xe1900
    buffer_load_dword v50, v15, s[16:19], s45 offen
    s_mov_b32 s45, 0xe1d80
    buffer_load_dword v51, v15, s[16:19], s45 offen
    s_mov_b32 s45, 0xe2200
    buffer_load_dword v52, v15, s[16:19], s45 offen
    s_mov_b32 s45, 0xe2680
    buffer_load_dword v53, v15, s[16:19], s45 offen
    s_mov_b32 s45, 0xe2b00
    buffer_load_dword v54, v15, s[16:19], s45 offen
    s_mov_b32 s45, 0xe2f80
    buffer_load_dword v55, v15, s[16:19], s45 offen
    s_waitcnt vmcnt(48)
    v_perm_b32 v1, v57, v56, s46
    v_accvgpr_write_b32 a152, v1
    v_perm_b32 v2, v59, v58, s46
    v_accvgpr_write_b32 a153, v2
    v_perm_b32 v1, v61, v60, s46
    v_accvgpr_write_b32 a154, v1
    v_perm_b32 v2, v63, v62, s46
    v_accvgpr_write_b32 a155, v2
    v_perm_b32 v1, v57, v56, s47
    v_accvgpr_write_b32 a156, v1
    v_perm_b32 v2, v59, v58, s47
    v_accvgpr_write_b32 a157, v2
    v_perm_b32 v1, v61, v60, s47
    v_accvgpr_write_b32 a158, v1
    v_perm_b32 v2, v63, v62, s47
    v_accvgpr_write_b32 a159, v2
    s_mov_b32 s45, 0xea000
    buffer_load_dword v56, v15, s[16:19], s45 offen
    s_mov_b32 s45, 0xea480
    buffer_load_dword v57, v15, s[16:19], s45 offen
    s_mov_b32 s45, 0xea900
    buffer_load_dword v58, v15, s[16:19], s45 offen
    s_mov_b32 s45, 0xead80
    buffer_load_dword v59, v15, s[16:19], s45 offen
    s_mov_b32 s45, 0xeb200
    buffer_load_dword v60, v15, s[16:19], s45 offen
    s_mov_b32 s45, 0xeb680
    buffer_load_dword v61, v15, s[16:19], s45 offen
    s_mov_b32 s45, 0xebb00
    buffer_load_dword v62, v15, s[16:19], s45 offen
    s_mov_b32 s45, 0xebf80
    buffer_load_dword v63, v15, s[16:19], s45 offen
    s_waitcnt vmcnt(48)
    v_perm_b32 v1, v65, v64, s46
    v_accvgpr_write_b32 a160, v1
    v_perm_b32 v2, v67, v66, s46
    v_accvgpr_write_b32 a161, v2
    v_perm_b32 v1, v69, v68, s46
    v_accvgpr_write_b32 a162, v1
    v_perm_b32 v2, v71, v70, s46
    v_accvgpr_write_b32 a163, v2
    v_perm_b32 v1, v65, v64, s47
    v_accvgpr_write_b32 a164, v1
    v_perm_b32 v2, v67, v66, s47
    v_accvgpr_write_b32 a165, v2
    v_perm_b32 v1, v69, v68, s47
    v_accvgpr_write_b32 a166, v1
    v_perm_b32 v2, v71, v70, s47
    v_accvgpr_write_b32 a167, v2
    s_mov_b32 s45, 0xf3000
    buffer_load_dword v64, v15, s[16:19], s45 offen
    s_mov_b32 s45, 0xf3480
    buffer_load_dword v65, v15, s[16:19], s45 offen
    s_mov_b32 s45, 0xf3900
    buffer_load_dword v66, v15, s[16:19], s45 offen
    s_mov_b32 s45, 0xf3d80
    buffer_load_dword v67, v15, s[16:19], s45 offen
    s_mov_b32 s45, 0xf4200
    buffer_load_dword v68, v15, s[16:19], s45 offen
    s_mov_b32 s45, 0xf4680
    buffer_load_dword v69, v15, s[16:19], s45 offen
    s_mov_b32 s45, 0xf4b00
    buffer_load_dword v70, v15, s[16:19], s45 offen
    s_mov_b32 s45, 0xf4f80
    buffer_load_dword v71, v15, s[16:19], s45 offen
    s_waitcnt vmcnt(48)
    v_perm_b32 v1, v17, v16, s46
    v_accvgpr_write_b32 a168, v1
    v_perm_b32 v2, v19, v18, s46
    v_accvgpr_write_b32 a169, v2
    v_perm_b32 v1, v21, v20, s46
    v_accvgpr_write_b32 a170, v1
    v_perm_b32 v2, v23, v22, s46
    v_accvgpr_write_b32 a171, v2
    v_perm_b32 v1, v17, v16, s47
    v_accvgpr_write_b32 a172, v1
    v_perm_b32 v2, v19, v18, s47
    v_accvgpr_write_b32 a173, v2
    v_perm_b32 v1, v21, v20, s47
    v_accvgpr_write_b32 a174, v1
    v_perm_b32 v2, v23, v22, s47
    v_accvgpr_write_b32 a175, v2
    s_mov_b32 s45, 0xfc000
    buffer_load_dword v16, v15, s[16:19], s45 offen
    s_mov_b32 s45, 0xfc480
    buffer_load_dword v17, v15, s[16:19], s45 offen
    s_mov_b32 s45, 0xfc900
    buffer_load_dword v18, v15, s[16:19], s45 offen
    s_mov_b32 s45, 0xfcd80
    buffer_load_dword v19, v15, s[16:19], s45 offen
    s_mov_b32 s45, 0xfd200
    buffer_load_dword v20, v15, s[16:19], s45 offen
    s_mov_b32 s45, 0xfd680
    buffer_load_dword v21, v15, s[16:19], s45 offen
    s_mov_b32 s45, 0xfdb00
    buffer_load_dword v22, v15, s[16:19], s45 offen
    s_mov_b32 s45, 0xfdf80
    buffer_load_dword v23, v15, s[16:19], s45 offen
    s_waitcnt vmcnt(48)
    v_perm_b32 v1, v25, v24, s46
    v_accvgpr_write_b32 a176, v1
    v_perm_b32 v2, v27, v26, s46
    v_accvgpr_write_b32 a177, v2
    v_perm_b32 v1, v29, v28, s46
    v_accvgpr_write_b32 a178, v1
    v_perm_b32 v2, v31, v30, s46
    v_accvgpr_write_b32 a179, v2
    v_perm_b32 v1, v25, v24, s47
    v_accvgpr_write_b32 a180, v1
    v_perm_b32 v2, v27, v26, s47
    v_accvgpr_write_b32 a181, v2
    v_perm_b32 v1, v29, v28, s47
    v_accvgpr_write_b32 a182, v1
    v_perm_b32 v2, v31, v30, s47
    v_accvgpr_write_b32 a183, v2
    s_mov_b32 s45, 0x105000
    buffer_load_dword v24, v15, s[16:19], s45 offen
    s_mov_b32 s45, 0x105480
    buffer_load_dword v25, v15, s[16:19], s45 offen
    s_mov_b32 s45, 0x105900
    buffer_load_dword v26, v15, s[16:19], s45 offen
    s_mov_b32 s45, 0x105d80
    buffer_load_dword v27, v15, s[16:19], s45 offen
    s_mov_b32 s45, 0x106200
    buffer_load_dword v28, v15, s[16:19], s45 offen
    s_mov_b32 s45, 0x106680
    buffer_load_dword v29, v15, s[16:19], s45 offen
    s_mov_b32 s45, 0x106b00
    buffer_load_dword v30, v15, s[16:19], s45 offen
    s_mov_b32 s45, 0x106f80
    buffer_load_dword v31, v15, s[16:19], s45 offen
    s_waitcnt vmcnt(48)
    v_perm_b32 v1, v33, v32, s46
    v_accvgpr_write_b32 a184, v1
    v_perm_b32 v2, v35, v34, s46
    v_accvgpr_write_b32 a185, v2
    v_perm_b32 v1, v37, v36, s46
    v_accvgpr_write_b32 a186, v1
    v_perm_b32 v2, v39, v38, s46
    v_accvgpr_write_b32 a187, v2
    v_perm_b32 v1, v33, v32, s47
    v_accvgpr_write_b32 a188, v1
    v_perm_b32 v2, v35, v34, s47
    v_accvgpr_write_b32 a189, v2
    v_perm_b32 v1, v37, v36, s47
    v_accvgpr_write_b32 a190, v1
    v_perm_b32 v2, v39, v38, s47
    v_accvgpr_write_b32 a191, v2
    s_mov_b32 s45, 0x10e000
    buffer_load_dword v32, v15, s[16:19], s45 offen
    s_mov_b32 s45, 0x10e480
    buffer_load_dword v33, v15, s[16:19], s45 offen
    s_mov_b32 s45, 0x10e900
    buffer_load_dword v34, v15, s[16:19], s45 offen
    s_mov_b32 s45, 0x10ed80
    buffer_load_dword v35, v15, s[16:19], s45 offen
    s_mov_b32 s45, 0x10f200
    buffer_load_dword v36, v15, s[16:19], s45 offen
    s_mov_b32 s45, 0x10f680
    buffer_load_dword v37, v15, s[16:19], s45 offen
    s_mov_b32 s45, 0x10fb00
    buffer_load_dword v38, v15, s[16:19], s45 offen
    s_mov_b32 s45, 0x10ff80
    buffer_load_dword v39, v15, s[16:19], s45 offen
    s_waitcnt vmcnt(48)
    v_perm_b32 v1, v41, v40, s46
    v_accvgpr_write_b32 a192, v1
    v_perm_b32 v2, v43, v42, s46
    v_accvgpr_write_b32 a193, v2
    v_perm_b32 v1, v45, v44, s46
    v_accvgpr_write_b32 a194, v1
    v_perm_b32 v2, v47, v46, s46
    v_accvgpr_write_b32 a195, v2
    v_perm_b32 v1, v41, v40, s47
    v_accvgpr_write_b32 a196, v1
    v_perm_b32 v2, v43, v42, s47
    v_accvgpr_write_b32 a197, v2
    v_perm_b32 v1, v45, v44, s47
    v_accvgpr_write_b32 a198, v1
    v_perm_b32 v2, v47, v46, s47
    v_accvgpr_write_b32 a199, v2
    s_mov_b32 s45, 0x117000
    buffer_load_dword v40, v15, s[16:19], s45 offen
    s_mov_b32 s45, 0x117480
    buffer_load_dword v41, v15, s[16:19], s45 offen
    s_mov_b32 s45, 0x117900
    buffer_load_dword v42, v15, s[16:19], s45 offen
    s_mov_b32 s45, 0x117d80
    buffer_load_dword v43, v15, s[16:19], s45 offen
    s_mov_b32 s45, 0x118200
    buffer_load_dword v44, v15, s[16:19], s45 offen
    s_mov_b32 s45, 0x118680
    buffer_load_dword v45, v15, s[16:19], s45 offen
    s_mov_b32 s45, 0x118b00
    buffer_load_dword v46, v15, s[16:19], s45 offen
    s_mov_b32 s45, 0x118f80
    buffer_load_dword v47, v15, s[16:19], s45 offen
    s_waitcnt vmcnt(48)
    v_perm_b32 v1, v49, v48, s46
    v_accvgpr_write_b32 a200, v1
    v_perm_b32 v2, v51, v50, s46
    v_accvgpr_write_b32 a201, v2
    v_perm_b32 v1, v53, v52, s46
    v_accvgpr_write_b32 a202, v1
    v_perm_b32 v2, v55, v54, s46
    v_accvgpr_write_b32 a203, v2
    v_perm_b32 v1, v49, v48, s47
    v_accvgpr_write_b32 a204, v1
    v_perm_b32 v2, v51, v50, s47
    v_accvgpr_write_b32 a205, v2
    v_perm_b32 v1, v53, v52, s47
    v_accvgpr_write_b32 a206, v1
    v_perm_b32 v2, v55, v54, s47
    v_accvgpr_write_b32 a207, v2
    s_waitcnt vmcnt(40)
    v_perm_b32 v1, v57, v56, s46
    v_accvgpr_write_b32 a208, v1
    v_perm_b32 v2, v59, v58, s46
    v_accvgpr_write_b32 a209, v2
    v_perm_b32 v1, v61, v60, s46
    v_accvgpr_write_b32 a210, v1
    v_perm_b32 v2, v63, v62, s46
    v_accvgpr_write_b32 a211, v2
    v_perm_b32 v1, v57, v56, s47
    v_accvgpr_write_b32 a212, v1
    v_perm_b32 v2, v59, v58, s47
    v_accvgpr_write_b32 a213, v2
    v_perm_b32 v1, v61, v60, s47
    v_accvgpr_write_b32 a214, v1
    v_perm_b32 v2, v63, v62, s47
    v_accvgpr_write_b32 a215, v2
    s_waitcnt vmcnt(32)
    v_perm_b32 v1, v65, v64, s46
    v_accvgpr_write_b32 a216, v1
    v_perm_b32 v2, v67, v66, s46
    v_accvgpr_write_b32 a217, v2
    v_perm_b32 v1, v69, v68, s46
    v_accvgpr_write_b32 a218, v1
    v_perm_b32 v2, v71, v70, s46
    v_accvgpr_write_b32 a219, v2
    v_perm_b32 v1, v65, v64, s47
    v_accvgpr_write_b32 a220, v1
    v_perm_b32 v2, v67, v66, s47
    v_accvgpr_write_b32 a221, v2
    v_perm_b32 v1, v69, v68, s47
    v_accvgpr_write_b32 a222, v1
    v_perm_b32 v2, v71, v70, s47
    v_accvgpr_write_b32 a223, v2
    s_waitcnt vmcnt(24)
    v_perm_b32 v1, v17, v16, s46
    v_accvgpr_write_b32 a224, v1
    v_perm_b32 v2, v19, v18, s46
    v_accvgpr_write_b32 a225, v2
    v_perm_b32 v1, v21, v20, s46
    v_accvgpr_write_b32 a226, v1
    v_perm_b32 v2, v23, v22, s46
    v_accvgpr_write_b32 a227, v2
    v_perm_b32 v1, v17, v16, s47
    v_accvgpr_write_b32 a228, v1
    v_perm_b32 v2, v19, v18, s47
    v_accvgpr_write_b32 a229, v2
    v_perm_b32 v1, v21, v20, s47
    v_accvgpr_write_b32 a230, v1
    v_perm_b32 v2, v23, v22, s47
    v_accvgpr_write_b32 a231, v2
    s_waitcnt vmcnt(16)
    v_perm_b32 v1, v25, v24, s46
    v_accvgpr_write_b32 a232, v1
    v_perm_b32 v2, v27, v26, s46
    v_accvgpr_write_b32 a233, v2
    v_perm_b32 v1, v29, v28, s46
    v_accvgpr_write_b32 a234, v1
    v_perm_b32 v2, v31, v30, s46
    v_accvgpr_write_b32 a235, v2
    v_perm_b32 v1, v25, v24, s47
    v_accvgpr_write_b32 a236, v1
    v_perm_b32 v2, v27, v26, s47
    v_accvgpr_write_b32 a237, v2
    v_perm_b32 v1, v29, v28, s47
    v_accvgpr_write_b32 a238, v1
    v_perm_b32 v2, v31, v30, s47
    v_accvgpr_write_b32 a239, v2
    s_waitcnt vmcnt(8)
    v_perm_b32 v1, v33, v32, s46
    v_accvgpr_write_b32 a240, v1
    v_perm_b32 v2, v35, v34, s46
    v_accvgpr_write_b32 a241, v2
    v_perm_b32 v1, v37, v36, s46
    v_accvgpr_write_b32 a242, v1
    v_perm_b32 v2, v39, v38, s46
    v_accvgpr_write_b32 a243, v2
    v_perm_b32 v1, v33, v32, s47
    v_accvgpr_write_b32 a244, v1
    v_perm_b32 v2, v35, v34, s47
    v_accvgpr_write_b32 a245, v2
    v_perm_b32 v1, v37, v36, s47
    v_accvgpr_write_b32 a246, v1
    v_perm_b32 v2, v39, v38, s47
    v_accvgpr_write_b32 a247, v2
    s_waitcnt vmcnt(0)
    v_perm_b32 v1, v41, v40, s46
    v_accvgpr_write_b32 a248, v1
    v_perm_b32 v2, v43, v42, s46
    v_accvgpr_write_b32 a249, v2
    v_perm_b32 v1, v45, v44, s46
    v_accvgpr_write_b32 a250, v1
    v_perm_b32 v2, v47, v46, s46
    v_accvgpr_write_b32 a251, v2
    v_perm_b32 v1, v41, v40, s47
    v_accvgpr_write_b32 a252, v1
    v_perm_b32 v2, v43, v42, s47
    v_accvgpr_write_b32 a253, v2
    v_perm_b32 v1, v45, v44, s47
    v_accvgpr_write_b32 a254, v1
    v_perm_b32 v2, v47, v46, s47
    v_accvgpr_write_b32 a255, v2
    v_lshlrev_b32 v6, 4, v0
    v_and_b32 v2, 7, v0
    v_lshlrev_b32 v2, 7, v2
    s_lshl_b32 s45, s32, 10
    v_add_u32_e64 v2, s45, v2
    v_mul_u32_u24 v3, 1152, v12
    v_lshl_add_u32 v3, v13, 4, v3
    v_add_u32 v3, s48, v3
    s_lshl_b32 s45, s32, 11
    v_add_u32_e64 v4, s45, v6
    s_mov_b32 s40, 0
L_wi_56:
    s_add_u32 s40, s40, 1
    s_cmp_gt_u32 s40, 0x100000
    s_cbranch_scc1 L_abort
    buffer_load_dword v16, off, s[12:15], 0 offset:64 sc1
    s_waitcnt vmcnt(0)
    v_cmp_ne_u32 vcc, 0x100, v16
    s_cbranch_vccnz L_wi_56
    s_mov_b32 s43, 0
    s_mov_b32 s49, 0
    s_mov_b32 s51, 0
    s_mov_b32 s52, 0
L_o_layer:
    s_mov_b32 s44, s41
L_o_loop:
    s_lshr_b32 s45, s44, 1
    s_lshl_b32 s45, s45, 12
    s_lshl_b32 s48, s43, 20
    s_add_u32 s45, s45, s48
    s_add_u32 s45, s45, 0x1850000
    s_mov_b32 s40, 0
    s_branch L_oe_59
L_of_57:
    s_add_u32 s40, s40, 1
    s_cmp_gt_u32 s40, 0x100000
    s_cbranch_scc1 L_abort
    s_sleep 1
L_oe_59:
    buffer_load_dword v16, v2, s[8:11], s45 offen sc1
    s_waitcnt vmcnt(0)
    s_cmp_eq_u32 s51, 0
    s_cbranch_scc1 L_onp_58
    v_mov_b32 v32, 1
    s_mov_b64 exec, 1
    buffer_store_dword v32, off, s[8:11], s51 offset:0 sc1
    s_mov_b64 exec, -1
    s_mov_b32 s51, 0
L_onp_58:
    v_cmp_eq_u32_e64 vcc, 0, v16
    s_cbranch_vccnz L_of_57
    s_lshl_b32 s45, s44, 17
    s_lshl_b32 s48, s32, 15
    s_add_u32 s45, s45, s48
    s_lshl_b32 s48, s43, 24
    s_add_u32 s45, s45, s48
    s_add_u32 s45, s45, 0x6000000
    buffer_load_dwordx4 v[64:67], v6, s[8:11], s45 offen offset:0 sc1
    buffer_load_dwordx4 v[68:71], v6, s[8:11], s45 offen offset:1024 sc1
    buffer_load_dwordx4 v[72:75], v6, s[8:11], s45 offen offset:2048 sc1
    buffer_load_dwordx4 v[76:79], v6, s[8:11], s45 offen offset:3072 sc1
    s_add_u32 s45, s45, 4096
    buffer_load_dwordx4 v[80:83], v6, s[8:11], s45 offen offset:0 sc1
    buffer_load_dwordx4 v[84:87], v6, s[8:11], s45 offen offset:1024 sc1
    buffer_load_dwordx4 v[88:91], v6, s[8:11], s45 offen offset:2048 sc1
    buffer_load_dwordx4 v[92:95], v6, s[8:11], s45 offen offset:3072 sc1
    s_add_u32 s45, s45, 4096
    buffer_load_dwordx4 v[96:99], v6, s[8:11], s45 offen offset:0 sc1
    buffer_load_dwordx4 v[100:103], v6, s[8:11], s45 offen offset:1024 sc1
    buffer_load_dwordx4 v[104:107], v6, s[8:11], s45 offen offset:2048 sc1
    buffer_load_dwordx4 v[108:111], v6, s[8:11], s45 offen offset:3072 sc1
    s_add_u32 s45, s45, 4096
    buffer_load_dwordx4 v[112:115], v6, s[8:11], s45 offen offset:0 sc1
    buffer_load_dwordx4 v[116:119], v6, s[8:11], s45 offen offset:1024 sc1
    buffer_load_dwordx4 v[120:123], v6, s[8:11], s45 offen offset:2048 sc1
    buffer_load_dwordx4 v[124:127], v6, s[8:11], s45 offen offset:3072 sc1
    s_add_u32 s45, s45, 4096
    buffer_load_dwordx4 v[128:131], v6, s[8:11], s45 offen offset:0 sc1
    buffer_load_dwordx4 v[132:135], v6, s[8:11], s45 offen offset:1024 sc1
    buffer_load_dwordx4 v[136:139], v6, s[8:11], s45 offen offset:2048 sc1
    buffer_load_dwordx4 v[140:143], v6, s[8:11], s45 offen offset:3072 sc1
    s_add_u32 s45, s45, 4096
    buffer_load_dwordx4 v[144:147], v6, s[8:11], s45 offen offset:0 sc1
    buffer_load_dwordx4 v[148:151], v6, s[8:11], s45 offen offset:1024 sc1
    buffer_load_dwordx4 v[152:155], v6, s[8:11], s45 offen offset:2048 sc1
    buffer_load_dwordx4 v[156:159], v6, s[8:11], s45 offen offset:3072 sc1
    s_add_u32 s45, s45, 4096
    buffer_load_dwordx4 v[160:163], v6, s[8:11], s45 offen offset:0 sc1
    buffer_load_dwordx4 v[164:167], v6, s[8:11], s45 offen offset:1024 sc1
    buffer_load_dwordx4 v[168:171], v6, s[8:11], s45 offen offset:2048 sc1
    buffer_load_dwordx4 v[172:175], v6, s[8:11], s45 offen offset:3072 sc1
    s_add_u32 s45, s45, 4096
    buffer_load_dwordx4 v[176:179], v6, s[8:11], s45 offen offset:0 sc1
    buffer_load_dwordx4 v[180:183], v6, s[8:11], s45 offen offset:1024 sc1
    buffer_load_dwordx4 v[184:187], v6, s[8:11], s45 offen offset:2048 sc1
    buffer_load_dwordx4 v[188:191], v6, s[8:11], s45 offen offset:3072 sc1
    s_add_u32 s45, s45, 4096
    s_mul_i32 s50, s44, 18432
    s_cmp_lg_u32 s43, 0
    s_cbranch_scc1 L_ol1_60
    buffer_load_dwordx4 v[24:27], v3, s[20:23], s50 offen
    s_branch L_olj_61
L_ol1_60:
    s_add_u32 s45, s50, 0xc20000
    buffer_load_dwordx4 v[24:27], v3, s[8:11], s45 offen sc1
L_olj_61:
    s_waitcnt vmcnt(32)
    v_mfma_f32_16x16x32_bf16 v[16:19], a[0:3], v[64:67], 0
    v_mfma_f32_16x16x32_bf16 v[20:23], a[4:7], v[64:67], 0
    s_waitcnt vmcnt(31)
    v_mfma_f32_16x16x32_bf16 v[16:19], a[8:11], v[68:71], v[16:19]
    v_mfma_f32_16x16x32_bf16 v[20:23], a[12:15], v[68:71], v[20:23]
    s_waitcnt vmcnt(30)
    v_mfma_f32_16x16x32_bf16 v[16:19], a[16:19], v[72:75], v[16:19]
    v_mfma_f32_16x16x32_bf16 v[20:23], a[20:23], v[72:75], v[20:23]
    s_waitcnt vmcnt(29)
    v_mfma_f32_16x16x32_bf16 v[16:19], a[24:27], v[76:79], v[16:19]
    v_mfma_f32_16x16x32_bf16 v[20:23], a[28:31], v[76:79], v[20:23]
    s_waitcnt vmcnt(28)
    v_mfma_f32_16x16x32_bf16 v[16:19], a[32:35], v[80:83], v[16:19]
    v_mfma_f32_16x16x32_bf16 v[20:23], a[36:39], v[80:83], v[20:23]
    s_waitcnt vmcnt(27)
    v_mfma_f32_16x16x32_bf16 v[16:19], a[40:43], v[84:87], v[16:19]
    v_mfma_f32_16x16x32_bf16 v[20:23], a[44:47], v[84:87], v[20:23]
    s_waitcnt vmcnt(26)
    v_mfma_f32_16x16x32_bf16 v[16:19], a[48:51], v[88:91], v[16:19]
    v_mfma_f32_16x16x32_bf16 v[20:23], a[52:55], v[88:91], v[20:23]
    s_waitcnt vmcnt(25)
    v_mfma_f32_16x16x32_bf16 v[16:19], a[56:59], v[92:95], v[16:19]
    v_mfma_f32_16x16x32_bf16 v[20:23], a[60:63], v[92:95], v[20:23]
    s_waitcnt vmcnt(24)
    v_mfma_f32_16x16x32_bf16 v[16:19], a[64:67], v[96:99], v[16:19]
    v_mfma_f32_16x16x32_bf16 v[20:23], a[68:71], v[96:99], v[20:23]
    s_waitcnt vmcnt(23)
    v_mfma_f32_16x16x32_bf16 v[16:19], a[72:75], v[100:103], v[16:19]
    v_mfma_f32_16x16x32_bf16 v[20:23], a[76:79], v[100:103], v[20:23]
    s_waitcnt vmcnt(22)
    v_mfma_f32_16x16x32_bf16 v[16:19], a[80:83], v[104:107], v[16:19]
    v_mfma_f32_16x16x32_bf16 v[20:23], a[84:87], v[104:107], v[20:23]
    s_waitcnt vmcnt(21)
    v_mfma_f32_16x16x32_bf16 v[16:19], a[88:91], v[108:111], v[16:19]
    v_mfma_f32_16x16x32_bf16 v[20:23], a[92:95], v[108:111], v[20:23]
    s_waitcnt vmcnt(20)
    v_mfma_f32_16x16x32_bf16 v[16:19], a[96:99], v[112:115], v[16:19]
    v_mfma_f32_16x16x32_bf16 v[20:23], a[100:103], v[112:115], v[20:23]
    s_waitcnt vmcnt(19)
    v_mfma_f32_16x16x32_bf16 v[16:19], a[104:107], v[116:119], v[16:19]
    v_mfma_f32_16x16x32_bf16 v[20:23], a[108:111], v[116:119], v[20:23]
    s_waitcnt vmcnt(18)
    v_mfma_f32_16x16x32_bf16 v[16:19], a[112:115], v[120:123], v[16:19]
    v_mfma_f32_16x16x32_bf16 v[20:23], a[116:119], v[120:123], v[20:23]
    s_waitcnt vmcnt(17)
    v_mfma_f32_16x16x32_bf16 v[16:19], a[120:123], v[124:127], v[16:19]
    v_mfma_f32_16x16x32_bf16 v[20:23], a[124:127], v[124:127], v[20:23]
    s_waitcnt vmcnt(16)
    v_mfma_f32_16x16x32_bf16 v[16:19], a[128:131], v[128:131], v[16:19]
    v_mfma_f32_16x16x32_bf16 v[20:23], a[132:135], v[128:131], v[20:23]
    s_waitcnt vmcnt(15)
    v_mfma_f32_16x16x32_bf16 v[16:19], a[136:139], v[132:135], v[16:19]
    v_mfma_f32_16x16x32_bf16 v[20:23], a[140:143], v[132:135], v[20:23]
    s_waitcnt vmcnt(14)
    v_mfma_f32_16x16x32_bf16 v[16:19], a[144:147], v[136:139], v[16:19]
    v_mfma_f32_16x16x32_bf16 v[20:23], a[148:151], v[136:139], v[20:23]
    s_waitcnt vmcnt(13)
    v_mfma_f32_16x16x32_bf16 v[16:19], a[152:155], v[140:143], v[16:19]
    v_mfma_f32_16x16x32_bf16 v[20:23], a[156:159], v[140:143], v[20:23]
    s_waitcnt vmcnt(12)
    v_mfma_f32_16x16x32_bf16 v[16:19], a[160:163], v[144:147], v[16:19]
    v_mfma_f32_16x16x32_bf16 v[20:23], a[164:167], v[144:147], v[20:23]
    s_waitcnt vmcnt(11)
    v_mfma_f32_16x16x32_bf16 v[16:19], a[168:171], v[148:151], v[16:19]
    v_mfma_f32_16x16x32_bf16 v[20:23], a[172:175], v[148:151], v[20:23]
    s_waitcnt vmcnt(10)
    v_mfma_f32_16x16x32_bf16 v[16:19], a[176:179], v[152:155], v[16:19]
    v_mfma_f32_16x16x32_bf16 v[20:23], a[180:183], v[152:155], v[20:23]
    s_waitcnt vmcnt(9)
    v_mfma_f32_16x16x32_bf16 v[16:19], a[184:187], v[156:159], v[16:19]
    v_mfma_f32_16x16x32_bf16 v[20:23], a[188:191], v[156:159], v[20:23]
    s_waitcnt vmcnt(8)
    v_mfma_f32_16x16x32_bf16 v[16:19], a[192:195], v[160:163], v[16:19]
    v_mfma_f32_16x16x32_bf16 v[20:23], a[196:199], v[160:163], v[20:23]
    s_waitcnt vmcnt(7)
    v_mfma_f32_16x16x32_bf16 v[16:19], a[200:203], v[164:167], v[16:19]
    v_mfma_f32_16x16x32_bf16 v[20:23], a[204:207], v[164:167], v[20:23]
    s_waitcnt vmcnt(6)
    v_mfma_f32_16x16x32_bf16 v[16:19], a[208:211], v[168:171], v[16:19]
    v_mfma_f32_16x16x32_bf16 v[20:23], a[212:215], v[168:171], v[20:23]
    s_waitcnt vmcnt(5)
    v_mfma_f32_16x16x32_bf16 v[16:19], a[216:219], v[172:175], v[16:19]
    v_mfma_f32_16x16x32_bf16 v[20:23], a[220:223], v[172:175], v[20:23]
    s_waitcnt vmcnt(4)
    v_mfma_f32_16x16x32_bf16 v[16:19], a[224:227], v[176:179], v[16:19]
    v_mfma_f32_16x16x32_bf16 v[20:23], a[228:231], v[176:179], v[20:23]
    s_waitcnt vmcnt(3)
    v_mfma_f32_16x16x32_bf16 v[16:19], a[232:235], v[180:183], v[16:19]
    v_mfma_f32_16x16x32_bf16 v[20:23], a[236:239], v[180:183], v[20:23]
    s_waitcnt vmcnt(2)
    v_mfma_f32_16x16x32_bf16 v[16:19], a[240:243], v[184:187], v[16:19]
    v_mfma_f32_16x16x32_bf16 v[20:23], a[244:247], v[184:187], v[20:23]
    s_waitcnt vmcnt(1)
    v_mfma_f32_16x16x32_bf16 v[16:19], a[248:251], v[188:191], v[16:19]
    v_mfma_f32_16x16x32_bf16 v[20:23], a[252:255], v[188:191], v[20:23]
    v_add_u32 v5, s49, v4
    s_nop 5
    ds_write_b128 v5, v[16:19]
    ds_write_b128 v5, v[20:23] offset:1024
    s_waitcnt lgkmcnt(0)
    s_barrier
    s_cmp_lg_u32 s32, s52
    s_cbranch_scc1 L_o_next
    v_xor_b32 v7, 2048, v5
    ds_read_b128 v[32:35], v7
    ds_read_b128 v[36:39], v7 offset:1024
    v_xor_b32 v7, 4096, v5
    ds_read_b128 v[40:43], v7
    ds_read_b128 v[44:47], v7 offset:1024
    v_xor_b32 v7, 6144, v5
    ds_read_b128 v[48:51], v7
    ds_read_b128 v[52:55], v7 offset:1024
    s_waitcnt lgkmcnt(0)
    v_pk_add_f32 v[16:17], v[16:17], v[32:33]
    v_pk_add_f32 v[40:41], v[40:41], v[48:49]
    v_pk_add_f32 v[18:19], v[18:19], v[34:35]
    v_pk_add_f32 v[42:43], v[42:43], v[50:51]
    v_pk_add_f32 v[20:21], v[20:21], v[36:37]
    v_pk_add_f32 v[44:45], v[44:45], v[52:53]
    v_pk_add_f32 v[22:23], v[22:23], v[38:39]
    v_pk_add_f32 v[46:47], v[46:47], v[54:55]
    v_pk_add_f32 v[16:17], v[16:17], v[40:41]
    v_pk_add_f32 v[18:19], v[18:19], v[42:43]
    v_pk_add_f32 v[20:21], v[20:21], v[44:45]
    v_pk_add_f32 v[22:23], v[22:23], v[46:47]
    s_waitcnt vmcnt(0)
    v_cvt_pk_bf16_f32 v16, v16, v20
    v_cvt_pk_bf16_f32 v17, v17, v21
    v_cvt_pk_bf16_f32 v18, v18, v22
    v_cvt_pk_bf16_f32 v19, v19, v23
    v_lshlrev_b32 v32, 16, v16
    v_and_b32 v33, 0xffff0000, v16
    v_lshlrev_b32_e64 v34, 16, v24
    v_and_b32 v35, 0xffff0000, v24
    v_pk_add_f32 v[32:33], v[32:33], v[34:35]
    v_cvt_pk_bf16_f32 v16, v32, v33
    v_lshlrev_b32_e64 v32, 16, v17
    v_and_b32 v33, 0xffff0000, v17
    v_lshlrev_b32_e64 v34, 16, v25
    v_and_b32 v35, 0xffff0000, v25
    v_pk_add_f32 v[32:33], v[32:33], v[34:35]
    v_cvt_pk_bf16_f32 v17, v32, v33
    v_lshlrev_b32_e64 v32, 16, v18
    v_and_b32 v33, 0xffff0000, v18
    v_lshlrev_b32_e64 v34, 16, v26
    v_and_b32 v35, 0xffff0000, v26
    v_pk_add_f32 v[32:33], v[32:33], v[34:35]
    v_cvt_pk_bf16_f32 v18, v32, v33
    v_lshlrev_b32_e64 v32, 16, v19
    v_and_b32 v33, 0xffff0000, v19
    v_lshlrev_b32_e64 v34, 16, v27
    v_and_b32 v35, 0xffff0000, v27
    v_pk_add_f32 v[32:33], v[32:33], v[34:35]
    v_cvt_pk_bf16_f32 v19, v32, v33
    s_mul_i32 s45, s43, 2359296
    s_add_u32 s45, s45, s50
    s_add_u32 s45, s45, 0x7a0000
    buffer_store_dwordx4 v[16:19], v3, s[8:11], s45 offen sc1
    s_cmp_lt_u32 s44, 120
    s_cbranch_scc1 L_onf_62
    s_lshl_b32 s45, s43, 3
    s_add_u32 s45, s45, s44
    s_mul_i32 s45, s45, 18
    s_add_u32 s45, s45, s42
    s_lshl_b32 s45, s45, 10
    s_add_u32 s45, s45, 0x17e4000
    buffer_store_dwordx4 v[16:19], v6, s[8:11], s45 offen sc1
L_onf_62:
    s_mul_i32 s45, s44, 18
    s_add_u32 s45, s45, s42
    s_lshl_b32 s45, s45, 7
    s_lshl_b32 s48, s43, 20
    s_add_u32 s45, s45, s48
    s_add_u32 s51, s45, 0x1890000
    s_cmp_lt_u32 s44, 125
    s_cbranch_scc1 L_o_next
    s_waitcnt vmcnt(0)
    v_mov_b32_e64 v32, 1
    s_mov_b64 exec, 1
    buffer_store_dword v32, off, s[8:11], s51 offset:0 sc1
    s_mov_b64 exec, -1
    s_mov_b32 s51, 0
L_o_next:
    s_xor_b32 s49, s49, 8192
    s_add_u32 s44, s44, 3
    s_cmp_lt_u32 s44, 128
    s_cbranch_scc1 L_o_loop
    s_add_u32 s43, s43, 1
    s_cmp_lt_u32 s43, 2
    s_cbranch_scc1 L_o_layer
    s_branch L_exit
L_role_d:
    s_mul_i32 s6, s5, 14
    s_add_u32 s6, s6, s4
    s_sub_u32 s7, s6, 18
    s_cmp_eq_u32 s5, 3
    s_cselect_b32 s41, s6, s7
    s_sub_u32 s6, s41, 2
    s_add_u32 s7, s41, 32
    s_cmp_ge_u32 s41, 42
    s_cselect_b32 s6, s6, s7
    s_cmp_ge_u32 s41, 40
    s_cselect_b32 s41, s6, s41
    s_mov_b32 s90, 0
L_d_setup:
    s_mov_b32 s91, 0
    s_load_dwordx2 s[80:81], s[0:1], 0
    s_load_dwordx4 s[84:87], s[0:1], 64
    s_load_dwordx2 s[82:83], s[0:1], 80
    s_cmp_lt_u32 s41, 8
    s_cselect_b32 s46, 1, 0
    s_cmp_ge_u32 s41, 72
    s_cselect_b32 s46, 2, s46
    s_lshl_b32 s47, s41, 2
    s_add_u32 s47, s47, s32
    v_and_b32 v12, 15, v0
    v_lshrrev_b32 v13, 4, v0
    v_lshlrev_b32 v6, 4, v0
    v_cmp_gt_u32 s[52:53], 12, v12
    s_lshl_b32 s44, s32, 2
    v_add_u32 v14, s44, v13
    v_mov_b32 v16, 0x7ff00000
    v_mul_u32_u24 v15, 1152, v14
    v_lshl_add_u32 v2, v12, 4, v15
    v_sub_u32_e64 v17, 47, v12
    v_lshl_add_u32 v3, v17, 4, v15
    v_cndmask_b32 v2, v16, v2, s[52:53]
    v_cndmask_b32 v3, v16, v3, s[52:53]
    s_and_b32 s44, s32, 1
    s_lshl_b32 s44, s44, 10
    s_lshr_b32 s45, s32, 1
    s_lshl_b32 s45, s45, 6
    s_add_u32 s44, s44, s45
    v_lshlrev_b32 v18, 4, v13
    v_add_u32 v18, s44, v18
    v_lshrrev_b32 v19, 2, v12
    v_lshl_add_u32 v4, v19, 11, v18
    v_and_b32_e64 v19, 3, v12
    v_lshl_add_u32 v4, v19, 8, v4
    v_cndmask_b32 v4, v16, v4, s[52:53]
    v_lshrrev_b32_e64 v19, 2, v17
    v_lshl_add_u32 v5, v19, 11, v18
    v_and_b32_e64 v19, 3, v17
    v_lshl_add_u32 v5, v19, 8, v5
    v_cndmask_b32 v5, v16, v5, s[52:53]
    v_mul_u32_u24 v7, 608, v14
    v_lshl_add_u32 v7, v12, 4, v7
    v_add_u32 v7, 81920, v7
    s_lshr_b32 s45, s32, 1
    s_mul_i32 s44, s45, 9728
    s_add_u32 s44, s44, 81920
    v_mul_u32_u24 v8, 608, v12
    v_lshl_add_u32 v8, v13, 4, v8
    v_add_u32_e64 v8, s44, v8
    s_and_b32 s44, s32, 1
    s_mul_i32 s50, s44, 11520
    s_lshl_b32 s49, s45, 5
    s_add_u32 s50, s50, s49
    s_add_u32 s50, s50, 102400
    v_mul_u32_u24 v9, 80, v12
    v_lshl_add_u32 v9, v13, 3, v9
    v_add_u32_e64 v9, s50, v9
    v_bfe_u32 v19, v0, 2, 2
    v_lshl_add_u32 v10, v13, 3, v19
    v_lshlrev_b32 v10, 6, v10
    v_and_b32 v19, 3, v0
    v_lshl_add_u32 v10, v19, 3, v10
    s_add_u32 s49, s49, 81920
    v_add_u32 v10, s49, v10
    s_mul_i32 s50, s45, 18688
    s_mul_i32 s49, s44, 576
    s_add_u32 s50, s50, s49
    s_add_u32 s50, s50, 118784
    v_mul_u32_u24 v11, 1168, v12
    v_lshl_add_u32 v11, v13, 4, v11
    v_add_u32_e64 v11, s50, v11
    v_mul_u32_u24 v1, 1168, v14
    v_min_u32 v19, 11, v12
    v_lshl_add_u32 v1, v19, 5, v1
    v_add_u32 v1, 118784, v1
    s_waitcnt lgkmcnt(0)
    s_mov_b32 s16, s80
    s_and_b32 s17, s81, 0xffff
    s_mov_b32 s18, 0x240000
    s_mov_b32 s19, 0x20000
    s_mov_b32 s20, s82
    s_and_b32 s21, s83, 0xffff
    s_mov_b32 s22, 0x240000
    s_mov_b32 s23, 0x20000
    s_mov_b32 s24, s84
    s_and_b32 s25, s85, 0xffff
    s_mov_b32 s26, 0x121000
    s_mov_b32 s27, 0x20000
    s_mov_b32 s28, s86
    s_and_b32 s29, s87, 0xffff
    s_mov_b32 s30, 0x121000
    s_mov_b32 s31, 0x20000
    s_cmp_lg_u32 s90, 0
    s_cbranch_scc1 L_d_help
    s_mov_b32 s42, 0
    s_mov_b32 s43, s41
    s_mul_i32 s44, s43, 18432
    buffer_load_dwordx4 v[16:19], v2, s[16:19], s44 offen offset:0
    buffer_load_dwordx4 v[20:23], v3, s[16:19], s44 offen offset:384
    buffer_load_dwordx4 v[24:27], v2, s[16:19], s44 offen offset:192
    buffer_load_dwordx4 v[28:31], v3, s[16:19], s44 offen offset:192
    buffer_load_dwordx4 v[32:35], v2, s[16:19], s44 offen offset:384
    buffer_load_dwordx4 v[36:39], v3, s[16:19], s44 offen offset:0
    s_mov_b32 s40, 0
L_wi_63:
    s_add_u32 s40, s40, 1
    s_cmp_gt_u32 s40, 0x100000
    s_cbranch_scc1 L_abort
    buffer_load_dword v88, off, s[12:15], 0 offset:64 sc1
    s_waitcnt vmcnt(0)
    v_cmp_ne_u32 vcc, 0x100, v88
    s_cbranch_vccnz L_wi_63
L_d_ln0:
    s_waitcnt vmcnt(0)
    v_lshlrev_b32_e64 v40, 16, v16
    v_and_b32 v41, 0xffff0000, v16
    v_lshlrev_b32_e64 v42, 16, v17
    v_and_b32 v43, 0xffff0000, v17
    v_lshlrev_b32_e64 v44, 16, v18
    v_and_b32 v45, 0xffff0000, v18
    v_lshlrev_b32_e64 v46, 16, v19
    v_and_b32 v47, 0xffff0000, v19
    v_lshlrev_b32_e64 v48, 16, v20
    v_and_b32 v49, 0xffff0000, v20
    v_lshlrev_b32_e64 v50, 16, v21
    v_and_b32 v51, 0xffff0000, v21
    v_lshlrev_b32_e64 v52, 16, v22
    v_and_b32 v53, 0xffff0000, v22
    v_lshlrev_b32_e64 v54, 16, v23
    v_and_b32 v55, 0xffff0000, v23
    v_lshlrev_b32_e64 v56, 16, v24
    v_and_b32 v57, 0xffff0000, v24
    v_lshlrev_b32_e64 v58, 16, v25
    v_and_b32 v59, 0xffff0000, v25
    v_lshlrev_b32_e64 v60, 16, v26
    v_and_b32 v61, 0xffff0000, v26
    v_lshlrev_b32_e64 v62, 16, v27
    v_and_b32 v63, 0xffff0000, v27
    v_lshlrev_b32_e64 v64, 16, v28
    v_and_b32 v65, 0xffff0000, v28
    v_lshlrev_b32_e64 v66, 16, v29
    v_and_b32 v67, 0xffff0000, v29
    v_lshlrev_b32_e64 v68, 16, v30
    v_and_b32 v69, 0xffff0000, v30
    v_lshlrev_b32_e64 v70, 16, v31
    v_and_b32 v71, 0xffff0000, v31
    v_lshlrev_b32_e64 v72, 16, v32
    v_and_b32 v73, 0xffff0000, v32
    v_lshlrev_b32_e64 v74, 16, v33
    v_and_b32 v75, 0xffff0000, v33
    v_lshlrev_b32_e64 v76, 16, v34
    v_and_b32 v77, 0xffff0000, v34
    v_lshlrev_b32_e64 v78, 16, v35
    v_and_b32 v79, 0xffff0000, v35
    v_lshlrev_b32_e64 v80, 16, v36
    v_and_b32 v81, 0xffff0000, v36
    v_lshlrev_b32_e64 v82, 16, v37
    v_and_b32 v83, 0xffff0000, v37
    v_lshlrev_b32_e64 v84, 16, v38
    v_and_b32 v85, 0xffff0000, v38
    v_lshlrev_b32_e64 v86, 16, v39
    v_and_b32 v87, 0xffff0000, v39
    v_pk_add_f32 v[88:89], v[40:41], v[42:43]
    v_pk_add_f32 v[90:91], v[44:45], v[46:47]
    v_pk_add_f32 v[88:89], v[88:89], v[48:49]
    v_pk_add_f32 v[90:91], v[90:91], v[50:51]
    v_pk_add_f32 v[88:89], v[88:89], v[52:53]
    v_pk_add_f32 v[90:91], v[90:91], v[54:55]
    v_pk_add_f32 v[88:89], v[88:89], v[56:57]
    v_pk_add_f32 v[90:91], v[90:91], v[58:59]
    v_pk_add_f32 v[88:89], v[88:89], v[60:61]
    v_pk_add_f32 v[90:91], v[90:91], v[62:63]
    v_pk_add_f32 v[88:89], v[88:89], v[64:65]
    v_pk_add_f32 v[90:91], v[90:91], v[66:67]
    v_pk_add_f32 v[88:89], v[88:89], v[68:69]
    v_pk_add_f32 v[90:91], v[90:91], v[70:71]
    v_pk_add_f32 v[88:89], v[88:89], v[72:73]
    v_pk_add_f32 v[90:91], v[90:91], v[74:75]
    v_pk_add_f32 v[88:89], v[88:89], v[76:77]
    v_pk_add_f32 v[90:91], v[90:91], v[78:79]
    v_pk_add_f32 v[88:89], v[88:89], v[80:81]
    v_pk_add_f32 v[90:91], v[90:91], v[82:83]
    v_pk_add_f32 v[88:89], v[88:89], v[84:85]
    v_pk_add_f32 v[90:91], v[90:91], v[86:87]
    v_pk_add_f32 v[88:89], v[88:89], v[90:91]
    v_add_f32_e64 v88, v88, v89
    v_cndmask_b32 v88, 0, v88, s[52:53]
    s_nop 1
    v_add_f32_dpp v88, v88, v88 row_ror:8 row_mask:0xf bank_mask:0xf
    s_nop 1
    v_add_f32_dpp v88, v88, v88 row_ror:4 row_mask:0xf bank_mask:0xf
    s_nop 1
    v_add_f32_dpp v88, v88, v88 row_ror:2 row_mask:0xf bank_mask:0xf
    s_nop 1
    v_add_f32_dpp v88, v88, v88 row_ror:1 row_mask:0xf bank_mask:0xf
    v_mul_f32 v88, 0xbae38e39, v88
    v_pk_add_f32 v[40:41], v[40:41], v[88:89] op_sel_hi:[1,0]
    v_pk_add_f32 v[42:43], v[42:43], v[88:89] op_sel_hi:[1,0]
    v_pk_add_f32 v[44:45], v[44:45], v[88:89] op_sel_hi:[1,0]
    v_pk_add_f32 v[46:47], v[46:47], v[88:89] op_sel_hi:[1,0]
    v_pk_add_f32 v[48:49], v[48:49], v[88:89] op_sel_hi:[1,0]
    v_pk_add_f32 v[50:51], v[50:51], v[88:89] op_sel_hi:[1,0]
    v_pk_add_f32 v[52:53], v[52:53], v[88:89] op_sel_hi:[1,0]
    v_pk_add_f32 v[54:55], v[54:55], v[88:89] op_sel_hi:[1,0]
    v_pk_add_f32 v[56:57], v[56:57], v[88:89] op_sel_hi:[1,0]
    v_pk_add_f32 v[58:59], v[58:59], v[88:89] op_sel_hi:[1,0]
    v_pk_add_f32 v[60:61], v[60:61], v[88:89] op_sel_hi:[1,0]
    v_pk_add_f32 v[62:63], v[62:63], v[88:89] op_sel_hi:[1,0]
    v_pk_add_f32 v[64:65], v[64:65], v[88:89] op_sel_hi:[1,0]
    v_pk_add_f32 v[66:67], v[66:67], v[88:89] op_sel_hi:[1,0]
    v_pk_add_f32 v[68:69], v[68:69], v[88:89] op_sel_hi:[1,0]
    v_pk_add_f32 v[70:71], v[70:71], v[88:89] op_sel_hi:[1,0]
    v_pk_add_f32 v[72:73], v[72:73], v[88:89] op_sel_hi:[1,0]
    v_pk_add_f32 v[74:75], v[74:75], v[88:89] op_sel_hi:[1,0]
    v_pk_add_f32 v[76:77], v[76:77], v[88:89] op_sel_hi:[1,0]
    v_pk_add_f32 v[78:79], v[78:79], v[88:89] op_sel_hi:[1,0]
    v_pk_add_f32 v[80:81], v[80:81], v[88:89] op_sel_hi:[1,0]
    v_pk_add_f32 v[82:83], v[82:83], v[88:89] op_sel_hi:[1,0]
    v_pk_add_f32 v[84:85], v[84:85], v[88:89] op_sel_hi:[1,0]
    v_pk_add_f32 v[86:87], v[86:87], v[88:89] op_sel_hi:[1,0]
    v_pk_mul_f32 v[88:89], v[40:41], v[40:41]
    v_pk_mul_f32 v[90:91], v[42:43], v[42:43]
    v_pk_fma_f32 v[88:89], v[44:45], v[44:45], v[88:89]
    v_pk_fma_f32 v[90:91], v[46:47], v[46:47], v[90:91]
    v_pk_fma_f32 v[88:89], v[48:49], v[48:49], v[88:89]
    v_pk_fma_f32 v[90:91], v[50:51], v[50:51], v[90:91]
    v_pk_fma_f32 v[88:89], v[52:53], v[52:53], v[88:89]
    v_pk_fma_f32 v[90:91], v[54:55], v[54:55], v[90:91]
    v_pk_fma_f32 v[88:89], v[56:57], v[56:57], v[88:89]
    v_pk_fma_f32 v[90:91], v[58:59], v[58:59], v[90:91]
    v_pk_fma_f32 v[88:89], v[60:61], v[60:61], v[88:89]
    v_pk_fma_f32 v[90:91], v[62:63], v[62:63], v[90:91]
    v_pk_fma_f32 v[88:89], v[64:65], v[64:65], v[88:89]
    v_pk_fma_f32 v[90:91], v[66:67], v[66:67], v[90:91]
    v_pk_fma_f32 v[88:89], v[68:69], v[68:69], v[88:89]
    v_pk_fma_f32 v[90:91], v[70:71], v[70:71], v[90:91]
    v_pk_fma_f32 v[88:89], v[72:73], v[72:73], v[88:89]
    v_pk_fma_f32 v[90:91], v[74:75], v[74:75], v[90:91]
    v_pk_fma_f32 v[88:89], v[76:77], v[76:77], v[88:89]
    v_pk_fma_f32 v[90:91], v[78:79], v[78:79], v[90:91]
    v_pk_fma_f32 v[88:89], v[80:81], v[80:81], v[88:89]
    v_pk_fma_f32 v[90:91], v[82:83], v[82:83], v[90:91]
    v_pk_fma_f32 v[88:89], v[84:85], v[84:85], v[88:89]
    v_pk_fma_f32 v[90:91], v[86:87], v[86:87], v[90:91]
    v_pk_add_f32 v[88:89], v[88:89], v[90:91]
    v_add_f32_e64 v88, v88, v89
    v_cndmask_b32 v88, 0, v88, s[52:53]
    s_nop 1
    v_add_f32_dpp v88, v88, v88 row_ror:8 row_mask:0xf bank_mask:0xf
    s_nop 1
    v_add_f32_dpp v88, v88, v88 row_ror:4 row_mask:0xf bank_mask:0xf
    s_nop 1
    v_add_f32_dpp v88, v88, v88 row_ror:2 row_mask:0xf bank_mask:0xf
    s_nop 1
    v_add_f32_dpp v88, v88, v88 row_ror:1 row_mask:0xf bank_mask:0xf
    v_mul_f32 v88, 0x3ae38e39, v88
    v_cvt_pk_bf16_f32 v88, v88, v88
    v_lshlrev_b32_e64 v88, 16, v88
    v_add_f32 v88, 0x3727c5ac, v88
    v_cvt_pk_bf16_f32 v88, v88, v88
    v_lshlrev_b32_e64 v88, 16, v88
    v_sqrt_f32 v88, v88
    s_nop 0
    v_cvt_pk_bf16_f32 v88, v88, v88
    v_lshlrev_b32_e64 v88, 16, v88
    v_rcp_f32 v88, v88
    s_nop 0
    v_pk_mul_f32 v[40:41], v[40:41], v[88:89] op_sel_hi:[1,0]
    v_pk_mul_f32 v[42:43], v[42:43], v[88:89] op_sel_hi:[1,0]
    v_pk_mul_f32 v[44:45], v[44:45], v[88:89] op_sel_hi:[1,0]
    v_pk_mul_f32 v[46:47], v[46:47], v[88:89] op_sel_hi:[1,0]
    v_pk_mul_f32 v[48:49], v[48:49], v[88:89] op_sel_hi:[1,0]
    v_pk_mul_f32 v[50:51], v[50:51], v[88:89] op_sel_hi:[1,0]
    v_pk_mul_f32 v[52:53], v[52:53], v[88:89] op_sel_hi:[1,0]
    v_pk_mul_f32 v[54:55], v[54:55], v[88:89] op_sel_hi:[1,0]
    v_pk_mul_f32 v[56:57], v[56:57], v[88:89] op_sel_hi:[1,0]
    v_pk_mul_f32 v[58:59], v[58:59], v[88:89] op_sel_hi:[1,0]
    v_pk_mul_f32 v[60:61], v[60:61], v[88:89] op_sel_hi:[1,0]
    v_pk_mul_f32 v[62:63], v[62:63], v[88:89] op_sel_hi:[1,0]
    v_pk_mul_f32 v[64:65], v[64:65], v[88:89] op_sel_hi:[1,0]
    v_pk_mul_f32 v[66:67], v[66:67], v[88:89] op_sel_hi:[1,0]
    v_pk_mul_f32 v[68:69], v[68:69], v[88:89] op_sel_hi:[1,0]
    v_pk_mul_f32 v[70:71], v[70:71], v[88:89] op_sel_hi:[1,0]
    v_pk_mul_f32 v[72:73], v[72:73], v[88:89] op_sel_hi:[1,0]
    v_pk_mul_f32 v[74:75], v[74:75], v[88:89] op_sel_hi:[1,0]
    v_pk_mul_f32 v[76:77], v[76:77], v[88:89] op_sel_hi:[1,0]
    v_pk_mul_f32 v[78:79], v[78:79], v[88:89] op_sel_hi:[1,0]
    v_pk_mul_f32 v[80:81], v[80:81], v[88:89] op_sel_hi:[1,0]
    v_pk_mul_f32 v[82:83], v[82:83], v[88:89] op_sel_hi:[1,0]
    v_pk_mul_f32 v[84:85], v[84:85], v[88:89] op_sel_hi:[1,0]
    v_pk_mul_f32 v[86:87], v[86:87], v[88:89] op_sel_hi:[1,0]
    v_cvt_pk_bf16_f32 v16, v40, v41
    v_cvt_pk_bf16_f32 v17, v42, v43
    v_cvt_pk_bf16_f32 v18, v44, v45
    v_cvt_pk_bf16_f32 v19, v46, v47
    v_cvt_pk_bf16_f32 v20, v48, v49
    v_cvt_pk_bf16_f32 v21, v50, v51
    v_cvt_pk_bf16_f32 v22, v52, v53
    v_cvt_pk_bf16_f32 v23, v54, v55
    v_cvt_pk_bf16_f32 v24, v56, v57
    v_cvt_pk_bf16_f32 v25, v58, v59
    v_cvt_pk_bf16_f32 v26, v60, v61
    v_cvt_pk_bf16_f32 v27, v62, v63
    v_cvt_pk_bf16_f32 v28, v64, v65
    v_cvt_pk_bf16_f32 v29, v66, v67
    v_cvt_pk_bf16_f32 v30, v68, v69
    v_cvt_pk_bf16_f32 v31, v70, v71
    v_cvt_pk_bf16_f32 v32, v72, v73
    v_cvt_pk_bf16_f32 v33, v74, v75
    v_cvt_pk_bf16_f32 v34, v76, v77
    v_cvt_pk_bf16_f32 v35, v78, v79
    v_cvt_pk_bf16_f32 v36, v80, v81
    v_cvt_pk_bf16_f32 v37, v82, v83
    v_cvt_pk_bf16_f32 v38, v84, v85
    v_cvt_pk_bf16_f32 v39, v86, v87
    s_lshr_b32 s44, s43, 1
    s_mul_i32 s44, s44, 36864
    s_and_b32 s45, s43, 1
    s_lshl_b32 s45, s45, 7
    s_add_u32 s44, s44, s45
    s_add_u32 s45, s42, 0
    s_mul_i32 s50, s45, 2359296
    s_add_u32 s44, s44, s50
    s_add_u32 s44, s44, 0x320000
    s_add_u32 s50, s44, 0
    buffer_store_dwordx4 v[16:19], v4, s[8:11], s50 offen sc1
    buffer_store_dwordx4 v[36:39], v5, s[8:11], s50 offen sc1
    s_add_u32 s50, s44, 6144
    buffer_store_dwordx4 v[24:27], v4, s[8:11], s50 offen sc1
    buffer_store_dwordx4 v[28:31], v5, s[8:11], s50 offen sc1
    s_add_u32 s50, s44, 12288
    buffer_store_dwordx4 v[32:35], v4, s[8:11], s50 offen sc1
    buffer_store_dwordx4 v[20:23], v5, s[8:11], s50 offen sc1
    s_lshl_b32 s44, s45, 20
    s_lshl_b32 s45, s43, 7
    s_add_u32 s44, s44, s45
    s_add_u32 s44, s44, 0x1800000
    s_waitcnt vmcnt(0)
    s_barrier
    s_cmp_lg_u32 s32, 0
    s_cbranch_scc1 L_df_64
    v_mov_b32 v88, 1
    s_mov_b64 exec, 1
    buffer_store_dword v88, off, s[8:11], s44 offset:0 sc1
    s_mov_b64 exec, -1
L_df_64:
    s_add_u32 s43, s43, 74
    s_cmp_ge_u32 s43, 128
    s_cbranch_scc1 L_d_ln0done
    s_mul_i32 s44, s43, 18432
    buffer_load_dwordx4 v[16:19], v2, s[16:19], s44 offen offset:0
    buffer_load_dwordx4 v[20:23], v3, s[16:19], s44 offen offset:384
    buffer_load_dwordx4 v[24:27], v2, s[16:19], s44 offen offset:192
    buffer_load_dwordx4 v[28:31], v3, s[16:19], s44 offen offset:192
    buffer_load_dwordx4 v[32:35], v2, s[16:19], s44 offen offset:384
    buffer_load_dwordx4 v[36:39], v3, s[16:19], s44 offen offset:0
    s_branch L_d_ln0
L_d_ln0done:
    s_cmp_ge_u32 s32, 2
    s_cselect_b32 s44, 1, 0
    s_cmp_lg_u32 s46, 0
    s_mov_b32 s56, 0xbe800000
    s_cselect_b32 s56, 0x3e800000, s56
    s_cselect_b32 s57, 0, 0x3a638e39
    s_cselect_b32 s58, 0x3a638e39, 0
    s_cmp_lg_u32 s44, 0
    s_cselect_b32 s56, s56, 0
    s_cselect_b32 s59, 0x3f000000, 0
    s_and_b32 s45, s32, 1
    s_mul_i32 s45, s45, 144
    v_add_u32 v16, s45, v12
    v_lshlrev_b32 v17, 3, v13
    v_cvt_f32_u32 v17, v17
    v_cmp_eq_u32 vcc, 0, v16
    s_cmp_lg_u32 s46, 0
    s_cselect_b64 s[54:55], vcc, 0
    v_mov_b32 v18, 288
    v_cndmask_b32 v18, v16, v18, s[54:55]
    s_cmp_lg_u32 s44, 0
    s_cselect_b64 s[54:55], 0, s[54:55]
    v_mov_b32_e64 v19, 1.0
    v_cndmask_b32 v19, v19, 0, s[54:55]
    v_cmp_eq_u32 vcc, 0, v13
    s_cmp_lg_u32 s46, 0
    s_cselect_b64 s[54:55], 0, vcc
    v_lshlrev_b32 v20, 31, v12
    v_xor_b32 v20, s59, v20
    v_cvt_f32_u32 v21, v18
    v_mov_b32_e64 v22, s57
    v_fmac_f32 v22, 0x3ae38e39, v21
    v_mov_b32 v23, s56
    v_fmac_f32 v23, s58, v21
    v_fmac_f32 v23, v17, v22
    v_cos_f32 v24, v23
    v_fmamk_f32 v25, v22, 0x3f800000, v23
    v_cos_f32_e64 v25, v25
    v_fmamk_f32 v26, v22, 0x40000000, v23
    v_cos_f32_e64 v26, v26
    v_fmamk_f32 v27, v22, 0x40400000, v23
    v_cos_f32_e64 v27, v27
    v_fmamk_f32 v28, v22, 0x40800000, v23
    v_cos_f32_e64 v28, v28
    v_fmamk_f32 v29, v22, 0x40a00000, v23
    v_cos_f32_e64 v29, v29
    v_fmamk_f32 v30, v22, 0x40c00000, v23
    v_cos_f32_e64 v30, v30
    v_fmamk_f32 v31, v22, 0x40e00000, v23
    v_cos_f32 v31, v31
    v_mul_f32 v24, v19, v24
    v_mul_f32 v25, v19, v25
    v_mul_f32 v26, v19, v26
    v_mul_f32 v27, v19, v27
    v_mul_f32 v28, v19, v28
    v_mul_f32 v29, v19, v29
    v_mul_f32 v30, v19, v30
    v_mul_f32_e64 v31, v19, v31
    v_cndmask_b32 v24, v24, v20, s[54:55]
    v_cvt_pk_bf16_f32 v24, v24, v25
    v_accvgpr_write_b32 a0, v24
    v_cvt_pk_bf16_f32 v26, v26, v27
    v_accvgpr_write_b32 a1, v26
    v_cvt_pk_bf16_f32 v28, v28, v29
    v_accvgpr_write_b32 a2, v28
    v_cvt_pk_bf16_f32 v30, v30, v31
    v_accvgpr_write_b32 a3, v30
    v_fmamk_f32 v24, v22, 0x42000000, v23
    v_cos_f32_e64 v24, v24
    v_fmamk_f32 v25, v22, 0x42040000, v23
    v_cos_f32_e64 v25, v25
    v_fmamk_f32 v26, v22, 0x42080000, v23
    v_cos_f32_e64 v26, v26
    v_fmamk_f32 v27, v22, 0x420c0000, v23
    v_cos_f32_e64 v27, v27
    v_fmamk_f32 v28, v22, 0x42100000, v23
    v_cos_f32_e64 v28, v28
    v_fmamk_f32 v29, v22, 0x42140000, v23
    v_cos_f32_e64 v29, v29
    v_fmamk_f32 v30, v22, 0x42180000, v23
    v_cos_f32_e64 v30, v30
    v_fmamk_f32 v31, v22, 0x421c0000, v23
    v_cos_f32 v31, v31
    v_mul_f32 v24, v19, v24
    v_mul_f32 v25, v19, v25
    v_mul_f32 v26, v19, v26
    v_mul_f32 v27, v19, v27
    v_mul_f32 v28, v19, v28
    v_mul_f32 v29, v19, v29
    v_mul_f32 v30, v19, v30
    v_mul_f32_e64 v31, v19, v31
    v_cvt_pk_bf16_f32 v24, v24, v25
    v_accvgpr_write_b32 a4, v24
    v_cvt_pk_bf16_f32 v26, v26, v27
    v_accvgpr_write_b32 a5, v26
    v_cvt_pk_bf16_f32 v28, v28, v29
    v_accvgpr_write_b32 a6, v28
    v_cvt_pk_bf16_f32 v30, v30, v31
    v_accvgpr_write_b32 a7, v30
    v_fmamk_f32 v24, v22, 0x42800000, v23
    v_cos_f32_e64 v24, v24
    v_fmamk_f32 v25, v22, 0x42820000, v23
    v_cos_f32_e64 v25, v25
    v_fmamk_f32 v26, v22, 0x42840000, v23
    v_cos_f32_e64 v26, v26
    v_fmamk_f32 v27, v22, 0x42860000, v23
    v_cos_f32_e64 v27, v27
    v_fmamk_f32 v28, v22, 0x42880000, v23
    v_cos_f32_e64 v28, v28
    v_fmamk_f32 v29, v22, 0x428a0000, v23
    v_cos_f32_e64 v29, v29
    v_fmamk_f32 v30, v22, 0x428c0000, v23
    v_cos_f32_e64 v30, v30
    v_fmamk_f32 v31, v22, 0x428e0000, v23
    v_cos_f32 v31, v31
    v_mul_f32 v24, v19, v24
    v_mul_f32 v25, v19, v25
    v_mul_f32 v26, v19, v26
    v_mul_f32 v27, v19, v27
    v_mul_f32 v28, v19, v28
    v_mul_f32 v29, v19, v29
    v_mul_f32 v30, v19, v30
    v_mul_f32_e64 v31, v19, v31
    v_cvt_pk_bf16_f32 v24, v24, v25
    v_accvgpr_write_b32 a8, v24
    v_cvt_pk_bf16_f32 v26, v26, v27
    v_accvgpr_write_b32 a9, v26
    v_cvt_pk_bf16_f32 v28, v28, v29
    v_accvgpr_write_b32 a10, v28
    v_cvt_pk_bf16_f32 v30, v30, v31
    v_accvgpr_write_b32 a11, v30
    v_fmamk_f32 v24, v22, 0x42c00000, v23
    v_cos_f32_e64 v24, v24
    v_fmamk_f32 v25, v22, 0x42c20000, v23
    v_cos_f32_e64 v25, v25
    v_fmamk_f32 v26, v22, 0x42c40000, v23
    v_cos_f32_e64 v26, v26
    v_fmamk_f32 v27, v22, 0x42c60000, v23
    v_cos_f32_e64 v27, v27
    v_fmamk_f32 v28, v22, 0x42c80000, v23
    v_cos_f32_e64 v28, v28
    v_fmamk_f32 v29, v22, 0x42ca0000, v23
    v_cos_f32_e64 v29, v29
    v_fmamk_f32 v30, v22, 0x42cc0000, v23
    v_cos_f32_e64 v30, v30
    v_fmamk_f32 v31, v22, 0x42ce0000, v23
    v_cos_f32 v31, v31
    v_mul_f32 v24, v19, v24
    v_mul_f32 v25, v19, v25
    v_mul_f32 v26, v19, v26
    v_mul_f32 v27, v19, v27
    v_mul_f32 v28, v19, v28
    v_mul_f32 v29, v19, v29
    v_mul_f32 v30, v19, v30
    v_mul_f32_e64 v31, v19, v31
    v_cvt_pk_bf16_f32 v24, v24, v25
    v_accvgpr_write_b32 a12, v24
    v_cvt_pk_bf16_f32 v26, v26, v27
    v_accvgpr_write_b32 a13, v26
    v_cvt_pk_bf16_f32 v28, v28, v29
    v_accvgpr_write_b32 a14, v28
    v_cvt_pk_bf16_f32 v30, v30, v31
    v_accvgpr_write_b32 a15, v30
    v_fmamk_f32 v24, v22, 0x43000000, v23
    v_cos_f32_e64 v24, v24
    v_fmamk_f32 v25, v22, 0x43010000, v23
    v_cos_f32_e64 v25, v25
    v_fmamk_f32 v26, v22, 0x43020000, v23
    v_cos_f32_e64 v26, v26
    v_fmamk_f32 v27, v22, 0x43030000, v23
    v_cos_f32_e64 v27, v27
    v_fmamk_f32 v28, v22, 0x43040000, v23
    v_cos_f32_e64 v28, v28
    v_fmamk_f32 v29, v22, 0x43050000, v23
    v_cos_f32_e64 v29, v29
    v_fmamk_f32 v30, v22, 0x43060000, v23
    v_cos_f32_e64 v30, v30
    v_fmamk_f32 v31, v22, 0x43070000, v23
    v_cos_f32 v31, v31
    v_mul_f32 v24, v19, v24
    v_mul_f32 v25, v19, v25
    v_mul_f32 v26, v19, v26
    v_mul_f32 v27, v19, v27
    v_mul_f32 v28, v19, v28
    v_mul_f32 v29, v19, v29
    v_mul_f32 v30, v19, v30
    v_mul_f32_e64 v31, v19, v31
    v_cvt_pk_bf16_f32 v24, v24, v25
    v_accvgpr_write_b32 a16, v24
    v_cvt_pk_bf16_f32 v26, v26, v27
    v_accvgpr_write_b32 a17, v26
    v_cvt_pk_bf16_f32 v28, v28, v29
    v_accvgpr_write_b32 a18, v28
    v_cvt_pk_bf16_f32 v30, v30, v31
    v_accvgpr_write_b32 a19, v30
    v_fmamk_f32 v24, v22, 0x43200000, v23
    v_cos_f32_e64 v24, v24
    v_fmamk_f32 v25, v22, 0x43210000, v23
    v_cos_f32_e64 v25, v25
    v_fmamk_f32 v26, v22, 0x43220000, v23
    v_cos_f32_e64 v26, v26
    v_fmamk_f32 v27, v22, 0x43230000, v23
    v_cos_f32_e64 v27, v27
    v_fmamk_f32 v28, v22, 0x43240000, v23
    v_cos_f32_e64 v28, v28
    v_fmamk_f32 v29, v22, 0x43250000, v23
    v_cos_f32_e64 v29, v29
    v_fmamk_f32 v30, v22, 0x43260000, v23
    v_cos_f32_e64 v30, v30
    v_fmamk_f32 v31, v22, 0x43270000, v23
    v_cos_f32 v31, v31
    v_mul_f32 v24, v19, v24
    v_mul_f32 v25, v19, v25
    v_mul_f32 v26, v19, v26
    v_mul_f32 v27, v19, v27
    v_mul_f32 v28, v19, v28
    v_mul_f32 v29, v19, v29
    v_mul_f32 v30, v19, v30
    v_mul_f32_e64 v31, v19, v31
    v_cvt_pk_bf16_f32 v24, v24, v25
    v_accvgpr_write_b32 a20, v24
    v_cvt_pk_bf16_f32 v26, v26, v27
    v_accvgpr_write_b32 a21, v26
    v_cvt_pk_bf16_f32 v28, v28, v29
    v_accvgpr_write_b32 a22, v28
    v_cvt_pk_bf16_f32 v30, v30, v31
    v_accvgpr_write_b32 a23, v30
    v_fmamk_f32 v24, v22, 0x43400000, v23
    v_cos_f32_e64 v24, v24
    v_fmamk_f32 v25, v22, 0x43410000, v23
    v_cos_f32_e64 v25, v25
    v_fmamk_f32 v26, v22, 0x43420000, v23
    v_cos_f32_e64 v26, v26
    v_fmamk_f32 v27, v22, 0x43430000, v23
    v_cos_f32_e64 v27, v27
    v_fmamk_f32 v28, v22, 0x43440000, v23
    v_cos_f32_e64 v28, v28
    v_fmamk_f32 v29, v22, 0x43450000, v23
    v_cos_f32_e64 v29, v29
    v_fmamk_f32 v30, v22, 0x43460000, v23
    v_cos_f32_e64 v30, v30
    v_fmamk_f32 v31, v22, 0x43470000, v23
    v_cos_f32 v31, v31
    v_mul_f32 v24, v19, v24
    v_mul_f32 v25, v19, v25
    v_mul_f32 v26, v19, v26
    v_mul_f32 v27, v19, v27
    v_mul_f32 v28, v19, v28
    v_mul_f32 v29, v19, v29
    v_mul_f32 v30, v19, v30
    v_mul_f32_e64 v31, v19, v31
    v_cvt_pk_bf16_f32 v24, v24, v25
    v_accvgpr_write_b32 a24, v24
    v_cvt_pk_bf16_f32 v26, v26, v27
    v_accvgpr_write_b32 a25, v26
    v_cvt_pk_bf16_f32 v28, v28, v29
    v_accvgpr_write_b32 a26, v28
    v_cvt_pk_bf16_f32 v30, v30, v31
    v_accvgpr_write_b32 a27, v30
    v_fmamk_f32 v24, v22, 0x43600000, v23
    v_cos_f32_e64 v24, v24
    v_fmamk_f32 v25, v22, 0x43610000, v23
    v_cos_f32_e64 v25, v25
    v_fmamk_f32 v26, v22, 0x43620000, v23
    v_cos_f32_e64 v26, v26
    v_fmamk_f32 v27, v22, 0x43630000, v23
    v_cos_f32_e64 v27, v27
    v_fmamk_f32 v28, v22, 0x43640000, v23
    v_cos_f32_e64 v28, v28
    v_fmamk_f32 v29, v22, 0x43650000, v23
    v_cos_f32_e64 v29, v29
    v_fmamk_f32 v30, v22, 0x43660000, v23
    v_cos_f32_e64 v30, v30
    v_fmamk_f32 v31, v22, 0x43670000, v23
    v_cos_f32 v31, v31
    v_mul_f32 v24, v19, v24
    v_mul_f32 v25, v19, v25
    v_mul_f32 v26, v19, v26
    v_mul_f32 v27, v19, v27
    v_mul_f32 v28, v19, v28
    v_mul_f32 v29, v19, v29
    v_mul_f32 v30, v19, v30
    v_mul_f32_e64 v31, v19, v31
    v_cvt_pk_bf16_f32 v24, v24, v25
    v_accvgpr_write_b32 a28, v24
    v_cvt_pk_bf16_f32 v26, v26, v27
    v_accvgpr_write_b32 a29, v26
    v_cvt_pk_bf16_f32 v28, v28, v29
    v_accvgpr_write_b32 a30, v28
    v_cvt_pk_bf16_f32 v30, v30, v31
    v_accvgpr_write_b32 a31, v30
    v_fmamk_f32 v24, v22, 0x43800000, v23
    v_cos_f32_e64 v24, v24
    v_fmamk_f32 v25, v22, 0x43808000, v23
    v_cos_f32_e64 v25, v25
    v_fmamk_f32 v26, v22, 0x43810000, v23
    v_cos_f32_e64 v26, v26
    v_fmamk_f32 v27, v22, 0x43818000, v23
    v_cos_f32_e64 v27, v27
    v_fmamk_f32 v28, v22, 0x43820000, v23
    v_cos_f32_e64 v28, v28
    v_fmamk_f32 v29, v22, 0x43828000, v23
    v_cos_f32_e64 v29, v29
    v_fmamk_f32 v30, v22, 0x43830000, v23
    v_cos_f32_e64 v30, v30
    v_fmamk_f32 v31, v22, 0x43838000, v23
    v_cos_f32 v31, v31
    v_mul_f32 v24, v19, v24
    v_mul_f32 v25, v19, v25
    v_mul_f32 v26, v19, v26
    v_mul_f32 v27, v19, v27
    v_mul_f32 v28, v19, v28
    v_mul_f32 v29, v19, v29
    v_mul_f32 v30, v19, v30
    v_mul_f32_e64 v31, v19, v31
    v_cvt_pk_bf16_f32 v24, v24, v25
    v_accvgpr_write_b32 a32, v24
    v_cvt_pk_bf16_f32 v26, v26, v27
    v_accvgpr_write_b32 a33, v26
    v_cvt_pk_bf16_f32 v28, v28, v29
    v_accvgpr_write_b32 a34, v28
    v_cvt_pk_bf16_f32 v30, v30, v31
    v_accvgpr_write_b32 a35, v30
    v_add_u32 v21, 16, v16
    v_cvt_f32_u32 v21, v21
    v_mov_b32_e64 v22, s57
    v_fmac_f32 v22, 0x3ae38e39, v21
    v_mov_b32 v23, s56
    v_fmac_f32 v23, s58, v21
    v_fmac_f32 v23, v17, v22
    v_cos_f32 v24, v23
    v_fmamk_f32 v25, v22, 0x3f800000, v23
    v_cos_f32_e64 v25, v25
    v_fmamk_f32 v26, v22, 0x40000000, v23
    v_cos_f32_e64 v26, v26
    v_fmamk_f32 v27, v22, 0x40400000, v23
    v_cos_f32_e64 v27, v27
    v_fmamk_f32 v28, v22, 0x40800000, v23
    v_cos_f32_e64 v28, v28
    v_fmamk_f32 v29, v22, 0x40a00000, v23
    v_cos_f32_e64 v29, v29
    v_fmamk_f32 v30, v22, 0x40c00000, v23
    v_cos_f32_e64 v30, v30
    v_fmamk_f32 v31, v22, 0x40e00000, v23
    v_cos_f32_e64 v31, v31
    v_cndmask_b32 v24, v24, v20, s[54:55]
    v_cvt_pk_bf16_f32 v24, v24, v25
    v_accvgpr_write_b32 a36, v24
    v_cvt_pk_bf16_f32 v26, v26, v27
    v_accvgpr_write_b32 a37, v26
    v_cvt_pk_bf16_f32 v28, v28, v29
    v_accvgpr_write_b32 a38, v28
    v_cvt_pk_bf16_f32 v30, v30, v31
    v_accvgpr_write_b32 a39, v30
    v_fmamk_f32 v24, v22, 0x42000000, v23
    v_cos_f32_e64 v24, v24
    v_fmamk_f32 v25, v22, 0x42040000, v23
    v_cos_f32_e64 v25, v25
    v_fmamk_f32 v26, v22, 0x42080000, v23
    v_cos_f32_e64 v26, v26
    v_fmamk_f32 v27, v22, 0x420c0000, v23
    v_cos_f32_e64 v27, v27
    v_fmamk_f32 v28, v22, 0x42100000, v23
    v_cos_f32_e64 v28, v28
    v_fmamk_f32 v29, v22, 0x42140000, v23
    v_cos_f32_e64 v29, v29
    v_fmamk_f32 v30, v22, 0x42180000, v23
    v_cos_f32_e64 v30, v30
    v_fmamk_f32 v31, v22, 0x421c0000, v23
    v_cos_f32_e64 v31, v31
    v_cvt_pk_bf16_f32 v24, v24, v25
    v_accvgpr_write_b32 a40, v24
    v_cvt_pk_bf16_f32 v26, v26, v27
    v_accvgpr_write_b32 a41, v26
    v_cvt_pk_bf16_f32 v28, v28, v29
    v_accvgpr_write_b32 a42, v28
    v_cvt_pk_bf16_f32 v30, v30, v31
    v_accvgpr_write_b32 a43, v30
    v_fmamk_f32 v24, v22, 0x42800000, v23
    v_cos_f32_e64 v24, v24
    v_fmamk_f32 v25, v22, 0x42820000, v23
    v_cos_f32_e64 v25, v25
    v_fmamk_f32 v26, v22, 0x42840000, v23
    v_cos_f32_e64 v26, v26
    v_fmamk_f32 v27, v22, 0x42860000, v23
    v_cos_f32_e64 v27, v27
    v_fmamk_f32 v28, v22, 0x42880000, v23
    v_cos_f32_e64 v28, v28
    v_fmamk_f32 v29, v22, 0x428a0000, v23
    v_cos_f32_e64 v29, v29
    v_fmamk_f32 v30, v22, 0x428c0000, v23
    v_cos_f32_e64 v30, v30
    v_fmamk_f32 v31, v22, 0x428e0000, v23
    v_cos_f32_e64 v31, v31
    v_cvt_pk_bf16_f32 v24, v24, v25
    v_accvgpr_write_b32 a44, v24
    v_cvt_pk_bf16_f32 v26, v26, v27
    v_accvgpr_write_b32 a45, v26
    v_cvt_pk_bf16_f32 v28, v28, v29
    v_accvgpr_write_b32 a46, v28
    v_cvt_pk_bf16_f32 v30, v30, v31
    v_accvgpr_write_b32 a47, v30
    v_fmamk_f32 v24, v22, 0x42c00000, v23
    v_cos_f32_e64 v24, v24
    v_fmamk_f32 v25, v22, 0x42c20000, v23
    v_cos_f32_e64 v25, v25
    v_fmamk_f32 v26, v22, 0x42c40000, v23
    v_cos_f32_e64 v26, v26
    v_fmamk_f32 v27, v22, 0x42c60000, v23
    v_cos_f32_e64 v27, v27
    v_fmamk_f32 v28, v22, 0x42c80000, v23
    v_cos_f32_e64 v28, v28
    v_fmamk_f32 v29, v22, 0x42ca0000, v23
    v_cos_f32_e64 v29, v29
    v_fmamk_f32 v30, v22, 0x42cc0000, v23
    v_cos_f32_e64 v30, v30
    v_fmamk_f32 v31, v22, 0x42ce0000, v23
    v_cos_f32_e64 v31, v31
    v_cvt_pk_bf16_f32 v24, v24, v25
    v_accvgpr_write_b32 a48, v24
    v_cvt_pk_bf16_f32 v26, v26, v27
    v_accvgpr_write_b32 a49, v26
    v_cvt_pk_bf16_f32 v28, v28, v29
    v_accvgpr_write_b32 a50, v28
    v_cvt_pk_bf16_f32 v30, v30, v31
    v_accvgpr_write_b32 a51, v30
    v_fmamk_f32 v24, v22, 0x43000000, v23
    v_cos_f32_e64 v24, v24
    v_fmamk_f32 v25, v22, 0x43010000, v23
    v_cos_f32_e64 v25, v25
    v_fmamk_f32 v26, v22, 0x43020000, v23
    v_cos_f32_e64 v26, v26
    v_fmamk_f32 v27, v22, 0x43030000, v23
    v_cos_f32_e64 v27, v27
    v_fmamk_f32 v28, v22, 0x43040000, v23
    v_cos_f32_e64 v28, v28
    v_fmamk_f32 v29, v22, 0x43050000, v23
    v_cos_f32_e64 v29, v29
    v_fmamk_f32 v30, v22, 0x43060000, v23
    v_cos_f32_e64 v30, v30
    v_fmamk_f32 v31, v22, 0x43070000, v23
    v_cos_f32_e64 v31, v31
    v_cvt_pk_bf16_f32 v24, v24, v25
    v_accvgpr_write_b32 a52, v24
    v_cvt_pk_bf16_f32 v26, v26, v27
    v_accvgpr_write_b32 a53, v26
    v_cvt_pk_bf16_f32 v28, v28, v29
    v_accvgpr_write_b32 a54, v28
    v_cvt_pk_bf16_f32 v30, v30, v31
    v_accvgpr_write_b32 a55, v30
    v_fmamk_f32 v24, v22, 0x43200000, v23
    v_cos_f32_e64 v24, v24
    v_fmamk_f32 v25, v22, 0x43210000, v23
    v_cos_f32_e64 v25, v25
    v_fmamk_f32 v26, v22, 0x43220000, v23
    v_cos_f32_e64 v26, v26
    v_fmamk_f32 v27, v22, 0x43230000, v23
    v_cos_f32_e64 v27, v27
    v_fmamk_f32 v28, v22, 0x43240000, v23
    v_cos_f32_e64 v28, v28
    v_fmamk_f32 v29, v22, 0x43250000, v23
    v_cos_f32_e64 v29, v29
    v_fmamk_f32 v30, v22, 0x43260000, v23
    v_cos_f32_e64 v30, v30
    v_fmamk_f32 v31, v22, 0x43270000, v23
    v_cos_f32_e64 v31, v31
    v_cvt_pk_bf16_f32 v24, v24, v25
    v_accvgpr_write_b32 a56, v24
    v_cvt_pk_bf16_f32 v26, v26, v27
    v_accvgpr_write_b32 a57, v26
    v_cvt_pk_bf16_f32 v28, v28, v29
    v_accvgpr_write_b32 a58, v28
    v_cvt_pk_bf16_f32 v30, v30, v31
    v_accvgpr_write_b32 a59, v30
    v_fmamk_f32 v24, v22, 0x43400000, v23
    v_cos_f32_e64 v24, v24
    v_fmamk_f32 v25, v22, 0x43410000, v23
    v_cos_f32_e64 v25, v25
    v_fmamk_f32 v26, v22, 0x43420000, v23
    v_cos_f32_e64 v26, v26
    v_fmamk_f32 v27, v22, 0x43430000, v23
    v_cos_f32_e64 v27, v27
    v_fmamk_f32 v28, v22, 0x43440000, v23
    v_cos_f32_e64 v28, v28
    v_fmamk_f32 v29, v22, 0x43450000, v23
    v_cos_f32_e64 v29, v29
    v_fmamk_f32 v30, v22, 0x43460000, v23
    v_cos_f32_e64 v30, v30
    v_fmamk_f32 v31, v22, 0x43470000, v23
    v_cos_f32_e64 v31, v31
    v_cvt_pk_bf16_f32 v24, v24, v25
    v_accvgpr_write_b32 a60, v24
    v_cvt_pk_bf16_f32 v26, v26, v27
    v_accvgpr_write_b32 a61, v26
    v_cvt_pk_bf16_f32 v28, v28, v29
    v_accvgpr_write_b32 a62, v28
    v_cvt_pk_bf16_f32 v30, v30, v31
    v_accvgpr_write_b32 a63, v30
    v_fmamk_f32 v24, v22, 0x43600000, v23
    v_cos_f32_e64 v24, v24
    v_fmamk_f32 v25, v22, 0x43610000, v23
    v_cos_f32_e64 v25, v25
    v_fmamk_f32 v26, v22, 0x43620000, v23
    v_cos_f32_e64 v26, v26
    v_fmamk_f32 v27, v22, 0x43630000, v23
    v_cos_f32_e64 v27, v27
    v_fmamk_f32 v28, v22, 0x43640000, v23
    v_cos_f32_e64 v28, v28
    v_fmamk_f32 v29, v22, 0x43650000, v23
    v_cos_f32_e64 v29, v29
    v_fmamk_f32 v30, v22, 0x43660000, v23
    v_cos_f32_e64 v30, v30
    v_fmamk_f32 v31, v22, 0x43670000, v23
    v_cos_f32_e64 v31, v31
    v_cvt_pk_bf16_f32 v24, v24, v25
    v_accvgpr_write_b32 a64, v24
    v_cvt_pk_bf16_f32 v26, v26, v27
    v_accvgpr_write_b32 a65, v26
    v_cvt_pk_bf16_f32 v28, v28, v29
    v_accvgpr_write_b32 a66, v28
    v_cvt_pk_bf16_f32 v30, v30, v31
    v_accvgpr_write_b32 a67, v30
    v_fmamk_f32 v24, v22, 0x43800000, v23
    v_cos_f32_e64 v24, v24
    v_fmamk_f32 v25, v22, 0x43808000, v23
    v_cos_f32_e64 v25, v25
    v_fmamk_f32 v26, v22, 0x43810000, v23
    v_cos_f32_e64 v26, v26
    v_fmamk_f32 v27, v22, 0x43818000, v23
    v_cos_f32_e64 v27, v27
    v_fmamk_f32 v28, v22, 0x43820000, v23
    v_cos_f32_e64 v28, v28
    v_fmamk_f32 v29, v22, 0x43828000, v23
    v_cos_f32_e64 v29, v29
    v_fmamk_f32 v30, v22, 0x43830000, v23
    v_cos_f32_e64 v30, v30
    v_fmamk_f32 v31, v22, 0x43838000, v23
    v_cos_f32_e64 v31, v31
    v_cvt_pk_bf16_f32 v24, v24, v25
    v_accvgpr_write_b32 a68, v24
    v_cvt_pk_bf16_f32 v26, v26, v27
    v_accvgpr_write_b32 a69, v26
    v_cvt_pk_bf16_f32 v28, v28, v29
    v_accvgpr_write_b32 a70, v28
    v_cvt_pk_bf16_f32 v30, v30, v31
    v_accvgpr_write_b32 a71, v30
    v_add_u32 v21, 32, v16
    v_cvt_f32_u32 v21, v21
    v_mov_b32_e64 v22, s57
    v_fmac_f32 v22, 0x3ae38e39, v21
    v_mov_b32 v23, s56
    v_fmac_f32 v23, s58, v21
    v_fmac_f32 v23, v17, v22
    v_cos_f32 v24, v23
    v_fmamk_f32 v25, v22, 0x3f800000, v23
    v_cos_f32_e64 v25, v25
    v_fmamk_f32 v26, v22, 0x40000000, v23
    v_cos_f32_e64 v26, v26
    v_fmamk_f32 v27, v22, 0x40400000, v23
    v_cos_f32_e64 v27, v27
    v_fmamk_f32 v28, v22, 0x40800000, v23
    v_cos_f32_e64 v28, v28
    v_fmamk_f32 v29, v22, 0x40a00000, v23
    v_cos_f32_e64 v29, v29
    v_fmamk_f32 v30, v22, 0x40c00000, v23
    v_cos_f32_e64 v30, v30
    v_fmamk_f32 v31, v22, 0x40e00000, v23
    v_cos_f32_e64 v31, v31
    v_cndmask_b32 v24, v24, v20, s[54:55]
    v_cvt_pk_bf16_f32 v24, v24, v25
    v_accvgpr_write_b32 a72, v24
    v_cvt_pk_bf16_f32 v26, v26, v27
    v_accvgpr_write_b32 a73, v26
    v_cvt_pk_bf16_f32 v28, v28, v29
    v_accvgpr_write_b32 a74, v28
    v_cvt_pk_bf16_f32 v30, v30, v31
    v_accvgpr_write_b32 a75, v30
    v_fmamk_f32 v24, v22, 0x42000000, v23
    v_cos_f32_e64 v24, v24
    v_fmamk_f32 v25, v22, 0x42040000, v23
    v_cos_f32_e64 v25, v25
    v_fmamk_f32 v26, v22, 0x42080000, v23
    v_cos_f32_e64 v26, v26
    v_fmamk_f32 v27, v22, 0x420c0000, v23
    v_cos_f32_e64 v27, v27
    v_fmamk_f32 v28, v22, 0x42100000, v23
    v_cos_f32_e64 v28, v28
    v_fmamk_f32 v29, v22, 0x42140000, v23
    v_cos_f32_e64 v29, v29
    v_fmamk_f32 v30, v22, 0x42180000, v23
    v_cos_f32_e64 v30, v30
    v_fmamk_f32 v31, v22, 0x421c0000, v23
    v_cos_f32_e64 v31, v31
    v_cvt_pk_bf16_f32 v24, v24, v25
    v_accvgpr_write_b32 a76, v24
    v_cvt_pk_bf16_f32 v26, v26, v27
    v_accvgpr_write_b32 a77, v26
    v_cvt_pk_bf16_f32 v28, v28, v29
    v_accvgpr_write_b32 a78, v28
    v_cvt_pk_bf16_f32 v30, v30, v31
    v_accvgpr_write_b32 a79, v30
    v_fmamk_f32 v24, v22, 0x42800000, v23
    v_cos_f32_e64 v24, v24
    v_fmamk_f32 v25, v22, 0x42820000, v23
    v_cos_f32_e64 v25, v25
    v_fmamk_f32 v26, v22, 0x42840000, v23
    v_cos_f32_e64 v26, v26
    v_fmamk_f32 v27, v22, 0x42860000, v23
    v_cos_f32_e64 v27, v27
    v_fmamk_f32 v28, v22, 0x42880000, v23
    v_cos_f32_e64 v28, v28
    v_fmamk_f32 v29, v22, 0x428a0000, v23
    v_cos_f32_e64 v29, v29
    v_fmamk_f32 v30, v22, 0x428c0000, v23
    v_cos_f32_e64 v30, v30
    v_fmamk_f32 v31, v22, 0x428e0000, v23
    v_cos_f32_e64 v31, v31
    v_cvt_pk_bf16_f32 v24, v24, v25
    v_accvgpr_write_b32 a80, v24
    v_cvt_pk_bf16_f32 v26, v26, v27
    v_accvgpr_write_b32 a81, v26
    v_cvt_pk_bf16_f32 v28, v28, v29
    v_accvgpr_write_b32 a82, v28
    v_cvt_pk_bf16_f32 v30, v30, v31
    v_accvgpr_write_b32 a83, v30
    v_fmamk_f32 v24, v22, 0x42c00000, v23
    v_cos_f32_e64 v24, v24
    v_fmamk_f32 v25, v22, 0x42c20000, v23
    v_cos_f32_e64 v25, v25
    v_fmamk_f32 v26, v22, 0x42c40000, v23
    v_cos_f32_e64 v26, v26
    v_fmamk_f32 v27, v22, 0x42c60000, v23
    v_cos_f32_e64 v27, v27
    v_fmamk_f32 v28, v22, 0x42c80000, v23
    v_cos_f32_e64 v28, v28
    v_fmamk_f32 v29, v22, 0x42ca0000, v23
    v_cos_f32_e64 v29, v29
    v_fmamk_f32 v30, v22, 0x42cc0000, v23
    v_cos_f32_e64 v30, v30
    v_fmamk_f32 v31, v22, 0x42ce0000, v23
    v_cos_f32_e64 v31, v31
    v_cvt_pk_bf16_f32 v24, v24, v25
    v_accvgpr_write_b32 a84, v24
    v_cvt_pk_bf16_f32 v26, v26, v27
    v_accvgpr_write_b32 a85, v26
    v_cvt_pk_bf16_f32 v28, v28, v29
    v_accvgpr_write_b32 a86, v28
    v_cvt_pk_bf16_f32 v30, v30, v31
    v_accvgpr_write_b32 a87, v30
    v_fmamk_f32 v24, v22, 0x43000000, v23
    v_cos_f32_e64 v24, v24
    v_fmamk_f32 v25, v22, 0x43010000, v23
    v_cos_f32_e64 v25, v25
    v_fmamk_f32 v26, v22, 0x43020000, v23
    v_cos_f32_e64 v26, v26
    v_fmamk_f32 v27, v22, 0x43030000, v23
    v_cos_f32_e64 v27, v27
    v_fmamk_f32 v28, v22, 0x43040000, v23
    v_cos_f32_e64 v28, v28
    v_fmamk_f32 v29, v22, 0x43050000, v23
    v_cos_f32_e64 v29, v29
    v_fmamk_f32 v30, v22, 0x43060000, v23
    v_cos_f32_e64 v30, v30
    v_fmamk_f32 v31, v22, 0x43070000, v23
    v_cos_f32_e64 v31, v31
    v_cvt_pk_bf16_f32 v24, v24, v25
    v_accvgpr_write_b32 a88, v24
    v_cvt_pk_bf16_f32 v26, v26, v27
    v_accvgpr_write_b32 a89, v26
    v_cvt_pk_bf16_f32 v28, v28, v29
    v_accvgpr_write_b32 a90, v28
    v_cvt_pk_bf16_f32 v30, v30, v31
    v_accvgpr_write_b32 a91, v30
    v_fmamk_f32 v24, v22, 0x43200000, v23
    v_cos_f32_e64 v24, v24
    v_fmamk_f32 v25, v22, 0x43210000, v23
    v_cos_f32_e64 v25, v25
    v_fmamk_f32 v26, v22, 0x43220000, v23
    v_cos_f32_e64 v26, v26
    v_fmamk_f32 v27, v22, 0x43230000, v23
    v_cos_f32_e64 v27, v27
    v_fmamk_f32 v28, v22, 0x43240000, v23
    v_cos_f32_e64 v28, v28
    v_fmamk_f32 v29, v22, 0x43250000, v23
    v_cos_f32_e64 v29, v29
    v_fmamk_f32 v30, v22, 0x43260000, v23
    v_cos_f32_e64 v30, v30
    v_fmamk_f32 v31, v22, 0x43270000, v23
    v_cos_f32_e64 v31, v31
    v_cvt_pk_bf16_f32 v24, v24, v25
    v_accvgpr_write_b32 a92, v24
    v_cvt_pk_bf16_f32 v26, v26, v27
    v_accvgpr_write_b32 a93, v26
    v_cvt_pk_bf16_f32 v28, v28, v29
    v_accvgpr_write_b32 a94, v28
    v_cvt_pk_bf16_f32 v30, v30, v31
    v_accvgpr_write_b32 a95, v30
    v_fmamk_f32 v24, v22, 0x43400000, v23
    v_cos_f32_e64 v24, v24
    v_fmamk_f32 v25, v22, 0x43410000, v23
    v_cos_f32_e64 v25, v25
    v_fmamk_f32 v26, v22, 0x43420000, v23
    v_cos_f32_e64 v26, v26
    v_fmamk_f32 v27, v22, 0x43430000, v23
    v_cos_f32_e64 v27, v27
    v_fmamk_f32 v28, v22, 0x43440000, v23
    v_cos_f32_e64 v28, v28
    v_fmamk_f32 v29, v22, 0x43450000, v23
    v_cos_f32_e64 v29, v29
    v_fmamk_f32 v30, v22, 0x43460000, v23
    v_cos_f32_e64 v30, v30
    v_fmamk_f32 v31, v22, 0x43470000, v23
    v_cos_f32_e64 v31, v31
    v_cvt_pk_bf16_f32 v24, v24, v25
    v_accvgpr_write_b32 a96, v24
    v_cvt_pk_bf16_f32 v26, v26, v27
    v_accvgpr_write_b32 a97, v26
    v_cvt_pk_bf16_f32 v28, v28, v29
    v_accvgpr_write_b32 a98, v28
    v_cvt_pk_bf16_f32 v30, v30, v31
    v_accvgpr_write_b32 a99, v30
    v_fmamk_f32 v24, v22, 0x43600000, v23
    v_cos_f32_e64 v24, v24
    v_fmamk_f32 v25, v22, 0x43610000, v23
    v_cos_f32_e64 v25, v25
    v_fmamk_f32 v26, v22, 0x43620000, v23
    v_cos_f32_e64 v26, v26
    v_fmamk_f32 v27, v22, 0x43630000, v23
    v_cos_f32_e64 v27, v27
    v_fmamk_f32 v28, v22, 0x43640000, v23
    v_cos_f32_e64 v28, v28
    v_fmamk_f32 v29, v22, 0x43650000, v23
    v_cos_f32_e64 v29, v29
    v_fmamk_f32 v30, v22, 0x43660000, v23
    v_cos_f32_e64 v30, v30
    v_fmamk_f32 v31, v22, 0x43670000, v23
    v_cos_f32_e64 v31, v31
    v_cvt_pk_bf16_f32 v24, v24, v25
    v_accvgpr_write_b32 a100, v24
    v_cvt_pk_bf16_f32 v26, v26, v27
    v_accvgpr_write_b32 a101, v26
    v_cvt_pk_bf16_f32 v28, v28, v29
    v_accvgpr_write_b32 a102, v28
    v_cvt_pk_bf16_f32 v30, v30, v31
    v_accvgpr_write_b32 a103, v30
    v_fmamk_f32 v24, v22, 0x43800000, v23
    v_cos_f32_e64 v24, v24
    v_fmamk_f32 v25, v22, 0x43808000, v23
    v_cos_f32_e64 v25, v25
    v_fmamk_f32 v26, v22, 0x43810000, v23
    v_cos_f32_e64 v26, v26
    v_fmamk_f32 v27, v22, 0x43818000, v23
    v_cos_f32_e64 v27, v27
    v_fmamk_f32 v28, v22, 0x43820000, v23
    v_cos_f32_e64 v28, v28
    v_fmamk_f32 v29, v22, 0x43828000, v23
    v_cos_f32_e64 v29, v29
    v_fmamk_f32 v30, v22, 0x43830000, v23
    v_cos_f32_e64 v30, v30
    v_fmamk_f32 v31, v22, 0x43838000, v23
    v_cos_f32_e64 v31, v31
    v_cvt_pk_bf16_f32 v24, v24, v25
    v_accvgpr_write_b32 a104, v24
    v_cvt_pk_bf16_f32 v26, v26, v27
    v_accvgpr_write_b32 a105, v26
    v_cvt_pk_bf16_f32 v28, v28, v29
    v_accvgpr_write_b32 a106, v28
    v_cvt_pk_bf16_f32 v30, v30, v31
    v_accvgpr_write_b32 a107, v30
    v_add_u32 v21, 48, v16
    v_cvt_f32_u32 v21, v21
    v_mov_b32_e64 v22, s57
    v_fmac_f32 v22, 0x3ae38e39, v21
    v_mov_b32 v23, s56
    v_fmac_f32 v23, s58, v21
    v_fmac_f32 v23, v17, v22
    v_cos_f32 v24, v23
    v_fmamk_f32 v25, v22, 0x3f800000, v23
    v_cos_f32_e64 v25, v25
    v_fmamk_f32 v26, v22, 0x40000000, v23
    v_cos_f32_e64 v26, v26
    v_fmamk_f32 v27, v22, 0x40400000, v23
    v_cos_f32_e64 v27, v27
    v_fmamk_f32 v28, v22, 0x40800000, v23
    v_cos_f32_e64 v28, v28
    v_fmamk_f32 v29, v22, 0x40a00000, v23
    v_cos_f32_e64 v29, v29
    v_fmamk_f32 v30, v22, 0x40c00000, v23
    v_cos_f32_e64 v30, v30
    v_fmamk_f32 v31, v22, 0x40e00000, v23
    v_cos_f32_e64 v31, v31
    v_cndmask_b32 v24, v24, v20, s[54:55]
    v_cvt_pk_bf16_f32 v24, v24, v25
    v_accvgpr_write_b32 a108, v24
    v_cvt_pk_bf16_f32 v26, v26, v27
    v_accvgpr_write_b32 a109, v26
    v_cvt_pk_bf16_f32 v28, v28, v29
    v_accvgpr_write_b32 a110, v28
    v_cvt_pk_bf16_f32 v30, v30, v31
    v_accvgpr_write_b32 a111, v30
    v_fmamk_f32 v24, v22, 0x42000000, v23
    v_cos_f32_e64 v24, v24
    v_fmamk_f32 v25, v22, 0x42040000, v23
    v_cos_f32_e64 v25, v25
    v_fmamk_f32 v26, v22, 0x42080000, v23
    v_cos_f32_e64 v26, v26
    v_fmamk_f32 v27, v22, 0x420c0000, v23
    v_cos_f32_e64 v27, v27
    v_fmamk_f32 v28, v22, 0x42100000, v23
    v_cos_f32_e64 v28, v28
    v_fmamk_f32 v29, v22, 0x42140000, v23
    v_cos_f32_e64 v29, v29
    v_fmamk_f32 v30, v22, 0x42180000, v23
    v_cos_f32_e64 v30, v30
    v_fmamk_f32 v31, v22, 0x421c0000, v23
    v_cos_f32_e64 v31, v31
    v_cvt_pk_bf16_f32 v24, v24, v25
    v_accvgpr_write_b32 a112, v24
    v_cvt_pk_bf16_f32 v26, v26, v27
    v_accvgpr_write_b32 a113, v26
    v_cvt_pk_bf16_f32 v28, v28, v29
    v_accvgpr_write_b32 a114, v28
    v_cvt_pk_bf16_f32 v30, v30, v31
    v_accvgpr_write_b32 a115, v30
    v_fmamk_f32 v24, v22, 0x42800000, v23
    v_cos_f32_e64 v24, v24
    v_fmamk_f32 v25, v22, 0x42820000, v23
    v_cos_f32_e64 v25, v25
    v_fmamk_f32 v26, v22, 0x42840000, v23
    v_cos_f32_e64 v26, v26
    v_fmamk_f32 v27, v22, 0x42860000, v23
    v_cos_f32_e64 v27, v27
    v_fmamk_f32 v28, v22, 0x42880000, v23
    v_cos_f32_e64 v28, v28
    v_fmamk_f32 v29, v22, 0x428a0000, v23
    v_cos_f32_e64 v29, v29
    v_fmamk_f32 v30, v22, 0x428c0000, v23
    v_cos_f32_e64 v30, v30
    v_fmamk_f32 v31, v22, 0x428e0000, v23
    v_cos_f32_e64 v31, v31
    v_cvt_pk_bf16_f32 v24, v24, v25
    v_accvgpr_write_b32 a116, v24
    v_cvt_pk_bf16_f32 v26, v26, v27
    v_accvgpr_write_b32 a117, v26
    v_cvt_pk_bf16_f32 v28, v28, v29
    v_accvgpr_write_b32 a118, v28
    v_cvt_pk_bf16_f32 v30, v30, v31
    v_accvgpr_write_b32 a119, v30
    v_fmamk_f32 v24, v22, 0x42c00000, v23
    v_cos_f32_e64 v24, v24
    v_fmamk_f32 v25, v22, 0x42c20000, v23
    v_cos_f32_e64 v25, v25
    v_fmamk_f32 v26, v22, 0x42c40000, v23
    v_cos_f32_e64 v26, v26
    v_fmamk_f32 v27, v22, 0x42c60000, v23
    v_cos_f32_e64 v27, v27
    v_fmamk_f32 v28, v22, 0x42c80000, v23
    v_cos_f32_e64 v28, v28
    v_fmamk_f32 v29, v22, 0x42ca0000, v23
    v_cos_f32_e64 v29, v29
    v_fmamk_f32 v30, v22, 0x42cc0000, v23
    v_cos_f32_e64 v30, v30
    v_fmamk_f32 v31, v22, 0x42ce0000, v23
    v_cos_f32_e64 v31, v31
    v_cvt_pk_bf16_f32 v24, v24, v25
    v_accvgpr_write_b32 a120, v24
    v_cvt_pk_bf16_f32 v26, v26, v27
    v_accvgpr_write_b32 a121, v26
    v_cvt_pk_bf16_f32 v28, v28, v29
    v_accvgpr_write_b32 a122, v28
    v_cvt_pk_bf16_f32 v30, v30, v31
    v_accvgpr_write_b32 a123, v30
    v_fmamk_f32 v24, v22, 0x43000000, v23
    v_cos_f32_e64 v24, v24
    v_fmamk_f32 v25, v22, 0x43010000, v23
    v_cos_f32_e64 v25, v25
    v_fmamk_f32 v26, v22, 0x43020000, v23
    v_cos_f32_e64 v26, v26
    v_fmamk_f32 v27, v22, 0x43030000, v23
    v_cos_f32_e64 v27, v27
    v_fmamk_f32 v28, v22, 0x43040000, v23
    v_cos_f32_e64 v28, v28
    v_fmamk_f32 v29, v22, 0x43050000, v23
    v_cos_f32_e64 v29, v29
    v_fmamk_f32 v30, v22, 0x43060000, v23
    v_cos_f32_e64 v30, v30
    v_fmamk_f32 v31, v22, 0x43070000, v23
    v_cos_f32_e64 v31, v31
    v_cvt_pk_bf16_f32 v24, v24, v25
    v_accvgpr_write_b32 a124, v24
    v_cvt_pk_bf16_f32 v26, v26, v27
    v_accvgpr_write_b32 a125, v26
    v_cvt_pk_bf16_f32 v28, v28, v29
    v_accvgpr_write_b32 a126, v28
    v_cvt_pk_bf16_f32 v30, v30, v31
    v_accvgpr_write_b32 a127, v30
    v_fmamk_f32 v24, v22, 0x43200000, v23
    v_cos_f32_e64 v24, v24
    v_fmamk_f32 v25, v22, 0x43210000, v23
    v_cos_f32_e64 v25, v25
    v_fmamk_f32 v26, v22, 0x43220000, v23
    v_cos_f32_e64 v26, v26
    v_fmamk_f32 v27, v22, 0x43230000, v23
    v_cos_f32_e64 v27, v27
    v_fmamk_f32 v28, v22, 0x43240000, v23
    v_cos_f32_e64 v28, v28
    v_fmamk_f32 v29, v22, 0x43250000, v23
    v_cos_f32_e64 v29, v29
    v_fmamk_f32 v30, v22, 0x43260000, v23
    v_cos_f32_e64 v30, v30
    v_fmamk_f32 v31, v22, 0x43270000, v23
    v_cos_f32_e64 v31, v31
    v_cvt_pk_bf16_f32 v24, v24, v25
    v_accvgpr_write_b32 a128, v24
    v_cvt_pk_bf16_f32 v26, v26, v27
    v_accvgpr_write_b32 a129, v26
    v_cvt_pk_bf16_f32 v28, v28, v29
    v_accvgpr_write_b32 a130, v28
    v_cvt_pk_bf16_f32 v30, v30, v31
    v_accvgpr_write_b32 a131, v30
    v_fmamk_f32 v24, v22, 0x43400000, v23
    v_cos_f32_e64 v24, v24
    v_fmamk_f32 v25, v22, 0x43410000, v23
    v_cos_f32_e64 v25, v25
    v_fmamk_f32 v26, v22, 0x43420000, v23
    v_cos_f32_e64 v26, v26
    v_fmamk_f32 v27, v22, 0x43430000, v23
    v_cos_f32_e64 v27, v27
    v_fmamk_f32 v28, v22, 0x43440000, v23
    v_cos_f32_e64 v28, v28
    v_fmamk_f32 v29, v22, 0x43450000, v23
    v_cos_f32_e64 v29, v29
    v_fmamk_f32 v30, v22, 0x43460000, v23
    v_cos_f32_e64 v30, v30
    v_fmamk_f32 v31, v22, 0x43470000, v23
    v_cos_f32_e64 v31, v31
    v_cvt_pk_bf16_f32 v24, v24, v25
    v_accvgpr_write_b32 a132, v24
    v_cvt_pk_bf16_f32 v26, v26, v27
    v_accvgpr_write_b32 a133, v26
    v_cvt_pk_bf16_f32 v28, v28, v29
    v_accvgpr_write_b32 a134, v28
    v_cvt_pk_bf16_f32 v30, v30, v31
    v_accvgpr_write_b32 a135, v30
    v_fmamk_f32 v24, v22, 0x43600000, v23
    v_cos_f32_e64 v24, v24
    v_fmamk_f32 v25, v22, 0x43610000, v23
    v_cos_f32_e64 v25, v25
    v_fmamk_f32 v26, v22, 0x43620000, v23
    v_cos_f32_e64 v26, v26
    v_fmamk_f32 v27, v22, 0x43630000, v23
    v_cos_f32_e64 v27, v27
    v_fmamk_f32 v28, v22, 0x43640000, v23
    v_cos_f32_e64 v28, v28
    v_fmamk_f32 v29, v22, 0x43650000, v23
    v_cos_f32_e64 v29, v29
    v_fmamk_f32 v30, v22, 0x43660000, v23
    v_cos_f32_e64 v30, v30
    v_fmamk_f32 v31, v22, 0x43670000, v23
    v_cos_f32_e64 v31, v31
    v_cvt_pk_bf16_f32 v24, v24, v25
    v_accvgpr_write_b32 a136, v24
    v_cvt_pk_bf16_f32 v26, v26, v27
    v_accvgpr_write_b32 a137, v26
    v_cvt_pk_bf16_f32 v28, v28, v29
    v_accvgpr_write_b32 a138, v28
    v_cvt_pk_bf16_f32 v30, v30, v31
    v_accvgpr_write_b32 a139, v30
    v_fmamk_f32 v24, v22, 0x43800000, v23
    v_cos_f32_e64 v24, v24
    v_fmamk_f32 v25, v22, 0x43808000, v23
    v_cos_f32_e64 v25, v25
    v_fmamk_f32 v26, v22, 0x43810000, v23
    v_cos_f32_e64 v26, v26
    v_fmamk_f32 v27, v22, 0x43818000, v23
    v_cos_f32_e64 v27, v27
    v_fmamk_f32 v28, v22, 0x43820000, v23
    v_cos_f32_e64 v28, v28
    v_fmamk_f32 v29, v22, 0x43828000, v23
    v_cos_f32_e64 v29, v29
    v_fmamk_f32 v30, v22, 0x43830000, v23
    v_cos_f32_e64 v30, v30
    v_fmamk_f32 v31, v22, 0x43838000, v23
    v_cos_f32_e64 v31, v31
    v_cvt_pk_bf16_f32 v24, v24, v25
    v_accvgpr_write_b32 a140, v24
    v_cvt_pk_bf16_f32 v26, v26, v27
    v_accvgpr_write_b32 a141, v26
    v_cvt_pk_bf16_f32 v28, v28, v29
    v_accvgpr_write_b32 a142, v28
    v_cvt_pk_bf16_f32 v30, v30, v31
    v_accvgpr_write_b32 a143, v30
    v_add_u32 v21, 64, v16
    v_cvt_f32_u32 v21, v21
    v_mov_b32_e64 v22, s57
    v_fmac_f32 v22, 0x3ae38e39, v21
    v_mov_b32 v23, s56
    v_fmac_f32 v23, s58, v21
    v_fmac_f32 v23, v17, v22
    v_cos_f32 v24, v23
    v_fmamk_f32 v25, v22, 0x3f800000, v23
    v_cos_f32_e64 v25, v25
    v_fmamk_f32 v26, v22, 0x40000000, v23
    v_cos_f32_e64 v26, v26
    v_fmamk_f32 v27, v22, 0x40400000, v23
    v_cos_f32_e64 v27, v27
    v_fmamk_f32 v28, v22, 0x40800000, v23
    v_cos_f32_e64 v28, v28
    v_fmamk_f32 v29, v22, 0x40a00000, v23
    v_cos_f32_e64 v29, v29
    v_fmamk_f32 v30, v22, 0x40c00000, v23
    v_cos_f32_e64 v30, v30
    v_fmamk_f32 v31, v22, 0x40e00000, v23
    v_cos_f32_e64 v31, v31
    v_cndmask_b32 v24, v24, v20, s[54:55]
    v_cvt_pk_bf16_f32 v24, v24, v25
    v_accvgpr_write_b32 a144, v24
    v_cvt_pk_bf16_f32 v26, v26, v27
    v_accvgpr_write_b32 a145, v26
    v_cvt_pk_bf16_f32 v28, v28, v29
    v_accvgpr_write_b32 a146, v28
    v_cvt_pk_bf16_f32 v30, v30, v31
    v_accvgpr_write_b32 a147, v30
    v_fmamk_f32 v24, v22, 0x42000000, v23
    v_cos_f32_e64 v24, v24
    v_fmamk_f32 v25, v22, 0x42040000, v23
    v_cos_f32_e64 v25, v25
    v_fmamk_f32 v26, v22, 0x42080000, v23
    v_cos_f32_e64 v26, v26
    v_fmamk_f32 v27, v22, 0x420c0000, v23
    v_cos_f32_e64 v27, v27
    v_fmamk_f32 v28, v22, 0x42100000, v23
    v_cos_f32_e64 v28, v28
    v_fmamk_f32 v29, v22, 0x42140000, v23
    v_cos_f32_e64 v29, v29
    v_fmamk_f32 v30, v22, 0x42180000, v23
    v_cos_f32_e64 v30, v30
    v_fmamk_f32 v31, v22, 0x421c0000, v23
    v_cos_f32_e64 v31, v31
    v_cvt_pk_bf16_f32 v24, v24, v25
    v_accvgpr_write_b32 a148, v24
    v_cvt_pk_bf16_f32 v26, v26, v27
    v_accvgpr_write_b32 a149, v26
    v_cvt_pk_bf16_f32 v28, v28, v29
    v_accvgpr_write_b32 a150, v28
    v_cvt_pk_bf16_f32 v30, v30, v31
    v_accvgpr_write_b32 a151, v30
    v_fmamk_f32 v24, v22, 0x42800000, v23
    v_cos_f32_e64 v24, v24
    v_fmamk_f32 v25, v22, 0x42820000, v23
    v_cos_f32_e64 v25, v25
    v_fmamk_f32 v26, v22, 0x42840000, v23
    v_cos_f32_e64 v26, v26
    v_fmamk_f32 v27, v22, 0x42860000, v23
    v_cos_f32_e64 v27, v27
    v_fmamk_f32 v28, v22, 0x42880000, v23
    v_cos_f32_e64 v28, v28
    v_fmamk_f32 v29, v22, 0x428a0000, v23
    v_cos_f32_e64 v29, v29
    v_fmamk_f32 v30, v22, 0x428c0000, v23
    v_cos_f32_e64 v30, v30
    v_fmamk_f32 v31, v22, 0x428e0000, v23
    v_cos_f32_e64 v31, v31
    v_cvt_pk_bf16_f32 v24, v24, v25
    v_accvgpr_write_b32 a152, v24
    v_cvt_pk_bf16_f32 v26, v26, v27
    v_accvgpr_write_b32 a153, v26
    v_cvt_pk_bf16_f32 v28, v28, v29
    v_accvgpr_write_b32 a154, v28
    v_cvt_pk_bf16_f32 v30, v30, v31
    v_accvgpr_write_b32 a155, v30
    v_fmamk_f32 v24, v22, 0x42c00000, v23
    v_cos_f32_e64 v24, v24
    v_fmamk_f32 v25, v22, 0x42c20000, v23
    v_cos_f32_e64 v25, v25
    v_fmamk_f32 v26, v22, 0x42c40000, v23
    v_cos_f32_e64 v26, v26
    v_fmamk_f32 v27, v22, 0x42c60000, v23
    v_cos_f32_e64 v27, v27
    v_fmamk_f32 v28, v22, 0x42c80000, v23
    v_cos_f32_e64 v28, v28
    v_fmamk_f32 v29, v22, 0x42ca0000, v23
    v_cos_f32_e64 v29, v29
    v_fmamk_f32 v30, v22, 0x42cc0000, v23
    v_cos_f32_e64 v30, v30
    v_fmamk_f32 v31, v22, 0x42ce0000, v23
    v_cos_f32_e64 v31, v31
    v_cvt_pk_bf16_f32 v24, v24, v25
    v_accvgpr_write_b32 a156, v24
    v_cvt_pk_bf16_f32 v26, v26, v27
    v_accvgpr_write_b32 a157, v26
    v_cvt_pk_bf16_f32 v28, v28, v29
    v_accvgpr_write_b32 a158, v28
    v_cvt_pk_bf16_f32 v30, v30, v31
    v_accvgpr_write_b32 a159, v30
    v_fmamk_f32 v24, v22, 0x43000000, v23
    v_cos_f32_e64 v24, v24
    v_fmamk_f32 v25, v22, 0x43010000, v23
    v_cos_f32_e64 v25, v25
    v_fmamk_f32 v26, v22, 0x43020000, v23
    v_cos_f32_e64 v26, v26
    v_fmamk_f32 v27, v22, 0x43030000, v23
    v_cos_f32_e64 v27, v27
    v_fmamk_f32 v28, v22, 0x43040000, v23
    v_cos_f32_e64 v28, v28
    v_fmamk_f32 v29, v22, 0x43050000, v23
    v_cos_f32_e64 v29, v29
    v_fmamk_f32 v30, v22, 0x43060000, v23
    v_cos_f32_e64 v30, v30
    v_fmamk_f32 v31, v22, 0x43070000, v23
    v_cos_f32_e64 v31, v31
    v_cvt_pk_bf16_f32 v24, v24, v25
    v_accvgpr_write_b32 a160, v24
    v_cvt_pk_bf16_f32 v26, v26, v27
    v_accvgpr_write_b32 a161, v26
    v_cvt_pk_bf16_f32 v28, v28, v29
    v_accvgpr_write_b32 a162, v28
    v_cvt_pk_bf16_f32 v30, v30, v31
    v_accvgpr_write_b32 a163, v30
    v_fmamk_f32 v24, v22, 0x43200000, v23
    v_cos_f32_e64 v24, v24
    v_fmamk_f32 v25, v22, 0x43210000, v23
    v_cos_f32_e64 v25, v25
    v_fmamk_f32 v26, v22, 0x43220000, v23
    v_cos_f32_e64 v26, v26
    v_fmamk_f32 v27, v22, 0x43230000, v23
    v_cos_f32_e64 v27, v27
    v_fmamk_f32 v28, v22, 0x43240000, v23
    v_cos_f32_e64 v28, v28
    v_fmamk_f32 v29, v22, 0x43250000, v23
    v_cos_f32_e64 v29, v29
    v_fmamk_f32 v30, v22, 0x43260000, v23
    v_cos_f32_e64 v30, v30
    v_fmamk_f32 v31, v22, 0x43270000, v23
    v_cos_f32_e64 v31, v31
    v_cvt_pk_bf16_f32 v24, v24, v25
    v_accvgpr_write_b32 a164, v24
    v_cvt_pk_bf16_f32 v26, v26, v27
    v_accvgpr_write_b32 a165, v26
    v_cvt_pk_bf16_f32 v28, v28, v29
    v_accvgpr_write_b32 a166, v28
    v_cvt_pk_bf16_f32 v30, v30, v31
    v_accvgpr_write_b32 a167, v30
    v_fmamk_f32 v24, v22, 0x43400000, v23
    v_cos_f32_e64 v24, v24
    v_fmamk_f32 v25, v22, 0x43410000, v23
    v_cos_f32_e64 v25, v25
    v_fmamk_f32 v26, v22, 0x43420000, v23
    v_cos_f32_e64 v26, v26
    v_fmamk_f32 v27, v22, 0x43430000, v23
    v_cos_f32_e64 v27, v27
    v_fmamk_f32 v28, v22, 0x43440000, v23
    v_cos_f32_e64 v28, v28
    v_fmamk_f32 v29, v22, 0x43450000, v23
    v_cos_f32_e64 v29, v29
    v_fmamk_f32 v30, v22, 0x43460000, v23
    v_cos_f32_e64 v30, v30
    v_fmamk_f32 v31, v22, 0x43470000, v23
    v_cos_f32_e64 v31, v31
    v_cvt_pk_bf16_f32 v24, v24, v25
    v_accvgpr_write_b32 a168, v24
    v_cvt_pk_bf16_f32 v26, v26, v27
    v_accvgpr_write_b32 a169, v26
    v_cvt_pk_bf16_f32 v28, v28, v29
    v_accvgpr_write_b32 a170, v28
    v_cvt_pk_bf16_f32 v30, v30, v31
    v_accvgpr_write_b32 a171, v30
    v_fmamk_f32 v24, v22, 0x43600000, v23
    v_cos_f32_e64 v24, v24
    v_fmamk_f32 v25, v22, 0x43610000, v23
    v_cos_f32_e64 v25, v25
    v_fmamk_f32 v26, v22, 0x43620000, v23
    v_cos_f32_e64 v26, v26
    v_fmamk_f32 v27, v22, 0x43630000, v23
    v_cos_f32_e64 v27, v27
    v_fmamk_f32 v28, v22, 0x43640000, v23
    v_cos_f32_e64 v28, v28
    v_fmamk_f32 v29, v22, 0x43650000, v23
    v_cos_f32_e64 v29, v29
    v_fmamk_f32 v30, v22, 0x43660000, v23
    v_cos_f32_e64 v30, v30
    v_fmamk_f32 v31, v22, 0x43670000, v23
    v_cos_f32_e64 v31, v31
    v_cvt_pk_bf16_f32 v24, v24, v25
    v_accvgpr_write_b32 a172, v24
    v_cvt_pk_bf16_f32 v26, v26, v27
    v_accvgpr_write_b32 a173, v26
    v_cvt_pk_bf16_f32 v28, v28, v29
    v_accvgpr_write_b32 a174, v28
    v_cvt_pk_bf16_f32 v30, v30, v31
    v_accvgpr_write_b32 a175, v30
    v_fmamk_f32 v24, v22, 0x43800000, v23
    v_cos_f32_e64 v24, v24
    v_fmamk_f32 v25, v22, 0x43808000, v23
    v_cos_f32_e64 v25, v25
    v_fmamk_f32 v26, v22, 0x43810000, v23
    v_cos_f32_e64 v26, v26
    v_fmamk_f32 v27, v22, 0x43818000, v23
    v_cos_f32_e64 v27, v27
    v_fmamk_f32 v28, v22, 0x43820000, v23
    v_cos_f32_e64 v28, v28
    v_fmamk_f32 v29, v22, 0x43828000, v23
    v_cos_f32_e64 v29, v29
    v_fmamk_f32 v30, v22, 0x43830000, v23
    v_cos_f32_e64 v30, v30
    v_fmamk_f32 v31, v22, 0x43838000, v23
    v_cos_f32_e64 v31, v31
    v_cvt_pk_bf16_f32 v24, v24, v25
    v_accvgpr_write_b32 a176, v24
    v_cvt_pk_bf16_f32 v26, v26, v27
    v_accvgpr_write_b32 a177, v26
    v_cvt_pk_bf16_f32 v28, v28, v29
    v_accvgpr_write_b32 a178, v28
    v_cvt_pk_bf16_f32 v30, v30, v31
    v_accvgpr_write_b32 a179, v30
    v_add_u32 v21, 80, v16
    v_cvt_f32_u32 v21, v21
    v_mov_b32 v22, s57
    v_fmac_f32 v22, 0x3ae38e39, v21
    v_mov_b32 v23, s56
    v_fmac_f32 v23, s58, v21
    v_fmac_f32 v23, v17, v22
    v_cos_f32 v24, v23
    v_fmamk_f32 v25, v22, 0x3f800000, v23
    v_cos_f32_e64 v25, v25
    v_fmamk_f32 v26, v22, 0x40000000, v23
    v_cos_f32_e64 v26, v26
    v_fmamk_f32 v27, v22, 0x40400000, v23
    v_cos_f32_e64 v27, v27
    v_fmamk_f32 v28, v22, 0x40800000, v23
    v_cos_f32_e64 v28, v28
    v_fmamk_f32 v29, v22, 0x40a00000, v23
    v_cos_f32_e64 v29, v29
    v_fmamk_f32 v30, v22, 0x40c00000, v23
    v_cos_f32_e64 v30, v30
    v_fmamk_f32 v31, v22, 0x40e00000, v23
    v_cos_f32_e64 v31, v31
    v_cndmask_b32 v24, v24, v20, s[54:55]
    v_cvt_pk_bf16_f32 v24, v24, v25
    v_accvgpr_write_b32 a180, v24
    v_cvt_pk_bf16_f32 v26, v26, v27
    v_accvgpr_write_b32 a181, v26
    v_cvt_pk_bf16_f32 v28, v28, v29
    v_accvgpr_write_b32 a182, v28
    v_cvt_pk_bf16_f32 v30, v30, v31
    v_accvgpr_write_b32 a183, v30
    v_fmamk_f32 v24, v22, 0x42000000, v23
    v_cos_f32_e64 v24, v24
    v_fmamk_f32 v25, v22, 0x42040000, v23
    v_cos_f32_e64 v25, v25
    v_fmamk_f32 v26, v22, 0x42080000, v23
    v_cos_f32_e64 v26, v26
    v_fmamk_f32 v27, v22, 0x420c0000, v23
    v_cos_f32_e64 v27, v27
    v_fmamk_f32 v28, v22, 0x42100000, v23
    v_cos_f32_e64 v28, v28
    v_fmamk_f32 v29, v22, 0x42140000, v23
    v_cos_f32_e64 v29, v29
    v_fmamk_f32 v30, v22, 0x42180000, v23
    v_cos_f32_e64 v30, v30
    v_fmamk_f32 v31, v22, 0x421c0000, v23
    v_cos_f32_e64 v31, v31
    v_cvt_pk_bf16_f32 v24, v24, v25
    v_accvgpr_write_b32 a184, v24
    v_cvt_pk_bf16_f32 v26, v26, v27
    v_accvgpr_write_b32 a185, v26
    v_cvt_pk_bf16_f32 v28, v28, v29
    v_accvgpr_write_b32 a186, v28
    v_cvt_pk_bf16_f32 v30, v30, v31
    v_accvgpr_write_b32 a187, v30
    v_fmamk_f32 v24, v22, 0x42800000, v23
    v_cos_f32_e64 v24, v24
    v_fmamk_f32 v25, v22, 0x42820000, v23
    v_cos_f32_e64 v25, v25
    v_fmamk_f32 v26, v22, 0x42840000, v23
    v_cos_f32_e64 v26, v26
    v_fmamk_f32 v27, v22, 0x42860000, v23
    v_cos_f32_e64 v27, v27
    v_fmamk_f32 v28, v22, 0x42880000, v23
    v_cos_f32_e64 v28, v28
    v_fmamk_f32 v29, v22, 0x428a0000, v23
    v_cos_f32_e64 v29, v29
    v_fmamk_f32 v30, v22, 0x428c0000, v23
    v_cos_f32_e64 v30, v30
    v_fmamk_f32 v31, v22, 0x428e0000, v23
    v_cos_f32_e64 v31, v31
    v_cvt_pk_bf16_f32 v24, v24, v25
    v_accvgpr_write_b32 a188, v24
    v_cvt_pk_bf16_f32 v26, v26, v27
    v_accvgpr_write_b32 a189, v26
    v_cvt_pk_bf16_f32 v28, v28, v29
    v_accvgpr_write_b32 a190, v28
    v_cvt_pk_bf16_f32 v30, v30, v31
    v_accvgpr_write_b32 a191, v30
    v_fmamk_f32 v24, v22, 0x42c00000, v23
    v_cos_f32_e64 v24, v24
    v_fmamk_f32 v25, v22, 0x42c20000, v23
    v_cos_f32_e64 v25, v25
    v_fmamk_f32 v26, v22, 0x42c40000, v23
    v_cos_f32_e64 v26, v26
    v_fmamk_f32 v27, v22, 0x42c60000, v23
    v_cos_f32_e64 v27, v27
    v_fmamk_f32 v28, v22, 0x42c80000, v23
    v_cos_f32_e64 v28, v28
    v_fmamk_f32 v29, v22, 0x42ca0000, v23
    v_cos_f32_e64 v29, v29
    v_fmamk_f32 v30, v22, 0x42cc0000, v23
    v_cos_f32_e64 v30, v30
    v_fmamk_f32 v31, v22, 0x42ce0000, v23
    v_cos_f32_e64 v31, v31
    v_cvt_pk_bf16_f32 v24, v24, v25
    v_accvgpr_write_b32 a192, v24
    v_cvt_pk_bf16_f32 v26, v26, v27
    v_accvgpr_write_b32 a193, v26
    v_cvt_pk_bf16_f32 v28, v28, v29
    v_accvgpr_write_b32 a194, v28
    v_cvt_pk_bf16_f32 v30, v30, v31
    v_accvgpr_write_b32 a195, v30
    v_fmamk_f32 v24, v22, 0x43000000, v23
    v_cos_f32_e64 v24, v24
    v_fmamk_f32 v25, v22, 0x43010000, v23
    v_cos_f32_e64 v25, v25
    v_fmamk_f32 v26, v22, 0x43020000, v23
    v_cos_f32_e64 v26, v26
    v_fmamk_f32 v27, v22, 0x43030000, v23
    v_cos_f32_e64 v27, v27
    v_fmamk_f32 v28, v22, 0x43040000, v23
    v_cos_f32_e64 v28, v28
    v_fmamk_f32 v29, v22, 0x43050000, v23
    v_cos_f32_e64 v29, v29
    v_fmamk_f32 v30, v22, 0x43060000, v23
    v_cos_f32_e64 v30, v30
    v_fmamk_f32 v31, v22, 0x43070000, v23
    v_cos_f32_e64 v31, v31
    v_cvt_pk_bf16_f32 v24, v24, v25
    v_accvgpr_write_b32 a196, v24
    v_cvt_pk_bf16_f32 v26, v26, v27
    v_accvgpr_write_b32 a197, v26
    v_cvt_pk_bf16_f32 v28, v28, v29
    v_accvgpr_write_b32 a198, v28
    v_cvt_pk_bf16_f32 v30, v30, v31
    v_accvgpr_write_b32 a199, v30
    v_fmamk_f32 v24, v22, 0x43200000, v23
    v_cos_f32_e64 v24, v24
    v_fmamk_f32 v25, v22, 0x43210000, v23
    v_cos_f32_e64 v25, v25
    v_fmamk_f32 v26, v22, 0x43220000, v23
    v_cos_f32_e64 v26, v26
    v_fmamk_f32 v27, v22, 0x43230000, v23
    v_cos_f32_e64 v27, v27
    v_fmamk_f32 v28, v22, 0x43240000, v23
    v_cos_f32_e64 v28, v28
    v_fmamk_f32 v29, v22, 0x43250000, v23
    v_cos_f32_e64 v29, v29
    v_fmamk_f32 v30, v22, 0x43260000, v23
    v_cos_f32_e64 v30, v30
    v_fmamk_f32 v31, v22, 0x43270000, v23
    v_cos_f32_e64 v31, v31
    v_cvt_pk_bf16_f32 v24, v24, v25
    v_accvgpr_write_b32 a200, v24
    v_cvt_pk_bf16_f32 v26, v26, v27
    v_accvgpr_write_b32 a201, v26
    v_cvt_pk_bf16_f32 v28, v28, v29
    v_accvgpr_write_b32 a202, v28
    v_cvt_pk_bf16_f32 v30, v30, v31
    v_accvgpr_write_b32 a203, v30
    v_fmamk_f32 v24, v22, 0x43400000, v23
    v_cos_f32_e64 v24, v24
    v_fmamk_f32 v25, v22, 0x43410000, v23
    v_cos_f32_e64 v25, v25
    v_fmamk_f32 v26, v22, 0x43420000, v23
    v_cos_f32_e64 v26, v26
    v_fmamk_f32 v27, v22, 0x43430000, v23
    v_cos_f32_e64 v27, v27
    v_fmamk_f32 v28, v22, 0x43440000, v23
    v_cos_f32_e64 v28, v28
    v_fmamk_f32 v29, v22, 0x43450000, v23
    v_cos_f32_e64 v29, v29
    v_fmamk_f32 v30, v22, 0x43460000, v23
    v_cos_f32_e64 v30, v30
    v_fmamk_f32 v31, v22, 0x43470000, v23
    v_cos_f32_e64 v31, v31
    v_cvt_pk_bf16_f32 v24, v24, v25
    v_accvgpr_write_b32 a204, v24
    v_cvt_pk_bf16_f32 v26, v26, v27
    v_accvgpr_write_b32 a205, v26
    v_cvt_pk_bf16_f32 v28, v28, v29
    v_accvgpr_write_b32 a206, v28
    v_cvt_pk_bf16_f32 v30, v30, v31
    v_accvgpr_write_b32 a207, v30
    v_fmamk_f32 v24, v22, 0x43600000, v23
    v_cos_f32_e64 v24, v24
    v_fmamk_f32 v25, v22, 0x43610000, v23
    v_cos_f32_e64 v25, v25
    v_fmamk_f32 v26, v22, 0x43620000, v23
    v_cos_f32_e64 v26, v26
    v_fmamk_f32 v27, v22, 0x43630000, v23
    v_cos_f32_e64 v27, v27
    v_fmamk_f32 v28, v22, 0x43640000, v23
    v_cos_f32_e64 v28, v28
    v_fmamk_f32 v29, v22, 0x43650000, v23
    v_cos_f32_e64 v29, v29
    v_fmamk_f32 v30, v22, 0x43660000, v23
    v_cos_f32_e64 v30, v30
    v_fmamk_f32 v31, v22, 0x43670000, v23
    v_cos_f32_e64 v31, v31
    v_cvt_pk_bf16_f32 v24, v24, v25
    v_accvgpr_write_b32 a208, v24
    v_cvt_pk_bf16_f32 v26, v26, v27
    v_accvgpr_write_b32 a209, v26
    v_cvt_pk_bf16_f32 v28, v28, v29
    v_accvgpr_write_b32 a210, v28
    v_cvt_pk_bf16_f32 v30, v30, v31
    v_accvgpr_write_b32 a211, v30
    v_fmamk_f32 v24, v22, 0x43800000, v23
    v_cos_f32_e64 v24, v24
    v_fmamk_f32 v25, v22, 0x43808000, v23
    v_cos_f32_e64 v25, v25
    v_fmamk_f32 v26, v22, 0x43810000, v23
    v_cos_f32_e64 v26, v26
    v_fmamk_f32 v27, v22, 0x43818000, v23
    v_cos_f32_e64 v27, v27
    v_fmamk_f32 v28, v22, 0x43820000, v23
    v_cos_f32_e64 v28, v28
    v_fmamk_f32 v29, v22, 0x43828000, v23
    v_cos_f32_e64 v29, v29
    v_fmamk_f32 v30, v22, 0x43830000, v23
    v_cos_f32_e64 v30, v30
    v_fmamk_f32 v31, v22, 0x43838000, v23
    v_cos_f32_e64 v31, v31
    v_cvt_pk_bf16_f32 v24, v24, v25
    v_accvgpr_write_b32 a212, v24
    v_cvt_pk_bf16_f32 v26, v26, v27
    v_accvgpr_write_b32 a213, v26
    v_cvt_pk_bf16_f32 v28, v28, v29
    v_accvgpr_write_b32 a214, v28
    v_cvt_pk_bf16_f32 v30, v30, v31
    v_accvgpr_write_b32 a215, v30
    v_add_u32 v21, 96, v16
    v_cvt_f32_u32 v21, v21
    v_mov_b32 v22, s57
    v_fmac_f32 v22, 0x3ae38e39, v21
    v_mov_b32 v23, s56
    v_fmac_f32 v23, s58, v21
    v_fmac_f32 v23, v17, v22
    v_cos_f32 v24, v23
    v_fmamk_f32 v25, v22, 0x3f800000, v23
    v_cos_f32_e64 v25, v25
    v_fmamk_f32 v26, v22, 0x40000000, v23
    v_cos_f32_e64 v26, v26
    v_fmamk_f32 v27, v22, 0x40400000, v23
    v_cos_f32_e64 v27, v27
    v_fmamk_f32 v28, v22, 0x40800000, v23
    v_cos_f32_e64 v28, v28
    v_fmamk_f32 v29, v22, 0x40a00000, v23
    v_cos_f32_e64 v29, v29
    v_fmamk_f32 v30, v22, 0x40c00000, v23
    v_cos_f32_e64 v30, v30
    v_fmamk_f32 v31, v22, 0x40e00000, v23
    v_cos_f32_e64 v31, v31
    v_cndmask_b32 v24, v24, v20, s[54:55]
    v_cvt_pk_bf16_f32 v24, v24, v25
    v_accvgpr_write_b32 a216, v24
    v_cvt_pk_bf16_f32 v26, v26, v27
    v_accvgpr_write_b32 a217, v26
    v_cvt_pk_bf16_f32 v28, v28, v29
    v_accvgpr_write_b32 a218, v28
    v_cvt_pk_bf16_f32 v30, v30, v31
    v_accvgpr_write_b32 a219, v30
    v_fmamk_f32 v24, v22, 0x42000000, v23
    v_cos_f32_e64 v24, v24
    v_fmamk_f32 v25, v22, 0x42040000, v23
    v_cos_f32_e64 v25, v25
    v_fmamk_f32 v26, v22, 0x42080000, v23
    v_cos_f32_e64 v26, v26
    v_fmamk_f32 v27, v22, 0x420c0000, v23
    v_cos_f32_e64 v27, v27
    v_fmamk_f32 v28, v22, 0x42100000, v23
    v_cos_f32_e64 v28, v28
    v_fmamk_f32 v29, v22, 0x42140000, v23
    v_cos_f32_e64 v29, v29
    v_fmamk_f32 v30, v22, 0x42180000, v23
    v_cos_f32_e64 v30, v30
    v_fmamk_f32 v31, v22, 0x421c0000, v23
    v_cos_f32_e64 v31, v31
    v_cvt_pk_bf16_f32 v24, v24, v25
    v_accvgpr_write_b32 a220, v24
    v_cvt_pk_bf16_f32 v26, v26, v27
    v_accvgpr_write_b32 a221, v26
    v_cvt_pk_bf16_f32 v28, v28, v29
    v_accvgpr_write_b32 a222, v28
    v_cvt_pk_bf16_f32 v30, v30, v31
    v_accvgpr_write_b32 a223, v30
    v_fmamk_f32 v24, v22, 0x42800000, v23
    v_cos_f32_e64 v24, v24
    v_fmamk_f32 v25, v22, 0x42820000, v23
    v_cos_f32_e64 v25, v25
    v_fmamk_f32 v26, v22, 0x42840000, v23
    v_cos_f32_e64 v26, v26
    v_fmamk_f32 v27, v22, 0x42860000, v23
    v_cos_f32_e64 v27, v27
    v_fmamk_f32 v28, v22, 0x42880000, v23
    v_cos_f32_e64 v28, v28
    v_fmamk_f32 v29, v22, 0x428a0000, v23
    v_cos_f32_e64 v29, v29
    v_fmamk_f32 v30, v22, 0x428c0000, v23
    v_cos_f32_e64 v30, v30
    v_fmamk_f32 v31, v22, 0x428e0000, v23
    v_cos_f32_e64 v31, v31
    v_cvt_pk_bf16_f32 v24, v24, v25
    v_accvgpr_write_b32 a224, v24
    v_cvt_pk_bf16_f32 v26, v26, v27
    v_accvgpr_write_b32 a225, v26
    v_cvt_pk_bf16_f32 v28, v28, v29
    v_accvgpr_write_b32 a226, v28
    v_cvt_pk_bf16_f32 v30, v30, v31
    v_accvgpr_write_b32 a227, v30
    v_fmamk_f32 v24, v22, 0x42c00000, v23
    v_cos_f32_e64 v24, v24
    v_fmamk_f32 v25, v22, 0x42c20000, v23
    v_cos_f32_e64 v25, v25
    v_fmamk_f32 v26, v22, 0x42c40000, v23
    v_cos_f32_e64 v26, v26
    v_fmamk_f32 v27, v22, 0x42c60000, v23
    v_cos_f32_e64 v27, v27
    v_fmamk_f32 v28, v22, 0x42c80000, v23
    v_cos_f32_e64 v28, v28
    v_fmamk_f32 v29, v22, 0x42ca0000, v23
    v_cos_f32_e64 v29, v29
    v_fmamk_f32 v30, v22, 0x42cc0000, v23
    v_cos_f32_e64 v30, v30
    v_fmamk_f32 v31, v22, 0x42ce0000, v23
    v_cos_f32_e64 v31, v31
    v_cvt_pk_bf16_f32 v24, v24, v25
    v_accvgpr_write_b32 a228, v24
    v_cvt_pk_bf16_f32 v26, v26, v27
    v_accvgpr_write_b32 a229, v26
    v_cvt_pk_bf16_f32 v28, v28, v29
    v_accvgpr_write_b32 a230, v28
    v_cvt_pk_bf16_f32 v30, v30, v31
    v_accvgpr_write_b32 a231, v30
    v_fmamk_f32 v24, v22, 0x43000000, v23
    v_cos_f32_e64 v24, v24
    v_fmamk_f32 v25, v22, 0x43010000, v23
    v_cos_f32_e64 v25, v25
    v_fmamk_f32 v26, v22, 0x43020000, v23
    v_cos_f32_e64 v26, v26
    v_fmamk_f32 v27, v22, 0x43030000, v23
    v_cos_f32_e64 v27, v27
    v_fmamk_f32 v28, v22, 0x43040000, v23
    v_cos_f32_e64 v28, v28
    v_fmamk_f32 v29, v22, 0x43050000, v23
    v_cos_f32_e64 v29, v29
    v_fmamk_f32 v30, v22, 0x43060000, v23
    v_cos_f32_e64 v30, v30
    v_fmamk_f32 v31, v22, 0x43070000, v23
    v_cos_f32_e64 v31, v31
    v_cvt_pk_bf16_f32 v24, v24, v25
    v_accvgpr_write_b32 a232, v24
    v_cvt_pk_bf16_f32 v26, v26, v27
    v_accvgpr_write_b32 a233, v26
    v_cvt_pk_bf16_f32 v28, v28, v29
    v_accvgpr_write_b32 a234, v28
    v_cvt_pk_bf16_f32 v30, v30, v31
    v_accvgpr_write_b32 a235, v30
    v_fmamk_f32 v24, v22, 0x43200000, v23
    v_cos_f32_e64 v24, v24
    v_fmamk_f32 v25, v22, 0x43210000, v23
    v_cos_f32_e64 v25, v25
    v_fmamk_f32 v26, v22, 0x43220000, v23
    v_cos_f32_e64 v26, v26
    v_fmamk_f32 v27, v22, 0x43230000, v23
    v_cos_f32_e64 v27, v27
    v_fmamk_f32 v28, v22, 0x43240000, v23
    v_cos_f32_e64 v28, v28
    v_fmamk_f32 v29, v22, 0x43250000, v23
    v_cos_f32_e64 v29, v29
    v_fmamk_f32 v30, v22, 0x43260000, v23
    v_cos_f32_e64 v30, v30
    v_fmamk_f32 v31, v22, 0x43270000, v23
    v_cos_f32_e64 v31, v31
    v_cvt_pk_bf16_f32 v24, v24, v25
    v_accvgpr_write_b32 a236, v24
    v_cvt_pk_bf16_f32 v26, v26, v27
    v_accvgpr_write_b32 a237, v26
    v_cvt_pk_bf16_f32 v28, v28, v29
    v_accvgpr_write_b32 a238, v28
    v_cvt_pk_bf16_f32 v30, v30, v31
    v_accvgpr_write_b32 a239, v30
    v_fmamk_f32 v24, v22, 0x43400000, v23
    v_cos_f32_e64 v24, v24
    v_fmamk_f32 v25, v22, 0x43410000, v23
    v_cos_f32_e64 v25, v25
    v_fmamk_f32 v26, v22, 0x43420000, v23
    v_cos_f32_e64 v26, v26
    v_fmamk_f32 v27, v22, 0x43430000, v23
    v_cos_f32_e64 v27, v27
    v_fmamk_f32 v28, v22, 0x43440000, v23
    v_cos_f32_e64 v28, v28
    v_fmamk_f32 v29, v22, 0x43450000, v23
    v_cos_f32_e64 v29, v29
    v_fmamk_f32 v30, v22, 0x43460000, v23
    v_cos_f32_e64 v30, v30
    v_fmamk_f32 v31, v22, 0x43470000, v23
    v_cos_f32_e64 v31, v31
    v_cvt_pk_bf16_f32 v24, v24, v25
    v_accvgpr_write_b32 a240, v24
    v_cvt_pk_bf16_f32 v26, v26, v27
    v_accvgpr_write_b32 a241, v26
    v_cvt_pk_bf16_f32 v28, v28, v29
    v_accvgpr_write_b32 a242, v28
    v_cvt_pk_bf16_f32 v30, v30, v31
    v_accvgpr_write_b32 a243, v30
    v_fmamk_f32 v24, v22, 0x43600000, v23
    v_cos_f32_e64 v24, v24
    v_fmamk_f32 v25, v22, 0x43610000, v23
    v_cos_f32_e64 v25, v25
    v_fmamk_f32 v26, v22, 0x43620000, v23
    v_cos_f32_e64 v26, v26
    v_fmamk_f32 v27, v22, 0x43630000, v23
    v_cos_f32_e64 v27, v27
    v_fmamk_f32 v28, v22, 0x43640000, v23
    v_cos_f32_e64 v28, v28
    v_fmamk_f32 v29, v22, 0x43650000, v23
    v_cos_f32_e64 v29, v29
    v_fmamk_f32 v30, v22, 0x43660000, v23
    v_cos_f32_e64 v30, v30
    v_fmamk_f32 v31, v22, 0x43670000, v23
    v_cos_f32_e64 v31, v31
    v_cvt_pk_bf16_f32 v24, v24, v25
    v_accvgpr_write_b32 a244, v24
    v_cvt_pk_bf16_f32 v26, v26, v27
    v_accvgpr_write_b32 a245, v26
    v_cvt_pk_bf16_f32 v28, v28, v29
    v_accvgpr_write_b32 a246, v28
    v_cvt_pk_bf16_f32 v30, v30, v31
    v_accvgpr_write_b32 a247, v30
    v_fmamk_f32 v24, v22, 0x43800000, v23
    v_cos_f32_e64 v24, v24
    v_fmamk_f32 v25, v22, 0x43808000, v23
    v_cos_f32_e64 v25, v25
    v_fmamk_f32 v26, v22, 0x43810000, v23
    v_cos_f32_e64 v26, v26
    v_fmamk_f32 v27, v22, 0x43818000, v23
    v_cos_f32_e64 v27, v27
    v_fmamk_f32 v28, v22, 0x43820000, v23
    v_cos_f32_e64 v28, v28
    v_fmamk_f32 v29, v22, 0x43828000, v23
    v_cos_f32_e64 v29, v29
    v_fmamk_f32 v30, v22, 0x43830000, v23
    v_cos_f32_e64 v30, v30
    v_fmamk_f32 v31, v22, 0x43838000, v23
    v_cos_f32_e64 v31, v31
    v_cvt_pk_bf16_f32 v24, v24, v25
    v_accvgpr_write_b32 a248, v24
    v_cvt_pk_bf16_f32 v26, v26, v27
    v_accvgpr_write_b32 a249, v26
    v_cvt_pk_bf16_f32 v28, v28, v29
    v_accvgpr_write_b32 a250, v28
    v_cvt_pk_bf16_f32 v30, v30, v31
    v_accvgpr_write_b32 a251, v30
    v_add_u32 v21, 112, v16
    v_cvt_f32_u32 v21, v21
    v_mov_b32 v22, s57
    v_fmac_f32 v22, 0x3ae38e39, v21
    v_mov_b32 v23, s56
    v_fmac_f32 v23, s58, v21
    v_fmac_f32 v23, v17, v22
    v_cos_f32 v24, v23
    v_fmamk_f32 v25, v22, 0x3f800000, v23
    v_cos_f32_e64 v25, v25
    v_fmamk_f32 v26, v22, 0x40000000, v23
    v_cos_f32_e64 v26, v26
    v_fmamk_f32 v27, v22, 0x40400000, v23
    v_cos_f32_e64 v27, v27
    v_fmamk_f32 v28, v22, 0x40800000, v23
    v_cos_f32_e64 v28, v28
    v_fmamk_f32 v29, v22, 0x40a00000, v23
    v_cos_f32_e64 v29, v29
    v_fmamk_f32 v30, v22, 0x40c00000, v23
    v_cos_f32_e64 v30, v30
    v_fmamk_f32 v31, v22, 0x40e00000, v23
    v_cos_f32_e64 v31, v31
    v_cndmask_b32 v24, v24, v20, s[54:55]
    v_cvt_pk_bf16_f32 v24, v24, v25
    v_accvgpr_write_b32 a252, v24
    v_cvt_pk_bf16_f32 v26, v26, v27
    v_accvgpr_write_b32 a253, v26
    v_cvt_pk_bf16_f32 v28, v28, v29
    v_accvgpr_write_b32 a254, v28
    v_cvt_pk_bf16_f32 v30, v30, v31
    v_accvgpr_write_b32 a255, v30
    v_fmamk_f32 v24, v22, 0x42000000, v23
    v_cos_f32_e64 v24, v24
    v_fmamk_f32 v25, v22, 0x42040000, v23
    v_cos_f32_e64 v25, v25
    v_fmamk_f32 v26, v22, 0x42080000, v23
    v_cos_f32_e64 v26, v26
    v_fmamk_f32 v27, v22, 0x420c0000, v23
    v_cos_f32_e64 v27, v27
    v_fmamk_f32 v28, v22, 0x42100000, v23
    v_cos_f32_e64 v28, v28
    v_fmamk_f32 v29, v22, 0x42140000, v23
    v_cos_f32_e64 v29, v29
    v_fmamk_f32 v30, v22, 0x42180000, v23
    v_cos_f32_e64 v30, v30
    v_fmamk_f32 v31, v22, 0x421c0000, v23
    v_cos_f32_e64 v31, v31
    v_cvt_pk_bf16_f32 v188, v24, v25
    v_cvt_pk_bf16_f32 v189, v26, v27
    v_cvt_pk_bf16_f32 v190, v28, v29
    v_cvt_pk_bf16_f32 v191, v30, v31
    v_fmamk_f32 v24, v22, 0x42800000, v23
    v_cos_f32_e64 v24, v24
    v_fmamk_f32 v25, v22, 0x42820000, v23
    v_cos_f32_e64 v25, v25
    v_fmamk_f32 v26, v22, 0x42840000, v23
    v_cos_f32_e64 v26, v26
    v_fmamk_f32 v27, v22, 0x42860000, v23
    v_cos_f32_e64 v27, v27
    v_fmamk_f32 v28, v22, 0x42880000, v23
    v_cos_f32_e64 v28, v28
    v_fmamk_f32 v29, v22, 0x428a0000, v23
    v_cos_f32_e64 v29, v29
    v_fmamk_f32 v30, v22, 0x428c0000, v23
    v_cos_f32_e64 v30, v30
    v_fmamk_f32 v31, v22, 0x428e0000, v23
    v_cos_f32_e64 v31, v31
    v_cvt_pk_bf16_f32 v192, v24, v25
    v_cvt_pk_bf16_f32 v193, v26, v27
    v_cvt_pk_bf16_f32 v194, v28, v29
    v_cvt_pk_bf16_f32 v195, v30, v31
    v_fmamk_f32 v24, v22, 0x42c00000, v23
    v_cos_f32_e64 v24, v24
    v_fmamk_f32 v25, v22, 0x42c20000, v23
    v_cos_f32_e64 v25, v25
    v_fmamk_f32 v26, v22, 0x42c40000, v23
    v_cos_f32_e64 v26, v26
    v_fmamk_f32 v27, v22, 0x42c60000, v23
    v_cos_f32_e64 v27, v27
    v_fmamk_f32 v28, v22, 0x42c80000, v23
    v_cos_f32_e64 v28, v28
    v_fmamk_f32 v29, v22, 0x42ca0000, v23
    v_cos_f32_e64 v29, v29
    v_fmamk_f32 v30, v22, 0x42cc0000, v23
    v_cos_f32_e64 v30, v30
    v_fmamk_f32 v31, v22, 0x42ce0000, v23
    v_cos_f32_e64 v31, v31
    v_cvt_pk_bf16_f32 v196, v24, v25
    v_cvt_pk_bf16_f32 v197, v26, v27
    v_cvt_pk_bf16_f32 v198, v28, v29
    v_cvt_pk_bf16_f32 v199, v30, v31
    v_fmamk_f32 v24, v22, 0x43000000, v23
    v_cos_f32_e64 v24, v24
    v_fmamk_f32 v25, v22, 0x43010000, v23
    v_cos_f32_e64 v25, v25
    v_fmamk_f32 v26, v22, 0x43020000, v23
    v_cos_f32_e64 v26, v26
    v_fmamk_f32 v27, v22, 0x43030000, v23
    v_cos_f32_e64 v27, v27
    v_fmamk_f32 v28, v22, 0x43040000, v23
    v_cos_f32_e64 v28, v28
    v_fmamk_f32 v29, v22, 0x43050000, v23
    v_cos_f32_e64 v29, v29
    v_fmamk_f32 v30, v22, 0x43060000, v23
    v_cos_f32_e64 v30, v30
    v_fmamk_f32 v31, v22, 0x43070000, v23
    v_cos_f32_e64 v31, v31
    v_cvt_pk_bf16_f32 v200, v24, v25
    v_cvt_pk_bf16_f32 v201, v26, v27
    v_cvt_pk_bf16_f32 v202, v28, v29
    v_cvt_pk_bf16_f32 v203, v30, v31
    v_fmamk_f32 v24, v22, 0x43200000, v23
    v_cos_f32_e64 v24, v24
    v_fmamk_f32 v25, v22, 0x43210000, v23
    v_cos_f32_e64 v25, v25
    v_fmamk_f32 v26, v22, 0x43220000, v23
    v_cos_f32_e64 v26, v26
    v_fmamk_f32 v27, v22, 0x43230000, v23
    v_cos_f32_e64 v27, v27
    v_fmamk_f32 v28, v22, 0x43240000, v23
    v_cos_f32_e64 v28, v28
    v_fmamk_f32 v29, v22, 0x43250000, v23
    v_cos_f32_e64 v29, v29
    v_fmamk_f32 v30, v22, 0x43260000, v23
    v_cos_f32_e64 v30, v30
    v_fmamk_f32 v31, v22, 0x43270000, v23
    v_cos_f32_e64 v31, v31
    v_cvt_pk_bf16_f32 v204, v24, v25
    v_cvt_pk_bf16_f32 v205, v26, v27
    v_cvt_pk_bf16_f32 v206, v28, v29
    v_cvt_pk_bf16_f32 v207, v30, v31
    v_fmamk_f32 v24, v22, 0x43400000, v23
    v_cos_f32_e64 v24, v24
    v_fmamk_f32 v25, v22, 0x43410000, v23
    v_cos_f32_e64 v25, v25
    v_fmamk_f32 v26, v22, 0x43420000, v23
    v_cos_f32_e64 v26, v26
    v_fmamk_f32 v27, v22, 0x43430000, v23
    v_cos_f32_e64 v27, v27
    v_fmamk_f32 v28, v22, 0x43440000, v23
    v_cos_f32_e64 v28, v28
    v_fmamk_f32 v29, v22, 0x43450000, v23
    v_cos_f32_e64 v29, v29
    v_fmamk_f32 v30, v22, 0x43460000, v23
    v_cos_f32_e64 v30, v30
    v_fmamk_f32 v31, v22, 0x43470000, v23
    v_cos_f32_e64 v31, v31
    v_cvt_pk_bf16_f32 v208, v24, v25
    v_cvt_pk_bf16_f32 v209, v26, v27
    v_cvt_pk_bf16_f32 v210, v28, v29
    v_cvt_pk_bf16_f32 v211, v30, v31
    v_fmamk_f32 v24, v22, 0x43600000, v23
    v_cos_f32_e64 v24, v24
    v_fmamk_f32 v25, v22, 0x43610000, v23
    v_cos_f32_e64 v25, v25
    v_fmamk_f32 v26, v22, 0x43620000, v23
    v_cos_f32_e64 v26, v26
    v_fmamk_f32 v27, v22, 0x43630000, v23
    v_cos_f32_e64 v27, v27
    v_fmamk_f32 v28, v22, 0x43640000, v23
    v_cos_f32_e64 v28, v28
    v_fmamk_f32 v29, v22, 0x43650000, v23
    v_cos_f32_e64 v29, v29
    v_fmamk_f32 v30, v22, 0x43660000, v23
    v_cos_f32_e64 v30, v30
    v_fmamk_f32 v31, v22, 0x43670000, v23
    v_cos_f32_e64 v31, v31
    v_cvt_pk_bf16_f32 v212, v24, v25
    v_cvt_pk_bf16_f32 v213, v26, v27
    v_cvt_pk_bf16_f32 v214, v28, v29
    v_cvt_pk_bf16_f32 v215, v30, v31
    v_fmamk_f32 v24, v22, 0x43800000, v23
    v_cos_f32_e64 v24, v24
    v_fmamk_f32 v25, v22, 0x43808000, v23
    v_cos_f32_e64 v25, v25
    v_fmamk_f32 v26, v22, 0x43810000, v23
    v_cos_f32_e64 v26, v26
    v_fmamk_f32 v27, v22, 0x43818000, v23
    v_cos_f32_e64 v27, v27
    v_fmamk_f32 v28, v22, 0x43820000, v23
    v_cos_f32_e64 v28, v28
    v_fmamk_f32 v29, v22, 0x43828000, v23
    v_cos_f32_e64 v29, v29
    v_fmamk_f32 v30, v22, 0x43830000, v23
    v_cos_f32_e64 v30, v30
    v_fmamk_f32 v31, v22, 0x43838000, v23
    v_cos_f32_e64 v31, v31
    v_cvt_pk_bf16_f32 v216, v24, v25
    v_cvt_pk_bf16_f32 v217, v26, v27
    v_cvt_pk_bf16_f32 v218, v28, v29
    v_cvt_pk_bf16_f32 v219, v30, v31
    v_add_u32 v21, 128, v16
    v_cvt_f32_u32 v21, v21
    v_mov_b32 v22, s57
    v_fmac_f32 v22, 0x3ae38e39, v21
    v_mov_b32 v23, s56
    v_fmac_f32 v23, s58, v21
    v_fmac_f32 v23, v17, v22
    v_cos_f32 v24, v23
    v_fmamk_f32 v25, v22, 0x3f800000, v23
    v_cos_f32_e64 v25, v25
    v_fmamk_f32 v26, v22, 0x40000000, v23
    v_cos_f32_e64 v26, v26
    v_fmamk_f32 v27, v22, 0x40400000, v23
    v_cos_f32_e64 v27, v27
    v_fmamk_f32 v28, v22, 0x40800000, v23
    v_cos_f32_e64 v28, v28
    v_fmamk_f32 v29, v22, 0x40a00000, v23
    v_cos_f32_e64 v29, v29
    v_fmamk_f32 v30, v22, 0x40c00000, v23
    v_cos_f32_e64 v30, v30
    v_fmamk_f32 v31, v22, 0x40e00000, v23
    v_cos_f32_e64 v31, v31
    v_cndmask_b32 v24, v24, v20, s[54:55]
    v_cvt_pk_bf16_f32 v220, v24, v25
    v_cvt_pk_bf16_f32 v221, v26, v27
    v_cvt_pk_bf16_f32 v222, v28, v29
    v_cvt_pk_bf16_f32 v223, v30, v31
    v_fmamk_f32 v24, v22, 0x42000000, v23
    v_cos_f32_e64 v24, v24
    v_fmamk_f32 v25, v22, 0x42040000, v23
    v_cos_f32_e64 v25, v25
    v_fmamk_f32 v26, v22, 0x42080000, v23
    v_cos_f32_e64 v26, v26
    v_fmamk_f32 v27, v22, 0x420c0000, v23
    v_cos_f32_e64 v27, v27
    v_fmamk_f32 v28, v22, 0x42100000, v23
    v_cos_f32_e64 v28, v28
    v_fmamk_f32 v29, v22, 0x42140000, v23
    v_cos_f32_e64 v29, v29
    v_fmamk_f32 v30, v22, 0x42180000, v23
    v_cos_f32_e64 v30, v30
    v_fmamk_f32 v31, v22, 0x421c0000, v23
    v_cos_f32_e64 v31, v31
    v_cvt_pk_bf16_f32 v224, v24, v25
    v_cvt_pk_bf16_f32 v225, v26, v27
    v_cvt_pk_bf16_f32 v226, v28, v29
    v_cvt_pk_bf16_f32 v227, v30, v31
    v_fmamk_f32 v24, v22, 0x42800000, v23
    v_cos_f32_e64 v24, v24
    v_fmamk_f32 v25, v22, 0x42820000, v23
    v_cos_f32_e64 v25, v25
    v_fmamk_f32 v26, v22, 0x42840000, v23
    v_cos_f32_e64 v26, v26
    v_fmamk_f32 v27, v22, 0x42860000, v23
    v_cos_f32_e64 v27, v27
    v_fmamk_f32 v28, v22, 0x42880000, v23
    v_cos_f32_e64 v28, v28
    v_fmamk_f32 v29, v22, 0x428a0000, v23
    v_cos_f32_e64 v29, v29
    v_fmamk_f32 v30, v22, 0x428c0000, v23
    v_cos_f32_e64 v30, v30
    v_fmamk_f32 v31, v22, 0x428e0000, v23
    v_cos_f32_e64 v31, v31
    v_cvt_pk_bf16_f32 v228, v24, v25
    v_cvt_pk_bf16_f32 v229, v26, v27
    v_cvt_pk_bf16_f32 v230, v28, v29
    v_cvt_pk_bf16_f32 v231, v30, v31
    v_fmamk_f32 v24, v22, 0x42c00000, v23
    v_cos_f32_e64 v24, v24
    v_fmamk_f32 v25, v22, 0x42c20000, v23
    v_cos_f32_e64 v25, v25
    v_fmamk_f32 v26, v22, 0x42c40000, v23
    v_cos_f32_e64 v26, v26
    v_fmamk_f32 v27, v22, 0x42c60000, v23
    v_cos_f32_e64 v27, v27
    v_fmamk_f32 v28, v22, 0x42c80000, v23
    v_cos_f32_e64 v28, v28
    v_fmamk_f32 v29, v22, 0x42ca0000, v23
    v_cos_f32_e64 v29, v29
    v_fmamk_f32 v30, v22, 0x42cc0000, v23
    v_cos_f32_e64 v30, v30
    v_fmamk_f32 v31, v22, 0x42ce0000, v23
    v_cos_f32_e64 v31, v31
    v_cvt_pk_bf16_f32 v232, v24, v25
    v_cvt_pk_bf16_f32 v233, v26, v27
    v_cvt_pk_bf16_f32 v234, v28, v29
    v_cvt_pk_bf16_f32 v235, v30, v31
    v_fmamk_f32 v24, v22, 0x43000000, v23
    v_cos_f32_e64 v24, v24
    v_fmamk_f32 v25, v22, 0x43010000, v23
    v_cos_f32_e64 v25, v25
    v_fmamk_f32 v26, v22, 0x43020000, v23
    v_cos_f32_e64 v26, v26
    v_fmamk_f32 v27, v22, 0x43030000, v23
    v_cos_f32_e64 v27, v27
    v_fmamk_f32 v28, v22, 0x43040000, v23
    v_cos_f32_e64 v28, v28
    v_fmamk_f32 v29, v22, 0x43050000, v23
    v_cos_f32_e64 v29, v29
    v_fmamk_f32 v30, v22, 0x43060000, v23
    v_cos_f32_e64 v30, v30
    v_fmamk_f32 v31, v22, 0x43070000, v23
    v_cos_f32_e64 v31, v31
    v_cvt_pk_bf16_f32 v236, v24, v25
    v_cvt_pk_bf16_f32 v237, v26, v27
    v_cvt_pk_bf16_f32 v238, v28, v29
    v_cvt_pk_bf16_f32 v239, v30, v31
    v_fmamk_f32 v24, v22, 0x43200000, v23
    v_cos_f32_e64 v24, v24
    v_fmamk_f32 v25, v22, 0x43210000, v23
    v_cos_f32_e64 v25, v25
    v_fmamk_f32 v26, v22, 0x43220000, v23
    v_cos_f32_e64 v26, v26
    v_fmamk_f32 v27, v22, 0x43230000, v23
    v_cos_f32_e64 v27, v27
    v_fmamk_f32 v28, v22, 0x43240000, v23
    v_cos_f32_e64 v28, v28
    v_fmamk_f32 v29, v22, 0x43250000, v23
    v_cos_f32_e64 v29, v29
    v_fmamk_f32 v30, v22, 0x43260000, v23
    v_cos_f32_e64 v30, v30
    v_fmamk_f32 v31, v22, 0x43270000, v23
    v_cos_f32_e64 v31, v31
    v_cvt_pk_bf16_f32 v240, v24, v25
    v_cvt_pk_bf16_f32 v241, v26, v27
    v_cvt_pk_bf16_f32 v242, v28, v29
    v_cvt_pk_bf16_f32 v243, v30, v31
    v_fmamk_f32 v24, v22, 0x43400000, v23
    v_cos_f32_e64 v24, v24
    v_fmamk_f32 v25, v22, 0x43410000, v23
    v_cos_f32_e64 v25, v25
    v_fmamk_f32 v26, v22, 0x43420000, v23
    v_cos_f32_e64 v26, v26
    v_fmamk_f32 v27, v22, 0x43430000, v23
    v_cos_f32_e64 v27, v27
    v_fmamk_f32 v28, v22, 0x43440000, v23
    v_cos_f32_e64 v28, v28
    v_fmamk_f32 v29, v22, 0x43450000, v23
    v_cos_f32_e64 v29, v29
    v_fmamk_f32 v30, v22, 0x43460000, v23
    v_cos_f32_e64 v30, v30
    v_fmamk_f32 v31, v22, 0x43470000, v23
    v_cos_f32_e64 v31, v31
    v_cvt_pk_bf16_f32 v244, v24, v25
    v_cvt_pk_bf16_f32 v245, v26, v27
    v_cvt_pk_bf16_f32 v246, v28, v29
    v_cvt_pk_bf16_f32 v247, v30, v31
    v_fmamk_f32 v24, v22, 0x43600000, v23
    v_cos_f32_e64 v24, v24
    v_fmamk_f32 v25, v22, 0x43610000, v23
    v_cos_f32_e64 v25, v25
    v_fmamk_f32 v26, v22, 0x43620000, v23
    v_cos_f32_e64 v26, v26
    v_fmamk_f32 v27, v22, 0x43630000, v23
    v_cos_f32_e64 v27, v27
    v_fmamk_f32 v28, v22, 0x43640000, v23
    v_cos_f32_e64 v28, v28
    v_fmamk_f32 v29, v22, 0x43650000, v23
    v_cos_f32_e64 v29, v29
    v_fmamk_f32 v30, v22, 0x43660000, v23
    v_cos_f32_e64 v30, v30
    v_fmamk_f32 v31, v22, 0x43670000, v23
    v_cos_f32_e64 v31, v31
    v_cvt_pk_bf16_f32 v248, v24, v25
    v_cvt_pk_bf16_f32 v249, v26, v27
    v_cvt_pk_bf16_f32 v250, v28, v29
    v_cvt_pk_bf16_f32 v251, v30, v31
    v_fmamk_f32 v24, v22, 0x43800000, v23
    v_cos_f32_e64 v24, v24
    v_fmamk_f32 v25, v22, 0x43808000, v23
    v_cos_f32_e64 v25, v25
    v_fmamk_f32 v26, v22, 0x43810000, v23
    v_cos_f32_e64 v26, v26
    v_fmamk_f32 v27, v22, 0x43818000, v23
    v_cos_f32_e64 v27, v27
    v_fmamk_f32 v28, v22, 0x43820000, v23
    v_cos_f32_e64 v28, v28
    v_fmamk_f32 v29, v22, 0x43828000, v23
    v_cos_f32_e64 v29, v29
    v_fmamk_f32 v30, v22, 0x43830000, v23
    v_cos_f32_e64 v30, v30
    v_fmamk_f32 v31, v22, 0x43838000, v23
    v_cos_f32_e64 v31, v31
    v_cvt_pk_bf16_f32 v252, v24, v25
    v_cvt_pk_bf16_f32 v253, v26, v27
    v_cvt_pk_bf16_f32 v254, v28, v29
    v_cvt_pk_bf16_f32 v255, v30, v31
    v_and_b32 v16, 31, v0
    v_cvt_f32_u32 v16, v16
    v_lshrrev_b32 v17, 5, v0
    v_lshlrev_b32 v17, 2, v17
    v_cvt_f32_u32 v17, v17
    v_cvt_f32_u32 v18, s32
    s_lshl_b32 s44, s32, 10
    v_add_u32 v19, s44, v6
    v_mov_b32_e64 v20, v17
    v_fmac_f32 v20, 0x41800000, v18
    v_add_f32_e64 v21, 0x0, v16
    v_mul_f32 v21, 0x3c800000, v21
    v_add_f32 v24, 0x0, v20
    v_mul_f32 v24, v24, v21
    v_sin_f32 v32, v24
    v_cos_f32 v24, v24
    v_add_f32 v25, 0x3f800000, v20
    v_mul_f32 v25, v25, v21
    v_sin_f32 v33, v25
    v_cos_f32 v25, v25
    v_add_f32 v26, 0x40000000, v20
    v_mul_f32 v26, v26, v21
    v_sin_f32 v34, v26
    v_cos_f32 v26, v26
    v_add_f32 v27, 0x40400000, v20
    v_mul_f32 v27, v27, v21
    v_sin_f32 v35, v27
    v_cos_f32_e64 v27, v27
    v_add_f32 v28, 0x41000000, v20
    v_mul_f32 v28, v28, v21
    v_sin_f32 v36, v28
    v_cos_f32_e64 v28, v28
    v_add_f32 v29, 0x41100000, v20
    v_mul_f32 v29, v29, v21
    v_sin_f32 v37, v29
    v_cos_f32_e64 v29, v29
    v_add_f32 v30, 0x41200000, v20
    v_mul_f32 v30, v30, v21
    v_sin_f32 v38, v30
    v_cos_f32_e64 v30, v30
    v_add_f32 v31, 0x41300000, v20
    v_mul_f32 v31, v31, v21
    v_sin_f32 v39, v31
    v_cos_f32_e64 v31, v31
    v_cvt_pk_bf16_f32 v40, v24, v25
    v_cvt_pk_bf16_f32 v44, v32, v33
    v_xor_b32 v48, 0x80008000, v44
    v_cvt_pk_bf16_f32 v41, v26, v27
    v_cvt_pk_bf16_f32 v45, v34, v35
    v_xor_b32 v49, 0x80008000, v45
    v_cvt_pk_bf16_f32 v42, v28, v29
    v_cvt_pk_bf16_f32 v46, v36, v37
    v_xor_b32 v50, 0x80008000, v46
    v_cvt_pk_bf16_f32 v43, v30, v31
    v_cvt_pk_bf16_f32 v47, v38, v39
    v_xor_b32 v51, 0x80008000, v47
    ds_write_b128 v19, v[40:43] offset:0
    ds_write_b128 v19, v[44:47] offset:8192
    ds_write_b128 v19, v[48:51] offset:16384
    s_waitcnt lgkmcnt(0)
    v_add_f32 v21, 0x42000000, v16
    v_mul_f32 v21, 0x3c800000, v21
    v_add_f32 v24, 0x0, v20
    v_mul_f32 v24, v24, v21
    v_sin_f32 v32, v24
    v_cos_f32 v24, v24
    v_add_f32 v25, 0x3f800000, v20
    v_mul_f32 v25, v25, v21
    v_sin_f32 v33, v25
    v_cos_f32 v25, v25
    v_add_f32 v26, 0x40000000, v20
    v_mul_f32 v26, v26, v21
    v_sin_f32 v34, v26
    v_cos_f32_e64 v26, v26
    v_add_f32 v27, 0x40400000, v20
    v_mul_f32 v27, v27, v21
    v_sin_f32 v35, v27
    v_cos_f32_e64 v27, v27
    v_add_f32 v28, 0x41000000, v20
    v_mul_f32 v28, v28, v21
    v_sin_f32 v36, v28
    v_cos_f32_e64 v28, v28
    v_add_f32 v29, 0x41100000, v20
    v_mul_f32 v29, v29, v21
    v_sin_f32 v37, v29
    v_cos_f32_e64 v29, v29
    v_add_f32 v30, 0x41200000, v20
    v_mul_f32 v30, v30, v21
    v_sin_f32 v38, v30
    v_cos_f32_e64 v30, v30
    v_add_f32 v31, 0x41300000, v20
    v_mul_f32 v31, v31, v21
    v_sin_f32 v39, v31
    v_cos_f32_e64 v31, v31
    v_cvt_pk_bf16_f32 v40, v24, v25
    v_cvt_pk_bf16_f32 v44, v32, v33
    v_xor_b32 v48, 0x80008000, v44
    v_cvt_pk_bf16_f32 v41, v26, v27
    v_cvt_pk_bf16_f32 v45, v34, v35
    v_xor_b32 v49, 0x80008000, v45
    v_cvt_pk_bf16_f32 v42, v28, v29
    v_cvt_pk_bf16_f32 v46, v36, v37
    v_xor_b32 v50, 0x80008000, v46
    v_cvt_pk_bf16_f32 v43, v30, v31
    v_cvt_pk_bf16_f32 v47, v38, v39
    v_xor_b32 v51, 0x80008000, v47
    ds_write_b128 v19, v[40:43] offset:4096
    ds_write_b128 v19, v[44:47] offset:12288
    ds_write_b128 v19, v[48:51] offset:20480
    s_waitcnt lgkmcnt(0)
    s_cmp_ge_u32 s32, 2
    s_cbranch_scc1 L_nf32_65
    v_mul_f32 v21, 0x3d000000, v16
    v_add_f32 v24, 0x0, v20
    v_mul_f32 v24, v24, v21
    v_sin_f32 v32, v24
    v_cos_f32 v24, v24
    v_add_f32 v25, 0x3f800000, v20
    v_mul_f32 v25, v25, v21
    v_sin_f32 v33, v25
    v_cos_f32 v25, v25
    v_add_f32 v26, 0x40000000, v20
    v_mul_f32 v26, v26, v21
    v_sin_f32 v34, v26
    v_cos_f32_e64 v26, v26
    v_add_f32 v27, 0x40400000, v20
    v_mul_f32 v27, v27, v21
    v_sin_f32 v35, v27
    v_cos_f32_e64 v27, v27
    v_add_f32 v28, 0x41000000, v20
    v_mul_f32 v28, v28, v21
    v_sin_f32 v36, v28
    v_cos_f32_e64 v28, v28
    v_add_f32 v29, 0x41100000, v20
    v_mul_f32 v29, v29, v21
    v_sin_f32 v37, v29
    v_cos_f32_e64 v29, v29
    v_add_f32 v30, 0x41200000, v20
    v_mul_f32 v30, v30, v21
    v_sin_f32 v38, v30
    v_cos_f32_e64 v30, v30
    v_add_f32 v31, 0x41300000, v20
    v_mul_f32 v31, v31, v21
    v_sin_f32 v39, v31
    v_cos_f32_e64 v31, v31
    v_cvt_pk_bf16_f32 v40, v24, v25
    v_cvt_pk_bf16_f32 v44, v32, v33
    v_xor_b32 v48, 0x80008000, v44
    v_cvt_pk_bf16_f32 v41, v26, v27
    v_cvt_pk_bf16_f32 v45, v34, v35
    v_xor_b32 v49, 0x80008000, v45
    v_cvt_pk_bf16_f32 v42, v28, v29
    v_cvt_pk_bf16_f32 v46, v36, v37
    v_xor_b32 v50, 0x80008000, v46
    v_cvt_pk_bf16_f32 v43, v30, v31
    v_cvt_pk_bf16_f32 v47, v38, v39
    v_xor_b32 v51, 0x80008000, v47
    ds_write_b128 v19, v[40:43] offset:24576
    ds_write_b128 v19, v[44:47] offset:26624
    ds_write_b128 v19, v[48:51] offset:28672
    s_waitcnt lgkmcnt(0)
L_nf32_65:
    s_lshl_b32 s44, s32, 11
    v_add_u32 v19, s44, v6
    v_mov_b32 v20, v17
    v_fmac_f32 v20, 0x41000000, v18
    v_add_f32_e64 v21, 0x0, v16
    v_mul_f32 v21, 0x3a000000, v21
    v_add_f32 v24, 0x0, v20
    v_mul_f32 v24, v24, v21
    v_sin_f32 v28, v24
    v_cos_f32 v24, v24
    v_add_f32 v25, 0x3f800000, v20
    v_mul_f32 v25, v25, v21
    v_sin_f32 v29, v25
    v_cos_f32 v25, v25
    v_add_f32 v26, 0x40000000, v20
    v_mul_f32 v26, v26, v21
    v_sin_f32 v30, v26
    v_cos_f32 v26, v26
    v_add_f32 v27, 0x40400000, v20
    v_mul_f32 v27, v27, v21
    v_sin_f32 v31, v27
    v_cos_f32 v27, v27
    ds_write_b128 v19, v[24:27] offset:30720
    ds_write_b128 v19, v[28:31] offset:31744
    s_waitcnt lgkmcnt(0)
    v_add_f32 v21, 0x42000000, v16
    v_mul_f32 v21, 0x3a000000, v21
    v_add_f32 v24, 0x0, v20
    v_mul_f32 v24, v24, v21
    v_sin_f32 v28, v24
    v_cos_f32 v24, v24
    v_add_f32 v25, 0x3f800000, v20
    v_mul_f32 v25, v25, v21
    v_sin_f32 v29, v25
    v_cos_f32 v25, v25
    v_add_f32 v26, 0x40000000, v20
    v_mul_f32 v26, v26, v21
    v_sin_f32 v30, v26
    v_cos_f32 v26, v26
    v_add_f32 v27, 0x40400000, v20
    v_mul_f32 v27, v27, v21
    v_sin_f32 v31, v27
    v_cos_f32_e64 v27, v27
    ds_write_b128 v19, v[24:27] offset:38912
    ds_write_b128 v19, v[28:31] offset:39936
    s_waitcnt lgkmcnt(0)
    v_mov_b32 v21, v16
    v_mul_f32 v21, 0x3a000000, v21
    v_add_f32 v24, 0x0, v20
    v_mul_f32 v24, v24, v21
    v_sin_f32 v28, v24
    v_cos_f32 v24, v24
    v_add_f32 v25, 0x3f800000, v20
    v_mul_f32 v25, v25, v21
    v_sin_f32 v29, v25
    v_cos_f32 v25, v25
    v_add_f32 v26, 0x40000000, v20
    v_mul_f32 v26, v26, v21
    v_sin_f32 v30, v26
    v_cos_f32 v26, v26
    v_add_f32 v27, 0x40400000, v20
    v_mul_f32 v27, v27, v21
    v_sin_f32 v31, v27
    v_cos_f32_e64 v27, v27
    v_mul_f32 v24, 0x35e38e39, v24
    v_mul_f32 v25, 0x35e38e39, v25
    v_mul_f32 v26, 0x35e38e39, v26
    v_mul_f32 v27, 0x35e38e39, v27
    v_mul_f32 v28, 0x35e38e39, v28
    v_mul_f32 v29, 0x35e38e39, v29
    v_mul_f32 v30, 0x35e38e39, v30
    v_mul_f32 v31, 0x35e38e39, v31
    ds_write_b128 v19, v[24:27] offset:47104
    ds_write_b128 v19, v[28:31] offset:48128
    s_waitcnt lgkmcnt(0)
    v_mov_b32 v21, v16
    v_mul_f32 v21, 0x3a000000, v21
    v_add_f32 v24, 0x42000000, v20
    v_mul_f32 v24, v24, v21
    v_sin_f32 v28, v24
    v_cos_f32_e64 v24, v24
    v_add_f32 v25, 0x42040000, v20
    v_mul_f32 v25, v25, v21
    v_sin_f32 v29, v25
    v_cos_f32_e64 v25, v25
    v_add_f32 v26, 0x42080000, v20
    v_mul_f32 v26, v26, v21
    v_sin_f32 v30, v26
    v_cos_f32_e64 v26, v26
    v_add_f32 v27, 0x420c0000, v20
    v_mul_f32 v27, v27, v21
    v_sin_f32 v31, v27
    v_cos_f32_e64 v27, v27
    v_mul_f32 v24, 0x35e38e39, v24
    v_mul_f32 v25, 0x35e38e39, v25
    v_mul_f32 v26, 0x35e38e39, v26
    v_mul_f32 v27, 0x35e38e39, v27
    v_mul_f32 v28, 0x35e38e39, v28
    v_mul_f32 v29, 0x35e38e39, v29
    v_mul_f32 v30, 0x35e38e39, v30
    v_mul_f32 v31, 0x35e38e39, v31
    ds_write_b128 v19, v[24:27] offset:55296
    ds_write_b128 v19, v[28:31] offset:56320
    s_waitcnt lgkmcnt(0)
    v_lshrrev_b32 v16, 1, v12
    s_lshl_b32 s44, s41, 2
    v_add_u32 v16, s44, v16
    v_and_b32 v17, 1, v12
    v_or_b32 v19, v16, v17
    v_cmp_eq_u32_e64 vcc, 0, v16
    v_mov_b32 v20, 288
    s_nop 0
    v_cndmask_b32 v16, v16, v20, vcc
    v_cmp_gt_u32 vcc, 8, v12
    s_nop 1
    v_cndmask_b32 v16, 0, v16, vcc
    v_cvt_f32_u32 v16, v16
    v_cvt_f32_u32 v17, v17
    v_mov_b32 v21, 1.0
    v_cmp_ne_u32 vcc, 0, v19
    s_nop 1
    v_cndmask_b32 v21, 0, v21, vcc
    v_cmp_ge_u32 vcc, 8, v12
    s_nop 1
    v_cndmask_b32 v21, 0, v21, vcc
    v_mul_f32 v22, 0x3ae38e39, v16
    v_mul_f32 v23, 0x3a638e39, v16
    v_fmac_f32 v23, 0x3e800000, v17
    v_lshlrev_b32 v17, 3, v13
    s_lshl_b32 s44, s32, 5
    v_add_u32 v17, s44, v17
    v_cvt_f32_u32 v17, v17
    v_fmac_f32 v23, v17, v22
    s_lshl_b32 s44, s32, 10
    s_add_u32 s44, s44, 63488
    v_add_u32_e64 v19, s44, v6
    v_fmamk_f32 v24, v22, 0x0, v23
    v_fract_f32 v24, v24
    v_cos_f32 v24, v24
    v_fmamk_f32 v25, v22, 0x3f800000, v23
    v_fract_f32 v25, v25
    v_cos_f32 v25, v25
    v_fmamk_f32 v26, v22, 0x40000000, v23
    v_fract_f32 v26, v26
    v_cos_f32 v26, v26
    v_fmamk_f32 v27, v22, 0x40400000, v23
    v_fract_f32 v27, v27
    v_cos_f32 v27, v27
    v_fmamk_f32 v28, v22, 0x40800000, v23
    v_fract_f32 v28, v28
    v_cos_f32 v28, v28
    v_fmamk_f32 v29, v22, 0x40a00000, v23
    v_fract_f32 v29, v29
    v_cos_f32 v29, v29
    v_fmamk_f32 v30, v22, 0x40c00000, v23
    v_fract_f32 v30, v30
    v_cos_f32 v30, v30
    v_fmamk_f32 v31, v22, 0x40e00000, v23
    v_fract_f32 v31, v31
    v_cos_f32 v31, v31
    v_mul_f32 v24, v21, v24
    v_mul_f32 v25, v21, v25
    v_mul_f32 v26, v21, v26
    v_mul_f32 v27, v21, v27
    v_mul_f32 v28, v21, v28
    v_mul_f32 v29, v21, v29
    v_mul_f32 v30, v21, v30
    v_mul_f32 v31, v21, v31
    v_cvt_pk_bf16_f32 v32, v24, v25
    v_cvt_pk_bf16_f32 v33, v26, v27
    v_cvt_pk_bf16_f32 v34, v28, v29
    v_cvt_pk_bf16_f32 v35, v30, v31
    ds_write_b128 v19, v[32:35] offset:0
    s_waitcnt lgkmcnt(0)
    v_fmamk_f32 v24, v22, 0x43000000, v23
    v_fract_f32 v24, v24
    v_cos_f32_e64 v24, v24
    v_fmamk_f32 v25, v22, 0x43010000, v23
    v_fract_f32 v25, v25
    v_cos_f32 v25, v25
    v_fmamk_f32 v26, v22, 0x43020000, v23
    v_fract_f32 v26, v26
    v_cos_f32 v26, v26
    v_fmamk_f32 v27, v22, 0x43030000, v23
    v_fract_f32 v27, v27
    v_cos_f32 v27, v27
    v_fmamk_f32 v28, v22, 0x43040000, v23
    v_fract_f32 v28, v28
    v_cos_f32 v28, v28
    v_fmamk_f32 v29, v22, 0x43050000, v23
    v_fract_f32 v29, v29
    v_cos_f32 v29, v29
    v_fmamk_f32 v30, v22, 0x43060000, v23
    v_fract_f32 v30, v30
    v_cos_f32 v30, v30
    v_fmamk_f32 v31, v22, 0x43070000, v23
    v_fract_f32 v31, v31
    v_cos_f32 v31, v31
    v_mul_f32 v24, v21, v24
    v_mul_f32 v25, v21, v25
    v_mul_f32 v26, v21, v26
    v_mul_f32 v27, v21, v27
    v_mul_f32 v28, v21, v28
    v_mul_f32 v29, v21, v29
    v_mul_f32 v30, v21, v30
    v_mul_f32 v31, v21, v31
    v_cvt_pk_bf16_f32 v32, v24, v25
    v_cvt_pk_bf16_f32 v33, v26, v27
    v_cvt_pk_bf16_f32 v34, v28, v29
    v_cvt_pk_bf16_f32 v35, v30, v31
    ds_write_b128 v19, v[32:35] offset:4096
    s_waitcnt lgkmcnt(0)
    v_fmamk_f32 v24, v22, 0x43800000, v23
    v_fract_f32 v24, v24
    v_cos_f32_e64 v24, v24
    v_fmamk_f32 v25, v22, 0x43808000, v23
    v_fract_f32 v25, v25
    v_cos_f32 v25, v25
    v_fmamk_f32 v26, v22, 0x43810000, v23
    v_fract_f32 v26, v26
    v_cos_f32 v26, v26
    v_fmamk_f32 v27, v22, 0x43818000, v23
    v_fract_f32 v27, v27
    v_cos_f32 v27, v27
    v_fmamk_f32 v28, v22, 0x43820000, v23
    v_fract_f32 v28, v28
    v_cos_f32 v28, v28
    v_fmamk_f32 v29, v22, 0x43828000, v23
    v_fract_f32 v29, v29
    v_cos_f32 v29, v29
    v_fmamk_f32 v30, v22, 0x43830000, v23
    v_fract_f32 v30, v30
    v_cos_f32 v30, v30
    v_fmamk_f32 v31, v22, 0x43838000, v23
    v_fract_f32 v31, v31
    v_cos_f32 v31, v31
    v_mul_f32 v24, v21, v24
    v_mul_f32 v25, v21, v25
    v_mul_f32 v26, v21, v26
    v_mul_f32 v27, v21, v27
    v_mul_f32 v28, v21, v28
    v_mul_f32 v29, v21, v29
    v_mul_f32 v30, v21, v30
    v_mul_f32 v31, v21, v31
    v_cvt_pk_bf16_f32 v32, v24, v25
    v_cvt_pk_bf16_f32 v33, v26, v27
    v_cvt_pk_bf16_f32 v34, v28, v29
    v_cvt_pk_bf16_f32 v35, v30, v31
    ds_write_b128 v19, v[32:35] offset:8192
    s_waitcnt lgkmcnt(0)
    v_fmamk_f32 v24, v22, 0x43c00000, v23
    v_fract_f32 v24, v24
    v_cos_f32_e64 v24, v24
    v_fmamk_f32 v25, v22, 0x43c08000, v23
    v_fract_f32 v25, v25
    v_cos_f32 v25, v25
    v_fmamk_f32 v26, v22, 0x43c10000, v23
    v_fract_f32 v26, v26
    v_cos_f32 v26, v26
    v_fmamk_f32 v27, v22, 0x43c18000, v23
    v_fract_f32 v27, v27
    v_cos_f32 v27, v27
    v_fmamk_f32 v28, v22, 0x43c20000, v23
    v_fract_f32 v28, v28
    v_cos_f32 v28, v28
    v_fmamk_f32 v29, v22, 0x43c28000, v23
    v_fract_f32 v29, v29
    v_cos_f32 v29, v29
    v_fmamk_f32 v30, v22, 0x43c30000, v23
    v_fract_f32 v30, v30
    v_cos_f32 v30, v30
    v_fmamk_f32 v31, v22, 0x43c38000, v23
    v_fract_f32 v31, v31
    v_cos_f32 v31, v31
    v_mul_f32 v24, v21, v24
    v_mul_f32 v25, v21, v25
    v_mul_f32 v26, v21, v26
    v_mul_f32 v27, v21, v27
    v_mul_f32 v28, v21, v28
    v_mul_f32 v29, v21, v29
    v_mul_f32 v30, v21, v30
    v_mul_f32 v31, v21, v31
    v_cvt_pk_bf16_f32 v32, v24, v25
    v_cvt_pk_bf16_f32 v33, v26, v27
    v_cvt_pk_bf16_f32 v34, v28, v29
    v_cvt_pk_bf16_f32 v35, v30, v31
    ds_write_b128 v19, v[32:35] offset:12288
    s_waitcnt lgkmcnt(0)
    s_cmp_ge_u32 s32, 2
    s_cbranch_scc1 L_td5_66
    v_fmamk_f32 v24, v22, 0x44000000, v23
    v_fract_f32 v24, v24
    v_cos_f32_e64 v24, v24
    v_fmamk_f32 v25, v22, 0x44004000, v23
    v_fract_f32 v25, v25
    v_cos_f32 v25, v25
    v_fmamk_f32 v26, v22, 0x44008000, v23
    v_fract_f32 v26, v26
    v_cos_f32 v26, v26
    v_fmamk_f32 v27, v22, 0x4400c000, v23
    v_fract_f32 v27, v27
    v_cos_f32 v27, v27
    v_fmamk_f32 v28, v22, 0x44010000, v23
    v_fract_f32 v28, v28
    v_cos_f32 v28, v28
    v_fmamk_f32 v29, v22, 0x44014000, v23
    v_fract_f32 v29, v29
    v_cos_f32 v29, v29
    v_fmamk_f32 v30, v22, 0x44018000, v23
    v_fract_f32 v30, v30
    v_cos_f32 v30, v30
    v_fmamk_f32 v31, v22, 0x4401c000, v23
    v_fract_f32 v31, v31
    v_cos_f32 v31, v31
    v_mul_f32 v24, v21, v24
    v_mul_f32 v25, v21, v25
    v_mul_f32 v26, v21, v26
    v_mul_f32 v27, v21, v27
    v_mul_f32 v28, v21, v28
    v_mul_f32 v29, v21, v29
    v_mul_f32 v30, v21, v30
    v_mul_f32 v31, v21, v31
    v_cvt_pk_bf16_f32 v32, v24, v25
    v_cvt_pk_bf16_f32 v33, v26, v27
    v_cvt_pk_bf16_f32 v34, v28, v29
    v_cvt_pk_bf16_f32 v35, v30, v31
    ds_write_b128 v19, v[32:35] offset:16384
    s_waitcnt lgkmcnt(0)
L_td5_66:
    s_cmp_eq_u32 s47, 0
    s_cselect_b32 s44, 288, s47
    s_lshl_b32 s44, s44, 1
    v_and_b32 v16, 31, v0
    v_lshrrev_b32_e64 v17, 5, v0
    v_lshl_add_u32 v16, v17, 8, v16
    v_mul_u32_u24 v16, 578, v16
    v_add_u32 v16, s44, v16
    s_mov_b32 s44, 0x0
    buffer_load_ushort v156, v16, s[24:27], s44 offen
    buffer_load_ushort v24, v16, s[28:31], s44 offen
    s_mov_b32 s44, 0x9080
    buffer_load_ushort v157, v16, s[24:27], s44 offen
    buffer_load_ushort v25, v16, s[28:31], s44 offen
    s_mov_b32 s44, 0x12100
    buffer_load_ushort v158, v16, s[24:27], s44 offen
    buffer_load_ushort v26, v16, s[28:31], s44 offen
    s_mov_b32 s44, 0x1b180
    buffer_load_ushort v159, v16, s[24:27], s44 offen
    buffer_load_ushort v27, v16, s[28:31], s44 offen
    s_mov_b32 s44, 0x48400
    buffer_load_ushort v160, v16, s[24:27], s44 offen
    buffer_load_ushort v28, v16, s[28:31], s44 offen
    s_mov_b32 s44, 0x51480
    buffer_load_ushort v161, v16, s[24:27], s44 offen
    buffer_load_ushort v29, v16, s[28:31], s44 offen
    s_mov_b32 s44, 0x5a500
    buffer_load_ushort v162, v16, s[24:27], s44 offen
    buffer_load_ushort v30, v16, s[28:31], s44 offen
    s_mov_b32 s44, 0x63580
    buffer_load_ushort v163, v16, s[24:27], s44 offen
    buffer_load_ushort v31, v16, s[28:31], s44 offen
    s_mov_b32 s44, 0x90800
    buffer_load_ushort v164, v16, s[24:27], s44 offen
    buffer_load_ushort v32, v16, s[28:31], s44 offen
    s_mov_b32 s44, 0x99880
    buffer_load_ushort v165, v16, s[24:27], s44 offen
    buffer_load_ushort v33, v16, s[28:31], s44 offen
    s_mov_b32 s44, 0xa2900
    buffer_load_ushort v166, v16, s[24:27], s44 offen
    buffer_load_ushort v34, v16, s[28:31], s44 offen
    s_mov_b32 s44, 0xab980
    buffer_load_ushort v167, v16, s[24:27], s44 offen
    buffer_load_ushort v35, v16, s[28:31], s44 offen
    s_mov_b32 s44, 0xd8c00
    buffer_load_ushort v168, v16, s[24:27], s44 offen
    buffer_load_ushort v36, v16, s[28:31], s44 offen
    s_mov_b32 s44, 0xe1c80
    buffer_load_ushort v169, v16, s[24:27], s44 offen
    buffer_load_ushort v37, v16, s[28:31], s44 offen
    s_mov_b32 s44, 0xead00
    buffer_load_ushort v170, v16, s[24:27], s44 offen
    buffer_load_ushort v38, v16, s[28:31], s44 offen
    s_mov_b32 s44, 0xf3d80
    buffer_load_ushort v171, v16, s[24:27], s44 offen
    buffer_load_ushort v39, v16, s[28:31], s44 offen
    s_waitcnt vmcnt(0)
    v_lshl_or_b32 v156, v24, 16, v156
    v_lshl_or_b32 v157, v25, 16, v157
    v_lshl_or_b32 v158, v26, 16, v158
    v_lshl_or_b32 v159, v27, 16, v159
    v_lshl_or_b32 v160, v28, 16, v160
    v_lshl_or_b32 v161, v29, 16, v161
    v_lshl_or_b32 v162, v30, 16, v162
    v_lshl_or_b32 v163, v31, 16, v163
    v_lshl_or_b32 v164, v32, 16, v164
    v_lshl_or_b32 v165, v33, 16, v165
    v_lshl_or_b32 v166, v34, 16, v166
    v_lshl_or_b32 v167, v35, 16, v167
    v_lshl_or_b32 v168, v36, 16, v168
    v_lshl_or_b32 v169, v37, 16, v169
    v_lshl_or_b32 v170, v38, 16, v170
    v_lshl_or_b32 v171, v39, 16, v171
    s_mov_b32 s44, 0x4840
    buffer_load_ushort v172, v16, s[24:27], s44 offen
    buffer_load_ushort v24, v16, s[28:31], s44 offen
    s_mov_b32 s44, 0xd8c0
    buffer_load_ushort v173, v16, s[24:27], s44 offen
    buffer_load_ushort v25, v16, s[28:31], s44 offen
    s_mov_b32 s44, 0x16940
    buffer_load_ushort v174, v16, s[24:27], s44 offen
    buffer_load_ushort v26, v16, s[28:31], s44 offen
    s_mov_b32 s44, 0x1f9c0
    buffer_load_ushort v175, v16, s[24:27], s44 offen
    buffer_load_ushort v27, v16, s[28:31], s44 offen
    s_mov_b32 s44, 0x4cc40
    buffer_load_ushort v176, v16, s[24:27], s44 offen
    buffer_load_ushort v28, v16, s[28:31], s44 offen
    s_mov_b32 s44, 0x55cc0
    buffer_load_ushort v177, v16, s[24:27], s44 offen
    buffer_load_ushort v29, v16, s[28:31], s44 offen
    s_mov_b32 s44, 0x5ed40
    buffer_load_ushort v178, v16, s[24:27], s44 offen
    buffer_load_ushort v30, v16, s[28:31], s44 offen
    s_mov_b32 s44, 0x67dc0
    buffer_load_ushort v179, v16, s[24:27], s44 offen
    buffer_load_ushort v31, v16, s[28:31], s44 offen
    s_mov_b32 s44, 0x95040
    buffer_load_ushort v180, v16, s[24:27], s44 offen
    buffer_load_ushort v32, v16, s[28:31], s44 offen
    s_mov_b32 s44, 0x9e0c0
    buffer_load_ushort v181, v16, s[24:27], s44 offen
    buffer_load_ushort v33, v16, s[28:31], s44 offen
    s_mov_b32 s44, 0xa7140
    buffer_load_ushort v182, v16, s[24:27], s44 offen
    buffer_load_ushort v34, v16, s[28:31], s44 offen
    s_mov_b32 s44, 0xb01c0
    buffer_load_ushort v183, v16, s[24:27], s44 offen
    buffer_load_ushort v35, v16, s[28:31], s44 offen
    s_mov_b32 s44, 0xdd440
    buffer_load_ushort v184, v16, s[24:27], s44 offen
    buffer_load_ushort v36, v16, s[28:31], s44 offen
    s_mov_b32 s44, 0xe64c0
    buffer_load_ushort v185, v16, s[24:27], s44 offen
    buffer_load_ushort v37, v16, s[28:31], s44 offen
    s_mov_b32 s44, 0xef540
    buffer_load_ushort v186, v16, s[24:27], s44 offen
    buffer_load_ushort v38, v16, s[28:31], s44 offen
    s_mov_b32 s44, 0xf85c0
    buffer_load_ushort v187, v16, s[24:27], s44 offen
    buffer_load_ushort v39, v16, s[28:31], s44 offen
    s_waitcnt vmcnt(0)
    v_lshl_or_b32 v172, v24, 16, v172
    v_lshl_or_b32 v173, v25, 16, v173
    v_lshl_or_b32 v174, v26, 16, v174
    v_lshl_or_b32 v175, v27, 16, v175
    v_lshl_or_b32 v176, v28, 16, v176
    v_lshl_or_b32 v177, v29, 16, v177
    v_lshl_or_b32 v178, v30, 16, v178
    v_lshl_or_b32 v179, v31, 16, v179
    v_lshl_or_b32 v180, v32, 16, v180
    v_lshl_or_b32 v181, v33, 16, v181
    v_lshl_or_b32 v182, v34, 16, v182
    v_lshl_or_b32 v183, v35, 16, v183
    v_lshl_or_b32 v184, v36, 16, v184
    v_lshl_or_b32 v185, v37, 16, v185
    v_lshl_or_b32 v186, v38, 16, v186
    v_lshl_or_b32 v187, v39, 16, v187
    s_cmp_lg_u32 s41, 8
    s_cbranch_scc1 L_d_nodump
    s_mul_i32 s44, s32, 82944
    s_add_u32 s44, s44, 0x1b00000
    buffer_store_dwordx4 a[0:3], v6, s[8:11], s44 offen offset:0 sc1
    buffer_store_dwordx4 a[4:7], v6, s[8:11], s44 offen offset:1024 sc1
    buffer_store_dwordx4 a[8:11], v6, s[8:11], s44 offen offset:2048 sc1
    buffer_store_dwordx4 a[12:15], v6, s[8:11], s44 offen offset:3072 sc1
    s_add_u32 s44, s44, 4096
    buffer_store_dwordx4 a[16:19], v6, s[8:11], s44 offen offset:0 sc1
    buffer_store_dwordx4 a[20:23], v6, s[8:11], s44 offen offset:1024 sc1
    buffer_store_dwordx4 a[24:27], v6, s[8:11], s44 offen offset:2048 sc1
    buffer_store_dwordx4 a[28:31], v6, s[8:11], s44 offen offset:3072 sc1
    s_add_u32 s44, s44, 4096
    buffer_store_dwordx4 a[32:35], v6, s[8:11], s44 offen offset:0 sc1
    buffer_store_dwordx4 a[36:39], v6, s[8:11], s44 offen offset:1024 sc1
    buffer_store_dwordx4 a[40:43], v6, s[8:11], s44 offen offset:2048 sc1
    buffer_store_dwordx4 a[44:47], v6, s[8:11], s44 offen offset:3072 sc1
    s_add_u32 s44, s44, 4096
    buffer_store_dwordx4 a[48:51], v6, s[8:11], s44 offen offset:0 sc1
    buffer_store_dwordx4 a[52:55], v6, s[8:11], s44 offen offset:1024 sc1
    buffer_store_dwordx4 a[56:59], v6, s[8:11], s44 offen offset:2048 sc1
    buffer_store_dwordx4 a[60:63], v6, s[8:11], s44 offen offset:3072 sc1
    s_add_u32 s44, s44, 4096
    buffer_store_dwordx4 a[64:67], v6, s[8:11], s44 offen offset:0 sc1
    buffer_store_dwordx4 a[68:71], v6, s[8:11], s44 offen offset:1024 sc1
    buffer_store_dwordx4 a[72:75], v6, s[8:11], s44 offen offset:2048 sc1
    buffer_store_dwordx4 a[76:79], v6, s[8:11], s44 offen offset:3072 sc1
    s_add_u32 s44, s44, 4096
    buffer_store_dwordx4 a[80:83], v6, s[8:11], s44 offen offset:0 sc1
    buffer_store_dwordx4 a[84:87], v6, s[8:11], s44 offen offset:1024 sc1
    buffer_store_dwordx4 a[88:91], v6, s[8:11], s44 offen offset:2048 sc1
    buffer_store_dwordx4 a[92:95], v6, s[8:11], s44 offen offset:3072 sc1
    s_add_u32 s44, s44, 4096
    buffer_store_dwordx4 a[96:99], v6, s[8:11], s44 offen offset:0 sc1
    buffer_store_dwordx4 a[100:103], v6, s[8:11], s44 offen offset:1024 sc1
    buffer_store_dwordx4 a[104:107], v6, s[8:11], s44 offen offset:2048 sc1
    buffer_store_dwordx4 a[108:111], v6, s[8:11], s44 offen offset:3072 sc1
    s_add_u32 s44, s44, 4096
    buffer_store_dwordx4 a[112:115], v6, s[8:11], s44 offen offset:0 sc1
    buffer_store_dwordx4 a[116:119], v6, s[8:11], s44 offen offset:1024 sc1
    buffer_store_dwordx4 a[120:123], v6, s[8:11], s44 offen offset:2048 sc1
    buffer_store_dwordx4 a[124:127], v6, s[8:11], s44 offen offset:3072 sc1
    s_add_u32 s44, s44, 4096
    buffer_store_dwordx4 a[128:131], v6, s[8:11], s44 offen offset:0 sc1
    buffer_store_dwordx4 a[132:135], v6, s[8:11], s44 offen offset:1024 sc1
    buffer_store_dwordx4 a[136:139], v6, s[8:11], s44 offen offset:2048 sc1
    buffer_store_dwordx4 a[140:143], v6, s[8:11], s44 offen offset:3072 sc1
    s_add_u32 s44, s44, 4096
    buffer_store_dwordx4 a[144:147], v6, s[8:11], s44 offen offset:0 sc1
    buffer_store_dwordx4 a[148:151], v6, s[8:11], s44 offen offset:1024 sc1
    buffer_store_dwordx4 a[152:155], v6, s[8:11], s44 offen offset:2048 sc1
    buffer_store_dwordx4 a[156:159], v6, s[8:11], s44 offen offset:3072 sc1
    s_add_u32 s44, s44, 4096
    buffer_store_dwordx4 a[160:163], v6, s[8:11], s44 offen offset:0 sc1
    buffer_store_dwordx4 a[164:167], v6, s[8:11], s44 offen offset:1024 sc1
    buffer_store_dwordx4 a[168:171], v6, s[8:11], s44 offen offset:2048 sc1
    buffer_store_dwordx4 a[172:175], v6, s[8:11], s44 offen offset:3072 sc1
    s_add_u32 s44, s44, 4096
    buffer_store_dwordx4 a[176:179], v6, s[8:11], s44 offen offset:0 sc1
    buffer_store_dwordx4 a[180:183], v6, s[8:11], s44 offen offset:1024 sc1
    buffer_store_dwordx4 a[184:187], v6, s[8:11], s44 offen offset:2048 sc1
    buffer_store_dwordx4 a[188:191], v6, s[8:11], s44 offen offset:3072 sc1
    s_add_u32 s44, s44, 4096
    buffer_store_dwordx4 a[192:195], v6, s[8:11], s44 offen offset:0 sc1
    buffer_store_dwordx4 a[196:199], v6, s[8:11], s44 offen offset:1024 sc1
    buffer_store_dwordx4 a[200:203], v6, s[8:11], s44 offen offset:2048 sc1
    buffer_store_dwordx4 a[204:207], v6, s[8:11], s44 offen offset:3072 sc1
    s_add_u32 s44, s44, 4096
    buffer_store_dwordx4 a[208:211], v6, s[8:11], s44 offen offset:0 sc1
    buffer_store_dwordx4 a[212:215], v6, s[8:11], s44 offen offset:1024 sc1
    buffer_store_dwordx4 a[216:219], v6, s[8:11], s44 offen offset:2048 sc1
    buffer_store_dwordx4 a[220:223], v6, s[8:11], s44 offen offset:3072 sc1
    s_add_u32 s44, s44, 4096
    buffer_store_dwordx4 a[224:227], v6, s[8:11], s44 offen offset:0 sc1
    buffer_store_dwordx4 a[228:231], v6, s[8:11], s44 offen offset:1024 sc1
    buffer_store_dwordx4 a[232:235], v6, s[8:11], s44 offen offset:2048 sc1
    buffer_store_dwordx4 a[236:239], v6, s[8:11], s44 offen offset:3072 sc1
    s_add_u32 s44, s44, 4096
    s_waitcnt vmcnt(40)
    buffer_store_dwordx4 a[240:243], v6, s[8:11], s44 offen offset:0 sc1
    buffer_store_dwordx4 a[244:247], v6, s[8:11], s44 offen offset:1024 sc1
    buffer_store_dwordx4 a[248:251], v6, s[8:11], s44 offen offset:2048 sc1
    buffer_store_dwordx4 a[252:255], v6, s[8:11], s44 offen offset:3072 sc1
    s_add_u32 s44, s44, 4096
    buffer_store_dwordx4 v[188:191], v6, s[8:11], s44 offen offset:0 sc1
    buffer_store_dwordx4 v[192:195], v6, s[8:11], s44 offen offset:1024 sc1
    buffer_store_dwordx4 v[196:199], v6, s[8:11], s44 offen offset:2048 sc1
    buffer_store_dwordx4 v[200:203], v6, s[8:11], s44 offen offset:3072 sc1
    s_add_u32 s44, s44, 4096
    buffer_store_dwordx4 v[204:207], v6, s[8:11], s44 offen offset:0 sc1
    buffer_store_dwordx4 v[208:211], v6, s[8:11], s44 offen offset:1024 sc1
    buffer_store_dwordx4 v[212:215], v6, s[8:11], s44 offen offset:2048 sc1
    buffer_store_dwordx4 v[216:219], v6, s[8:11], s44 offen offset:3072 sc1
    s_add_u32 s44, s44, 4096
    buffer_store_dwordx4 v[220:223], v6, s[8:11], s44 offen offset:0 sc1
    buffer_store_dwordx4 v[224:227], v6, s[8:11], s44 offen offset:1024 sc1
    buffer_store_dwordx4 v[228:231], v6, s[8:11], s44 offen offset:2048 sc1
    buffer_store_dwordx4 v[232:235], v6, s[8:11], s44 offen offset:3072 sc1
    s_add_u32 s44, s44, 4096
    buffer_store_dwordx4 v[236:239], v6, s[8:11], s44 offen offset:0 sc1
    buffer_store_dwordx4 v[240:243], v6, s[8:11], s44 offen offset:1024 sc1
    buffer_store_dwordx4 v[244:247], v6, s[8:11], s44 offen offset:2048 sc1
    buffer_store_dwordx4 v[248:251], v6, s[8:11], s44 offen offset:3072 sc1
    s_add_u32 s44, s44, 4096
    buffer_store_dwordx4 v[252:255], v6, s[8:11], s44 offen offset:0 sc1
    s_mov_b32 s44, 0
    s_add_u32 s44, s44, 0x180fa00
    s_waitcnt vmcnt(0)
    s_barrier
    s_cmp_lg_u32 s32, 0
    s_cbranch_scc1 L_df_67
    v_mov_b32 v14, 1
    s_mov_b64 exec, 1
    buffer_store_dword v14, off, s[8:11], s44 offset:0 sc1
    s_mov_b64 exec, -1
L_df_67:
L_d_nodump:
    s_barrier
    s_cmp_lg_u32 s46, 0
    s_cbranch_scc1 L_d_layer
    s_mov_b32 s43, 0x204000
    s_mov_b32 s51, 1
    s_mov_b32 s48, 1
    s_mov_b32 s63, 0x1800000
    s_mov_b32 s91, 1
    s_branch L_d_inv
L_d_layer:
    s_cmp_eq_u32 s46, 0
    s_cbranch_scc1 L_d_fft
    s_and_b32 s43, s41, 15
L_d_fwd:
    s_lshl_b32 s44, s42, 20
    s_mul_i32 s45, s43, 2304
    s_add_u32 s44, s44, s45
    s_add_u32 s44, s44, 0x1890000
    s_cmp_lg_u32 s32, 0
    s_cbranch_scc1 L_wfs_68
    s_mov_b32 s40, 0
    v_min_u32 v16, 17, v0
    v_lshlrev_b32 v16, 7, v16
    s_branch L_wfe_70
L_wf_69:
    s_add_u32 s40, s40, 1
    s_cmp_gt_u32 s40, 0x100000
    s_cbranch_scc1 L_abort
    s_sleep 1
L_wfe_70:
    buffer_load_dword v18, v16, s[8:11], s44 offen sc1
    s_waitcnt vmcnt(0)
    v_cmpx_eq_u32 vcc, 0, v18
    s_cbranch_execnz L_wf_69
    s_mov_b64 exec, -1
L_wfs_68:
    s_barrier
    s_mul_i32 s44, s42, 2359296
    s_mul_i32 s45, s43, 18432
    s_add_u32 s44, s44, s45
    s_add_u32 s44, s44, 0x7a0000
    buffer_load_dwordx4 v[16:19], v2, s[8:11], s44 offen offset:0 sc1
    buffer_load_dwordx4 v[20:23], v3, s[8:11], s44 offen offset:384 sc1
    buffer_load_dwordx4 v[24:27], v2, s[8:11], s44 offen offset:192 sc1
    buffer_load_dwordx4 v[28:31], v3, s[8:11], s44 offen offset:192 sc1
    buffer_load_dwordx4 v[32:35], v2, s[8:11], s44 offen offset:384 sc1
    buffer_load_dwordx4 v[36:39], v3, s[8:11], s44 offen offset:0 sc1
    s_waitcnt vmcnt(0)
    v_lshlrev_b32 v40, 16, v16
    v_and_b32 v41, 0xffff0000, v16
    v_lshlrev_b32_e64 v42, 16, v17
    v_and_b32 v43, 0xffff0000, v17
    v_lshlrev_b32_e64 v44, 16, v18
    v_and_b32 v45, 0xffff0000, v18
    v_lshlrev_b32_e64 v46, 16, v19
    v_and_b32 v47, 0xffff0000, v19
    v_lshlrev_b32_e64 v48, 16, v20
    v_and_b32 v49, 0xffff0000, v20
    v_lshlrev_b32_e64 v50, 16, v21
    v_and_b32 v51, 0xffff0000, v21
    v_lshlrev_b32_e64 v52, 16, v22
    v_and_b32 v53, 0xffff0000, v22
    v_lshlrev_b32_e64 v54, 16, v23
    v_and_b32 v55, 0xffff0000, v23
    v_lshlrev_b32_e64 v56, 16, v24
    v_and_b32 v57, 0xffff0000, v24
    v_lshlrev_b32_e64 v58, 16, v25
    v_and_b32 v59, 0xffff0000, v25
    v_lshlrev_b32_e64 v60, 16, v26
    v_and_b32 v61, 0xffff0000, v26
    v_lshlrev_b32_e64 v62, 16, v27
    v_and_b32 v63, 0xffff0000, v27
    v_lshlrev_b32_e64 v64, 16, v28
    v_and_b32 v65, 0xffff0000, v28
    v_lshlrev_b32_e64 v66, 16, v29
    v_and_b32 v67, 0xffff0000, v29
    v_lshlrev_b32_e64 v68, 16, v30
    v_and_b32 v69, 0xffff0000, v30
    v_lshlrev_b32_e64 v70, 16, v31
    v_and_b32 v71, 0xffff0000, v31
    v_lshlrev_b32_e64 v72, 16, v32
    v_and_b32 v73, 0xffff0000, v32
    v_lshlrev_b32_e64 v74, 16, v33
    v_and_b32 v75, 0xffff0000, v33
    v_lshlrev_b32_e64 v76, 16, v34
    v_and_b32 v77, 0xffff0000, v34
    v_lshlrev_b32_e64 v78, 16, v35
    v_and_b32 v79, 0xffff0000, v35
    v_lshlrev_b32_e64 v80, 16, v36
    v_and_b32 v81, 0xffff0000, v36
    v_lshlrev_b32_e64 v82, 16, v37
    v_and_b32 v83, 0xffff0000, v37
    v_lshlrev_b32_e64 v84, 16, v38
    v_and_b32 v85, 0xffff0000, v38
    v_lshlrev_b32_e64 v86, 16, v39
    v_and_b32 v87, 0xffff0000, v39
    v_pk_add_f32 v[88:89], v[40:41], v[42:43]
    v_pk_add_f32 v[90:91], v[44:45], v[46:47]
    v_pk_add_f32 v[88:89], v[88:89], v[48:49]
    v_pk_add_f32 v[90:91], v[90:91], v[50:51]
    v_pk_add_f32 v[88:89], v[88:89], v[52:53]
    v_pk_add_f32 v[90:91], v[90:91], v[54:55]
    v_pk_add_f32 v[88:89], v[88:89], v[56:57]
    v_pk_add_f32 v[90:91], v[90:91], v[58:59]
    v_pk_add_f32 v[88:89], v[88:89], v[60:61]
    v_pk_add_f32 v[90:91], v[90:91], v[62:63]
    v_pk_add_f32 v[88:89], v[88:89], v[64:65]
    v_pk_add_f32 v[90:91], v[90:91], v[66:67]
    v_pk_add_f32 v[88:89], v[88:89], v[68:69]
    v_pk_add_f32 v[90:91], v[90:91], v[70:71]
    v_pk_add_f32 v[88:89], v[88:89], v[72:73]
    v_pk_add_f32 v[90:91], v[90:91], v[74:75]
    v_pk_add_f32 v[88:89], v[88:89], v[76:77]
    v_pk_add_f32 v[90:91], v[90:91], v[78:79]
    v_pk_add_f32 v[88:89], v[88:89], v[80:81]
    v_pk_add_f32 v[90:91], v[90:91], v[82:83]
    v_pk_add_f32 v[88:89], v[88:89], v[84:85]
    v_pk_add_f32 v[90:91], v[90:91], v[86:87]
    v_pk_add_f32 v[88:89], v[88:89], v[90:91]
    v_add_f32_e64 v88, v88, v89
    v_cndmask_b32 v88, 0, v88, s[52:53]
    s_nop 1
    v_add_f32_dpp v88, v88, v88 row_ror:8 row_mask:0xf bank_mask:0xf
    s_nop 1
    v_add_f32_dpp v88, v88, v88 row_ror:4 row_mask:0xf bank_mask:0xf
    s_nop 1
    v_add_f32_dpp v88, v88, v88 row_ror:2 row_mask:0xf bank_mask:0xf
    s_nop 1
    v_add_f32_dpp v88, v88, v88 row_ror:1 row_mask:0xf bank_mask:0xf
    v_mul_f32 v88, 0xbae38e39, v88
    v_pk_add_f32 v[40:41], v[40:41], v[88:89] op_sel_hi:[1,0]
    v_pk_add_f32 v[42:43], v[42:43], v[88:89] op_sel_hi:[1,0]
    v_pk_add_f32 v[44:45], v[44:45], v[88:89] op_sel_hi:[1,0]
    v_pk_add_f32 v[46:47], v[46:47], v[88:89] op_sel_hi:[1,0]
    v_pk_add_f32 v[48:49], v[48:49], v[88:89] op_sel_hi:[1,0]
    v_pk_add_f32 v[50:51], v[50:51], v[88:89] op_sel_hi:[1,0]
    v_pk_add_f32 v[52:53], v[52:53], v[88:89] op_sel_hi:[1,0]
    v_pk_add_f32 v[54:55], v[54:55], v[88:89] op_sel_hi:[1,0]
    v_pk_add_f32 v[56:57], v[56:57], v[88:89] op_sel_hi:[1,0]
    v_pk_add_f32 v[58:59], v[58:59], v[88:89] op_sel_hi:[1,0]
    v_pk_add_f32 v[60:61], v[60:61], v[88:89] op_sel_hi:[1,0]
    v_pk_add_f32 v[62:63], v[62:63], v[88:89] op_sel_hi:[1,0]
    v_pk_add_f32 v[64:65], v[64:65], v[88:89] op_sel_hi:[1,0]
    v_pk_add_f32 v[66:67], v[66:67], v[88:89] op_sel_hi:[1,0]
    v_pk_add_f32 v[68:69], v[68:69], v[88:89] op_sel_hi:[1,0]
    v_pk_add_f32 v[70:71], v[70:71], v[88:89] op_sel_hi:[1,0]
    v_pk_add_f32 v[72:73], v[72:73], v[88:89] op_sel_hi:[1,0]
    v_pk_add_f32 v[74:75], v[74:75], v[88:89] op_sel_hi:[1,0]
    v_pk_add_f32 v[76:77], v[76:77], v[88:89] op_sel_hi:[1,0]
    v_pk_add_f32 v[78:79], v[78:79], v[88:89] op_sel_hi:[1,0]
    v_pk_add_f32 v[80:81], v[80:81], v[88:89] op_sel_hi:[1,0]
    v_pk_add_f32 v[82:83], v[82:83], v[88:89] op_sel_hi:[1,0]
    v_pk_add_f32 v[84:85], v[84:85], v[88:89] op_sel_hi:[1,0]
    v_pk_add_f32 v[86:87], v[86:87], v[88:89] op_sel_hi:[1,0]
    v_pk_mul_f32 v[88:89], v[40:41], v[40:41]
    v_pk_mul_f32 v[90:91], v[42:43], v[42:43]
    v_pk_fma_f32 v[88:89], v[44:45], v[44:45], v[88:89]
    v_pk_fma_f32 v[90:91], v[46:47], v[46:47], v[90:91]
    v_pk_fma_f32 v[88:89], v[48:49], v[48:49], v[88:89]
    v_pk_fma_f32 v[90:91], v[50:51], v[50:51], v[90:91]
    v_pk_fma_f32 v[88:89], v[52:53], v[52:53], v[88:89]
    v_pk_fma_f32 v[90:91], v[54:55], v[54:55], v[90:91]
    v_pk_fma_f32 v[88:89], v[56:57], v[56:57], v[88:89]
    v_pk_fma_f32 v[90:91], v[58:59], v[58:59], v[90:91]
    v_pk_fma_f32 v[88:89], v[60:61], v[60:61], v[88:89]
    v_pk_fma_f32 v[90:91], v[62:63], v[62:63], v[90:91]
    v_pk_fma_f32 v[88:89], v[64:65], v[64:65], v[88:89]
    v_pk_fma_f32 v[90:91], v[66:67], v[66:67], v[90:91]
    v_pk_fma_f32 v[88:89], v[68:69], v[68:69], v[88:89]
    v_pk_fma_f32 v[90:91], v[70:71], v[70:71], v[90:91]
    v_pk_fma_f32 v[88:89], v[72:73], v[72:73], v[88:89]
    v_pk_fma_f32 v[90:91], v[74:75], v[74:75], v[90:91]
    v_pk_fma_f32 v[88:89], v[76:77], v[76:77], v[88:89]
    v_pk_fma_f32 v[90:91], v[78:79], v[78:79], v[90:91]
    v_pk_fma_f32 v[88:89], v[80:81], v[80:81], v[88:89]
    v_pk_fma_f32 v[90:91], v[82:83], v[82:83], v[90:91]
    v_pk_fma_f32 v[88:89], v[84:85], v[84:85], v[88:89]
    v_pk_fma_f32 v[90:91], v[86:87], v[86:87], v[90:91]
    v_pk_add_f32 v[88:89], v[88:89], v[90:91]
    v_add_f32_e64 v88, v88, v89
    v_cndmask_b32 v88, 0, v88, s[52:53]
    s_nop 1
    v_add_f32_dpp v88, v88, v88 row_ror:8 row_mask:0xf bank_mask:0xf
    s_nop 1
    v_add_f32_dpp v88, v88, v88 row_ror:4 row_mask:0xf bank_mask:0xf
    s_nop 1
    v_add_f32_dpp v88, v88, v88 row_ror:2 row_mask:0xf bank_mask:0xf
    s_nop 1
    v_add_f32_dpp v88, v88, v88 row_ror:1 row_mask:0xf bank_mask:0xf
    v_mul_f32 v88, 0x3ae38e39, v88
    v_cvt_pk_bf16_f32 v88, v88, v88
    v_lshlrev_b32_e64 v88, 16, v88
    v_add_f32 v88, 0x3727c5ac, v88
    v_cvt_pk_bf16_f32 v88, v88, v88
    v_lshlrev_b32_e64 v88, 16, v88
    v_sqrt_f32 v88, v88
    s_nop 0
    v_cvt_pk_bf16_f32 v88, v88, v88
    v_lshlrev_b32 v88, 16, v88
    v_rcp_f32 v88, v88
    v_pk_add_f32 v[92:93], v[40:41], v[54:55] op_sel:[0,1] op_sel_hi:[1,0]
    v_pk_add_f32 v[116:117], v[40:41], v[54:55] op_sel:[0,1] op_sel_hi:[1,0] neg_lo:[0,1] neg_hi:[0,1]
    v_pk_add_f32 v[94:95], v[42:43], v[52:53] op_sel:[0,1] op_sel_hi:[1,0]
    v_pk_add_f32 v[118:119], v[42:43], v[52:53] op_sel:[0,1] op_sel_hi:[1,0] neg_lo:[0,1] neg_hi:[0,1]
    v_pk_add_f32 v[96:97], v[44:45], v[50:51] op_sel:[0,1] op_sel_hi:[1,0]
    v_pk_add_f32 v[120:121], v[44:45], v[50:51] op_sel:[0,1] op_sel_hi:[1,0] neg_lo:[0,1] neg_hi:[0,1]
    v_pk_add_f32 v[98:99], v[46:47], v[48:49] op_sel:[0,1] op_sel_hi:[1,0]
    v_pk_add_f32 v[122:123], v[46:47], v[48:49] op_sel:[0,1] op_sel_hi:[1,0] neg_lo:[0,1] neg_hi:[0,1]
    v_pk_add_f32 v[100:101], v[56:57], v[70:71] op_sel:[0,1] op_sel_hi:[1,0]
    v_pk_add_f32 v[124:125], v[56:57], v[70:71] op_sel:[0,1] op_sel_hi:[1,0] neg_lo:[0,1] neg_hi:[0,1]
    v_pk_add_f32 v[102:103], v[58:59], v[68:69] op_sel:[0,1] op_sel_hi:[1,0]
    v_pk_add_f32 v[126:127], v[58:59], v[68:69] op_sel:[0,1] op_sel_hi:[1,0] neg_lo:[0,1] neg_hi:[0,1]
    v_pk_add_f32 v[104:105], v[60:61], v[66:67] op_sel:[0,1] op_sel_hi:[1,0]
    v_pk_add_f32 v[128:129], v[60:61], v[66:67] op_sel:[0,1] op_sel_hi:[1,0] neg_lo:[0,1] neg_hi:[0,1]
    v_pk_add_f32 v[106:107], v[62:63], v[64:65] op_sel:[0,1] op_sel_hi:[1,0]
    v_pk_add_f32 v[130:131], v[62:63], v[64:65] op_sel:[0,1] op_sel_hi:[1,0] neg_lo:[0,1] neg_hi:[0,1]
    v_pk_add_f32 v[108:109], v[72:73], v[86:87] op_sel:[0,1] op_sel_hi:[1,0]
    v_pk_add_f32 v[132:133], v[72:73], v[86:87] op_sel:[0,1] op_sel_hi:[1,0] neg_lo:[0,1] neg_hi:[0,1]
    v_pk_add_f32 v[110:111], v[74:75], v[84:85] op_sel:[0,1] op_sel_hi:[1,0]
    v_pk_add_f32 v[134:135], v[74:75], v[84:85] op_sel:[0,1] op_sel_hi:[1,0] neg_lo:[0,1] neg_hi:[0,1]
    v_pk_add_f32 v[112:113], v[76:77], v[82:83] op_sel:[0,1] op_sel_hi:[1,0]
    v_pk_add_f32 v[136:137], v[76:77], v[82:83] op_sel:[0,1] op_sel_hi:[1,0] neg_lo:[0,1] neg_hi:[0,1]
    v_pk_add_f32 v[114:115], v[78:79], v[80:81] op_sel:[0,1] op_sel_hi:[1,0]
    v_pk_add_f32 v[138:139], v[78:79], v[80:81] op_sel:[0,1] op_sel_hi:[1,0] neg_lo:[0,1] neg_hi:[0,1]
    v_pk_mul_f32 v[92:93], v[92:93], v[88:89] op_sel_hi:[1,0]
    v_pk_mul_f32 v[94:95], v[94:95], v[88:89] op_sel_hi:[1,0]
    v_pk_mul_f32 v[96:97], v[96:97], v[88:89] op_sel_hi:[1,0]
    v_pk_mul_f32 v[98:99], v[98:99], v[88:89] op_sel_hi:[1,0]
    v_pk_mul_f32 v[100:101], v[100:101], v[88:89] op_sel_hi:[1,0]
    v_pk_mul_f32 v[102:103], v[102:103], v[88:89] op_sel_hi:[1,0]
    v_pk_mul_f32 v[104:105], v[104:105], v[88:89] op_sel_hi:[1,0]
    v_pk_mul_f32 v[106:107], v[106:107], v[88:89] op_sel_hi:[1,0]
    v_pk_mul_f32 v[108:109], v[108:109], v[88:89] op_sel_hi:[1,0]
    v_pk_mul_f32 v[110:111], v[110:111], v[88:89] op_sel_hi:[1,0]
    v_pk_mul_f32 v[112:113], v[112:113], v[88:89] op_sel_hi:[1,0]
    v_pk_mul_f32 v[114:115], v[114:115], v[88:89] op_sel_hi:[1,0]
    v_pk_mul_f32 v[116:117], v[116:117], v[88:89] op_sel_hi:[1,0]
    v_pk_mul_f32 v[118:119], v[118:119], v[88:89] op_sel_hi:[1,0]
    v_pk_mul_f32 v[120:121], v[120:121], v[88:89] op_sel_hi:[1,0]
    v_pk_mul_f32 v[122:123], v[122:123], v[88:89] op_sel_hi:[1,0]
    v_pk_mul_f32 v[124:125], v[124:125], v[88:89] op_sel_hi:[1,0]
    v_pk_mul_f32 v[126:127], v[126:127], v[88:89] op_sel_hi:[1,0]
    v_pk_mul_f32 v[128:129], v[128:129], v[88:89] op_sel_hi:[1,0]
    v_pk_mul_f32 v[130:131], v[130:131], v[88:89] op_sel_hi:[1,0]
    v_pk_mul_f32 v[132:133], v[132:133], v[88:89] op_sel_hi:[1,0]
    v_pk_mul_f32 v[134:135], v[134:135], v[88:89] op_sel_hi:[1,0]
    v_pk_mul_f32 v[136:137], v[136:137], v[88:89] op_sel_hi:[1,0]
    v_pk_mul_f32 v[138:139], v[138:139], v[88:89] op_sel_hi:[1,0]
    v_cvt_pk_bf16_f32 v16, v92, v93
    v_cvt_pk_bf16_f32 v17, v94, v95
    v_cvt_pk_bf16_f32 v18, v96, v97
    v_cvt_pk_bf16_f32 v19, v98, v99
    v_cvt_pk_bf16_f32 v20, v100, v101
    v_cvt_pk_bf16_f32 v21, v102, v103
    v_cvt_pk_bf16_f32 v22, v104, v105
    v_cvt_pk_bf16_f32 v23, v106, v107
    v_cvt_pk_bf16_f32 v24, v108, v109
    v_cvt_pk_bf16_f32 v25, v110, v111
    v_cvt_pk_bf16_f32 v26, v112, v113
    v_cvt_pk_bf16_f32 v27, v114, v115
    v_cvt_pk_bf16_f32 v28, v116, v117
    v_cvt_pk_bf16_f32 v29, v118, v119
    v_cvt_pk_bf16_f32 v30, v120, v121
    v_cvt_pk_bf16_f32 v31, v122, v123
    v_cvt_pk_bf16_f32 v32, v124, v125
    v_cvt_pk_bf16_f32 v33, v126, v127
    v_cvt_pk_bf16_f32 v34, v128, v129
    v_cvt_pk_bf16_f32 v35, v130, v131
    v_cvt_pk_bf16_f32 v36, v132, v133
    v_cvt_pk_bf16_f32 v37, v134, v135
    v_cvt_pk_bf16_f32 v38, v136, v137
    v_cvt_pk_bf16_f32 v39, v138, v139
    s_mov_b64 exec, s[52:53]
    ds_write_b128 v7, v[16:19] offset:0
    ds_write_b128 v7, v[28:31] offset:9728
    ds_write_b128 v7, v[20:23] offset:192
    ds_write_b128 v7, v[32:35] offset:9920
    ds_write_b128 v7, v[24:27] offset:384
    ds_write_b128 v7, v[36:39] offset:10112
    s_mov_b64 exec, -1
    s_waitcnt lgkmcnt(0)
    s_barrier
    ds_read_b128 v[16:19], v8 offset:0
    ds_read_b128 v[20:23], v8 offset:64
    ds_read_b128 v[24:27], v8 offset:128
    ds_read_b128 v[28:31], v8 offset:192
    ds_read_b128 v[32:35], v8 offset:256
    ds_read_b128 v[36:39], v8 offset:320
    ds_read_b128 v[40:43], v8 offset:384
    ds_read_b128 v[44:47], v8 offset:448
    ds_read_b128 v[48:51], v8 offset:512
    s_waitcnt lgkmcnt(8)
    v_mfma_f32_16x16x32_bf16 v[52:55], v[16:19], a[0:3], 0
    v_mfma_f32_16x16x32_bf16 v[56:59], v[16:19], a[36:39], 0
    v_mfma_f32_16x16x32_bf16 v[60:63], v[16:19], a[72:75], 0
    v_mfma_f32_16x16x32_bf16 v[64:67], v[16:19], a[108:111], 0
    v_mfma_f32_16x16x32_bf16 v[68:71], v[16:19], a[144:147], 0
    v_mfma_f32_16x16x32_bf16 v[72:75], v[16:19], a[180:183], 0
    v_mfma_f32_16x16x32_bf16 v[76:79], v[16:19], a[216:219], 0
    v_mfma_f32_16x16x32_bf16 v[80:83], v[16:19], a[252:255], 0
    v_mfma_f32_16x16x32_bf16 v[84:87], v[16:19], v[220:223], 0
    s_waitcnt lgkmcnt(7)
    v_mfma_f32_16x16x32_bf16 v[52:55], v[20:23], a[4:7], v[52:55]
    v_mfma_f32_16x16x32_bf16 v[56:59], v[20:23], a[40:43], v[56:59]
    v_mfma_f32_16x16x32_bf16 v[60:63], v[20:23], a[76:79], v[60:63]
    v_mfma_f32_16x16x32_bf16 v[64:67], v[20:23], a[112:115], v[64:67]
    v_mfma_f32_16x16x32_bf16 v[68:71], v[20:23], a[148:151], v[68:71]
    v_mfma_f32_16x16x32_bf16 v[72:75], v[20:23], a[184:187], v[72:75]
    v_mfma_f32_16x16x32_bf16 v[76:79], v[20:23], a[220:223], v[76:79]
    v_mfma_f32_16x16x32_bf16 v[80:83], v[20:23], v[188:191], v[80:83]
    v_mfma_f32_16x16x32_bf16 v[84:87], v[20:23], v[224:227], v[84:87]
    s_waitcnt lgkmcnt(6)
    v_mfma_f32_16x16x32_bf16 v[52:55], v[24:27], a[8:11], v[52:55]
    v_mfma_f32_16x16x32_bf16 v[56:59], v[24:27], a[44:47], v[56:59]
    v_mfma_f32_16x16x32_bf16 v[60:63], v[24:27], a[80:83], v[60:63]
    v_mfma_f32_16x16x32_bf16 v[64:67], v[24:27], a[116:119], v[64:67]
    v_mfma_f32_16x16x32_bf16 v[68:71], v[24:27], a[152:155], v[68:71]
    v_mfma_f32_16x16x32_bf16 v[72:75], v[24:27], a[188:191], v[72:75]
    v_mfma_f32_16x16x32_bf16 v[76:79], v[24:27], a[224:227], v[76:79]
    v_mfma_f32_16x16x32_bf16 v[80:83], v[24:27], v[192:195], v[80:83]
    v_mfma_f32_16x16x32_bf16 v[84:87], v[24:27], v[228:231], v[84:87]
    s_waitcnt lgkmcnt(5)
    v_mfma_f32_16x16x32_bf16 v[52:55], v[28:31], a[12:15], v[52:55]
    v_mfma_f32_16x16x32_bf16 v[56:59], v[28:31], a[48:51], v[56:59]
    v_mfma_f32_16x16x32_bf16 v[60:63], v[28:31], a[84:87], v[60:63]
    v_mfma_f32_16x16x32_bf16 v[64:67], v[28:31], a[120:123], v[64:67]
    v_mfma_f32_16x16x32_bf16 v[68:71], v[28:31], a[156:159], v[68:71]
    v_mfma_f32_16x16x32_bf16 v[72:75], v[28:31], a[192:195], v[72:75]
    v_mfma_f32_16x16x32_bf16 v[76:79], v[28:31], a[228:231], v[76:79]
    v_mfma_f32_16x16x32_bf16 v[80:83], v[28:31], v[196:199], v[80:83]
    v_mfma_f32_16x16x32_bf16 v[84:87], v[28:31], v[232:235], v[84:87]
    s_waitcnt lgkmcnt(4)
    v_mfma_f32_16x16x32_bf16 v[52:55], v[32:35], a[16:19], v[52:55]
    v_mfma_f32_16x16x32_bf16 v[56:59], v[32:35], a[52:55], v[56:59]
    v_mfma_f32_16x16x32_bf16 v[60:63], v[32:35], a[88:91], v[60:63]
    v_mfma_f32_16x16x32_bf16 v[64:67], v[32:35], a[124:127], v[64:67]
    v_mfma_f32_16x16x32_bf16 v[68:71], v[32:35], a[160:163], v[68:71]
    v_mfma_f32_16x16x32_bf16 v[72:75], v[32:35], a[196:199], v[72:75]
    v_mfma_f32_16x16x32_bf16 v[76:79], v[32:35], a[232:235], v[76:79]
    v_mfma_f32_16x16x32_bf16 v[80:83], v[32:35], v[200:203], v[80:83]
    v_mfma_f32_16x16x32_bf16 v[84:87], v[32:35], v[236:239], v[84:87]
    s_waitcnt lgkmcnt(3)
    v_mfma_f32_16x16x32_bf16 v[52:55], v[36:39], a[20:23], v[52:55]
    v_mfma_f32_16x16x32_bf16 v[56:59], v[36:39], a[56:59], v[56:59]
    v_mfma_f32_16x16x32_bf16 v[60:63], v[36:39], a[92:95], v[60:63]
    v_mfma_f32_16x16x32_bf16 v[64:67], v[36:39], a[128:131], v[64:67]
    v_mfma_f32_16x16x32_bf16 v[68:71], v[36:39], a[164:167], v[68:71]
    v_mfma_f32_16x16x32_bf16 v[72:75], v[36:39], a[200:203], v[72:75]
    v_mfma_f32_16x16x32_bf16 v[76:79], v[36:39], a[236:239], v[76:79]
    v_mfma_f32_16x16x32_bf16 v[80:83], v[36:39], v[204:207], v[80:83]
    v_mfma_f32_16x16x32_bf16 v[84:87], v[36:39], v[240:243], v[84:87]
    s_waitcnt lgkmcnt(2)
    v_mfma_f32_16x16x32_bf16 v[52:55], v[40:43], a[24:27], v[52:55]
    v_mfma_f32_16x16x32_bf16 v[56:59], v[40:43], a[60:63], v[56:59]
    v_mfma_f32_16x16x32_bf16 v[60:63], v[40:43], a[96:99], v[60:63]
    v_mfma_f32_16x16x32_bf16 v[64:67], v[40:43], a[132:135], v[64:67]
    v_mfma_f32_16x16x32_bf16 v[68:71], v[40:43], a[168:171], v[68:71]
    v_mfma_f32_16x16x32_bf16 v[72:75], v[40:43], a[204:207], v[72:75]
    v_mfma_f32_16x16x32_bf16 v[76:79], v[40:43], a[240:243], v[76:79]
    v_mfma_f32_16x16x32_bf16 v[80:83], v[40:43], v[208:211], v[80:83]
    v_mfma_f32_16x16x32_bf16 v[84:87], v[40:43], v[244:247], v[84:87]
    s_waitcnt lgkmcnt(1)
    v_mfma_f32_16x16x32_bf16 v[52:55], v[44:47], a[28:31], v[52:55]
    v_mfma_f32_16x16x32_bf16 v[56:59], v[44:47], a[64:67], v[56:59]
    v_mfma_f32_16x16x32_bf16 v[60:63], v[44:47], a[100:103], v[60:63]
    v_mfma_f32_16x16x32_bf16 v[64:67], v[44:47], a[136:139], v[64:67]
    v_mfma_f32_16x16x32_bf16 v[68:71], v[44:47], a[172:175], v[68:71]
    v_mfma_f32_16x16x32_bf16 v[72:75], v[44:47], a[208:211], v[72:75]
    v_mfma_f32_16x16x32_bf16 v[76:79], v[44:47], a[244:247], v[76:79]
    v_mfma_f32_16x16x32_bf16 v[80:83], v[44:47], v[212:215], v[80:83]
    v_mfma_f32_16x16x32_bf16 v[84:87], v[44:47], v[248:251], v[84:87]
    s_waitcnt lgkmcnt(0)
    v_mfma_f32_16x16x32_bf16 v[52:55], v[48:51], a[32:35], v[52:55]
    v_mfma_f32_16x16x32_bf16 v[56:59], v[48:51], a[68:71], v[56:59]
    v_mfma_f32_16x16x32_bf16 v[60:63], v[48:51], a[104:107], v[60:63]
    v_mfma_f32_16x16x32_bf16 v[64:67], v[48:51], a[140:143], v[64:67]
    v_mfma_f32_16x16x32_bf16 v[68:71], v[48:51], a[176:179], v[68:71]
    v_mfma_f32_16x16x32_bf16 v[72:75], v[48:51], a[212:215], v[72:75]
    v_mfma_f32_16x16x32_bf16 v[76:79], v[48:51], a[248:251], v[76:79]
    v_mfma_f32_16x16x32_bf16 v[80:83], v[48:51], v[216:219], v[80:83]
    v_mfma_f32_16x16x32_bf16 v[84:87], v[48:51], v[252:255], v[84:87]
    s_mul_i32 s44, s42, 2359296
    s_lshl_b32 s45, s43, 6
    s_add_u32 s44, s44, s45
    s_lshl_b32 s45, s32, 17
    s_add_u32 s44, s44, s45
    s_add_u32 s44, s44, 0xe60000
    v_lshrrev_b32 v14, 2, v0
    v_and_b32 v15, 3, v0
    v_lshlrev_b32 v15, 4, v15
    s_mul_i32 s45, s32, 1280
    s_add_u32 s45, s45, 102400
    v_mul_u32_u24 v16, 80, v14
    v_add3_u32 v16, v16, v15, s45
    v_lshl_add_u32 v14, v14, 13, v15
    v_cvt_pk_bf16_f32 v52, v52, v53
    v_cvt_pk_bf16_f32 v53, v54, v55
    ds_write_b64 v9, v[52:53] offset:0
    v_cvt_pk_bf16_f32 v56, v56, v57
    v_cvt_pk_bf16_f32 v57, v58, v59
    ds_write_b64 v9, v[56:57] offset:1280
    v_cvt_pk_bf16_f32 v60, v60, v61
    v_cvt_pk_bf16_f32 v61, v62, v63
    ds_write_b64 v9, v[60:61] offset:2560
    v_cvt_pk_bf16_f32 v64, v64, v65
    v_cvt_pk_bf16_f32 v65, v66, v67
    ds_write_b64 v9, v[64:65] offset:3840
    v_cvt_pk_bf16_f32 v68, v68, v69
    v_cvt_pk_bf16_f32 v69, v70, v71
    ds_write_b64 v9, v[68:69] offset:5120
    v_cvt_pk_bf16_f32 v72, v72, v73
    v_cvt_pk_bf16_f32 v73, v74, v75
    ds_write_b64 v9, v[72:73] offset:6400
    v_cvt_pk_bf16_f32 v76, v76, v77
    v_cvt_pk_bf16_f32 v77, v78, v79
    ds_write_b64 v9, v[76:77] offset:7680
    v_cvt_pk_bf16_f32 v80, v80, v81
    v_cvt_pk_bf16_f32 v81, v82, v83
    ds_write_b64 v9, v[80:81] offset:8960
    v_cvt_pk_bf16_f32 v84, v84, v85
    v_cvt_pk_bf16_f32 v85, v86, v87
    ds_write_b64 v9, v[84:85] offset:10240
    s_waitcnt lgkmcnt(0)
    s_barrier
    ds_read_b128 v[20:23], v16 offset:0
    ds_read_b128 v[24:27], v16 offset:5120
    ds_read_b128 v[28:31], v16 offset:10240
    ds_read_b128 v[32:35], v16 offset:15360
    ds_read_b128 v[36:39], v16 offset:20480
    s_waitcnt lgkmcnt(4)
    buffer_store_dwordx4 v[20:23], v14, s[8:11], s44 offen sc1
    s_add_u32 s44, s44, 524288
    s_waitcnt lgkmcnt(3)
    buffer_store_dwordx4 v[24:27], v14, s[8:11], s44 offen sc1
    s_add_u32 s44, s44, 524288
    s_waitcnt lgkmcnt(2)
    buffer_store_dwordx4 v[28:31], v14, s[8:11], s44 offen sc1
    s_add_u32 s44, s44, 524288
    s_waitcnt lgkmcnt(1)
    buffer_store_dwordx4 v[32:35], v14, s[8:11], s44 offen sc1
    s_add_u32 s44, s44, 524288
    s_cmp_ge_u32 s32, 2
    s_cbranch_scc1 L_f5_71
    s_waitcnt lgkmcnt(0)
    buffer_store_dwordx4 v[36:39], v14, s[8:11], s44 offen sc1
    s_add_u32 s44, s44, 524288
L_f5_71:
    s_waitcnt lgkmcnt(0)
    s_lshl_b32 s44, s42, 20
    s_lshl_b32 s45, s43, 7
    s_add_u32 s44, s44, s45
    s_add_u32 s44, s44, 0x1804000
    s_waitcnt vmcnt(0)
    s_barrier
    s_cmp_lg_u32 s32, 0
    s_cbranch_scc1 L_df_72
    v_mov_b32_e64 v14, 1
    s_mov_b64 exec, 1
    buffer_store_dword v14, off, s[8:11], s44 offset:0 sc1
    s_mov_b64 exec, -1
L_df_72:
    s_add_u32 s43, s43, 10
    s_cmp_lt_u32 s43, 120
    s_cbranch_scc1 L_d_fwd
    s_cmp_eq_u32 s46, 2
    s_cbranch_scc1 L_d_next
L_d_fft:
    s_lshl_b32 s44, s42, 20
    s_add_u32 s44, s44, 0x1804000
    s_cmp_lg_u32 s32, 0
    s_cbranch_scc1 L_wfs_73
    s_mov_b32 s40, 0
    v_mov_b32 v16, 12160
L_wfp_74:
    s_add_u32 s40, s40, 1
    s_cmp_gt_u32 s40, 0x100000
    s_cbranch_scc1 L_abort
    s_sleep 16
    buffer_load_dword v18, v16, s[8:11], s44 offen sc1
    s_waitcnt vmcnt(0)
    v_cmp_eq_u32 vcc, 0, v18
    s_cbranch_vccnz L_wfp_74
    v_min_u32 v16, 63, v0
    v_lshlrev_b32 v16, 7, v16
    v_add_u32 v17, 64, v0
    v_min_u32 v17, 95, v17
    v_lshlrev_b32 v17, 7, v17
    s_branch L_wfe_76
L_wf_75:
    s_add_u32 s40, s40, 1
    s_cmp_gt_u32 s40, 0x100000
    s_cbranch_scc1 L_abort
L_wfe_76:
    buffer_load_dword v18, v16, s[8:11], s44 offen sc1
    buffer_load_dword v19, v17, s[8:11], s44 offen sc1
    s_waitcnt vmcnt(0)
    v_min_u32 v20, v18, v19
    v_cmpx_eq_u32 vcc, 0, v20
    s_cbranch_execnz L_wf_75
    s_mov_b64 exec, -1
L_wfs_73:
    s_barrier
    s_mul_i32 s44, s42, 2359296
    s_lshl_b32 s45, s47, 13
    s_add_u32 s49, s44, s45
    s_add_u32 s44, s49, 0xe60000
    s_mul_i32 s45, s32, 9216
    s_add_u32 s45, s45, 81920
    s_add_u32 m0, s45, 0
    s_nop 0
    buffer_load_dwordx4 v6, s[8:11], s44 offen offset:0 sc1 lds
    buffer_load_dwordx4 v6, s[8:11], s44 offen offset:1024 sc1 lds
    buffer_load_dwordx4 v6, s[8:11], s44 offen offset:2048 sc1 lds
    buffer_load_dwordx4 v6, s[8:11], s44 offen offset:3072 sc1 lds
    s_add_u32 m0, s45, 4096
    s_add_u32 s44, s44, 4096
    buffer_load_dwordx4 v6, s[8:11], s44 offen offset:0 sc1 lds
    buffer_load_dwordx4 v6, s[8:11], s44 offen offset:1024 sc1 lds
    v_lshrrev_b32 v14, 5, v0
    v_lshlrev_b32 v14, 9, v14
    v_bfe_u32 v15, v0, 2, 2
    v_lshl_add_u32 v14, v15, 7, v14
    v_bfe_u32 v15, v0, 4, 1
    v_lshl_add_u32 v14, v15, 6, v14
    v_and_b32_e64 v15, 3, v0
    v_lshl_add_u32 v14, v15, 3, v14
    v_add_u32 v14, s45, v14
    ds_read_b128 v[128:131], v6 offset:0
    ds_read_b128 v[132:135], v6 offset:8192
    ds_read_b128 v[136:139], v6 offset:16384
    ds_read_b128 v[140:143], v6 offset:1024
    s_waitcnt vmcnt(0)
    ds_read_b64_tr_b16 v[80:81], v14 offset:0
    ds_read_b64_tr_b16 v[82:83], v14 offset:1024
    ds_read_b64_tr_b16 v[96:97], v14 offset:32
    ds_read_b64_tr_b16 v[98:99], v14 offset:1056
    ds_read_b64_tr_b16 v[84:85], v14 offset:2048
    ds_read_b64_tr_b16 v[86:87], v14 offset:3072
    ds_read_b64_tr_b16 v[100:101], v14 offset:2080
    ds_read_b64_tr_b16 v[102:103], v14 offset:3104
    ds_read_b64_tr_b16 v[88:89], v14 offset:4096
    ds_read_b64_tr_b16 v[90:91], v14 offset:5120
    ds_read_b64_tr_b16 v[104:105], v14 offset:4128
    ds_read_b64_tr_b16 v[106:107], v14 offset:5152
    s_waitcnt lgkmcnt(8)
    v_mfma_f32_32x32x16_bf16 v[16:31], v[80:83], v[128:131], 0
    v_mfma_f32_32x32x16_bf16 v[32:47], v[96:99], v[128:131], 0
    ds_read_b128 v[128:131], v6 offset:9216
    v_mfma_f32_32x32x16_bf16 v[16:31], v[96:99], v[132:135], v[16:31]
    ds_read_b128 v[132:135], v6 offset:17408
    v_mfma_f32_32x32x16_bf16 v[32:47], v[80:83], v[136:139], v[32:47]
    ds_read_b128 v[136:139], v6 offset:2048
    s_waitcnt lgkmcnt(7)
    v_mfma_f32_32x32x16_bf16 v[16:31], v[84:87], v[140:143], v[16:31]
    v_mfma_f32_32x32x16_bf16 v[32:47], v[100:103], v[140:143], v[32:47]
    ds_read_b128 v[140:143], v6 offset:10240
    s_waitcnt lgkmcnt(3)
    v_mfma_f32_32x32x16_bf16 v[16:31], v[100:103], v[128:131], v[16:31]
    ds_read_b128 v[128:131], v6 offset:18432
    s_waitcnt lgkmcnt(3)
    v_mfma_f32_32x32x16_bf16 v[32:47], v[84:87], v[132:135], v[32:47]
    ds_read_b128 v[132:135], v6 offset:4096
    s_waitcnt lgkmcnt(3)
    v_mfma_f32_32x32x16_bf16 v[16:31], v[88:91], v[136:139], v[16:31]
    v_mfma_f32_32x32x16_bf16 v[32:47], v[104:107], v[136:139], v[32:47]
    ds_read_b128 v[136:139], v6 offset:12288
    s_waitcnt lgkmcnt(3)
    v_mfma_f32_32x32x16_bf16 v[16:31], v[104:107], v[140:143], v[16:31]
    ds_read_b128 v[140:143], v6 offset:20480
    s_waitcnt lgkmcnt(3)
    v_mfma_f32_32x32x16_bf16 v[32:47], v[88:91], v[128:131], v[32:47]
    ds_read_b128 v[128:131], v6 offset:5120
    s_waitcnt lgkmcnt(3)
    v_mfma_f32_32x32x16_bf16 v[48:63], v[80:83], v[132:135], 0
    v_mfma_f32_32x32x16_bf16 v[64:79], v[96:99], v[132:135], 0
    ds_read_b128 v[132:135], v6 offset:13312
    s_waitcnt lgkmcnt(3)
    v_mfma_f32_32x32x16_bf16 v[48:63], v[96:99], v[136:139], v[48:63]
    ds_read_b128 v[136:139], v6 offset:21504
    s_waitcnt lgkmcnt(3)
    v_mfma_f32_32x32x16_bf16 v[64:79], v[80:83], v[140:143], v[64:79]
    ds_read_b128 v[140:143], v6 offset:6144
    s_waitcnt lgkmcnt(3)
    v_mfma_f32_32x32x16_bf16 v[48:63], v[84:87], v[128:131], v[48:63]
    v_mfma_f32_32x32x16_bf16 v[64:79], v[100:103], v[128:131], v[64:79]
    ds_read_b128 v[128:131], v6 offset:14336
    s_waitcnt lgkmcnt(3)
    v_mfma_f32_32x32x16_bf16 v[48:63], v[100:103], v[132:135], v[48:63]
    ds_read_b128 v[132:135], v6 offset:22528
    s_waitcnt lgkmcnt(3)
    v_mfma_f32_32x32x16_bf16 v[64:79], v[84:87], v[136:139], v[64:79]
    s_waitcnt lgkmcnt(2)
    v_mfma_f32_32x32x16_bf16 v[48:63], v[88:91], v[140:143], v[48:63]
    v_mfma_f32_32x32x16_bf16 v[64:79], v[104:107], v[140:143], v[64:79]
    s_waitcnt lgkmcnt(1)
    v_mfma_f32_32x32x16_bf16 v[48:63], v[104:107], v[128:131], v[48:63]
    s_waitcnt lgkmcnt(0)
    v_mfma_f32_32x32x16_bf16 v[64:79], v[88:91], v[132:135], v[64:79]
    s_lshl_b32 s44, s42, 20
    s_add_u32 s44, s44, 0x1807800
    s_cmp_lg_u32 s32, 0
    s_cbranch_scc1 L_wfs_77
    s_mov_b32 s40, 0
    v_min_u32 v152, 0, v0
    v_lshlrev_b32 v152, 7, v152
    s_branch L_wfe_79
L_wf_78:
    s_add_u32 s40, s40, 1
    s_cmp_gt_u32 s40, 0x100000
    s_cbranch_scc1 L_abort
    s_sleep 16
L_wfe_79:
    buffer_load_dword v154, v152, s[8:11], s44 offen sc1
    s_waitcnt vmcnt(0)
    v_cmpx_eq_u32 vcc, 0, v154
    s_cbranch_execnz L_wf_78
    s_mov_b64 exec, -1
L_wfs_77:
    s_barrier
    s_mov_b32 s51, 0
L_dpass_80:
    v_add_u32 v15, 63488, v6
    ds_read_b128 v[140:143], v15 offset:0
    ds_read_b128 v[144:147], v15 offset:1024
    s_lshl_b32 s43, s51, 2
    s_add_u32 s43, s43, s32
    s_lshl_b32 s44, s42, 3
    s_add_u32 s44, s44, s43
    s_mul_i32 s60, s44, 18432
    s_add_u32 s60, s60, 0x1a00000
    s_lshl_b32 s44, s42, 20
    s_mul_i32 s50, s43, 2304
    s_add_u32 s44, s44, s50
    s_add_u32 s44, s44, 0x18d3800
    s_mov_b32 s40, 0
    v_min_u32 v152, 17, v0
    v_lshlrev_b32 v152, 7, v152
L_ww_81:
    s_add_u32 s40, s40, 1
    s_cmp_gt_u32 s40, 0x100000
    s_cbranch_scc1 L_abort
    s_sleep 1
    buffer_load_dword v153, v152, s[8:11], s44 offen sc1
    s_waitcnt vmcnt(0)
    v_cmpx_eq_u32 vcc, 0, v153
    s_cbranch_execnz L_ww_81
    s_mov_b64 exec, -1
    buffer_load_dwordx4 v[80:83], v6, s[8:11], s60 offen offset:0 sc1
    buffer_load_dwordx4 v[84:87], v6, s[8:11], s60 offen offset:1024 sc1
    buffer_load_dwordx4 v[88:91], v6, s[8:11], s60 offen offset:2048 sc1
    buffer_load_dwordx4 v[92:95], v6, s[8:11], s60 offen offset:3072 sc1
    s_add_u32 s60, s60, 4096
    buffer_load_dwordx4 v[96:99], v6, s[8:11], s60 offen offset:0 sc1
    buffer_load_dwordx4 v[100:103], v6, s[8:11], s60 offen offset:1024 sc1
    buffer_load_dwordx4 v[104:107], v6, s[8:11], s60 offen offset:2048 sc1
    buffer_load_dwordx4 v[108:111], v6, s[8:11], s60 offen offset:3072 sc1
    s_add_u32 s60, s60, 4096
    buffer_load_dwordx4 v[112:115], v6, s[8:11], s60 offen offset:0 sc1
    buffer_load_dwordx4 v[116:119], v6, s[8:11], s60 offen offset:1024 sc1
    buffer_load_dwordx4 v[120:123], v6, s[8:11], s60 offen offset:2048 sc1
    buffer_load_dwordx4 v[124:127], v6, s[8:11], s60 offen offset:3072 sc1
    s_add_u32 s60, s60, 4096
    buffer_load_dwordx4 v[128:131], v6, s[8:11], s60 offen offset:0 sc1
    buffer_load_dwordx4 v[132:135], v6, s[8:11], s60 offen offset:1024 sc1
    buffer_load_dwordx4 v[136:139], v6, s[8:11], s60 offen offset:2048 sc1
    s_waitcnt vmcnt(14)
    s_waitcnt lgkmcnt(1)
    v_mfma_f32_16x16x32_bf16 v[148:151], v[80:83], v[140:143], 0
    ds_read_b128 v[140:143], v15 offset:2048
    v_mfma_f32_16x16x32_bf16 v[152:155], v[80:83], v[80:83], 0
    buffer_load_dwordx4 v[80:83], v6, s[8:11], s60 offen offset:3072 sc1
    s_waitcnt vmcnt(14)
    s_waitcnt lgkmcnt(1)
    v_mfma_f32_16x16x32_bf16 v[148:151], v[84:87], v[144:147], v[148:151]
    ds_read_b128 v[144:147], v15 offset:3072
    v_mfma_f32_16x16x32_bf16 v[152:155], v[84:87], v[84:87], v[152:155]
    s_add_u32 s60, s60, 4096
    buffer_load_dwordx4 v[84:87], v6, s[8:11], s60 offen offset:0 sc1
    s_waitcnt vmcnt(14)
    s_waitcnt lgkmcnt(1)
    v_mfma_f32_16x16x32_bf16 v[148:151], v[88:91], v[140:143], v[148:151]
    ds_read_b128 v[140:143], v15 offset:4096
    v_mfma_f32_16x16x32_bf16 v[152:155], v[88:91], v[88:91], v[152:155]
    buffer_load_dwordx4 v[88:91], v6, s[8:11], s60 offen offset:1024 sc1
    s_waitcnt vmcnt(14)
    s_waitcnt lgkmcnt(1)
    v_mfma_f32_16x16x32_bf16 v[148:151], v[92:95], v[144:147], v[148:151]
    ds_read_b128 v[144:147], v15 offset:5120
    v_mfma_f32_16x16x32_bf16 v[152:155], v[92:95], v[92:95], v[152:155]
    s_waitcnt vmcnt(13)
    s_waitcnt lgkmcnt(1)
    v_mfma_f32_16x16x32_bf16 v[148:151], v[96:99], v[140:143], v[148:151]
    ds_read_b128 v[140:143], v15 offset:6144
    v_mfma_f32_16x16x32_bf16 v[152:155], v[96:99], v[96:99], v[152:155]
    s_waitcnt vmcnt(12)
    s_waitcnt lgkmcnt(1)
    v_mfma_f32_16x16x32_bf16 v[148:151], v[100:103], v[144:147], v[148:151]
    ds_read_b128 v[144:147], v15 offset:7168
    v_mfma_f32_16x16x32_bf16 v[152:155], v[100:103], v[100:103], v[152:155]
    s_waitcnt vmcnt(11)
    s_waitcnt lgkmcnt(1)
    v_mfma_f32_16x16x32_bf16 v[148:151], v[104:107], v[140:143], v[148:151]
    ds_read_b128 v[140:143], v15 offset:8192
    v_mfma_f32_16x16x32_bf16 v[152:155], v[104:107], v[104:107], v[152:155]
    s_waitcnt vmcnt(10)
    s_waitcnt lgkmcnt(1)
    v_mfma_f32_16x16x32_bf16 v[148:151], v[108:111], v[144:147], v[148:151]
    ds_read_b128 v[144:147], v15 offset:9216
    v_mfma_f32_16x16x32_bf16 v[152:155], v[108:111], v[108:111], v[152:155]
    s_waitcnt vmcnt(9)
    s_waitcnt lgkmcnt(1)
    v_mfma_f32_16x16x32_bf16 v[148:151], v[112:115], v[140:143], v[148:151]
    ds_read_b128 v[140:143], v15 offset:10240
    v_mfma_f32_16x16x32_bf16 v[152:155], v[112:115], v[112:115], v[152:155]
    s_waitcnt vmcnt(8)
    s_waitcnt lgkmcnt(1)
    v_mfma_f32_16x16x32_bf16 v[148:151], v[116:119], v[144:147], v[148:151]
    ds_read_b128 v[144:147], v15 offset:11264
    v_mfma_f32_16x16x32_bf16 v[152:155], v[116:119], v[116:119], v[152:155]
    s_waitcnt vmcnt(7)
    s_waitcnt lgkmcnt(1)
    v_mfma_f32_16x16x32_bf16 v[148:151], v[120:123], v[140:143], v[148:151]
    ds_read_b128 v[140:143], v15 offset:12288
    v_mfma_f32_16x16x32_bf16 v[152:155], v[120:123], v[120:123], v[152:155]
    s_waitcnt vmcnt(6)
    s_waitcnt lgkmcnt(1)
    v_mfma_f32_16x16x32_bf16 v[148:151], v[124:127], v[144:147], v[148:151]
    ds_read_b128 v[144:147], v15 offset:13312
    v_mfma_f32_16x16x32_bf16 v[152:155], v[124:127], v[124:127], v[152:155]
    s_waitcnt vmcnt(5)
    s_waitcnt lgkmcnt(1)
    v_mfma_f32_16x16x32_bf16 v[148:151], v[128:131], v[140:143], v[148:151]
    ds_read_b128 v[140:143], v15 offset:14336
    v_mfma_f32_16x16x32_bf16 v[152:155], v[128:131], v[128:131], v[152:155]
    s_waitcnt vmcnt(4)
    s_waitcnt lgkmcnt(1)
    v_mfma_f32_16x16x32_bf16 v[148:151], v[132:135], v[144:147], v[148:151]
    ds_read_b128 v[144:147], v15 offset:15360
    v_mfma_f32_16x16x32_bf16 v[152:155], v[132:135], v[132:135], v[152:155]
    s_waitcnt vmcnt(3)
    s_waitcnt lgkmcnt(1)
    v_mfma_f32_16x16x32_bf16 v[148:151], v[136:139], v[140:143], v[148:151]
    ds_read_b128 v[140:143], v15 offset:16384
    v_mfma_f32_16x16x32_bf16 v[152:155], v[136:139], v[136:139], v[152:155]
    s_waitcnt vmcnt(2)
    s_waitcnt lgkmcnt(1)
    v_mfma_f32_16x16x32_bf16 v[148:151], v[80:83], v[144:147], v[148:151]
    ds_read_b128 v[144:147], v15 offset:17408
    v_mfma_f32_16x16x32_bf16 v[152:155], v[80:83], v[80:83], v[152:155]
    s_waitcnt vmcnt(1)
    s_waitcnt lgkmcnt(1)
    v_mfma_f32_16x16x32_bf16 v[148:151], v[84:87], v[140:143], v[148:151]
    v_mfma_f32_16x16x32_bf16 v[152:155], v[84:87], v[84:87], v[152:155]
    s_waitcnt vmcnt(0)
    s_waitcnt lgkmcnt(0)
    v_mfma_f32_16x16x32_bf16 v[148:151], v[88:91], v[144:147], v[148:151]
    v_mfma_f32_16x16x32_bf16 v[152:155], v[88:91], v[88:91], v[152:155]
    s_lshl_b32 s50, s51, 13
    s_add_u32 s50, s50, 118784
    s_lshl_b32 s44, s32, 10
    s_add_u32 s44, s44, s50
    v_add_u32 v15, s44, v6
    v_lshlrev_b32 v121, 10, v13
    v_lshrrev_b32 v122, 2, v12
    v_lshl_add_u32 v121, v122, 8, v121
    v_and_b32_e64 v122, 3, v12
    v_lshl_add_u32 v121, v122, 2, v121
    v_add_u32_e64 v121, s50, v121
    v_lshl_add_u32 v123, v12, 4, v121
    ds_write_b128 v15, v[148:151]
    ds_write_b128 v15, v[152:155] offset:4096
    s_lshl_b32 s44, s32, 5
    v_add_u32 v122, s44, v121
    v_lshlrev_b32_e64 v125, 6, v13
    v_lshl_add_u32 v125, v12, 1, v125
    s_lshl_b32 s44, s51, 8
    s_add_u32 s44, s44, s45
    v_add_u32 v125, s44, v125
    s_cmp_lg_u32 s43, 0
    s_cbranch_scc1 L_dnb_82
    s_lshl_b32 s44, s42, 20
    s_add_u32 s44, s44, 0x1807000
    s_mov_b32 s40, 0
    v_min_u32 v126, 23, v0
    v_lshlrev_b32_e64 v126, 7, v126
L_ww_83:
    s_add_u32 s40, s40, 1
    s_cmp_gt_u32 s40, 0x100000
    s_cbranch_scc1 L_abort
    buffer_load_dword v127, v126, s[8:11], s44 offen sc1
    s_waitcnt vmcnt(0)
    v_cmpx_eq_u32 vcc, 0, v127
    s_cbranch_execnz L_ww_83
    s_mov_b64 exec, -1
    s_add_u32 s44, s49, 0xe61800
    s_mov_b32 m0, 88064
    s_nop 0
    buffer_load_dwordx4 v6, s[8:11], s44 offen offset:0 sc1 lds
    s_add_u32 s44, s49, 0xe63800
    s_mov_b32 m0, 97280
    s_nop 0
    buffer_load_dwordx4 v6, s[8:11], s44 offen offset:0 sc1 lds
    s_add_u32 s44, s49, 0xe65800
    s_mov_b32 m0, 106496
    s_nop 0
    buffer_load_dwordx4 v6, s[8:11], s44 offen offset:0 sc1 lds
    s_add_u32 s44, s49, 0xe67800
    s_mov_b32 m0, 115712
    s_nop 0
    buffer_load_dwordx4 v6, s[8:11], s44 offen offset:0 sc1 lds
    s_mov_b32 exec_hi, 0
    s_add_u32 s44, s49, 0xe61800
    s_mov_b32 m0, 88064
    s_nop 0
    buffer_load_dwordx4 v6, s[8:11], s44 offen offset:1024 sc1 lds
    s_add_u32 s44, s49, 0xe63800
    s_mov_b32 m0, 97280
    s_nop 0
    buffer_load_dwordx4 v6, s[8:11], s44 offen offset:1024 sc1 lds
    s_add_u32 s44, s49, 0xe65800
    s_mov_b32 m0, 106496
    s_nop 0
    buffer_load_dwordx4 v6, s[8:11], s44 offen offset:1024 sc1 lds
    s_add_u32 s44, s49, 0xe67800
    s_mov_b32 m0, 115712
    s_nop 0
    buffer_load_dwordx4 v6, s[8:11], s44 offen offset:1024 sc1 lds
    s_mov_b32 exec_hi, -1
    s_waitcnt vmcnt(0)
L_dnb_82:
    s_waitcnt lgkmcnt(0)
    s_barrier
    ds_read_b32 v126, v121 offset:128
    ds_read_b32 v128, v123 offset:4096
    ds_read2_b32 v[130:131], v122 offset0:0 offset1:4
    s_waitcnt lgkmcnt(1)
    v_mul_f32 v126, 0x3ae38e39, v126
    v_mul_f32 v128, 0x3ae38e39, v128
    v_fma_f32 v128, -v126, v126, v128
    v_max_f32_e64 v128, 0, v128
    v_cvt_pk_bf16_f32 v128, v128, v128
    v_lshlrev_b32_e64 v128, 16, v128
    v_add_f32 v128, 0x3727c5ac, v128
    v_cvt_pk_bf16_f32 v128, v128, v128
    v_lshlrev_b32_e64 v128, 16, v128
    v_sqrt_f32 v128, v128
    s_nop 0
    v_cvt_pk_bf16_f32 v128, v128, v128
    v_lshlrev_b32 v128, 16, v128
    v_rcp_f32 v128, v128
    s_waitcnt lgkmcnt(0)
    v_mul_f32 v130, v130, v128
    v_mul_f32 v131, v131, v128
    v_cvt_pk_bf16_f32 v130, v130, v131
    ds_write_b16 v125, v130 offset:7680
    ds_write_b16_d16_hi v125, v130 offset:7712
    s_add_u32 s51, s51, 1
    s_cmp_lt_u32 s51, 2
    s_cbranch_scc1 L_dpass_80
L_fft_tail:
    ds_read_b64_tr_b16 v[92:93], v14 offset:6144
    ds_read_b64_tr_b16 v[94:95], v14 offset:7168
    ds_read_b64_tr_b16 v[108:109], v14 offset:6176
    ds_read_b64_tr_b16 v[110:111], v14 offset:7200
    ds_read_b128 v[136:139], v6 offset:3072
    ds_read_b128 v[140:143], v6 offset:11264
    ds_read_b128 v[128:131], v6 offset:19456
    ds_read_b128 v[132:135], v6 offset:7168
    v_and_b32_e64 v14, 31, v0
    v_mul_u32_u24 v14, 144, v14
    v_lshrrev_b32_e64 v15, 5, v0
    v_lshl_add_u32 v14, v15, 3, v14
    v_add_u32_e64 v14, s45, v14
    s_waitcnt lgkmcnt(4)
    s_waitcnt lgkmcnt(3)
    v_mfma_f32_32x32x16_bf16 v[16:31], v[92:95], v[136:139], v[16:31]
    v_mfma_f32_32x32x16_bf16 v[32:47], v[108:111], v[136:139], v[32:47]
    ds_read_b128 v[136:139], v6 offset:15360
    s_waitcnt lgkmcnt(3)
    v_mfma_f32_32x32x16_bf16 v[16:31], v[108:111], v[140:143], v[16:31]
    ds_read_b128 v[140:143], v6 offset:23552
    s_waitcnt lgkmcnt(3)
    v_mfma_f32_32x32x16_bf16 v[32:47], v[92:95], v[128:131], v[32:47]
    ds_read_b128 v[144:147], v6 offset:30720
    ds_read_b128 v[148:151], v6 offset:31744
    ds_read_b128 v[96:99], v6 offset:32768
    ds_read_b128 v[100:103], v6 offset:33792
    s_waitcnt lgkmcnt(6)
    v_mfma_f32_32x32x16_bf16 v[48:63], v[92:95], v[132:135], v[48:63]
    v_mfma_f32_32x32x16_bf16 v[64:79], v[108:111], v[132:135], v[64:79]
    s_waitcnt lgkmcnt(5)
    v_mfma_f32_32x32x16_bf16 v[48:63], v[108:111], v[136:139], v[48:63]
    s_waitcnt lgkmcnt(4)
    v_mfma_f32_32x32x16_bf16 v[64:79], v[92:95], v[140:143], v[64:79]
    s_waitcnt lgkmcnt(2)
    v_mul_f32 v152, v16, v144
    v_mul_f32 v153, v17, v145
    v_mul_f32 v154, v32, v144
    v_mul_f32 v155, v33, v145
    v_fmac_f32 v152, v32, v148
    v_fmac_f32 v153, v33, v149
    v_fma_f32 v154, -v16, v148, v154
    v_fma_f32 v155, -v17, v149, v155
    v_cvt_pk_bf16_f32 v112, v152, v153
    v_cvt_pk_bf16_f32 v120, v154, v155
    v_mul_f32 v152, v18, v146
    v_mul_f32 v153, v19, v147
    v_mul_f32 v154, v34, v146
    v_mul_f32 v155, v35, v147
    v_fmac_f32 v152, v34, v150
    v_fmac_f32 v153, v35, v151
    v_fma_f32 v154, -v18, v150, v154
    v_fma_f32 v155, -v19, v151, v155
    ds_read_b128 v[144:147], v6 offset:34816
    ds_read_b128 v[148:151], v6 offset:35840
    v_cvt_pk_bf16_f32 v113, v152, v153
    v_cvt_pk_bf16_f32 v121, v154, v155
    s_waitcnt lgkmcnt(2)
    v_mul_f32 v152, v20, v96
    v_mul_f32 v153, v21, v97
    v_mul_f32 v154, v36, v96
    v_mul_f32 v155, v37, v97
    v_fmac_f32 v152, v36, v100
    v_fmac_f32_e64 v153, v37, v101
    v_fma_f32 v154, -v20, v100, v154
    v_fma_f32 v155, -v21, v101, v155
    v_cvt_pk_bf16_f32 v114, v152, v153
    v_cvt_pk_bf16_f32 v122, v154, v155
    v_mul_f32 v152, v22, v98
    v_mul_f32 v153, v23, v99
    v_mul_f32 v154, v38, v98
    v_mul_f32 v155, v39, v99
    v_fmac_f32 v152, v38, v102
    v_fmac_f32 v153, v39, v103
    v_fma_f32 v154, -v22, v102, v154
    v_fma_f32 v155, -v23, v103, v155
    ds_read_b128 v[96:99], v6 offset:36864
    ds_read_b128 v[100:103], v6 offset:37888
    v_cvt_pk_bf16_f32 v115, v152, v153
    v_cvt_pk_bf16_f32 v123, v154, v155
    s_waitcnt lgkmcnt(2)
    v_mul_f32 v152, v24, v144
    v_mul_f32 v153, v25, v145
    v_mul_f32 v154, v40, v144
    v_mul_f32 v155, v41, v145
    v_fmac_f32 v152, v40, v148
    v_fmac_f32_e64 v153, v41, v149
    v_fma_f32 v154, -v24, v148, v154
    v_fma_f32 v155, -v25, v149, v155
    v_cvt_pk_bf16_f32 v116, v152, v153
    v_cvt_pk_bf16_f32 v124, v154, v155
    v_mul_f32 v152, v26, v146
    v_mul_f32 v153, v27, v147
    v_mul_f32 v154, v42, v146
    v_mul_f32 v155, v43, v147
    v_fmac_f32 v152, v42, v150
    v_fmac_f32 v153, v43, v151
    v_fma_f32 v154, -v26, v150, v154
    v_fma_f32 v155, -v27, v151, v155
    v_cvt_pk_bf16_f32 v117, v152, v153
    v_cvt_pk_bf16_f32 v125, v154, v155
    s_waitcnt lgkmcnt(0)
    v_mul_f32 v152, v28, v96
    v_mul_f32 v153, v29, v97
    v_mul_f32 v154, v44, v96
    v_mul_f32 v155, v45, v97
    v_fmac_f32 v152, v44, v100
    v_fmac_f32_e64 v153, v45, v101
    v_fma_f32 v154, -v28, v100, v154
    v_fma_f32 v155, -v29, v101, v155
    v_cvt_pk_bf16_f32 v118, v152, v153
    v_cvt_pk_bf16_f32 v126, v154, v155
    v_mul_f32 v152, v30, v98
    v_mul_f32 v153, v31, v99
    v_mul_f32 v154, v46, v98
    v_mul_f32 v155, v47, v99
    v_fmac_f32 v152, v46, v102
    v_fmac_f32 v153, v47, v103
    v_fma_f32 v154, -v30, v102, v154
    v_fma_f32 v155, -v31, v103, v155
    v_cvt_pk_bf16_f32 v119, v152, v153
    v_cvt_pk_bf16_f32 v127, v154, v155
    ds_read_b128 v[128:131], v6 offset:24576
    ds_read_b128 v[132:135], v6 offset:26624
    ds_read_b128 v[136:139], v6 offset:28672
    ds_read_b128 v[140:143], v6 offset:25600
    ds_read_b128 v[80:83], v6 offset:27648
    ds_read_b128 v[84:87], v6 offset:29696
    ds_read_b128 v[144:147], v6 offset:38912
    ds_read_b128 v[148:151], v6 offset:39936
    ds_read_b128 v[96:99], v6 offset:40960
    ds_read_b128 v[100:103], v6 offset:41984
    s_waitcnt lgkmcnt(4)
    v_mfma_f32_32x32x16_bf16 v[16:31], v[128:131], v[112:115], 0
    v_mfma_f32_32x32x16_bf16 v[32:47], v[128:131], v[120:123], 0
    s_waitcnt lgkmcnt(2)
    v_mul_f32 v152, v48, v144
    v_mul_f32 v153, v49, v145
    v_mul_f32 v154, v64, v144
    v_mul_f32 v155, v65, v145
    v_fmac_f32 v152, v64, v148
    v_fmac_f32 v153, v65, v149
    v_fma_f32 v154, -v48, v148, v154
    v_fma_f32 v155, -v49, v149, v155
    v_cvt_pk_bf16_f32 v88, v152, v153
    v_cvt_pk_bf16_f32 v104, v154, v155
    v_mul_f32 v152, v50, v146
    v_mul_f32 v153, v51, v147
    v_mfma_f32_32x32x16_bf16 v[16:31], v[132:135], v[120:123], v[16:31]
    v_mul_f32 v154, v66, v146
    v_mul_f32 v155, v67, v147
    v_fmac_f32 v152, v66, v150
    v_fmac_f32 v153, v67, v151
    v_fma_f32 v154, -v50, v150, v154
    v_fma_f32 v155, -v51, v151, v155
    ds_read_b128 v[144:147], v6 offset:43008
    ds_read_b128 v[148:151], v6 offset:44032
    v_cvt_pk_bf16_f32 v89, v152, v153
    v_cvt_pk_bf16_f32 v105, v154, v155
    s_waitcnt lgkmcnt(2)
    v_mul_f32 v152, v52, v96
    v_mul_f32 v153, v53, v97
    v_mul_f32 v154, v68, v96
    v_mfma_f32_32x32x16_bf16 v[32:47], v[136:139], v[112:115], v[32:47]
    v_mul_f32 v155, v69, v97
    v_fmac_f32 v152, v68, v100
    v_fmac_f32_e64 v153, v69, v101
    v_fma_f32 v154, -v52, v100, v154
    v_fma_f32 v155, -v53, v101, v155
    v_cvt_pk_bf16_f32 v90, v152, v153
    v_cvt_pk_bf16_f32 v106, v154, v155
    v_mul_f32 v152, v54, v98
    v_mul_f32 v153, v55, v99
    v_mul_f32 v154, v70, v98
    v_mul_f32 v155, v71, v99
    v_fmac_f32_e64 v152, v70, v102
    v_mfma_f32_32x32x16_bf16 v[16:31], v[140:143], v[116:119], v[16:31]
    v_fmac_f32_e64 v153, v71, v103
    v_fma_f32 v154, -v54, v102, v154
    v_fma_f32 v155, -v55, v103, v155
    ds_read_b128 v[96:99], v6 offset:45056
    ds_read_b128 v[100:103], v6 offset:46080
    v_cvt_pk_bf16_f32 v91, v152, v153
    v_cvt_pk_bf16_f32 v107, v154, v155
    s_waitcnt lgkmcnt(2)
    v_mul_f32 v152, v56, v144
    v_mul_f32 v153, v57, v145
    v_mul_f32 v154, v72, v144
    v_mul_f32 v155, v73, v145
    v_fmac_f32 v152, v72, v148
    v_fmac_f32_e64 v153, v73, v149
    v_mfma_f32_32x32x16_bf16 v[32:47], v[140:143], v[124:127], v[32:47]
    v_fma_f32 v154, -v56, v148, v154
    v_fma_f32 v155, -v57, v149, v155
    v_cvt_pk_bf16_f32 v92, v152, v153
    v_cvt_pk_bf16_f32 v108, v154, v155
    v_mul_f32 v152, v58, v146
    v_mul_f32 v153, v59, v147
    v_mul_f32 v154, v74, v146
    v_mul_f32 v155, v75, v147
    v_fmac_f32 v152, v74, v150
    v_fmac_f32 v153, v75, v151
    v_fma_f32 v154, -v58, v150, v154
    v_fma_f32 v155, -v59, v151, v155
    v_mfma_f32_32x32x16_bf16 v[16:31], v[80:83], v[124:127], v[16:31]
    v_cvt_pk_bf16_f32 v93, v152, v153
    v_cvt_pk_bf16_f32 v109, v154, v155
    s_waitcnt lgkmcnt(0)
    v_mul_f32 v152, v60, v96
    v_mul_f32 v153, v61, v97
    v_mul_f32 v154, v76, v96
    v_mul_f32 v155, v77, v97
    v_fmac_f32 v152, v76, v100
    v_fmac_f32_e64 v153, v77, v101
    v_fma_f32 v154, -v60, v100, v154
    v_fma_f32 v155, -v61, v101, v155
    v_cvt_pk_bf16_f32 v94, v152, v153
    v_mfma_f32_32x32x16_bf16 v[32:47], v[84:87], v[116:119], v[32:47]
    v_cvt_pk_bf16_f32 v110, v154, v155
    v_mul_f32 v152, v62, v98
    v_mul_f32 v153, v63, v99
    v_mul_f32 v154, v78, v98
    v_mul_f32 v155, v79, v99
    v_fmac_f32 v152, v78, v102
    v_fmac_f32 v153, v79, v103
    v_fma_f32 v154, -v62, v102, v154
    v_fma_f32 v155, -v63, v103, v155
    v_cvt_pk_bf16_f32 v95, v152, v153
    v_cvt_pk_bf16_f32 v111, v154, v155
    v_mfma_f32_32x32x16_bf16 v[48:63], v[128:131], v[88:91], 0
    v_mfma_f32_32x32x16_bf16 v[64:79], v[128:131], v[104:107], 0
    v_lshlrev_b32_e64 v144, 16, v156
    v_and_b32 v148, 0xffff0000, v156
    v_lshlrev_b32_e64 v145, 16, v157
    v_and_b32 v149, 0xffff0000, v157
    v_lshlrev_b32_e64 v146, 16, v158
    v_and_b32 v150, 0xffff0000, v158
    v_lshlrev_b32_e64 v147, 16, v159
    v_and_b32 v151, 0xffff0000, v159
    v_mul_f32 v152, v16, v144
    v_mul_f32 v153, v17, v145
    v_mul_f32 v154, v32, v144
    v_mul_f32 v155, v33, v145
    v_fma_f32 v152, -v32, v148, v152
    v_fma_f32 v153, -v33, v149, v153
    v_fmac_f32 v154, v16, v148
    v_fmac_f32 v155, v17, v149
    v_mfma_f32_32x32x16_bf16 v[48:63], v[132:135], v[104:107], v[48:63]
    v_cvt_pk_bf16_f32 v112, v152, v153
    v_cvt_pk_bf16_f32 v120, v154, v155
    v_mul_f32 v152, v18, v146
    v_mul_f32 v153, v19, v147
    v_mul_f32 v154, v34, v146
    v_mul_f32 v155, v35, v147
    v_fma_f32 v152, -v34, v150, v152
    v_fma_f32 v153, -v35, v151, v153
    v_fmac_f32 v154, v18, v150
    v_fmac_f32 v155, v19, v151
    v_cvt_pk_bf16_f32 v113, v152, v153
    v_cvt_pk_bf16_f32 v121, v154, v155
    v_lshlrev_b32_e64 v96, 16, v160
    v_and_b32 v100, 0xffff0000, v160
    v_lshlrev_b32_e64 v97, 16, v161
    v_and_b32 v101, 0xffff0000, v161
    v_mfma_f32_32x32x16_bf16 v[64:79], v[136:139], v[88:91], v[64:79]
    v_lshlrev_b32_e64 v98, 16, v162
    v_and_b32 v102, 0xffff0000, v162
    v_lshlrev_b32_e64 v99, 16, v163
    v_and_b32 v103, 0xffff0000, v163
    v_mul_f32 v152, v20, v96
    v_mul_f32 v153, v21, v97
    v_mul_f32 v154, v36, v96
    v_mul_f32 v155, v37, v97
    v_fma_f32 v152, -v36, v100, v152
    v_fma_f32 v153, -v37, v101, v153
    v_fmac_f32 v154, v20, v100
    v_fmac_f32 v155, v21, v101
    v_cvt_pk_bf16_f32 v114, v152, v153
    v_cvt_pk_bf16_f32 v122, v154, v155
    v_mul_f32 v152, v22, v98
    v_mul_f32 v153, v23, v99
    v_mfma_f32_32x32x16_bf16 v[48:63], v[140:143], v[92:95], v[48:63]
    v_mul_f32 v154, v38, v98
    v_mul_f32 v155, v39, v99
    v_fma_f32 v152, -v38, v102, v152
    v_fma_f32 v153, -v39, v103, v153
    v_fmac_f32 v154, v22, v102
    v_fmac_f32 v155, v23, v103
    v_cvt_pk_bf16_f32 v115, v152, v153
    v_cvt_pk_bf16_f32 v123, v154, v155
    v_lshlrev_b32_e64 v144, 16, v164
    v_and_b32 v148, 0xffff0000, v164
    v_lshlrev_b32_e64 v145, 16, v165
    v_and_b32 v149, 0xffff0000, v165
    v_lshlrev_b32_e64 v146, 16, v166
    v_and_b32 v150, 0xffff0000, v166
    v_lshlrev_b32_e64 v147, 16, v167
    v_and_b32 v151, 0xffff0000, v167
    v_mfma_f32_32x32x16_bf16 v[64:79], v[140:143], v[108:111], v[64:79]
    v_mul_f32 v152, v24, v144
    v_mul_f32 v153, v25, v145
    v_mul_f32 v154, v40, v144
    v_mul_f32 v155, v41, v145
    v_fma_f32 v152, -v40, v148, v152
    v_fma_f32 v153, -v41, v149, v153
    v_fmac_f32 v154, v24, v148
    v_fmac_f32 v155, v25, v149
    v_cvt_pk_bf16_f32 v116, v152, v153
    v_cvt_pk_bf16_f32 v124, v154, v155
    v_mul_f32 v152, v26, v146
    v_mul_f32 v153, v27, v147
    v_mul_f32 v154, v42, v146
    v_mul_f32 v155, v43, v147
    v_fma_f32 v152, -v42, v150, v152
    v_fma_f32 v153, -v43, v151, v153
    v_mfma_f32_32x32x16_bf16 v[48:63], v[80:83], v[108:111], v[48:63]
    v_fmac_f32 v154, v26, v150
    v_fmac_f32 v155, v27, v151
    v_cvt_pk_bf16_f32 v117, v152, v153
    v_cvt_pk_bf16_f32 v125, v154, v155
    v_lshlrev_b32_e64 v96, 16, v168
    v_and_b32 v100, 0xffff0000, v168
    v_lshlrev_b32_e64 v97, 16, v169
    v_and_b32 v101, 0xffff0000, v169
    v_lshlrev_b32_e64 v98, 16, v170
    v_and_b32 v102, 0xffff0000, v170
    v_lshlrev_b32_e64 v99, 16, v171
    v_and_b32 v103, 0xffff0000, v171
    v_mul_f32 v152, v28, v96
    v_mul_f32 v153, v29, v97
    v_mul_f32 v154, v44, v96
    v_mul_f32 v155, v45, v97
    v_mfma_f32_32x32x16_bf16 v[64:79], v[84:87], v[92:95], v[64:79]
    v_fma_f32 v152, -v44, v100, v152
    v_fma_f32 v153, -v45, v101, v153
    v_fmac_f32 v154, v28, v100
    v_fmac_f32 v155, v29, v101
    v_cvt_pk_bf16_f32 v118, v152, v153
    v_cvt_pk_bf16_f32 v126, v154, v155
    v_mul_f32 v152, v30, v98
    v_mul_f32 v153, v31, v99
    v_mul_f32 v154, v46, v98
    v_mul_f32 v155, v47, v99
    v_fma_f32 v152, -v46, v102, v152
    v_fma_f32 v153, -v47, v103, v153
    v_fmac_f32 v154, v30, v102
    v_fmac_f32 v155, v31, v103
    v_cvt_pk_bf16_f32 v119, v152, v153
    v_cvt_pk_bf16_f32 v127, v154, v155
    v_mfma_f32_32x32x16_bf16 v[16:31], v[112:115], v[128:131], 0
    v_mfma_f32_32x32x16_bf16 v[32:47], v[120:123], v[128:131], 0
    v_lshlrev_b32_e64 v144, 16, v172
    v_and_b32 v148, 0xffff0000, v172
    v_lshlrev_b32_e64 v145, 16, v173
    v_and_b32 v149, 0xffff0000, v173
    v_lshlrev_b32_e64 v146, 16, v174
    v_and_b32 v150, 0xffff0000, v174
    v_lshlrev_b32_e64 v147, 16, v175
    v_and_b32 v151, 0xffff0000, v175
    v_mul_f32 v152, v48, v144
    v_mul_f32 v153, v49, v145
    v_mul_f32 v154, v64, v144
    v_mul_f32 v155, v65, v145
    v_fma_f32 v152, -v64, v148, v152
    v_fma_f32 v153, -v65, v149, v153
    v_fmac_f32 v154, v48, v148
    v_fmac_f32 v155, v49, v149
    v_mfma_f32_32x32x16_bf16 v[16:31], v[120:123], v[136:139], v[16:31]
    v_cvt_pk_bf16_f32 v88, v152, v153
    v_cvt_pk_bf16_f32 v104, v154, v155
    v_mul_f32 v152, v50, v146
    v_mul_f32 v153, v51, v147
    v_mul_f32 v154, v66, v146
    v_mul_f32 v155, v67, v147
    v_fma_f32 v152, -v66, v150, v152
    v_fma_f32 v153, -v67, v151, v153
    v_fmac_f32 v154, v50, v150
    v_fmac_f32 v155, v51, v151
    v_cvt_pk_bf16_f32 v89, v152, v153
    v_cvt_pk_bf16_f32 v105, v154, v155
    v_lshlrev_b32_e64 v96, 16, v176
    v_and_b32 v100, 0xffff0000, v176
    v_lshlrev_b32_e64 v97, 16, v177
    v_and_b32 v101, 0xffff0000, v177
    v_mfma_f32_32x32x16_bf16 v[32:47], v[112:115], v[132:135], v[32:47]
    v_lshlrev_b32_e64 v98, 16, v178
    v_and_b32 v102, 0xffff0000, v178
    v_lshlrev_b32_e64 v99, 16, v179
    v_and_b32 v103, 0xffff0000, v179
    v_mul_f32 v152, v52, v96
    v_mul_f32 v153, v53, v97
    v_mul_f32 v154, v68, v96
    v_mul_f32 v155, v69, v97
    v_fma_f32 v152, -v68, v100, v152
    v_fma_f32 v153, -v69, v101, v153
    v_fmac_f32 v154, v52, v100
    v_fmac_f32 v155, v53, v101
    v_cvt_pk_bf16_f32 v90, v152, v153
    v_cvt_pk_bf16_f32 v106, v154, v155
    v_mul_f32 v152, v54, v98
    v_mul_f32 v153, v55, v99
    v_mfma_f32_32x32x16_bf16 v[16:31], v[116:119], v[140:143], v[16:31]
    v_mul_f32 v154, v70, v98
    v_mul_f32 v155, v71, v99
    v_fma_f32 v152, -v70, v102, v152
    v_fma_f32 v153, -v71, v103, v153
    v_fmac_f32 v154, v54, v102
    v_fmac_f32 v155, v55, v103
    v_cvt_pk_bf16_f32 v91, v152, v153
    v_cvt_pk_bf16_f32 v107, v154, v155
    v_lshlrev_b32_e64 v144, 16, v180
    v_and_b32 v148, 0xffff0000, v180
    v_lshlrev_b32_e64 v145, 16, v181
    v_and_b32 v149, 0xffff0000, v181
    v_lshlrev_b32_e64 v146, 16, v182
    v_and_b32 v150, 0xffff0000, v182
    v_lshlrev_b32_e64 v147, 16, v183
    v_and_b32 v151, 0xffff0000, v183
    v_mfma_f32_32x32x16_bf16 v[32:47], v[124:127], v[140:143], v[32:47]
    v_mul_f32 v152, v56, v144
    v_mul_f32 v153, v57, v145
    v_mul_f32 v154, v72, v144
    v_mul_f32 v155, v73, v145
    v_fma_f32 v152, -v72, v148, v152
    v_fma_f32 v153, -v73, v149, v153
    v_fmac_f32 v154, v56, v148
    v_fmac_f32 v155, v57, v149
    v_cvt_pk_bf16_f32 v92, v152, v153
    v_cvt_pk_bf16_f32 v108, v154, v155
    v_mul_f32 v152, v58, v146
    v_mul_f32 v153, v59, v147
    v_mul_f32 v154, v74, v146
    v_mul_f32 v155, v75, v147
    v_fma_f32 v152, -v74, v150, v152
    v_fma_f32 v153, -v75, v151, v153
    v_mfma_f32_32x32x16_bf16 v[16:31], v[124:127], v[84:87], v[16:31]
    v_fmac_f32 v154, v58, v150
    v_fmac_f32 v155, v59, v151
    v_cvt_pk_bf16_f32 v93, v152, v153
    v_cvt_pk_bf16_f32 v109, v154, v155
    v_lshlrev_b32_e64 v96, 16, v184
    v_and_b32 v100, 0xffff0000, v184
    v_lshlrev_b32_e64 v97, 16, v185
    v_and_b32 v101, 0xffff0000, v185
    v_lshlrev_b32_e64 v98, 16, v186
    v_and_b32 v102, 0xffff0000, v186
    v_lshlrev_b32_e64 v99, 16, v187
    v_and_b32 v103, 0xffff0000, v187
    v_mul_f32 v152, v60, v96
    v_mul_f32 v153, v61, v97
    v_mul_f32 v154, v76, v96
    v_mul_f32 v155, v77, v97
    v_mfma_f32_32x32x16_bf16 v[32:47], v[116:119], v[80:83], v[32:47]
    v_fma_f32 v152, -v76, v100, v152
    v_fma_f32 v153, -v77, v101, v153
    v_fmac_f32 v154, v60, v100
    v_fmac_f32 v155, v61, v101
    v_cvt_pk_bf16_f32 v94, v152, v153
    v_cvt_pk_bf16_f32 v110, v154, v155
    v_mul_f32 v152, v62, v98
    v_mul_f32 v153, v63, v99
    v_mul_f32 v154, v78, v98
    v_mul_f32 v155, v79, v99
    v_fma_f32 v152, -v78, v102, v152
    v_fma_f32 v153, -v79, v103, v153
    v_fmac_f32 v154, v62, v102
    v_fmac_f32 v155, v63, v103
    v_cvt_pk_bf16_f32 v95, v152, v153
    v_cvt_pk_bf16_f32 v111, v154, v155
    ds_read_b128 v[144:147], v6 offset:47104
    ds_read_b128 v[148:151], v6 offset:48128
    ds_read_b128 v[96:99], v6 offset:49152
    ds_read_b128 v[100:103], v6 offset:50176
    v_mfma_f32_32x32x16_bf16 v[48:63], v[88:91], v[128:131], 0
    v_mfma_f32_32x32x16_bf16 v[64:79], v[104:107], v[128:131], 0
    s_waitcnt lgkmcnt(2)
    v_mul_f32 v152, v16, v144
    v_mul_f32 v153, v17, v145
    v_mul_f32 v154, v32, v144
    v_mul_f32_e64 v155, v33, v145
    v_fma_f32 v152, -v32, v148, v152
    v_fma_f32 v153, -v33, v149, v153
    v_fmac_f32 v154, v16, v148
    v_fmac_f32 v155, v17, v149
    v_cvt_pk_bf16_f32 v112, v152, v153
    v_cvt_pk_bf16_f32 v120, v154, v155
    v_mul_f32 v152, v18, v146
    v_mul_f32 v153, v19, v147
    v_mfma_f32_32x32x16_bf16 v[48:63], v[104:107], v[136:139], v[48:63]
    v_mul_f32 v154, v34, v146
    v_mul_f32 v155, v35, v147
    v_fma_f32 v152, -v34, v150, v152
    v_fma_f32 v153, -v35, v151, v153
    v_fmac_f32 v154, v18, v150
    v_fmac_f32 v155, v19, v151
    ds_read_b128 v[144:147], v6 offset:51200
    ds_read_b128 v[148:151], v6 offset:52224
    v_cvt_pk_bf16_f32 v113, v152, v153
    v_cvt_pk_bf16_f32 v121, v154, v155
    s_waitcnt lgkmcnt(2)
    v_mul_f32 v152, v20, v96
    v_mul_f32 v153, v21, v97
    v_mul_f32 v154, v36, v96
    v_mfma_f32_32x32x16_bf16 v[64:79], v[88:91], v[132:135], v[64:79]
    v_mul_f32_e64 v155, v37, v97
    v_fma_f32 v152, -v36, v100, v152
    v_fma_f32 v153, -v37, v101, v153
    v_fmac_f32 v154, v20, v100
    v_fmac_f32 v155, v21, v101
    v_cvt_pk_bf16_f32 v114, v152, v153
    v_cvt_pk_bf16_f32 v122, v154, v155
    v_mul_f32 v152, v22, v98
    v_mul_f32 v153, v23, v99
    v_mul_f32 v154, v38, v98
    v_mul_f32 v155, v39, v99
    v_fma_f32 v152, -v38, v102, v152
    v_mfma_f32_32x32x16_bf16 v[48:63], v[92:95], v[140:143], v[48:63]
    v_fma_f32 v153, -v39, v103, v153
    v_fmac_f32 v154, v22, v102
    v_fmac_f32 v155, v23, v103
    ds_read_b128 v[96:99], v6 offset:53248
    ds_read_b128 v[100:103], v6 offset:54272
    v_cvt_pk_bf16_f32 v115, v152, v153
    v_cvt_pk_bf16_f32 v123, v154, v155
    s_waitcnt lgkmcnt(2)
    v_mul_f32 v152, v24, v144
    v_mul_f32 v153, v25, v145
    v_mul_f32 v154, v40, v144
    v_mul_f32_e64 v155, v41, v145
    v_fma_f32 v152, -v40, v148, v152
    v_fma_f32 v153, -v41, v149, v153
    v_mfma_f32_32x32x16_bf16 v[64:79], v[108:111], v[140:143], v[64:79]
    v_fmac_f32 v154, v24, v148
    v_fmac_f32 v155, v25, v149
    v_cvt_pk_bf16_f32 v116, v152, v153
    v_cvt_pk_bf16_f32 v124, v154, v155
    v_mul_f32 v152, v26, v146
    v_mul_f32 v153, v27, v147
    v_mul_f32 v154, v42, v146
    v_mul_f32 v155, v43, v147
    v_fma_f32 v152, -v42, v150, v152
    v_fma_f32 v153, -v43, v151, v153
    v_fmac_f32 v154, v26, v150
    v_fmac_f32 v155, v27, v151
    v_mfma_f32_32x32x16_bf16 v[48:63], v[108:111], v[84:87], v[48:63]
    v_cvt_pk_bf16_f32 v117, v152, v153
    v_cvt_pk_bf16_f32 v125, v154, v155
    s_waitcnt lgkmcnt(0)
    v_mul_f32 v152, v28, v96
    v_mul_f32 v153, v29, v97
    v_mul_f32 v154, v44, v96
    v_mul_f32_e64 v155, v45, v97
    v_fma_f32 v152, -v44, v100, v152
    v_fma_f32 v153, -v45, v101, v153
    v_fmac_f32 v154, v28, v100
    v_fmac_f32 v155, v29, v101
    v_cvt_pk_bf16_f32 v118, v152, v153
    v_mfma_f32_32x32x16_bf16 v[64:79], v[92:95], v[80:83], v[64:79]
    v_cvt_pk_bf16_f32 v126, v154, v155
    v_mul_f32 v152, v30, v98
    v_mul_f32 v153, v31, v99
    v_mul_f32 v154, v46, v98
    v_mul_f32 v155, v47, v99
    v_fma_f32 v152, -v46, v102, v152
    v_fma_f32 v153, -v47, v103, v153
    v_fmac_f32 v154, v30, v102
    v_fmac_f32 v155, v31, v103
    v_cvt_pk_bf16_f32 v119, v152, v153
    v_cvt_pk_bf16_f32 v127, v154, v155
    ds_read_b128 v[128:131], v6 offset:0
    ds_read_b128 v[132:135], v6 offset:8192
    ds_read_b128 v[136:139], v6 offset:16384
    ds_read_b128 v[140:143], v6 offset:1024
    ds_read_b128 v[144:147], v6 offset:55296
    ds_read_b128 v[148:151], v6 offset:56320
    ds_read_b128 v[96:99], v6 offset:57344
    ds_read_b128 v[100:103], v6 offset:58368
    s_waitcnt lgkmcnt(7)
    v_mfma_f32_32x32x16_bf16 v[16:31], v[112:115], v[128:131], 0
    v_mfma_f32_32x32x16_bf16 v[32:47], v[120:123], v[128:131], 0
    ds_read_b128 v[128:131], v6 offset:9216
    s_waitcnt lgkmcnt(3)
    v_mul_f32 v152, v48, v144
    v_mul_f32 v153, v49, v145
    v_mul_f32 v154, v64, v144
    v_mul_f32 v155, v65, v145
    v_fma_f32 v152, -v64, v148, v152
    v_fma_f32 v153, -v65, v149, v153
    v_fmac_f32 v154, v48, v148
    v_fmac_f32 v155, v49, v149
    v_cvt_pk_bf16_f32 v88, v152, v153
    v_cvt_pk_bf16_f32 v104, v154, v155
    v_mul_f32 v152, v50, v146
    v_mul_f32 v153, v51, v147
    v_mfma_f32_32x32x16_bf16 v[32:47], v[112:115], v[132:135], v[32:47]
    ds_read_b128 v[132:135], v6 offset:17408
    v_mul_f32 v154, v66, v146
    v_mul_f32 v155, v67, v147
    v_fma_f32 v152, -v66, v150, v152
    v_fma_f32 v153, -v67, v151, v153
    v_fmac_f32 v154, v50, v150
    v_fmac_f32 v155, v51, v151
    ds_read_b128 v[144:147], v6 offset:59392
    ds_read_b128 v[148:151], v6 offset:60416
    v_cvt_pk_bf16_f32 v89, v152, v153
    v_cvt_pk_bf16_f32 v105, v154, v155
    s_waitcnt lgkmcnt(4)
    v_mul_f32 v152, v52, v96
    v_mul_f32 v153, v53, v97
    v_mul_f32 v154, v68, v96
    v_mfma_f32_32x32x16_bf16 v[16:31], v[120:123], v[136:139], v[16:31]
    ds_read_b128 v[136:139], v6 offset:2048
    v_mul_f32_e64 v155, v69, v97
    v_fma_f32 v152, -v68, v100, v152
    v_fma_f32 v153, -v69, v101, v153
    v_fmac_f32 v154, v52, v100
    v_fmac_f32 v155, v53, v101
    v_cvt_pk_bf16_f32 v90, v152, v153
    v_cvt_pk_bf16_f32 v106, v154, v155
    v_mul_f32 v152, v54, v98
    v_mul_f32 v153, v55, v99
    v_mul_f32 v154, v70, v98
    v_mul_f32 v155, v71, v99
    v_fma_f32 v152, -v70, v102, v152
    v_mfma_f32_32x32x16_bf16 v[16:31], v[116:119], v[140:143], v[16:31]
    v_fma_f32 v153, -v71, v103, v153
    v_fmac_f32 v154, v54, v102
    v_fmac_f32 v155, v55, v103
    ds_read_b128 v[96:99], v6 offset:61440
    ds_read_b128 v[100:103], v6 offset:62464
    v_cvt_pk_bf16_f32 v91, v152, v153
    v_cvt_pk_bf16_f32 v107, v154, v155
    s_waitcnt lgkmcnt(3)
    v_mul_f32 v152, v56, v144
    v_mul_f32 v153, v57, v145
    v_mul_f32 v154, v72, v144
    v_mul_f32_e64 v155, v73, v145
    v_fma_f32 v152, -v72, v148, v152
    v_fma_f32 v153, -v73, v149, v153
    v_mfma_f32_32x32x16_bf16 v[32:47], v[124:127], v[140:143], v[32:47]
    ds_read_b128 v[140:143], v6 offset:10240
    v_fmac_f32 v154, v56, v148
    v_fmac_f32 v155, v57, v149
    v_cvt_pk_bf16_f32 v92, v152, v153
    v_cvt_pk_bf16_f32 v108, v154, v155
    v_mul_f32 v152, v58, v146
    v_mul_f32 v153, v59, v147
    v_mul_f32 v154, v74, v146
    v_mul_f32 v155, v75, v147
    v_fma_f32 v152, -v74, v150, v152
    v_fma_f32 v153, -v75, v151, v153
    v_fmac_f32 v154, v58, v150
    v_fmac_f32 v155, v59, v151
    v_mfma_f32_32x32x16_bf16 v[32:47], v[116:119], v[128:131], v[32:47]
    ds_read_b128 v[128:131], v6 offset:18432
    v_cvt_pk_bf16_f32 v93, v152, v153
    v_cvt_pk_bf16_f32 v109, v154, v155
    s_waitcnt lgkmcnt(2)
    v_mul_f32 v152, v60, v96
    v_mul_f32 v153, v61, v97
    v_mul_f32 v154, v76, v96
    v_mul_f32_e64 v155, v77, v97
    v_fma_f32 v152, -v76, v100, v152
    v_fma_f32 v153, -v77, v101, v153
    v_fmac_f32 v154, v60, v100
    v_fmac_f32 v155, v61, v101
    v_cvt_pk_bf16_f32 v94, v152, v153
    v_mfma_f32_32x32x16_bf16 v[16:31], v[124:127], v[132:135], v[16:31]
    ds_read_b128 v[132:135], v6 offset:3072
    v_cvt_pk_bf16_f32 v110, v154, v155
    v_mul_f32 v152, v62, v98
    v_mul_f32 v153, v63, v99
    v_mul_f32 v154, v78, v98
    v_mul_f32 v155, v79, v99
    v_fma_f32 v152, -v78, v102, v152
    v_fma_f32 v153, -v79, v103, v153
    v_fmac_f32 v154, v62, v102
    v_fmac_f32 v155, v63, v103
    v_cvt_pk_bf16_f32 v95, v152, v153
    v_cvt_pk_bf16_f32 v111, v154, v155
    v_mfma_f32_32x32x16_bf16 v[16:31], v[88:91], v[136:139], v[16:31]
    v_mfma_f32_32x32x16_bf16 v[32:47], v[104:107], v[136:139], v[32:47]
    ds_read_b128 v[136:139], v6 offset:11264
    v_lshrrev_b32_e64 v15, 3, v0
    s_waitcnt lgkmcnt(3)
    v_mfma_f32_32x32x16_bf16 v[32:47], v[88:91], v[140:143], v[32:47]
    ds_read_b128 v[140:143], v6 offset:19456
    v_mul_u32_u24 v15, 144, v15
    s_waitcnt lgkmcnt(3)
    v_mfma_f32_32x32x16_bf16 v[16:31], v[104:107], v[128:131], v[16:31]
    ds_read_b128 v[128:131], v6 offset:4096
    v_and_b32 v152, 7, v0
    s_waitcnt lgkmcnt(3)
    v_mfma_f32_32x32x16_bf16 v[16:31], v[92:95], v[132:135], v[16:31]
    v_lshl_add_u32 v15, v152, 4, v15
    v_mfma_f32_32x32x16_bf16 v[32:47], v[108:111], v[132:135], v[32:47]
    ds_read_b128 v[132:135], v6 offset:12288
    v_add_u32_e64 v15, s45, v15
    s_waitcnt lgkmcnt(3)
    v_mfma_f32_32x32x16_bf16 v[32:47], v[92:95], v[136:139], v[32:47]
    ds_read_b128 v[136:139], v6 offset:20480
    s_waitcnt lgkmcnt(3)
    v_mfma_f32_32x32x16_bf16 v[16:31], v[108:111], v[140:143], v[16:31]
    ds_read_b128 v[140:143], v6 offset:5120
    s_add_u32 s50, s49, 0x12e0000
    s_waitcnt lgkmcnt(3)
    v_mfma_f32_32x32x16_bf16 v[48:63], v[112:115], v[128:131], 0
    v_mfma_f32_32x32x16_bf16 v[64:79], v[120:123], v[128:131], 0
    ds_read_b128 v[128:131], v6 offset:13312
    s_nop 5
    v_cvt_pk_bf16_f32 v16, v16, v17
    v_cvt_pk_bf16_f32 v17, v18, v19
    ds_write_b64 v14, v[16:17] offset:0
    v_cvt_pk_bf16_f32 v20, v20, v21
    v_cvt_pk_bf16_f32 v21, v22, v23
    s_waitcnt lgkmcnt(4)
    v_mfma_f32_32x32x16_bf16 v[64:79], v[112:115], v[132:135], v[64:79]
    ds_read_b128 v[132:135], v6 offset:21504
    ds_write_b64 v14, v[20:21] offset:16
    v_cvt_pk_bf16_f32 v24, v24, v25
    v_cvt_pk_bf16_f32 v25, v26, v27
    ds_write_b64 v14, v[24:25] offset:64
    v_cvt_pk_bf16_f32 v28, v28, v29
    s_waitcnt lgkmcnt(6)
    v_mfma_f32_32x32x16_bf16 v[48:63], v[120:123], v[136:139], v[48:63]
    ds_read_b128 v[136:139], v6 offset:6144
    v_cvt_pk_bf16_f32 v29, v30, v31
    ds_write_b64 v14, v[28:29] offset:80
    v_cvt_pk_bf16_f32 v32, v32, v33
    v_cvt_pk_bf16_f32 v33, v34, v35
    ds_write_b64 v14, v[32:33] offset:32
    s_waitcnt lgkmcnt(8)
    v_mfma_f32_32x32x16_bf16 v[48:63], v[116:119], v[140:143], v[48:63]
    v_cvt_pk_bf16_f32 v36, v36, v37
    v_cvt_pk_bf16_f32 v37, v38, v39
    ds_write_b64 v14, v[36:37] offset:48
    v_cvt_pk_bf16_f32 v40, v40, v41
    v_cvt_pk_bf16_f32 v41, v42, v43
    v_mfma_f32_32x32x16_bf16 v[64:79], v[124:127], v[140:143], v[64:79]
    ds_read_b128 v[140:143], v6 offset:14336
    ds_write_b64 v14, v[40:41] offset:96
    v_cvt_pk_bf16_f32 v44, v44, v45
    v_cvt_pk_bf16_f32 v45, v46, v47
    ds_write_b64 v14, v[44:45] offset:112
    ds_read_b128 v[16:19], v15 offset:0
    s_waitcnt lgkmcnt(12)
    v_mfma_f32_32x32x16_bf16 v[64:79], v[116:119], v[128:131], v[64:79]
    ds_read_b128 v[128:131], v6 offset:22528
    ds_read_b128 v[20:23], v15 offset:1152
    ds_read_b128 v[24:27], v15 offset:2304
    ds_read_b128 v[28:31], v15 offset:3456
    s_waitcnt lgkmcnt(14)
    v_mfma_f32_32x32x16_bf16 v[48:63], v[124:127], v[132:135], v[48:63]
    ds_read_b128 v[132:135], v6 offset:7168
    s_waitcnt lgkmcnt(12)
    v_mfma_f32_32x32x16_bf16 v[48:63], v[88:91], v[136:139], v[48:63]
    s_waitcnt lgkmcnt(5)
    buffer_store_dwordx4 v[16:19], v6, s[8:11], s50 offen offset:0 sc1
    s_waitcnt lgkmcnt(3)
    buffer_store_dwordx4 v[20:23], v6, s[8:11], s50 offen offset:1024 sc1
    v_mfma_f32_32x32x16_bf16 v[64:79], v[104:107], v[136:139], v[64:79]
    ds_read_b128 v[136:139], v6 offset:15360
    s_waitcnt lgkmcnt(3)
    buffer_store_dwordx4 v[24:27], v6, s[8:11], s50 offen offset:2048 sc1
    s_waitcnt lgkmcnt(2)
    buffer_store_dwordx4 v[28:31], v6, s[8:11], s50 offen offset:3072 sc1
    v_mfma_f32_32x32x16_bf16 v[64:79], v[88:91], v[140:143], v[64:79]
    ds_read_b128 v[140:143], v6 offset:23552
    v_mfma_f32_32x32x16_bf16 v[48:63], v[104:107], v[128:131], v[48:63]
    s_waitcnt lgkmcnt(2)
    v_mfma_f32_32x32x16_bf16 v[48:63], v[92:95], v[132:135], v[48:63]
    v_mfma_f32_32x32x16_bf16 v[64:79], v[108:111], v[132:135], v[64:79]
    s_waitcnt lgkmcnt(1)
    v_mfma_f32_32x32x16_bf16 v[64:79], v[92:95], v[136:139], v[64:79]
    s_waitcnt lgkmcnt(0)
    v_mfma_f32_32x32x16_bf16 v[48:63], v[108:111], v[140:143], v[48:63]
    s_nop 11
    v_cvt_pk_bf16_f32 v48, v48, v49
    v_cvt_pk_bf16_f32 v49, v50, v51
    ds_write_b64 v14, v[48:49] offset:4608
    v_cvt_pk_bf16_f32 v52, v52, v53
    v_cvt_pk_bf16_f32 v53, v54, v55
    ds_write_b64 v14, v[52:53] offset:4624
    v_cvt_pk_bf16_f32 v56, v56, v57
    v_cvt_pk_bf16_f32 v57, v58, v59
    ds_write_b64 v14, v[56:57] offset:4672
    v_cvt_pk_bf16_f32 v60, v60, v61
    v_cvt_pk_bf16_f32 v61, v62, v63
    ds_write_b64 v14, v[60:61] offset:4688
    v_cvt_pk_bf16_f32 v64, v64, v65
    v_cvt_pk_bf16_f32 v65, v66, v67
    ds_write_b64 v14, v[64:65] offset:4640
    v_cvt_pk_bf16_f32 v68, v68, v69
    v_cvt_pk_bf16_f32 v69, v70, v71
    ds_write_b64 v14, v[68:69] offset:4656
    v_cvt_pk_bf16_f32 v72, v72, v73
    v_cvt_pk_bf16_f32 v73, v74, v75
    ds_write_b64 v14, v[72:73] offset:4704
    v_cvt_pk_bf16_f32 v76, v76, v77
    v_cvt_pk_bf16_f32 v77, v78, v79
    ds_write_b64 v14, v[76:77] offset:4720
    s_lshl_b32 s44, s42, 20
    s_lshl_b32 s45, s41, 7
    s_add_u32 s62, s44, s45
    s_mul_i32 s44, s91, 0x20000000
    s_add_u32 s62, s62, s44
    s_add_u32 s50, s50, 4096
    ds_read_b128 v[48:51], v15 offset:4608
    ds_read_b128 v[52:55], v15 offset:5760
    ds_read_b128 v[56:59], v15 offset:6912
    ds_read_b128 v[60:63], v15 offset:8064
    s_add_u32 s62, s62, 0x1808000
    s_waitcnt vmcnt(0)
    s_barrier
    s_cmp_lg_u32 s32, 0
    s_cbranch_scc1 L_df_84
    v_mov_b32 v14, 1
    s_mov_b64 exec, 1
    buffer_store_dword v14, off, s[8:11], s62 offset:0 sc1
    s_mov_b64 exec, -1
L_df_84:
    s_waitcnt lgkmcnt(3)
    buffer_store_dwordx4 v[48:51], v6, s[8:11], s50 offen offset:0 sc1
    s_waitcnt lgkmcnt(2)
    buffer_store_dwordx4 v[52:55], v6, s[8:11], s50 offen offset:1024 sc1
    s_waitcnt lgkmcnt(1)
    buffer_store_dwordx4 v[56:59], v6, s[8:11], s50 offen offset:2048 sc1
    s_waitcnt lgkmcnt(0)
    buffer_store_dwordx4 v[60:63], v6, s[8:11], s50 offen offset:3072 sc1
    s_cmp_eq_u32 s46, 0
    s_cbranch_scc1 L_d_toinv
    s_add_u32 s62, s62, 0x4000
    s_waitcnt vmcnt(0)
    s_barrier
    s_cmp_lg_u32 s32, 0
    s_cbranch_scc1 L_df_85
    v_mov_b32 v14, 1
    s_mov_b64 exec, 1
    buffer_store_dword v14, off, s[8:11], s62 offset:0 sc1
    s_mov_b64 exec, -1
L_df_85:
    s_branch L_d_next
L_d_toinv:
    s_sub_u32 s43, s41, 8
    s_mov_b32 s51, 0
    s_mul_i32 s44, s42, 2359296
    s_mul_i32 s49, s43, 18432
    s_add_u32 s50, s44, s49
    s_add_u32 s50, s50, 0x7a0000
    buffer_load_dwordx4 v[128:131], v2, s[8:11], s50 offen offset:0 sc1
    buffer_load_dwordx4 v[132:135], v3, s[8:11], s50 offen offset:384 sc1
    buffer_load_dwordx4 v[136:139], v2, s[8:11], s50 offen offset:192 sc1
    buffer_load_dwordx4 v[140:143], v3, s[8:11], s50 offen offset:192 sc1
    buffer_load_dwordx4 v[144:147], v2, s[8:11], s50 offen offset:384 sc1
    buffer_load_dwordx4 v[148:151], v3, s[8:11], s50 offen offset:0 sc1
    v_lshrrev_b32 v14, 2, v0
    v_lshlrev_b32 v14, 13, v14
    v_and_b32_e64 v15, 3, v0
    v_lshl_add_u32 v14, v15, 4, v14
    s_mul_i32 s44, s42, 2359296
    s_lshl_b32 s45, s43, 6
    s_add_u32 s44, s44, s45
    s_min_u32 s45, s32, 1
    s_lshl_b32 s50, s45, 17
    s_add_u32 s50, s50, s44
    s_add_u32 s50, s50, 0x14e0000
    s_lshl_b32 s61, s45, 10
    s_lshl_b32 s45, s32, 17
    s_add_u32 s44, s44, s45
    s_add_u32 s44, s44, 0x12e0000
    s_lshl_b32 s45, s32, 10
    s_lshl_b32 s60, s42, 20
    s_add_u32 s60, s60, 0x1808000
    s_add_u32 s63, s60, 16384
    s_cmp_lg_u32 s32, 0
    s_cbranch_scc1 L_yo_86
    s_mov_b32 s40, 0
    v_lshlrev_b32 v40, 7, v0
    v_and_b32 v41, 7, v0
    v_lshlrev_b32 v41, 7, v41
    v_add_u32 v41, 8192, v41
    buffer_load_dword v42, v40, s[8:11], s60 offen sc1
    buffer_load_dword v43, v41, s[8:11], s60 offen sc1
    s_waitcnt vmcnt(8)
    s_barrier
    s_branch L_yc_88
L_yl_87:
    s_add_u32 s40, s40, 1
    s_cmp_gt_u32 s40, 0x100000
    s_cbranch_scc1 L_abort
    buffer_load_dword v42, v40, s[8:11], s60 offen sc1
    buffer_load_dword v43, v41, s[8:11], s60 offen sc1
L_yc_88:
    s_waitcnt vmcnt(0)
    v_min_u32_e64 v44, v42, v43
    v_cmpx_eq_u32 vcc, 0, v44
    s_cbranch_execnz L_yl_87
    s_mov_b64 exec, -1
    s_branch L_yj_89
L_yo_86:
    s_waitcnt vmcnt(6)
    s_barrier
    s_cmp_lg_u32 s32, 3
    s_cbranch_scc1 L_yj_89
    s_add_u32 s62, s62, 16384
    v_mov_b32 v40, 1
    s_mov_b64 exec, 1
    buffer_store_dword v40, off, s[8:11], s62 offset:0 sc1
    s_mov_b64 exec, -1
L_yj_89:
    s_barrier
    s_add_u32 m0, s45, 81920
    s_nop 0
    buffer_load_dwordx4 v14, s[8:11], s44 offen sc1 lds
    s_add_u32 s44, s44, 524288
    s_add_u32 m0, s45, 86016
    s_nop 0
    buffer_load_dwordx4 v14, s[8:11], s44 offen sc1 lds
    s_add_u32 s44, s44, 524288
    s_add_u32 m0, s45, 90112
    s_nop 0
    buffer_load_dwordx4 v14, s[8:11], s44 offen sc1 lds
    s_add_u32 s44, s44, 524288
    s_add_u32 m0, s45, 94208
    s_nop 0
    buffer_load_dwordx4 v14, s[8:11], s44 offen sc1 lds
    s_add_u32 s44, s44, 524288
    s_add_u32 m0, s61, 98304
    s_nop 0
    buffer_load_dwordx4 v14, s[8:11], s50 offen sc1 lds
    s_waitcnt vmcnt(0)
    s_barrier
L_d_inv:
    s_cmp_eq_u32 s51, 0
    s_cbranch_scc1 L_g3_90
    s_cmp_lg_u32 s48, 0
    s_cbranch_scc1 L_g4_91
    s_mov_b32 s40, 0
L_g5_92:
    s_add_u32 s40, s40, 1
    s_cmp_gt_u32 s40, 0x100000
    s_cbranch_scc1 L_abort
    v_lshlrev_b32 v92, 7, v0
    v_and_b32 v93, 7, v0
    v_lshlrev_b32_e64 v93, 7, v93
    v_add_u32 v93, 8192, v93
    buffer_load_dword v94, v92, s[8:11], s63 offen sc1
    buffer_load_dword v95, v93, s[8:11], s63 offen sc1
    s_waitcnt vmcnt(0)
    v_min_u32 v94, v94, v95
    v_cmp_eq_u32 vcc, 0, v94
    s_cbranch_vccnz L_g5_92
    v_lshrrev_b32 v14, 2, v0
    v_lshlrev_b32 v14, 13, v14
    v_and_b32 v15, 3, v0
    v_lshl_add_u32 v14, v15, 4, v14
    s_mul_i32 s44, s42, 2359296
    s_lshl_b32 s45, s43, 6
    s_add_u32 s44, s44, s45
    s_min_u32 s45, s32, 1
    s_lshl_b32 s50, s45, 17
    s_add_u32 s50, s50, s44
    s_add_u32 s50, s50, 0x14e0000
    s_lshl_b32 s61, s45, 10
    s_lshl_b32 s45, s32, 17
    s_add_u32 s44, s44, s45
    s_add_u32 s44, s44, 0x12e0000
    s_lshl_b32 s45, s32, 10
    s_add_u32 m0, s45, 100352
    s_nop 0
    buffer_load_dwordx4 v14, s[8:11], s44 offen sc1 lds
    s_add_u32 s44, s44, 524288
    s_add_u32 m0, s45, 104448
    s_nop 0
    buffer_load_dwordx4 v14, s[8:11], s44 offen sc1 lds
    s_add_u32 s44, s44, 524288
    s_add_u32 m0, s45, 108544
    s_nop 0
    buffer_load_dwordx4 v14, s[8:11], s44 offen sc1 lds
    s_add_u32 s44, s44, 524288
    s_add_u32 m0, s45, 112640
    s_nop 0
    buffer_load_dwordx4 v14, s[8:11], s44 offen sc1 lds
    s_add_u32 s44, s44, 524288
    s_add_u32 m0, s61, 116736
    s_nop 0
    buffer_load_dwordx4 v14, s[8:11], s50 offen sc1 lds
L_g4_91:
    s_mul_i32 s44, s42, 2359296
    s_mul_i32 s49, s43, 18432
    s_add_u32 s50, s44, s49
    s_add_u32 s50, s50, 0x7a0000
    buffer_load_dwordx4 v[128:131], v2, s[8:11], s50 offen offset:0 sc1
    buffer_load_dwordx4 v[132:135], v3, s[8:11], s50 offen offset:384 sc1
    buffer_load_dwordx4 v[136:139], v2, s[8:11], s50 offen offset:192 sc1
    buffer_load_dwordx4 v[140:143], v3, s[8:11], s50 offen offset:192 sc1
    buffer_load_dwordx4 v[144:147], v2, s[8:11], s50 offen offset:384 sc1
    buffer_load_dwordx4 v[148:151], v3, s[8:11], s50 offen offset:0 sc1
    s_waitcnt vmcnt(6)
    s_barrier
L_g3_90:
    s_mul_i32 s44, s51, 18432
    v_add_u32_e64 v14, s44, v10
    ds_read_b64_tr_b16 v[16:17], v14 offset:0
    ds_read_b64_tr_b16 v[18:19], v14 offset:256
    ds_read_b64_tr_b16 v[20:21], v14 offset:2048
    ds_read_b64_tr_b16 v[22:23], v14 offset:2304
    ds_read_b64_tr_b16 v[24:25], v14 offset:4096
    ds_read_b64_tr_b16 v[26:27], v14 offset:4352
    ds_read_b64_tr_b16 v[28:29], v14 offset:6144
    ds_read_b64_tr_b16 v[30:31], v14 offset:6400
    ds_read_b64_tr_b16 v[32:33], v14 offset:8192
    ds_read_b64_tr_b16 v[34:35], v14 offset:8448
    ds_read_b64_tr_b16 v[36:37], v14 offset:10240
    ds_read_b64_tr_b16 v[38:39], v14 offset:10496
    ds_read_b64_tr_b16 v[40:41], v14 offset:12288
    ds_read_b64_tr_b16 v[42:43], v14 offset:12544
    s_waitcnt lgkmcnt(8)
    ds_read_b64_tr_b16 v[44:45], v14 offset:14336
    ds_read_b64_tr_b16 v[46:47], v14 offset:14592
    ds_read_b64_tr_b16 v[48:49], v14 offset:16384
    ds_read_b64_tr_b16 v[50:51], v14 offset:16640
    s_waitcnt lgkmcnt(15)
    v_mfma_f32_16x16x32_bf16 v[52:55], a[0:3], v[16:19], 0
    v_mfma_f32_16x16x32_bf16 v[56:59], a[36:39], v[16:19], 0
    v_mfma_f32_16x16x32_bf16 v[60:63], a[72:75], v[16:19], 0
    v_mfma_f32_16x16x32_bf16 v[64:67], a[108:111], v[16:19], 0
    v_mfma_f32_16x16x32_bf16 v[68:71], a[144:147], v[16:19], 0
    v_mfma_f32_16x16x32_bf16 v[72:75], a[180:183], v[16:19], 0
    v_mfma_f32_16x16x32_bf16 v[76:79], a[216:219], v[16:19], 0
    v_mfma_f32_16x16x32_bf16 v[80:83], a[252:255], v[16:19], 0
    v_mfma_f32_16x16x32_bf16 v[84:87], v[220:223], v[16:19], 0
    s_waitcnt lgkmcnt(14)
    v_mfma_f32_16x16x32_bf16 v[52:55], a[4:7], v[20:23], v[52:55]
    v_mfma_f32_16x16x32_bf16 v[56:59], a[40:43], v[20:23], v[56:59]
    v_mfma_f32_16x16x32_bf16 v[60:63], a[76:79], v[20:23], v[60:63]
    v_mfma_f32_16x16x32_bf16 v[64:67], a[112:115], v[20:23], v[64:67]
    v_mfma_f32_16x16x32_bf16 v[68:71], a[148:151], v[20:23], v[68:71]
    v_mfma_f32_16x16x32_bf16 v[72:75], a[184:187], v[20:23], v[72:75]
    v_mfma_f32_16x16x32_bf16 v[76:79], a[220:223], v[20:23], v[76:79]
    v_mfma_f32_16x16x32_bf16 v[80:83], v[188:191], v[20:23], v[80:83]
    v_mfma_f32_16x16x32_bf16 v[84:87], v[224:227], v[20:23], v[84:87]
    s_waitcnt lgkmcnt(12)
    v_mfma_f32_16x16x32_bf16 v[52:55], a[8:11], v[24:27], v[52:55]
    v_mfma_f32_16x16x32_bf16 v[56:59], a[44:47], v[24:27], v[56:59]
    v_mfma_f32_16x16x32_bf16 v[60:63], a[80:83], v[24:27], v[60:63]
    v_mfma_f32_16x16x32_bf16 v[64:67], a[116:119], v[24:27], v[64:67]
    v_mfma_f32_16x16x32_bf16 v[68:71], a[152:155], v[24:27], v[68:71]
    v_mfma_f32_16x16x32_bf16 v[72:75], a[188:191], v[24:27], v[72:75]
    v_mfma_f32_16x16x32_bf16 v[76:79], a[224:227], v[24:27], v[76:79]
    v_mfma_f32_16x16x32_bf16 v[80:83], v[192:195], v[24:27], v[80:83]
    v_mfma_f32_16x16x32_bf16 v[84:87], v[228:231], v[24:27], v[84:87]
    s_cmp_eq_u32 s42, 1
    s_cbranch_scc1 L_ny_93
    v_lshlrev_b32 v92, 7, v0
    v_and_b32 v93, 7, v0
    v_lshlrev_b32_e64 v93, 7, v93
    v_add_u32 v93, 8192, v93
    buffer_load_dword v94, v92, s[8:11], s63 offen sc1
    buffer_load_dword v95, v93, s[8:11], s63 offen sc1
L_ny_93:
    s_waitcnt lgkmcnt(10)
    v_mfma_f32_16x16x32_bf16 v[52:55], a[12:15], v[28:31], v[52:55]
    v_mfma_f32_16x16x32_bf16 v[56:59], a[48:51], v[28:31], v[56:59]
    v_mfma_f32_16x16x32_bf16 v[60:63], a[84:87], v[28:31], v[60:63]
    v_mfma_f32_16x16x32_bf16 v[64:67], a[120:123], v[28:31], v[64:67]
    v_mfma_f32_16x16x32_bf16 v[68:71], a[156:159], v[28:31], v[68:71]
    v_mfma_f32_16x16x32_bf16 v[72:75], a[192:195], v[28:31], v[72:75]
    v_mfma_f32_16x16x32_bf16 v[76:79], a[228:231], v[28:31], v[76:79]
    v_mfma_f32_16x16x32_bf16 v[80:83], v[196:199], v[28:31], v[80:83]
    v_mfma_f32_16x16x32_bf16 v[84:87], v[232:235], v[28:31], v[84:87]
    s_waitcnt lgkmcnt(8)
    v_mfma_f32_16x16x32_bf16 v[52:55], a[16:19], v[32:35], v[52:55]
    v_mfma_f32_16x16x32_bf16 v[56:59], a[52:55], v[32:35], v[56:59]
    v_mfma_f32_16x16x32_bf16 v[60:63], a[88:91], v[32:35], v[60:63]
    v_mfma_f32_16x16x32_bf16 v[64:67], a[124:127], v[32:35], v[64:67]
    v_mfma_f32_16x16x32_bf16 v[68:71], a[160:163], v[32:35], v[68:71]
    v_mfma_f32_16x16x32_bf16 v[72:75], a[196:199], v[32:35], v[72:75]
    v_mfma_f32_16x16x32_bf16 v[76:79], a[232:235], v[32:35], v[76:79]
    v_mfma_f32_16x16x32_bf16 v[80:83], v[200:203], v[32:35], v[80:83]
    v_mfma_f32_16x16x32_bf16 v[84:87], v[236:239], v[32:35], v[84:87]
    s_waitcnt lgkmcnt(6)
    v_mfma_f32_16x16x32_bf16 v[52:55], a[20:23], v[36:39], v[52:55]
    v_mfma_f32_16x16x32_bf16 v[56:59], a[56:59], v[36:39], v[56:59]
    v_mfma_f32_16x16x32_bf16 v[60:63], a[92:95], v[36:39], v[60:63]
    v_mfma_f32_16x16x32_bf16 v[64:67], a[128:131], v[36:39], v[64:67]
    v_mfma_f32_16x16x32_bf16 v[68:71], a[164:167], v[36:39], v[68:71]
    v_mfma_f32_16x16x32_bf16 v[72:75], a[200:203], v[36:39], v[72:75]
    v_mfma_f32_16x16x32_bf16 v[76:79], a[236:239], v[36:39], v[76:79]
    v_mfma_f32_16x16x32_bf16 v[80:83], v[204:207], v[36:39], v[80:83]
    v_mfma_f32_16x16x32_bf16 v[84:87], v[240:243], v[36:39], v[84:87]
    s_waitcnt lgkmcnt(4)
    v_mfma_f32_16x16x32_bf16 v[52:55], a[24:27], v[40:43], v[52:55]
    v_mfma_f32_16x16x32_bf16 v[56:59], a[60:63], v[40:43], v[56:59]
    v_mfma_f32_16x16x32_bf16 v[60:63], a[96:99], v[40:43], v[60:63]
    v_mfma_f32_16x16x32_bf16 v[64:67], a[132:135], v[40:43], v[64:67]
    v_mfma_f32_16x16x32_bf16 v[68:71], a[168:171], v[40:43], v[68:71]
    v_mfma_f32_16x16x32_bf16 v[72:75], a[204:207], v[40:43], v[72:75]
    v_mfma_f32_16x16x32_bf16 v[76:79], a[240:243], v[40:43], v[76:79]
    v_mfma_f32_16x16x32_bf16 v[80:83], v[208:211], v[40:43], v[80:83]
    v_mfma_f32_16x16x32_bf16 v[84:87], v[244:247], v[40:43], v[84:87]
    s_waitcnt lgkmcnt(2)
    v_mfma_f32_16x16x32_bf16 v[52:55], a[28:31], v[44:47], v[52:55]
    v_mfma_f32_16x16x32_bf16 v[56:59], a[64:67], v[44:47], v[56:59]
    v_mfma_f32_16x16x32_bf16 v[60:63], a[100:103], v[44:47], v[60:63]
    v_mfma_f32_16x16x32_bf16 v[64:67], a[136:139], v[44:47], v[64:67]
    v_mfma_f32_16x16x32_bf16 v[68:71], a[172:175], v[44:47], v[68:71]
    v_mfma_f32_16x16x32_bf16 v[72:75], a[208:211], v[44:47], v[72:75]
    v_mfma_f32_16x16x32_bf16 v[76:79], a[244:247], v[44:47], v[76:79]
    v_mfma_f32_16x16x32_bf16 v[80:83], v[212:215], v[44:47], v[80:83]
    v_mfma_f32_16x16x32_bf16 v[84:87], v[248:251], v[44:47], v[84:87]
    s_waitcnt lgkmcnt(0)
    v_mfma_f32_16x16x32_bf16 v[52:55], a[32:35], v[48:51], v[52:55]
    v_mfma_f32_16x16x32_bf16 v[56:59], a[68:71], v[48:51], v[56:59]
    v_mfma_f32_16x16x32_bf16 v[60:63], a[104:107], v[48:51], v[60:63]
    v_mfma_f32_16x16x32_bf16 v[64:67], a[140:143], v[48:51], v[64:67]
    v_mfma_f32_16x16x32_bf16 v[68:71], a[176:179], v[48:51], v[68:71]
    v_mfma_f32_16x16x32_bf16 v[72:75], a[212:215], v[48:51], v[72:75]
    v_mfma_f32_16x16x32_bf16 v[76:79], a[248:251], v[48:51], v[76:79]
    v_mfma_f32_16x16x32_bf16 v[80:83], v[216:219], v[48:51], v[80:83]
    v_mfma_f32_16x16x32_bf16 v[84:87], v[252:255], v[48:51], v[84:87]
    ds_write_b128 v11, v[52:55] offset:0
    ds_write_b128 v11, v[56:59] offset:64
    ds_write_b128 v11, v[60:63] offset:128
    ds_write_b128 v11, v[64:67] offset:192
    ds_write_b128 v11, v[68:71] offset:256
    ds_write_b128 v11, v[72:75] offset:320
    ds_write_b128 v11, v[76:79] offset:384
    ds_write_b128 v11, v[80:83] offset:448
    ds_write_b128 v11, v[84:87] offset:512
    s_waitcnt vmcnt(0)
    v_min_u32 v94, v94, v95
    v_cmp_eq_u32 vcc, 0, v94
    s_mov_b32 s48, 0
    s_cmp_eq_u32 s42, 1
    s_cbranch_scc1 L_g6_94
    s_cbranch_vccnz L_g6_94
    s_cmp_lg_u32 s51, 0
    s_cbranch_scc1 L_g6_94
    s_mov_b32 s48, 1
    s_add_u32 s60, s43, 64
    v_lshrrev_b32 v14, 2, v0
    v_lshlrev_b32 v14, 13, v14
    v_and_b32 v15, 3, v0
    v_lshl_add_u32 v14, v15, 4, v14
    s_mul_i32 s44, s42, 2359296
    s_lshl_b32 s45, s60, 6
    s_add_u32 s44, s44, s45
    s_min_u32 s45, s32, 1
    s_lshl_b32 s50, s45, 17
    s_add_u32 s50, s50, s44
    s_add_u32 s50, s50, 0x14e0000
    s_lshl_b32 s61, s45, 10
    s_lshl_b32 s45, s32, 17
    s_add_u32 s44, s44, s45
    s_add_u32 s44, s44, 0x12e0000
    s_lshl_b32 s45, s32, 10
    s_add_u32 m0, s45, 100352
    s_nop 0
    buffer_load_dwordx4 v14, s[8:11], s44 offen sc1 lds
    s_add_u32 s44, s44, 524288
    s_add_u32 m0, s45, 104448
    s_nop 0
    buffer_load_dwordx4 v14, s[8:11], s44 offen sc1 lds
    s_add_u32 s44, s44, 524288
    s_add_u32 m0, s45, 108544
    s_nop 0
    buffer_load_dwordx4 v14, s[8:11], s44 offen sc1 lds
    s_add_u32 s44, s44, 524288
    s_add_u32 m0, s45, 112640
    s_nop 0
    buffer_load_dwordx4 v14, s[8:11], s44 offen sc1 lds
    s_add_u32 s44, s44, 524288
    s_add_u32 m0, s61, 116736
    s_nop 0
    buffer_load_dwordx4 v14, s[8:11], s50 offen sc1 lds
L_g6_94:
    s_waitcnt lgkmcnt(0)
    s_barrier
    ds_read_b128 v[16:19], v1 offset:0
    ds_read_b128 v[92:95], v1 offset:18688
    ds_read_b128 v[20:23], v1 offset:16
    ds_read_b128 v[96:99], v1 offset:18704
    ds_read_b128 v[24:27], v1 offset:384
    ds_read_b128 v[100:103], v1 offset:19072
    ds_read_b128 v[28:31], v1 offset:400
    ds_read_b128 v[104:107], v1 offset:19088
    ds_read_b128 v[32:35], v1 offset:768
    ds_read_b128 v[108:111], v1 offset:19456
    ds_read_b128 v[36:39], v1 offset:784
    ds_read_b128 v[112:115], v1 offset:19472
    v_lshlrev_b32_e64 v40, 16, v128
    v_and_b32 v41, 0xffff0000, v128
    v_lshlrev_b32_e64 v42, 16, v129
    v_and_b32 v43, 0xffff0000, v129
    v_lshlrev_b32_e64 v44, 16, v130
    v_and_b32 v45, 0xffff0000, v130
    v_lshlrev_b32_e64 v46, 16, v131
    v_and_b32 v47, 0xffff0000, v131
    v_lshlrev_b32_e64 v48, 16, v132
    v_and_b32 v49, 0xffff0000, v132
    v_lshlrev_b32_e64 v50, 16, v133
    v_and_b32 v51, 0xffff0000, v133
    v_lshlrev_b32_e64 v52, 16, v134
    v_and_b32 v53, 0xffff0000, v134
    v_lshlrev_b32_e64 v54, 16, v135
    v_and_b32 v55, 0xffff0000, v135
    v_lshlrev_b32_e64 v56, 16, v136
    v_and_b32 v57, 0xffff0000, v136
    v_lshlrev_b32_e64 v58, 16, v137
    v_and_b32 v59, 0xffff0000, v137
    v_lshlrev_b32_e64 v60, 16, v138
    v_and_b32 v61, 0xffff0000, v138
    v_lshlrev_b32_e64 v62, 16, v139
    v_and_b32 v63, 0xffff0000, v139
    v_lshlrev_b32_e64 v64, 16, v140
    v_and_b32 v65, 0xffff0000, v140
    v_lshlrev_b32_e64 v66, 16, v141
    v_and_b32 v67, 0xffff0000, v141
    v_lshlrev_b32_e64 v68, 16, v142
    v_and_b32 v69, 0xffff0000, v142
    v_lshlrev_b32_e64 v70, 16, v143
    v_and_b32 v71, 0xffff0000, v143
    v_lshlrev_b32_e64 v72, 16, v144
    v_and_b32 v73, 0xffff0000, v144
    v_lshlrev_b32_e64 v74, 16, v145
    v_and_b32 v75, 0xffff0000, v145
    v_lshlrev_b32_e64 v76, 16, v146
    v_and_b32 v77, 0xffff0000, v146
    v_lshlrev_b32_e64 v78, 16, v147
    v_and_b32 v79, 0xffff0000, v147
    v_lshlrev_b32_e64 v80, 16, v148
    v_and_b32 v81, 0xffff0000, v148
    v_lshlrev_b32_e64 v82, 16, v149
    v_and_b32 v83, 0xffff0000, v149
    v_lshlrev_b32_e64 v84, 16, v150
    v_and_b32 v85, 0xffff0000, v150
    v_lshlrev_b32 v86, 16, v151
    v_and_b32 v87, 0xffff0000, v151
    s_waitcnt lgkmcnt(0)
    v_pk_add_f32 v[40:41], v[40:41], v[16:17]
    v_pk_add_f32 v[54:55], v[54:55], v[16:17] op_sel:[0,1] op_sel_hi:[1,0]
    v_pk_add_f32 v[40:41], v[40:41], v[92:93] neg_lo:[0,1] neg_hi:[0,1]
    v_pk_add_f32 v[54:55], v[54:55], v[92:93] op_sel:[0,1] op_sel_hi:[1,0]
    v_pk_add_f32 v[42:43], v[42:43], v[18:19]
    v_pk_add_f32 v[52:53], v[52:53], v[18:19] op_sel:[0,1] op_sel_hi:[1,0]
    v_pk_add_f32 v[42:43], v[42:43], v[94:95] neg_lo:[0,1] neg_hi:[0,1]
    v_pk_add_f32 v[52:53], v[52:53], v[94:95] op_sel:[0,1] op_sel_hi:[1,0]
    v_pk_add_f32 v[44:45], v[44:45], v[20:21]
    v_pk_add_f32 v[50:51], v[50:51], v[20:21] op_sel:[0,1] op_sel_hi:[1,0]
    v_pk_add_f32 v[44:45], v[44:45], v[96:97] neg_lo:[0,1] neg_hi:[0,1]
    v_pk_add_f32 v[50:51], v[50:51], v[96:97] op_sel:[0,1] op_sel_hi:[1,0]
    v_pk_add_f32 v[46:47], v[46:47], v[22:23]
    v_pk_add_f32 v[48:49], v[48:49], v[22:23] op_sel:[0,1] op_sel_hi:[1,0]
    v_pk_add_f32 v[46:47], v[46:47], v[98:99] neg_lo:[0,1] neg_hi:[0,1]
    v_pk_add_f32 v[48:49], v[48:49], v[98:99] op_sel:[0,1] op_sel_hi:[1,0]
    v_pk_add_f32 v[56:57], v[56:57], v[24:25]
    v_pk_add_f32 v[70:71], v[70:71], v[24:25] op_sel:[0,1] op_sel_hi:[1,0]
    v_pk_add_f32 v[56:57], v[56:57], v[100:101] neg_lo:[0,1] neg_hi:[0,1]
    v_pk_add_f32 v[70:71], v[70:71], v[100:101] op_sel:[0,1] op_sel_hi:[1,0]
    v_pk_add_f32 v[58:59], v[58:59], v[26:27]
    v_pk_add_f32 v[68:69], v[68:69], v[26:27] op_sel:[0,1] op_sel_hi:[1,0]
    v_pk_add_f32 v[58:59], v[58:59], v[102:103] neg_lo:[0,1] neg_hi:[0,1]
    v_pk_add_f32 v[68:69], v[68:69], v[102:103] op_sel:[0,1] op_sel_hi:[1,0]
    v_pk_add_f32 v[60:61], v[60:61], v[28:29]
    v_pk_add_f32 v[66:67], v[66:67], v[28:29] op_sel:[0,1] op_sel_hi:[1,0]
    v_pk_add_f32 v[60:61], v[60:61], v[104:105] neg_lo:[0,1] neg_hi:[0,1]
    v_pk_add_f32 v[66:67], v[66:67], v[104:105] op_sel:[0,1] op_sel_hi:[1,0]
    v_pk_add_f32 v[62:63], v[62:63], v[30:31]
    v_pk_add_f32 v[64:65], v[64:65], v[30:31] op_sel:[0,1] op_sel_hi:[1,0]
    v_pk_add_f32 v[62:63], v[62:63], v[106:107] neg_lo:[0,1] neg_hi:[0,1]
    v_pk_add_f32 v[64:65], v[64:65], v[106:107] op_sel:[0,1] op_sel_hi:[1,0]
    v_pk_add_f32 v[72:73], v[72:73], v[32:33]
    v_pk_add_f32 v[86:87], v[86:87], v[32:33] op_sel:[0,1] op_sel_hi:[1,0]
    v_pk_add_f32 v[72:73], v[72:73], v[108:109] neg_lo:[0,1] neg_hi:[0,1]
    v_pk_add_f32 v[86:87], v[86:87], v[108:109] op_sel:[0,1] op_sel_hi:[1,0]
    v_pk_add_f32 v[74:75], v[74:75], v[34:35]
    v_pk_add_f32 v[84:85], v[84:85], v[34:35] op_sel:[0,1] op_sel_hi:[1,0]
    v_pk_add_f32 v[74:75], v[74:75], v[110:111] neg_lo:[0,1] neg_hi:[0,1]
    v_pk_add_f32 v[84:85], v[84:85], v[110:111] op_sel:[0,1] op_sel_hi:[1,0]
    v_pk_add_f32 v[76:77], v[76:77], v[36:37]
    v_pk_add_f32 v[82:83], v[82:83], v[36:37] op_sel:[0,1] op_sel_hi:[1,0]
    v_pk_add_f32 v[76:77], v[76:77], v[112:113] neg_lo:[0,1] neg_hi:[0,1]
    v_pk_add_f32 v[82:83], v[82:83], v[112:113] op_sel:[0,1] op_sel_hi:[1,0]
    v_pk_add_f32 v[78:79], v[78:79], v[38:39]
    v_pk_add_f32 v[80:81], v[80:81], v[38:39] op_sel:[0,1] op_sel_hi:[1,0]
    v_pk_add_f32 v[78:79], v[78:79], v[114:115] neg_lo:[0,1] neg_hi:[0,1]
    v_pk_add_f32 v[80:81], v[80:81], v[114:115] op_sel:[0,1] op_sel_hi:[1,0]
    v_cvt_pk_bf16_f32 v128, v40, v41
    v_cvt_pk_bf16_f32 v129, v42, v43
    v_cvt_pk_bf16_f32 v130, v44, v45
    v_cvt_pk_bf16_f32 v131, v46, v47
    v_cvt_pk_bf16_f32 v132, v48, v49
    v_cvt_pk_bf16_f32 v133, v50, v51
    v_cvt_pk_bf16_f32 v134, v52, v53
    v_cvt_pk_bf16_f32 v135, v54, v55
    v_cvt_pk_bf16_f32 v136, v56, v57
    v_cvt_pk_bf16_f32 v137, v58, v59
    v_cvt_pk_bf16_f32 v138, v60, v61
    v_cvt_pk_bf16_f32 v139, v62, v63
    v_cvt_pk_bf16_f32 v140, v64, v65
    v_cvt_pk_bf16_f32 v141, v66, v67
    v_cvt_pk_bf16_f32 v142, v68, v69
    v_cvt_pk_bf16_f32 v143, v70, v71
    v_cvt_pk_bf16_f32 v144, v72, v73
    v_cvt_pk_bf16_f32 v145, v74, v75
    v_cvt_pk_bf16_f32 v146, v76, v77
    v_cvt_pk_bf16_f32 v147, v78, v79
    v_cvt_pk_bf16_f32 v148, v80, v81
    v_cvt_pk_bf16_f32 v149, v82, v83
    v_cvt_pk_bf16_f32 v150, v84, v85
    v_cvt_pk_bf16_f32 v151, v86, v87
    s_cmp_eq_u32 s42, 1
    s_cbranch_scc1 L_ilast_95
    s_add_u32 s44, s49, 0xc20000
    buffer_store_dwordx4 v[128:131], v2, s[8:11], s44 offen offset:0 sc1
    buffer_store_dwordx4 v[132:135], v3, s[8:11], s44 offen offset:384 sc1
    buffer_store_dwordx4 v[136:139], v2, s[8:11], s44 offen offset:192 sc1
    buffer_store_dwordx4 v[140:143], v3, s[8:11], s44 offen offset:192 sc1
    buffer_store_dwordx4 v[144:147], v2, s[8:11], s44 offen offset:384 sc1
    buffer_store_dwordx4 v[148:151], v3, s[8:11], s44 offen offset:0 sc1
    v_lshlrev_b32_e64 v40, 16, v128
    v_and_b32 v41, 0xffff0000, v128
    v_lshlrev_b32_e64 v42, 16, v129
    v_and_b32 v43, 0xffff0000, v129
    v_lshlrev_b32_e64 v44, 16, v130
    v_and_b32 v45, 0xffff0000, v130
    v_lshlrev_b32_e64 v46, 16, v131
    v_and_b32 v47, 0xffff0000, v131
    v_lshlrev_b32_e64 v48, 16, v132
    v_and_b32 v49, 0xffff0000, v132
    v_lshlrev_b32_e64 v50, 16, v133
    v_and_b32 v51, 0xffff0000, v133
    v_lshlrev_b32_e64 v52, 16, v134
    v_and_b32 v53, 0xffff0000, v134
    v_lshlrev_b32_e64 v54, 16, v135
    v_and_b32 v55, 0xffff0000, v135
    v_lshlrev_b32_e64 v56, 16, v136
    v_and_b32 v57, 0xffff0000, v136
    v_lshlrev_b32_e64 v58, 16, v137
    v_and_b32 v59, 0xffff0000, v137
    v_lshlrev_b32_e64 v60, 16, v138
    v_and_b32 v61, 0xffff0000, v138
    v_lshlrev_b32_e64 v62, 16, v139
    v_and_b32 v63, 0xffff0000, v139
    v_lshlrev_b32_e64 v64, 16, v140
    v_and_b32 v65, 0xffff0000, v140
    v_lshlrev_b32_e64 v66, 16, v141
    v_and_b32 v67, 0xffff0000, v141
    v_lshlrev_b32_e64 v68, 16, v142
    v_and_b32 v69, 0xffff0000, v142
    v_lshlrev_b32_e64 v70, 16, v143
    v_and_b32 v71, 0xffff0000, v143
    v_lshlrev_b32_e64 v72, 16, v144
    v_and_b32 v73, 0xffff0000, v144
    v_lshlrev_b32_e64 v74, 16, v145
    v_and_b32 v75, 0xffff0000, v145
    v_lshlrev_b32_e64 v76, 16, v146
    v_and_b32 v77, 0xffff0000, v146
    v_lshlrev_b32_e64 v78, 16, v147
    v_and_b32 v79, 0xffff0000, v147
    v_lshlrev_b32_e64 v80, 16, v148
    v_and_b32 v81, 0xffff0000, v148
    v_lshlrev_b32_e64 v82, 16, v149
    v_and_b32 v83, 0xffff0000, v149
    v_lshlrev_b32_e64 v84, 16, v150
    v_and_b32 v85, 0xffff0000, v150
    v_lshlrev_b32_e64 v86, 16, v151
    v_and_b32 v87, 0xffff0000, v151
    v_pk_add_f32 v[88:89], v[40:41], v[42:43]
    v_pk_add_f32 v[90:91], v[44:45], v[46:47]
    v_pk_add_f32 v[88:89], v[88:89], v[48:49]
    v_pk_add_f32 v[90:91], v[90:91], v[50:51]
    v_pk_add_f32 v[88:89], v[88:89], v[52:53]
    v_pk_add_f32 v[90:91], v[90:91], v[54:55]
    v_pk_add_f32 v[88:89], v[88:89], v[56:57]
    v_pk_add_f32 v[90:91], v[90:91], v[58:59]
    v_pk_add_f32 v[88:89], v[88:89], v[60:61]
    v_pk_add_f32 v[90:91], v[90:91], v[62:63]
    v_pk_add_f32 v[88:89], v[88:89], v[64:65]
    v_pk_add_f32 v[90:91], v[90:91], v[66:67]
    v_pk_add_f32 v[88:89], v[88:89], v[68:69]
    v_pk_add_f32 v[90:91], v[90:91], v[70:71]
    v_pk_add_f32 v[88:89], v[88:89], v[72:73]
    v_pk_add_f32 v[90:91], v[90:91], v[74:75]
    v_pk_add_f32 v[88:89], v[88:89], v[76:77]
    v_pk_add_f32 v[90:91], v[90:91], v[78:79]
    v_pk_add_f32 v[88:89], v[88:89], v[80:81]
    v_pk_add_f32 v[90:91], v[90:91], v[82:83]
    v_pk_add_f32 v[88:89], v[88:89], v[84:85]
    v_pk_add_f32 v[90:91], v[90:91], v[86:87]
    v_pk_add_f32 v[88:89], v[88:89], v[90:91]
    v_add_f32_e64 v88, v88, v89
    v_cndmask_b32 v88, 0, v88, s[52:53]
    s_nop 1
    v_add_f32_dpp v88, v88, v88 row_ror:8 row_mask:0xf bank_mask:0xf
    s_nop 1
    v_add_f32_dpp v88, v88, v88 row_ror:4 row_mask:0xf bank_mask:0xf
    s_nop 1
    v_add_f32_dpp v88, v88, v88 row_ror:2 row_mask:0xf bank_mask:0xf
    s_nop 1
    v_add_f32_dpp v88, v88, v88 row_ror:1 row_mask:0xf bank_mask:0xf
    v_mul_f32 v88, 0xbae38e39, v88
    v_pk_add_f32 v[40:41], v[40:41], v[88:89] op_sel_hi:[1,0]
    v_pk_add_f32 v[42:43], v[42:43], v[88:89] op_sel_hi:[1,0]
    v_pk_add_f32 v[44:45], v[44:45], v[88:89] op_sel_hi:[1,0]
    v_pk_add_f32 v[46:47], v[46:47], v[88:89] op_sel_hi:[1,0]
    v_pk_add_f32 v[48:49], v[48:49], v[88:89] op_sel_hi:[1,0]
    v_pk_add_f32 v[50:51], v[50:51], v[88:89] op_sel_hi:[1,0]
    v_pk_add_f32 v[52:53], v[52:53], v[88:89] op_sel_hi:[1,0]
    v_pk_add_f32 v[54:55], v[54:55], v[88:89] op_sel_hi:[1,0]
    v_pk_add_f32 v[56:57], v[56:57], v[88:89] op_sel_hi:[1,0]
    v_pk_add_f32 v[58:59], v[58:59], v[88:89] op_sel_hi:[1,0]
    v_pk_add_f32 v[60:61], v[60:61], v[88:89] op_sel_hi:[1,0]
    v_pk_add_f32 v[62:63], v[62:63], v[88:89] op_sel_hi:[1,0]
    v_pk_add_f32 v[64:65], v[64:65], v[88:89] op_sel_hi:[1,0]
    v_pk_add_f32 v[66:67], v[66:67], v[88:89] op_sel_hi:[1,0]
    v_pk_add_f32 v[68:69], v[68:69], v[88:89] op_sel_hi:[1,0]
    v_pk_add_f32 v[70:71], v[70:71], v[88:89] op_sel_hi:[1,0]
    v_pk_add_f32 v[72:73], v[72:73], v[88:89] op_sel_hi:[1,0]
    v_pk_add_f32 v[74:75], v[74:75], v[88:89] op_sel_hi:[1,0]
    v_pk_add_f32 v[76:77], v[76:77], v[88:89] op_sel_hi:[1,0]
    v_pk_add_f32 v[78:79], v[78:79], v[88:89] op_sel_hi:[1,0]
    v_pk_add_f32 v[80:81], v[80:81], v[88:89] op_sel_hi:[1,0]
    v_pk_add_f32 v[82:83], v[82:83], v[88:89] op_sel_hi:[1,0]
    v_pk_add_f32 v[84:85], v[84:85], v[88:89] op_sel_hi:[1,0]
    v_pk_add_f32 v[86:87], v[86:87], v[88:89] op_sel_hi:[1,0]
    v_pk_mul_f32 v[88:89], v[40:41], v[40:41]
    v_pk_mul_f32 v[90:91], v[42:43], v[42:43]
    v_pk_fma_f32 v[88:89], v[44:45], v[44:45], v[88:89]
    v_pk_fma_f32 v[90:91], v[46:47], v[46:47], v[90:91]
    v_pk_fma_f32 v[88:89], v[48:49], v[48:49], v[88:89]
    v_pk_fma_f32 v[90:91], v[50:51], v[50:51], v[90:91]
    v_pk_fma_f32 v[88:89], v[52:53], v[52:53], v[88:89]
    v_pk_fma_f32 v[90:91], v[54:55], v[54:55], v[90:91]
    v_pk_fma_f32 v[88:89], v[56:57], v[56:57], v[88:89]
    v_pk_fma_f32 v[90:91], v[58:59], v[58:59], v[90:91]
    v_pk_fma_f32 v[88:89], v[60:61], v[60:61], v[88:89]
    v_pk_fma_f32 v[90:91], v[62:63], v[62:63], v[90:91]
    v_pk_fma_f32 v[88:89], v[64:65], v[64:65], v[88:89]
    v_pk_fma_f32 v[90:91], v[66:67], v[66:67], v[90:91]
    v_pk_fma_f32 v[88:89], v[68:69], v[68:69], v[88:89]
    v_pk_fma_f32 v[90:91], v[70:71], v[70:71], v[90:91]
    v_pk_fma_f32 v[88:89], v[72:73], v[72:73], v[88:89]
    v_pk_fma_f32 v[90:91], v[74:75], v[74:75], v[90:91]
    v_pk_fma_f32 v[88:89], v[76:77], v[76:77], v[88:89]
    v_pk_fma_f32 v[90:91], v[78:79], v[78:79], v[90:91]
    v_pk_fma_f32 v[88:89], v[80:81], v[80:81], v[88:89]
    v_pk_fma_f32 v[90:91], v[82:83], v[82:83], v[90:91]
    v_pk_fma_f32 v[88:89], v[84:85], v[84:85], v[88:89]
    v_pk_fma_f32 v[90:91], v[86:87], v[86:87], v[90:91]
    v_pk_add_f32 v[88:89], v[88:89], v[90:91]
    v_add_f32_e64 v88, v88, v89
    v_cndmask_b32 v88, 0, v88, s[52:53]
    s_nop 1
    v_add_f32_dpp v88, v88, v88 row_ror:8 row_mask:0xf bank_mask:0xf
    s_nop 1
    v_add_f32_dpp v88, v88, v88 row_ror:4 row_mask:0xf bank_mask:0xf
    s_nop 1
    v_add_f32_dpp v88, v88, v88 row_ror:2 row_mask:0xf bank_mask:0xf
    s_nop 1
    v_add_f32_dpp v88, v88, v88 row_ror:1 row_mask:0xf bank_mask:0xf
    v_mul_f32 v88, 0x3ae38e39, v88
    v_cvt_pk_bf16_f32 v88, v88, v88
    v_lshlrev_b32_e64 v88, 16, v88
    v_add_f32 v88, 0x3727c5ac, v88
    v_cvt_pk_bf16_f32 v88, v88, v88
    v_lshlrev_b32_e64 v88, 16, v88
    v_sqrt_f32 v88, v88
    s_nop 0
    v_cvt_pk_bf16_f32 v88, v88, v88
    v_lshlrev_b32_e64 v88, 16, v88
    v_rcp_f32 v88, v88
    s_nop 0
    v_pk_mul_f32 v[40:41], v[40:41], v[88:89] op_sel_hi:[1,0]
    v_pk_mul_f32 v[42:43], v[42:43], v[88:89] op_sel_hi:[1,0]
    v_pk_mul_f32 v[44:45], v[44:45], v[88:89] op_sel_hi:[1,0]
    v_pk_mul_f32 v[46:47], v[46:47], v[88:89] op_sel_hi:[1,0]
    v_pk_mul_f32 v[48:49], v[48:49], v[88:89] op_sel_hi:[1,0]
    v_pk_mul_f32 v[50:51], v[50:51], v[88:89] op_sel_hi:[1,0]
    v_pk_mul_f32 v[52:53], v[52:53], v[88:89] op_sel_hi:[1,0]
    v_pk_mul_f32 v[54:55], v[54:55], v[88:89] op_sel_hi:[1,0]
    v_pk_mul_f32 v[56:57], v[56:57], v[88:89] op_sel_hi:[1,0]
    v_pk_mul_f32 v[58:59], v[58:59], v[88:89] op_sel_hi:[1,0]
    v_pk_mul_f32 v[60:61], v[60:61], v[88:89] op_sel_hi:[1,0]
    v_pk_mul_f32 v[62:63], v[62:63], v[88:89] op_sel_hi:[1,0]
    v_pk_mul_f32 v[64:65], v[64:65], v[88:89] op_sel_hi:[1,0]
    v_pk_mul_f32 v[66:67], v[66:67], v[88:89] op_sel_hi:[1,0]
    v_pk_mul_f32 v[68:69], v[68:69], v[88:89] op_sel_hi:[1,0]
    v_pk_mul_f32 v[70:71], v[70:71], v[88:89] op_sel_hi:[1,0]
    v_pk_mul_f32 v[72:73], v[72:73], v[88:89] op_sel_hi:[1,0]
    v_pk_mul_f32 v[74:75], v[74:75], v[88:89] op_sel_hi:[1,0]
    v_pk_mul_f32 v[76:77], v[76:77], v[88:89] op_sel_hi:[1,0]
    v_pk_mul_f32 v[78:79], v[78:79], v[88:89] op_sel_hi:[1,0]
    v_pk_mul_f32 v[80:81], v[80:81], v[88:89] op_sel_hi:[1,0]
    v_pk_mul_f32 v[82:83], v[82:83], v[88:89] op_sel_hi:[1,0]
    v_pk_mul_f32 v[84:85], v[84:85], v[88:89] op_sel_hi:[1,0]
    v_pk_mul_f32 v[86:87], v[86:87], v[88:89] op_sel_hi:[1,0]
    v_cvt_pk_bf16_f32 v16, v40, v41
    v_cvt_pk_bf16_f32 v17, v42, v43
    v_cvt_pk_bf16_f32 v18, v44, v45
    v_cvt_pk_bf16_f32 v19, v46, v47
    v_cvt_pk_bf16_f32 v20, v48, v49
    v_cvt_pk_bf16_f32 v21, v50, v51
    v_cvt_pk_bf16_f32 v22, v52, v53
    v_cvt_pk_bf16_f32 v23, v54, v55
    v_cvt_pk_bf16_f32 v24, v56, v57
    v_cvt_pk_bf16_f32 v25, v58, v59
    v_cvt_pk_bf16_f32 v26, v60, v61
    v_cvt_pk_bf16_f32 v27, v62, v63
    v_cvt_pk_bf16_f32 v28, v64, v65
    v_cvt_pk_bf16_f32 v29, v66, v67
    v_cvt_pk_bf16_f32 v30, v68, v69
    v_cvt_pk_bf16_f32 v31, v70, v71
    v_cvt_pk_bf16_f32 v32, v72, v73
    v_cvt_pk_bf16_f32 v33, v74, v75
    v_cvt_pk_bf16_f32 v34, v76, v77
    v_cvt_pk_bf16_f32 v35, v78, v79
    v_cvt_pk_bf16_f32 v36, v80, v81
    v_cvt_pk_bf16_f32 v37, v82, v83
    v_cvt_pk_bf16_f32 v38, v84, v85
    v_cvt_pk_bf16_f32 v39, v86, v87
    s_lshr_b32 s44, s43, 1
    s_mul_i32 s44, s44, 36864
    s_and_b32 s45, s43, 1
    s_lshl_b32 s45, s45, 7
    s_add_u32 s44, s44, s45
    s_add_u32 s45, s42, 1
    s_mul_i32 s50, s45, 2359296
    s_add_u32 s44, s44, s50
    s_add_u32 s44, s44, 0x320000
    s_add_u32 s50, s44, 0
    buffer_store_dwordx4 v[16:19], v4, s[8:11], s50 offen sc1
    buffer_store_dwordx4 v[36:39], v5, s[8:11], s50 offen sc1
    s_add_u32 s50, s44, 6144
    buffer_store_dwordx4 v[24:27], v4, s[8:11], s50 offen sc1
    buffer_store_dwordx4 v[28:31], v5, s[8:11], s50 offen sc1
    s_add_u32 s50, s44, 12288
    buffer_store_dwordx4 v[32:35], v4, s[8:11], s50 offen sc1
    buffer_store_dwordx4 v[20:23], v5, s[8:11], s50 offen sc1
    s_lshl_b32 s44, s45, 20
    s_lshl_b32 s45, s43, 7
    s_add_u32 s44, s44, s45
    s_add_u32 s44, s44, 0x1800000
    s_waitcnt vmcnt(0)
    s_barrier
    s_cmp_lg_u32 s32, 0
    s_cbranch_scc1 L_df_97
    v_mov_b32 v88, 1
    s_mov_b64 exec, 1
    buffer_store_dword v88, off, s[8:11], s44 offset:0 sc1
    s_mov_b64 exec, -1
L_df_97:
    s_branch L_idone_96
L_ilast_95:
    buffer_store_dwordx4 v[128:131], v2, s[20:23], s49 offen offset:0 nt
    buffer_store_dwordx4 v[132:135], v3, s[20:23], s49 offen offset:384 nt
    buffer_store_dwordx4 v[136:139], v2, s[20:23], s49 offen offset:192 nt
    buffer_store_dwordx4 v[140:143], v3, s[20:23], s49 offen offset:192 nt
    buffer_store_dwordx4 v[144:147], v2, s[20:23], s49 offen offset:384 nt
    buffer_store_dwordx4 v[148:151], v3, s[20:23], s49 offen offset:0 nt
    s_cmp_lg_u32 s91, 0
    s_cbranch_scc1 L_d_help2
    s_branch L_exit
L_idone_96:
    s_cmp_lg_u32 s91, 0
    s_mov_b32 s91, 0
    s_cbranch_scc1 L_d_layer
    s_add_u32 s43, s43, 64
    s_add_u32 s51, s51, 1
    s_cmp_lt_u32 s51, 2
    s_cbranch_scc1 L_d_inv
L_d_next:
    s_add_u32 s42, s42, 1
    s_cmp_lt_u32 s42, 2
    s_cbranch_scc1 L_d_layer
    s_branch L_exit
L_d_help:
    s_mov_b32 s44, 0x180fa00
    s_cmp_lg_u32 s32, 0
    s_cbranch_scc1 L_wfs_98
    s_mov_b32 s40, 0
    v_min_u32 v16, 0, v0
    v_lshlrev_b32 v16, 7, v16
    s_branch L_wfe_100
L_wf_99:
    s_add_u32 s40, s40, 1
    s_cmp_gt_u32 s40, 0x100000
    s_cbranch_scc1 L_abort
    s_sleep 1
L_wfe_100:
    buffer_load_dword v18, v16, s[8:11], s44 offen sc1
    s_waitcnt vmcnt(0)
    v_cmpx_eq_u32 vcc, 0, v18
    s_cbranch_execnz L_wf_99
    s_mov_b64 exec, -1
L_wfs_98:
    s_barrier
    s_mul_i32 s44, s32, 82944
    s_add_u32 s44, s44, 0x1b00000
    buffer_load_dwordx4 a[0:3], v6, s[8:11], s44 offen offset:0 sc1
    buffer_load_dwordx4 a[4:7], v6, s[8:11], s44 offen offset:1024 sc1
    buffer_load_dwordx4 a[8:11], v6, s[8:11], s44 offen offset:2048 sc1
    buffer_load_dwordx4 a[12:15], v6, s[8:11], s44 offen offset:3072 sc1
    s_add_u32 s44, s44, 4096
    buffer_load_dwordx4 a[16:19], v6, s[8:11], s44 offen offset:0 sc1
    buffer_load_dwordx4 a[20:23], v6, s[8:11], s44 offen offset:1024 sc1
    buffer_load_dwordx4 a[24:27], v6, s[8:11], s44 offen offset:2048 sc1
    buffer_load_dwordx4 a[28:31], v6, s[8:11], s44 offen offset:3072 sc1
    s_add_u32 s44, s44, 4096
    buffer_load_dwordx4 a[32:35], v6, s[8:11], s44 offen offset:0 sc1
    buffer_load_dwordx4 a[36:39], v6, s[8:11], s44 offen offset:1024 sc1
    buffer_load_dwordx4 a[40:43], v6, s[8:11], s44 offen offset:2048 sc1
    buffer_load_dwordx4 a[44:47], v6, s[8:11], s44 offen offset:3072 sc1
    s_add_u32 s44, s44, 4096
    buffer_load_dwordx4 a[48:51], v6, s[8:11], s44 offen offset:0 sc1
    buffer_load_dwordx4 a[52:55], v6, s[8:11], s44 offen offset:1024 sc1
    buffer_load_dwordx4 a[56:59], v6, s[8:11], s44 offen offset:2048 sc1
    buffer_load_dwordx4 a[60:63], v6, s[8:11], s44 offen offset:3072 sc1
    s_add_u32 s44, s44, 4096
    buffer_load_dwordx4 a[64:67], v6, s[8:11], s44 offen offset:0 sc1
    buffer_load_dwordx4 a[68:71], v6, s[8:11], s44 offen offset:1024 sc1
    buffer_load_dwordx4 a[72:75], v6, s[8:11], s44 offen offset:2048 sc1
    buffer_load_dwordx4 a[76:79], v6, s[8:11], s44 offen offset:3072 sc1
    s_add_u32 s44, s44, 4096
    buffer_load_dwordx4 a[80:83], v6, s[8:11], s44 offen offset:0 sc1
    buffer_load_dwordx4 a[84:87], v6, s[8:11], s44 offen offset:1024 sc1
    buffer_load_dwordx4 a[88:91], v6, s[8:11], s44 offen offset:2048 sc1
    buffer_load_dwordx4 a[92:95], v6, s[8:11], s44 offen offset:3072 sc1
    s_add_u32 s44, s44, 4096
    buffer_load_dwordx4 a[96:99], v6, s[8:11], s44 offen offset:0 sc1
    buffer_load_dwordx4 a[100:103], v6, s[8:11], s44 offen offset:1024 sc1
    buffer_load_dwordx4 a[104:107], v6, s[8:11], s44 offen offset:2048 sc1
    buffer_load_dwordx4 a[108:111], v6, s[8:11], s44 offen offset:3072 sc1
    s_add_u32 s44, s44, 4096
    buffer_load_dwordx4 a[112:115], v6, s[8:11], s44 offen offset:0 sc1
    buffer_load_dwordx4 a[116:119], v6, s[8:11], s44 offen offset:1024 sc1
    buffer_load_dwordx4 a[120:123], v6, s[8:11], s44 offen offset:2048 sc1
    buffer_load_dwordx4 a[124:127], v6, s[8:11], s44 offen offset:3072 sc1
    s_add_u32 s44, s44, 4096
    buffer_load_dwordx4 a[128:131], v6, s[8:11], s44 offen offset:0 sc1
    buffer_load_dwordx4 a[132:135], v6, s[8:11], s44 offen offset:1024 sc1
    buffer_load_dwordx4 a[136:139], v6, s[8:11], s44 offen offset:2048 sc1
    buffer_load_dwordx4 a[140:143], v6, s[8:11], s44 offen offset:3072 sc1
    s_add_u32 s44, s44, 4096
    buffer_load_dwordx4 a[144:147], v6, s[8:11], s44 offen offset:0 sc1
    buffer_load_dwordx4 a[148:151], v6, s[8:11], s44 offen offset:1024 sc1
    buffer_load_dwordx4 a[152:155], v6, s[8:11], s44 offen offset:2048 sc1
    buffer_load_dwordx4 a[156:159], v6, s[8:11], s44 offen offset:3072 sc1
    s_add_u32 s44, s44, 4096
    buffer_load_dwordx4 a[160:163], v6, s[8:11], s44 offen offset:0 sc1
    buffer_load_dwordx4 a[164:167], v6, s[8:11], s44 offen offset:1024 sc1
    buffer_load_dwordx4 a[168:171], v6, s[8:11], s44 offen offset:2048 sc1
    buffer_load_dwordx4 a[172:175], v6, s[8:11], s44 offen offset:3072 sc1
    s_add_u32 s44, s44, 4096
    buffer_load_dwordx4 a[176:179], v6, s[8:11], s44 offen offset:0 sc1
    buffer_load_dwordx4 a[180:183], v6, s[8:11], s44 offen offset:1024 sc1
    buffer_load_dwordx4 a[184:187], v6, s[8:11], s44 offen offset:2048 sc1
    buffer_load_dwordx4 a[188:191], v6, s[8:11], s44 offen offset:3072 sc1
    s_add_u32 s44, s44, 4096
    buffer_load_dwordx4 a[192:195], v6, s[8:11], s44 offen offset:0 sc1
    buffer_load_dwordx4 a[196:199], v6, s[8:11], s44 offen offset:1024 sc1
    buffer_load_dwordx4 a[200:203], v6, s[8:11], s44 offen offset:2048 sc1
    buffer_load_dwordx4 a[204:207], v6, s[8:11], s44 offen offset:3072 sc1
    s_add_u32 s44, s44, 4096
    buffer_load_dwordx4 a[208:211], v6, s[8:11], s44 offen offset:0 sc1
    buffer_load_dwordx4 a[212:215], v6, s[8:11], s44 offen offset:1024 sc1
    buffer_load_dwordx4 a[216:219], v6, s[8:11], s44 offen offset:2048 sc1
    buffer_load_dwordx4 a[220:223], v6, s[8:11], s44 offen offset:3072 sc1
    s_add_u32 s44, s44, 4096
    buffer_load_dwordx4 a[224:227], v6, s[8:11], s44 offen offset:0 sc1
    buffer_load_dwordx4 a[228:231], v6, s[8:11], s44 offen offset:1024 sc1
    buffer_load_dwordx4 a[232:235], v6, s[8:11], s44 offen offset:2048 sc1
    buffer_load_dwordx4 a[236:239], v6, s[8:11], s44 offen offset:3072 sc1
    s_add_u32 s44, s44, 4096
    s_waitcnt vmcnt(40)
    buffer_load_dwordx4 a[240:243], v6, s[8:11], s44 offen offset:0 sc1
    buffer_load_dwordx4 a[244:247], v6, s[8:11], s44 offen offset:1024 sc1
    buffer_load_dwordx4 a[248:251], v6, s[8:11], s44 offen offset:2048 sc1
    buffer_load_dwordx4 a[252:255], v6, s[8:11], s44 offen offset:3072 sc1
    s_add_u32 s44, s44, 4096
    buffer_load_dwordx4 v[188:191], v6, s[8:11], s44 offen offset:0 sc1
    buffer_load_dwordx4 v[192:195], v6, s[8:11], s44 offen offset:1024 sc1
    buffer_load_dwordx4 v[196:199], v6, s[8:11], s44 offen offset:2048 sc1
    buffer_load_dwordx4 v[200:203], v6, s[8:11], s44 offen offset:3072 sc1
    s_add_u32 s44, s44, 4096
    buffer_load_dwordx4 v[204:207], v6, s[8:11], s44 offen offset:0 sc1
    buffer_load_dwordx4 v[208:211], v6, s[8:11], s44 offen offset:1024 sc1
    buffer_load_dwordx4 v[212:215], v6, s[8:11], s44 offen offset:2048 sc1
    buffer_load_dwordx4 v[216:219], v6, s[8:11], s44 offen offset:3072 sc1
    s_add_u32 s44, s44, 4096
    buffer_load_dwordx4 v[220:223], v6, s[8:11], s44 offen offset:0 sc1
    buffer_load_dwordx4 v[224:227], v6, s[8:11], s44 offen offset:1024 sc1
    buffer_load_dwordx4 v[228:231], v6, s[8:11], s44 offen offset:2048 sc1
    buffer_load_dwordx4 v[232:235], v6, s[8:11], s44 offen offset:3072 sc1
    s_add_u32 s44, s44, 4096
    buffer_load_dwordx4 v[236:239], v6, s[8:11], s44 offen offset:0 sc1
    buffer_load_dwordx4 v[240:243], v6, s[8:11], s44 offen offset:1024 sc1
    buffer_load_dwordx4 v[244:247], v6, s[8:11], s44 offen offset:2048 sc1
    buffer_load_dwordx4 v[248:251], v6, s[8:11], s44 offen offset:3072 sc1
    s_add_u32 s44, s44, 4096
    buffer_load_dwordx4 v[252:255], v6, s[8:11], s44 offen offset:0 sc1
    s_mov_b32 s42, 1
    s_mov_b32 s43, 0x204000
    s_mov_b32 s51, 1
    s_mov_b32 s48, 1
    s_mov_b32 s63, 0x1800000
    s_mov_b32 s91, 1
    s_branch L_d_inv
L_d_help2:
    s_mov_b32 s91, 0
    s_add_u32 s43, s90, 63
    s_mov_b32 s51, 1
    s_mov_b32 s48, 0
    s_mov_b32 s63, 0x190c000
    s_lshl_b32 s44, s90, 7
    s_add_u32 s44, s44, 0x1908000
    s_cmp_lg_u32 s32, 0
    s_cbranch_scc1 L_wfs_101
    s_mov_b32 s40, 0
    v_min_u32 v16, 0, v0
    v_lshlrev_b32 v16, 7, v16
    s_branch L_wfe_103
L_wf_102:
    s_add_u32 s40, s40, 1
    s_cmp_gt_u32 s40, 0x100000
    s_cbranch_scc1 L_abort
    s_sleep 4
L_wfe_103:
    buffer_load_dword v18, v16, s[8:11], s44 offen sc1
    s_waitcnt vmcnt(0)
    v_cmpx_eq_u32 vcc, 0, v18
    s_cbranch_execnz L_wf_102
    s_mov_b64 exec, -1
L_wfs_101:
    s_barrier
    s_cmp_lg_u32 s32, 0
    s_cbranch_scc1 L_wfs_104
    s_mov_b32 s40, 0
    v_min_u32 v16, 63, v0
    v_lshlrev_b32 v16, 7, v16
    v_add_u32_e64 v17, 64, v0
    v_min_u32 v17, 71, v17
    v_lshlrev_b32 v17, 7, v17
    s_branch L_wfe_106
L_wf_105:
    s_add_u32 s40, s40, 1
    s_cmp_gt_u32 s40, 0x100000
    s_cbranch_scc1 L_abort
L_wfe_106:
    buffer_load_dword v18, v16, s[8:11], s63 offen sc1
    buffer_load_dword v19, v17, s[8:11], s63 offen sc1
    s_waitcnt vmcnt(0)
    v_min_u32 v20, v18, v19
    v_cmpx_eq_u32 vcc, 0, v20
    s_cbranch_execnz L_wf_105
    s_mov_b64 exec, -1
L_wfs_104:
    s_barrier
    v_lshrrev_b32 v14, 2, v0
    v_lshlrev_b32 v14, 13, v14
    v_and_b32_e64 v15, 3, v0
    v_lshl_add_u32 v14, v15, 4, v14
    s_mul_i32 s44, s42, 2359296
    s_lshl_b32 s45, s43, 6
    s_add_u32 s44, s44, s45
    s_min_u32 s45, s32, 1
    s_lshl_b32 s50, s45, 17
    s_add_u32 s50, s50, s44
    s_add_u32 s50, s50, 0x14e0000
    s_lshl_b32 s61, s45, 10
    s_lshl_b32 s45, s32, 17
    s_add_u32 s44, s44, s45
    s_add_u32 s44, s44, 0x12e0000
    s_lshl_b32 s45, s32, 10
    s_add_u32 m0, s45, 100352
    s_nop 0
    buffer_load_dwordx4 v14, s[8:11], s44 offen sc1 lds
    s_add_u32 s44, s44, 524288
    s_add_u32 m0, s45, 104448
    s_nop 0
    buffer_load_dwordx4 v14, s[8:11], s44 offen sc1 lds
    s_add_u32 s44, s44, 524288
    s_add_u32 m0, s45, 108544
    s_nop 0
    buffer_load_dwordx4 v14, s[8:11], s44 offen sc1 lds
    s_add_u32 s44, s44, 524288
    s_add_u32 m0, s45, 112640
    s_nop 0
    buffer_load_dwordx4 v14, s[8:11], s44 offen sc1 lds
    s_add_u32 s44, s44, 524288
    s_add_u32 m0, s61, 116736
    s_nop 0
    buffer_load_dwordx4 v14, s[8:11], s50 offen sc1 lds
    s_mov_b32 s48, 1
    s_branch L_d_inv
.section .rodata,"a"
.p2align 6
.amdhsa_kernel interleave_layers__memory_aug_recurrent_mem_tr__spectral_gfnet__prompt_kernel
  .amdhsa_next_free_vgpr 512
  .amdhsa_next_free_sgpr 102
  .amdhsa_accum_offset 256
  .amdhsa_group_segment_fixed_size 0
  .amdhsa_kernarg_size 104
  .amdhsa_user_sgpr_count 2
  .amdhsa_user_sgpr_kernarg_segment_ptr 1
  .amdhsa_system_sgpr_workgroup_id_x 1
  .amdhsa_float_denorm_mode_32 3
.end_amdhsa_kernel
```
